```python
import torch

def _softmax(x, axis=-1):
    return torch.softmax(x, dim=axis)
def _gelu(x):
    return torch.nn.functional.gelu(x, approximate="tanh")
def _silu(x):
    return torch.nn.functional.silu(x)
def _sigmoid(x):
    return torch.sigmoid(x)
def _layernorm(x, axis=-1, eps=1e-5):
    m = x.mean(dim=axis, keepdim=True)
    v = x.var(dim=axis, keepdim=True, unbiased=False)
    return (x - m) / torch.sqrt(v + eps)
def _scatter_add(tgt, idx, src, axis=0):
    return tgt.clone().index_add_(axis, idx, src)
def _segment_sum(src, seg, n):
    out = torch.zeros((n,) + src.shape[1:], dtype=src.dtype)
    return out.index_add_(0, seg, src)
def _pad(x, pw):
    flat = tuple(v for pair in reversed(pw) for v in pair)
    return torch.nn.functional.pad(x, flat)

kernel_name = 'gated_mix__compressed_kv_cla__glu_gated_glu__prompt'

def setup_inputs():

    _w = (lambda a: (lambda t: t.to(torch.bfloat16) if t.is_floating_point() else t)(torch.as_tensor(a)))
    def _A_setup():
        B, H, Sq, Sk, D, M = 1, 16, 2048, 2048, 256, 448
        Dc = 4 * D
        return {
            "x": _w((lambda *s: torch.randn(*s, dtype=torch.bfloat16) * 0.05)(B, Sq, M)),
            "c_kv": _w((lambda *s: torch.randn(*s, dtype=torch.bfloat16) * 0.8)(B, Sk, Dc)),
            "w_q": _w((lambda *s: torch.randn(*s, dtype=torch.bfloat16) * 6.4)(M, H, D) * (M ** -0.5)),
            "w_uk": _w((lambda *s: torch.randn(*s, dtype=torch.bfloat16) * 6.4)(Dc, H, D) * (Dc ** -0.5)),
            "w_uv": _w((lambda *s: torch.randn(*s, dtype=torch.bfloat16) * 0.8)(Dc, H, D) * (Dc ** -0.5)),
            "w_o": _w((lambda *s: torch.randn(*s, dtype=torch.bfloat16) * 0.8)(H, D, M) * ((H * D) ** -0.5)),
        }
    _A_in = _A_setup()

    def _B_setup():
        B, S, D, F = 1, 2048, 448, 1792
        return {
            "x": _w((lambda *s: torch.randn(*s, dtype=torch.bfloat16) * 0.05)(B, S, D)),
            "w_gate": _w((lambda *s: torch.randn(*s, dtype=torch.bfloat16) * 3.2)(D, F)),
            "w_up": _w((lambda *s: torch.randn(*s, dtype=torch.bfloat16) * 0.05)(D, F)),
            "w_down": _w((lambda *s: torch.randn(*s, dtype=torch.bfloat16) * 0.05)(F, D)),
        }
    _B_in = _B_setup()

    return {
        "A_x": _A_in["x"],
        "A_c_kv": _A_in["c_kv"],
        "A_w_q": _A_in["w_q"],
        "A_w_uk": _A_in["w_uk"],
        "A_w_uv": _A_in["w_uv"],
        "A_w_o": _A_in["w_o"],
        "B_x": _B_in["x"],
        "B_w_gate": _B_in["w_gate"],
        "B_w_up": _B_in["w_up"],
        "B_w_down": _B_in["w_down"],
        "gate_w": _w((lambda *s: torch.randn(*s, dtype=torch.bfloat16) * 0.05)(448) * 16.0),
    }

def reference(A_x, A_c_kv, A_w_q, A_w_uk, A_w_uv, A_w_o, B_x, B_w_gate, B_w_up, B_w_down, gate_w):
    def _A_ref(x, c_kv, w_q, w_uk, w_uv, w_o):
        B, Sq, M = x.shape[0], x.shape[1], x.shape[2]
        Sk = c_kv.shape[1]
        H, D = w_q.shape[1], w_q.shape[2]
        q = torch.einsum("bqm,mhd->bhqd", x, w_q)
        k = torch.einsum("bkc,chd->bhkd", c_kv, w_uk)
        v = torch.einsum("bkc,chd->bhkd", c_kv, w_uv)
        scores = torch.einsum("bhqd,bhkd->bhqk", q, k) * (D ** -0.5)
        off = Sk - Sq
        qi = torch.arange(Sq)[:, None]
        kj = torch.arange(Sk)[None, :]
        cmask = kj <= (qi + off)
        scores = torch.where(cmask[None, None], scores, -1e9)
        p = _softmax(scores, axis=-1)
        ctx = torch.einsum("bhqk,bhkd->bhqd", p, v)
        return torch.einsum("bhqd,hdm->bqm", ctx, w_o)

    def _B_ref(x, w_gate, w_up, w_down):
        g = torch.einsum("bsd,df->bsf", x, w_gate)
        u = torch.einsum("bsd,df->bsf", x, w_up)
        h = _sigmoid(g) * u
        return torch.einsum("bsf,fd->bsd", h, w_down)

    x = A_x
    g = _sigmoid((x * gate_w).sum(-1, keepdims=True))
    a = _A_ref(x, A_c_kv, A_w_q, A_w_uk, A_w_uv, A_w_o)
    b = _B_ref(x, B_w_gate, B_w_up, B_w_down)
    return g * a + (1 - g) * b
```

```asm
; @launch grid=(256,1,1) block=(256,1,1) lds=163840
.amdgcn_target "amdgcn-amd-amdhsa--gfx950"
.text
.globl gated_mix__compressed_kv_cla__glu_gated_glu__prompt_kernel
.p2align 8
.type gated_mix__compressed_kv_cla__glu_gated_glu__prompt_kernel,@function
gated_mix__compressed_kv_cla__glu_gated_glu__prompt_kernel:
s_cmp_ge_u32 s2, 256
s_cbranch_scc1 L_f_end
s_load_dwordx16 s[32:47], s[0:1], 0
s_load_dwordx8 s[48:55], s[0:1], 64
s_load_dwordx4 s[56:59], s[0:1], 96
v_lshrrev_b32 v17, 6, v0
v_and_b32 v0, 63, v0
v_readfirstlane_b32 s16, v17
s_bfe_u32 s72, s2, 0x30003
s_mov_b32 s6, 4194304
s_mov_b32 s7, 0x20000
v_lshrrev_b32 v17, 3, v0
v_mul_u32_u24 v17, 2048, v17
v_lshrrev_b32 v18, 4, v0
v_xor_b32 v18, v18, v0
v_and_b32 v18, 7, v18
v_lshl_add_u32 v1, v18, 4, v17
v_xor_b32 v17, 64, v1
v_add_u32 v2, 15360, v17
v_add_u32 v3, 30720, v1
v_add_u32 v4, 46080, v17
s_lshl_b32 s27, s16, 13
s_lshl_b32 s19, s72, 19
s_lshl_b32 s30, s16, 17
s_add_u32 s19, s19, s30
s_add_u32 s20, s19, 65536
s_waitcnt lgkmcnt(0)
s_mov_b64 s[4:5], s[34:35]
s_add_u32 m0, s27, 0
s_nop 0
buffer_load_dwordx4 v1, s[4:7], s19 offen offset:0 lds
buffer_load_dwordx4 v2, s[4:7], s19 offen offset:1024 lds
buffer_load_dwordx4 v3, s[4:7], s19 offen offset:2048 lds
buffer_load_dwordx4 v4, s[4:7], s19 offen offset:3072 lds
s_add_u32 s19, s19, 128
s_add_u32 m0, s27, 4096
s_nop 0
buffer_load_dwordx4 v1, s[4:7], s20 offen offset:0 lds
buffer_load_dwordx4 v2, s[4:7], s20 offen offset:1024 lds
buffer_load_dwordx4 v3, s[4:7], s20 offen offset:2048 lds
buffer_load_dwordx4 v4, s[4:7], s20 offen offset:3072 lds
s_add_u32 s20, s20, 128
v_lshrrev_b32 v18, 4, v0
v_mul_u32_u24 v17, 8192, v18
v_lshlrev_b32 v18, 1, v18
v_xor_b32 v18, v18, v0
v_and_b32 v18, 15, v18
v_lshl_add_u32 v5, v18, 4, v17
v_add_u32 v6, 31744, v5
v_xor_b32 v17, 0x80, v6
v_add_u32 v7, 31744, v17
v_add_u32 v8, 31744, v7
s_and_b32 s71, s2, 7
s_lshr_b32 s70, s2, 3
s_bfe_u32 s31, s2, 0x10006
s_lshl_b32 s73, s71, 1
s_add_u32 s73, s73, s31
s_lshl_b32 s31, s73, 9
s_add_u32 s21, s30, s31
s_lshl_b32 s25, s16, 12
s_add_u32 s25, s25, 98304
s_mov_b32 s10, 8388608
s_mov_b32 s11, 0x20000
s_cmp_lt_u32 s70, 16
s_cselect_b64 s[8:9], s[40:41], s[38:39]
s_add_u32 s80, s8, 256
s_addc_u32 s81, s9, 0
s_xor_b64 s[80:81], s[80:81], s[8:9]
s_add_u32 m0, s25, 0
s_nop 0
buffer_load_dwordx4 v5, s[8:11], s21 offen offset:0 lds
buffer_load_dwordx4 v6, s[8:11], s21 offen offset:1024 lds
buffer_load_dwordx4 v7, s[8:11], s21 offen offset:2048 lds
buffer_load_dwordx4 v8, s[8:11], s21 offen offset:3072 lds
s_xor_b64 s[8:9], s[8:9], s[80:81]
v_lshlrev_b32 v16, 4, v0
s_and_b32 s17, s16, 1
s_lshr_b32 s18, s16, 1
s_mov_b32 s68, s21
s_mov_b32 s22, 524288
s_mov_b32 s79, 896
s_mov_b32 s12, s58
s_mov_b32 s13, s59
s_mov_b32 s14, 268435456
s_mov_b32 s15, 0x20000
s_add_u32 s24, s27, 65536
s_mov_b32 s23, 0
v_lshlrev_b32 v17, 2, v0
v_mov_b32 v18, 0
s_lshl_b32 s30, s2, 8
s_add_u32 s30, s30, 82903040
buffer_store_dword v18, v17, s[12:15], s30 offen sc0 sc1
v_lshrrev_b32 v17, 4, v0
v_bfe_u32 v18, v0, 2, 2
v_lshl_add_u32 v19, v17, 3, v18
v_lshlrev_b32 v19, 8, v19
v_and_b32 v20, 1, v0
v_lshl_add_u32 v19, v20, 3, v19
v_add_u32 v19, 98304, v19
v_and_b32 v17, 1, v17
v_lshl_add_u32 v18, v17, 2, v18
v_lshlrev_b32 v18, 1, v18
v_bfe_u32 v20, v0, 1, 1
s_lshl_b32 s30, s17, 3
v_add_u32 v20, s30, v20
v_add_u32 v17, 0, v20
v_xor_b32 v17, v17, v18
v_lshl_add_u32 v9, v17, 4, v19
v_add_u32 v17, 2, v20
v_xor_b32 v17, v17, v18
v_lshl_add_u32 v10, v17, 4, v19
v_add_u32 v17, 4, v20
v_xor_b32 v17, v17, v18
v_lshl_add_u32 v11, v17, 4, v19
v_add_u32 v17, 6, v20
v_xor_b32 v17, v17, v18
v_lshl_add_u32 v12, v17, 4, v19
v_and_b32 v17, 15, v0
s_lshl_b32 s30, s18, 7
v_add_u32 v18, s30, v17
v_lshlrev_b32 v18, 7, v18
v_lshrrev_b32 v17, 1, v17
v_lshrrev_b32 v19, 4, v0
v_xor_b32 v20, v19, v17
v_lshl_add_u32 v13, v20, 4, v18
s_add_u32 m0, s25, 16384
s_nop 0
buffer_load_dwordx4 v5, s[8:11], s21 offen offset:0 lds
s_mul_i32 s30, s71, 14
s_add_u32 s30, s30, s70
s_lshr_b32 s75, s30, 3
s_and_b32 s30, s30, 7
s_cmp_lt_u32 s70, 16
s_cselect_b32 s74, s30, s72
s_mov_b32 s82, 8192
s_cselect_b32 s82, 3584, s82
s_mov_b32 s67, 3670016
s_cselect_b32 s67, 1605632, s67
s_cmp_lt_u32 s70, 32
s_mov_b32 s62, 4194304
s_cselect_b32 s62, 1835008, s62
s_cselect_b32 s60, s32, s34
s_cselect_b32 s61, s33, s35
buffer_load_dwordx4 v6, s[8:11], s21 offen offset:1024 lds
s_lshl_b32 s31, s75, 8
s_mul_i32 s30, s16, 57344
s_add_u32 s30, s30, s31
s_cmp_lt_u32 s70, 16
s_cselect_b32 s65, s46, s36
s_cselect_b32 s66, s47, s37
s_cselect_b32 s68, s30, s68
buffer_load_dwordx4 v7, s[8:11], s21 offen offset:2048 lds
s_lshl_b32 s69, s82, 6
s_sub_u32 s26, 15, s72
s_cmp_eq_u32 s17, 1
s_cselect_b32 s76, s72, s26
s_lshl_b32 s76, s76, 7
s_lshl_b32 s31, s18, 6
s_add_u32 s76, s76, s31
s_lshl_b32 s30, s74, 8
s_lshl_b32 s31, s16, 6
s_add_u32 s30, s30, s31
s_cmp_lt_u32 s70, 16
s_cselect_b32 s30, s30, s76
buffer_load_dwordx4 v8, s[8:11], s21 offen offset:3072 lds
s_mul_i32 s63, s30, s79
s_lshl_b32 s31, s79, 5
s_add_u32 s64, s63, s31
s_and_b32 s30, s70, 30
s_cmp_eq_u32 s30, 14
s_cselect_b32 s62, 0, s62
s_cselect_b32 s67, 0, s67
v_lshrrev_b32 v17, 3, v0
v_mul_u32_u24 v17, 896, v17
v_lshrrev_b32 v18, 4, v0
s_xor_b64 s[8:9], s[8:9], s[80:81]
s_add_u32 s21, s21, s22
s_add_u32 m0, s27, 32768
s_nop 0
buffer_load_dwordx4 v1, s[4:7], s19 offen offset:0 lds
v_xor_b32 v18, v18, v0
v_and_b32 v18, 7, v18
v_lshl_add_u32 v32, v18, 4, v17
v_xor_b32 v17, 64, v32
v_add_u32 v33, 6144, v17
v_add_u32 v34, 12288, v32
v_add_u32 v35, 18432, v17
s_lshl_b32 s30, s82, 2
s_sub_u32 s30, s30, 1024
v_lshrrev_b32 v18, 4, v0
v_mul_u32_u24 v17, s82, v18
buffer_load_dwordx4 v2, s[4:7], s19 offen offset:1024 lds
v_lshlrev_b32 v18, 1, v18
v_xor_b32 v18, v18, v0
v_and_b32 v18, 15, v18
v_lshl_add_u32 v36, v18, 4, v17
v_add_u32 v37, s30, v36
v_xor_b32 v17, 0x80, v37
v_add_u32 v38, s30, v17
v_add_u32 v39, s30, v38
v_accvgpr_write_b32 a160, v32
v_accvgpr_write_b32 a161, v33
v_accvgpr_write_b32 a162, v34
buffer_load_dwordx4 v3, s[4:7], s19 offen offset:2048 lds
v_accvgpr_write_b32 a163, v35
v_accvgpr_write_b32 a164, v36
v_accvgpr_write_b32 a165, v37
v_accvgpr_write_b32 a166, v38
v_accvgpr_write_b32 a167, v39
s_lshl_b32 s30, s73, 20
s_lshl_b32 s31, s72, 17
s_add_u32 s30, s30, s31
s_lshl_b32 s31, s18, 16
s_add_u32 s30, s30, s31
s_lshl_b32 s31, s17, 11
buffer_load_dwordx4 v4, s[4:7], s19 offen offset:3072 lds
s_add_u32 s76, s30, s31
s_lshl_b32 s31, s17, 12
s_add_u32 s77, s30, s31
s_lshl_b32 s29, s73, 20
s_lshl_b32 s31, s26, 16
s_add_u32 s29, s29, s31
s_lshl_b32 s31, s18, 15
s_add_u32 s29, s29, s31
s_lshl_b32 s31, s17, 11
s_add_u32 s29, s29, s31
s_add_u32 s29, s29, 0
s_add_u32 s19, s19, 128
s_add_u32 m0, s27, 36864
s_nop 0
buffer_load_dwordx4 v1, s[4:7], s20 offen offset:0 lds
s_add_u32 s77, s77, 33554432
s_add_u32 s76, s76, 16777216
s_cmp_lt_u32 s70, 16
s_cselect_b32 s28, s77, s76
s_lshl_b32 s30, s74, 4
s_lshl_b32 s31, s18, 3
s_add_u32 s30, s30, s31
s_mul_i32 s30, s30, 184
s_lshl_b32 s31, s75, 2
s_add_u32 s30, s30, s31
s_lshl_b32 s31, s17, 1
buffer_load_dwordx4 v2, s[4:7], s20 offen offset:1024 lds
s_add_u32 s30, s30, s31
s_add_u32 s30, s30, 128
s_lshl_b32 s30, s30, 10
s_add_u32 s30, s30, 50331648
s_cmp_lt_u32 s70, 16
s_cselect_b32 s29, s30, s29
s_mov_b32 s78, s46
s_mov_b32 s79, s47
s_add_u32 s74, s36, 256
s_addc_u32 s75, s37, 0
s_cmp_lt_u32 s70, 16
s_cselect_b32 s74, s48, s74
s_cselect_b32 s75, s49, s75
buffer_load_dwordx4 v3, s[4:7], s20 offen offset:2048 lds
s_xor_b32 s74, s74, s65
s_xor_b32 s75, s75, s66
s_getpc_b64 s[0:1]
L_f_pc:
s_mov_b32 s44, s0
s_mov_b32 s45, s1
s_mov_b32 s46, L_f_end-L_f_pc
s_mov_b32 s47, 0x20000
s_lshr_b32 s30, s2, 3
s_lshl_b32 s30, s30, 2
buffer_load_dwordx4 v4, s[4:7], s20 offen offset:3072 lds
s_add_u32 s30, s30, s16
s_lshl_b32 s30, s30, 10
v_and_b32 v17, 7, v0
v_lshlrev_b32 v17, 7, v17
buffer_load_dword v31, v17, s[44:47], s30 offen
s_lshr_b32 s83, s2, 5
s_mul_i32 s30, s16, 2
s_add_u32 s83, s83, s30
s_and_b32 s83, s83, 7
s_and_b32 s3, s2, 31
s_lshl_b32 s3, s3, 2
s_add_u32 s20, s20, 128
s_add_u32 m0, s25, 32768
s_nop 0
buffer_load_dwordx4 v5, s[8:11], s21 offen offset:0 lds
s_add_u32 s3, s3, s16
s_lshl_b32 s30, s83, 7
s_add_u32 s3, s3, s30
s_add_u32 s30, s3, 0
s_add_u32 s31, s30, 1048704
s_bfe_u32 s76, s31, 0x40007
s_lshl_b32 s76, s76, 19
s_and_b32 s46, s31, 63
s_lshl_b32 s46, s46, 13
s_add_u32 s46, s46, s76
s_mov_b32 s47, 128
buffer_load_dwordx4 v6, s[8:11], s21 offen offset:1024 lds
s_bitcmp1_b32 s31, 6
s_cselect_b32 s44, s40, s38
s_cselect_b32 s45, s41, s39
s_lshl_b32 s31, s30, 13
s_cmp_lt_u32 s30, 512
s_cselect_b32 s44, s34, s44
s_cselect_b32 s45, s35, s45
s_cselect_b32 s46, s31, s46
s_add_u32 s44, s44, s46
s_addc_u32 s45, s45, 0
v_mul_lo_u32 v17, v0, s47
buffer_load_dwordx4 v7, s[8:11], s21 offen offset:2048 lds
v_mov_b32 v18, s45
v_add_co_u32 v22, vcc, s44, v17
s_nop 1
v_addc_co_u32 v23, vcc, 0, v18, vcc
s_add_u32 s30, s3, 1024
s_add_u32 s31, s30, 1048704
s_bfe_u32 s76, s31, 0x40007
s_lshl_b32 s76, s76, 19
s_and_b32 s46, s31, 63
s_lshl_b32 s46, s46, 13
s_add_u32 s46, s46, s76
buffer_load_dwordx4 v8, s[8:11], s21 offen offset:3072 lds
s_mov_b32 s47, 128
s_bitcmp1_b32 s31, 6
s_cselect_b32 s44, s40, s38
s_cselect_b32 s45, s41, s39
s_sub_u32 s31, s30, 1920
s_lshl_b32 s31, s31, 13
s_cmp_ge_u32 s30, 1920
s_cselect_b32 s44, s32, s44
s_cselect_b32 s45, s33, s45
s_cselect_b32 s46, s31, s46
s_cselect_b32 s47, 128, s47
s_xor_b64 s[8:9], s[8:9], s[80:81]
s_add_u32 m0, s27, 65536
s_nop 0
buffer_load_dwordx4 v1, s[4:7], s19 offen offset:0 lds
s_add_u32 s44, s44, s46
s_addc_u32 s45, s45, 0
v_mul_lo_u32 v17, v0, s47
v_mov_b32 v18, s45
v_add_co_u32 v24, vcc, s44, v17
s_nop 1
v_addc_co_u32 v25, vcc, 0, v18, vcc
s_add_u32 s30, s3, 2048
s_sub_u32 s31, s30, 1920
s_lshl_b32 s31, s31, 13
s_cmp_ge_u32 s30, 1920
s_cselect_b32 s44, s32, s44
s_cselect_b32 s45, s33, s45
s_cselect_b32 s46, s31, s46
s_cselect_b32 s47, 128, s47
buffer_load_dwordx4 v2, s[4:7], s19 offen offset:1024 lds
s_sub_u32 s31, s30, 2144
s_lshl_b32 s31, s31, 13
s_cmp_ge_u32 s30, 2144
s_cselect_b32 s44, s36, s44
s_cselect_b32 s45, s37, s45
s_cselect_b32 s46, s31, s46
s_cselect_b32 s47, 128, s47
buffer_load_dwordx4 v3, s[4:7], s19 offen offset:2048 lds
s_sub_u32 s31, s30, 2592
s_lshl_b32 s31, s31, 13
s_cmp_ge_u32 s30, 2592
s_cselect_b32 s44, s78, s44
s_cselect_b32 s45, s79, s45
s_cselect_b32 s46, s31, s46
s_cselect_b32 s47, 128, s47
s_sub_u32 s31, s30, 2788
s_lshl_b32 s31, s31, 13
s_cmp_ge_u32 s30, 2788
s_cselect_b32 s44, s48, s44
s_cselect_b32 s45, s49, s45
s_cselect_b32 s46, s31, s46
s_cselect_b32 s47, 128, s47
buffer_load_dwordx4 v4, s[4:7], s19 offen offset:3072 lds
s_sub_u32 s31, s30, 2984
s_lshl_b32 s31, s31, 13
s_cmp_ge_u32 s30, 2984
s_cselect_b32 s44, s42, s44
s_cselect_b32 s45, s43, s45
s_cselect_b32 s46, s31, s46
s_cselect_b32 s47, 128, s47
s_add_u32 s44, s44, s46
s_addc_u32 s45, s45, 0
s_add_u32 s19, s19, 128
s_add_u32 m0, s25, 49152
s_nop 0
buffer_load_dwordx4 v5, s[8:11], s21 offen offset:0 lds
v_mul_lo_u32 v17, v0, s47
v_mov_b32 v18, s45
v_add_co_u32 v26, vcc, s44, v17
s_nop 1
v_addc_co_u32 v27, vcc, 0, v18, vcc
s_add_u32 s30, s3, 3072
s_sub_u32 s31, s30, 2984
s_lshl_b32 s31, s31, 13
s_cmp_ge_u32 s30, 2984
s_cselect_b32 s44, s42, s44
s_cselect_b32 s45, s43, s45
s_cselect_b32 s46, s31, s46
s_cselect_b32 s47, 128, s47
buffer_load_dwordx4 v6, s[8:11], s21 offen offset:1024 lds
s_sub_u32 s31, s30, 3432
s_lshl_b32 s31, s31, 13
s_cmp_ge_u32 s30, 3432
s_cselect_b32 s44, s50, s44
s_cselect_b32 s45, s51, s45
s_cselect_b32 s46, s31, s46
s_cselect_b32 s47, 128, s47
s_sub_u32 s31, s30, 3628
buffer_load_dwordx4 v7, s[8:11], s21 offen offset:2048 lds
s_lshl_b32 s31, s31, 13
s_mov_b32 s31, 0
s_cmp_ge_u32 s30, 3628
s_cselect_b32 s44, s32, s44
s_cselect_b32 s45, s33, s45
s_cselect_b32 s46, s31, s46
s_cselect_b32 s47, 128, s47
s_add_u32 s44, s44, s46
s_addc_u32 s45, s45, 0
v_mul_lo_u32 v17, v0, s47
v_mov_b32 v18, s45
buffer_load_dwordx4 v8, s[8:11], s21 offen offset:3072 lds
s_xor_b64 s[8:9], s[8:9], s[80:81]
s_add_u32 s21, s21, s22
v_add_co_u32 v28, vcc, s44, v17
s_nop 1
v_addc_co_u32 v29, vcc, 0, v18, vcc
s_add_u32 s46, s83, 6
s_cmp_eq_u32 s16, 0
s_cselect_b32 s46, s46, 0x7fff
v_mov_b32 v20, s52
v_mov_b32 v21, s53
s_lshl_b32 s83, 16843009, s83
s_mov_b32 s3, 0
v_add_u32 v15, 0, v13
v_xor_b32 v14, 64, v15
s_waitcnt vmcnt(26)
s_barrier
ds_read_b64_tr_b16 a[0:1], v9 offset:0
ds_read_b64_tr_b16 a[2:3], v9 offset:1024
ds_read_b64_tr_b16 a[4:5], v9 offset:8192
ds_read_b64_tr_b16 a[6:7], v9 offset:9216
ds_read_b64_tr_b16 a[8:9], v10 offset:0
ds_read_b64_tr_b16 a[10:11], v10 offset:1024
ds_read_b64_tr_b16 a[12:13], v10 offset:8192
ds_read_b64_tr_b16 a[14:15], v10 offset:9216
ds_read_b64_tr_b16 a[16:17], v11 offset:0
ds_read_b64_tr_b16 a[18:19], v11 offset:1024
ds_read_b64_tr_b16 a[20:21], v11 offset:8192
ds_read_b64_tr_b16 a[22:23], v11 offset:9216
ds_read_b64_tr_b16 a[24:25], v12 offset:0
ds_read_b64_tr_b16 a[26:27], v12 offset:1024
ds_read_b64_tr_b16 a[28:29], v12 offset:8192
ds_read_b64_tr_b16 a[30:31], v12 offset:9216
ds_read_b128 a[96:99], v15 offset:8192
ds_read_b128 a[100:103], v14 offset:8192
ds_read_b128 a[104:107], v15 offset:10240
ds_read_b128 a[108:111], v14 offset:10240
ds_read_b128 a[112:115], v15 offset:12288
ds_read_b128 a[116:119], v14 offset:12288
ds_read_b128 a[120:123], v15 offset:14336
ds_read_b128 a[124:127], v14 offset:14336
s_waitcnt vmcnt(21) lgkmcnt(0)
s_barrier
s_cmp_lt_u32 s70, 16
s_cbranch_scc0 L_k1_hi
v_mfma_f32_16x16x32_bf16 v[48:51], a[96:99], a[0:3], 0
v_mfma_f32_16x16x32_bf16 v[48:51], a[100:103], a[4:7], v[48:51]
ds_read_b128 a[64:67], v15 offset:0
v_mfma_f32_16x16x32_bf16 v[80:83], a[100:103], a[12:15], 0
s_add_u32 m0, s25, 0
v_mfma_f32_16x16x32_bf16 v[80:83], a[96:99], a[8:11], v[80:83]
ds_read_b128 a[68:71], v14 offset:0
v_mfma_f32_16x16x32_bf16 v[112:115], a[96:99], a[16:19], 0
buffer_load_dwordx4 v5, s[8:11], s21 offen offset:0 lds
v_mfma_f32_16x16x32_bf16 v[112:115], a[100:103], a[20:23], v[112:115]
ds_read_b128 a[72:75], v15 offset:2048
v_mfma_f32_16x16x32_bf16 v[144:147], a[100:103], a[28:31], 0
v_mfma_f32_16x16x32_bf16 v[144:147], a[96:99], a[24:27], v[144:147]
ds_read_b128 a[76:79], v14 offset:2048
v_mfma_f32_16x16x32_bf16 v[52:55], a[104:107], a[0:3], 0
s_bitcmp1_b32 s83, s3
s_cselect_b64 s[44:45], -1, 0
v_mfma_f32_16x16x32_bf16 v[52:55], a[108:111], a[4:7], v[52:55]
ds_read_b128 a[80:83], v15 offset:4096
v_mfma_f32_16x16x32_bf16 v[84:87], a[108:111], a[12:15], 0
buffer_load_dwordx4 v6, s[8:11], s21 offen offset:1024 lds
v_mfma_f32_16x16x32_bf16 v[84:87], a[104:107], a[8:11], v[84:87]
ds_read_b128 a[84:87], v14 offset:4096
v_mfma_f32_16x16x32_bf16 v[116:119], a[104:107], a[16:19], 0
v_cndmask_b32 v18, v20, v22, s[44:45]
v_cndmask_b32 v19, v21, v23, s[44:45]
v_mfma_f32_16x16x32_bf16 v[116:119], a[108:111], a[20:23], v[116:119]
ds_read_b128 a[88:91], v15 offset:6144
v_mfma_f32_16x16x32_bf16 v[148:151], a[108:111], a[28:31], 0
v_cndmask_b32 v22, v22, v24, s[44:45]
v_cndmask_b32 v23, v23, v25, s[44:45]
v_mfma_f32_16x16x32_bf16 v[148:151], a[104:107], a[24:27], v[148:151]
ds_read_b128 a[92:95], v14 offset:6144
v_mfma_f32_16x16x32_bf16 v[56:59], a[112:115], a[0:3], 0
buffer_load_dwordx4 v7, s[8:11], s21 offen offset:2048 lds
v_mfma_f32_16x16x32_bf16 v[56:59], a[116:119], a[4:7], v[56:59]
ds_read_b64_tr_b16 a[32:33], v9 offset:16384
v_mfma_f32_16x16x32_bf16 v[88:91], a[116:119], a[12:15], 0
v_cndmask_b32 v24, v24, v26, s[44:45]
v_cndmask_b32 v25, v25, v27, s[44:45]
v_mfma_f32_16x16x32_bf16 v[88:91], a[112:115], a[8:11], v[88:91]
ds_read_b64_tr_b16 a[34:35], v9 offset:17408
v_mfma_f32_16x16x32_bf16 v[120:123], a[112:115], a[16:19], 0
v_mfma_f32_16x16x32_bf16 v[120:123], a[116:119], a[20:23], v[120:123]
ds_read_b64_tr_b16 a[36:37], v9 offset:24576
v_mfma_f32_16x16x32_bf16 v[152:155], a[116:119], a[28:31], 0
buffer_load_dwordx4 v8, s[8:11], s21 offen offset:3072 lds
v_mfma_f32_16x16x32_bf16 v[152:155], a[112:115], a[24:27], v[152:155]
ds_read_b64_tr_b16 a[38:39], v9 offset:25600
v_mfma_f32_16x16x32_bf16 v[60:63], a[120:123], a[0:3], 0
s_xor_b64 s[8:9], s[8:9], s[80:81]
v_mfma_f32_16x16x32_bf16 v[60:63], a[124:127], a[4:7], v[60:63]
ds_read_b64_tr_b16 a[40:41], v10 offset:16384
v_mfma_f32_16x16x32_bf16 v[92:95], a[124:127], a[12:15], 0
s_add_u32 m0, s24, 4096
v_mfma_f32_16x16x32_bf16 v[92:95], a[120:123], a[8:11], v[92:95]
ds_read_b64_tr_b16 a[42:43], v10 offset:17408
v_mfma_f32_16x16x32_bf16 v[124:127], a[120:123], a[16:19], 0
buffer_load_dwordx4 v1, s[4:7], s20 offen offset:0 lds
v_mfma_f32_16x16x32_bf16 v[124:127], a[124:127], a[20:23], v[124:127]
ds_read_b64_tr_b16 a[44:45], v10 offset:24576
v_mfma_f32_16x16x32_bf16 v[156:159], a[124:127], a[28:31], 0
v_cndmask_b32 v26, v26, v28, s[44:45]
v_cndmask_b32 v27, v27, v29, s[44:45]
v_mfma_f32_16x16x32_bf16 v[156:159], a[120:123], a[24:27], v[156:159]
ds_read_b64_tr_b16 a[46:47], v10 offset:25600
s_waitcnt lgkmcnt(8)
v_mfma_f32_16x16x32_bf16 v[32:35], a[64:67], a[0:3], 0
s_cmp_eq_u32 s3, s46
s_cbranch_scc1 L_pf479_do
L_pf479_back:
v_mfma_f32_16x16x32_bf16 v[32:35], a[68:71], a[4:7], v[32:35]
ds_read_b64_tr_b16 a[48:49], v11 offset:16384
v_mfma_f32_16x16x32_bf16 v[64:67], a[68:71], a[12:15], 0
buffer_load_dwordx4 v2, s[4:7], s20 offen offset:1024 lds
v_mfma_f32_16x16x32_bf16 v[64:67], a[64:67], a[8:11], v[64:67]
ds_read_b64_tr_b16 a[50:51], v11 offset:17408
v_mfma_f32_16x16x32_bf16 v[96:99], a[64:67], a[16:19], 0
s_add_u32 s3, s3, 1
v_mfma_f32_16x16x32_bf16 v[96:99], a[68:71], a[20:23], v[96:99]
ds_read_b64_tr_b16 a[52:53], v11 offset:24576
v_mfma_f32_16x16x32_bf16 v[128:131], a[68:71], a[28:31], 0
v_mfma_f32_16x16x32_bf16 v[128:131], a[64:67], a[24:27], v[128:131]
ds_read_b64_tr_b16 a[54:55], v11 offset:25600
v_mfma_f32_16x16x32_bf16 v[36:39], a[72:75], a[0:3], 0
buffer_load_dwordx4 v3, s[4:7], s20 offen offset:2048 lds
v_mfma_f32_16x16x32_bf16 v[36:39], a[76:79], a[4:7], v[36:39]
ds_read_b64_tr_b16 a[56:57], v12 offset:16384
v_mfma_f32_16x16x32_bf16 v[68:71], a[76:79], a[12:15], 0
v_mfma_f32_16x16x32_bf16 v[68:71], a[72:75], a[8:11], v[68:71]
ds_read_b64_tr_b16 a[58:59], v12 offset:17408
v_mfma_f32_16x16x32_bf16 v[100:103], a[72:75], a[16:19], 0
v_mfma_f32_16x16x32_bf16 v[100:103], a[76:79], a[20:23], v[100:103]
ds_read_b64_tr_b16 a[60:61], v12 offset:24576
v_mfma_f32_16x16x32_bf16 v[132:135], a[76:79], a[28:31], 0
buffer_load_dwordx4 v4, s[4:7], s20 offen offset:3072 lds
v_mfma_f32_16x16x32_bf16 v[132:135], a[72:75], a[24:27], v[132:135]
ds_read_b64_tr_b16 a[62:63], v12 offset:25600
v_mfma_f32_16x16x32_bf16 v[40:43], a[80:83], a[0:3], 0
s_add_u32 s20, s20, 128
v_mfma_f32_16x16x32_bf16 v[40:43], a[84:87], a[4:7], v[40:43]
v_mfma_f32_16x16x32_bf16 v[72:75], a[84:87], a[12:15], 0
global_load_dword v31, v[18:19], off
v_mfma_f32_16x16x32_bf16 v[72:75], a[80:83], a[8:11], v[72:75]
v_mfma_f32_16x16x32_bf16 v[104:107], a[80:83], a[16:19], 0
v_mfma_f32_16x16x32_bf16 v[104:107], a[84:87], a[20:23], v[104:107]
v_mfma_f32_16x16x32_bf16 v[136:139], a[84:87], a[28:31], 0
v_mfma_f32_16x16x32_bf16 v[136:139], a[80:83], a[24:27], v[136:139]
v_mfma_f32_16x16x32_bf16 v[44:47], a[88:91], a[0:3], 0
v_mfma_f32_16x16x32_bf16 v[44:47], a[92:95], a[4:7], v[44:47]
v_mfma_f32_16x16x32_bf16 v[76:79], a[92:95], a[12:15], 0
v_mfma_f32_16x16x32_bf16 v[76:79], a[88:91], a[8:11], v[76:79]
v_mfma_f32_16x16x32_bf16 v[108:111], a[88:91], a[16:19], 0
v_mfma_f32_16x16x32_bf16 v[108:111], a[92:95], a[20:23], v[108:111]
v_mfma_f32_16x16x32_bf16 v[140:143], a[92:95], a[28:31], 0
s_waitcnt vmcnt(17) lgkmcnt(0)
v_mfma_f32_16x16x32_bf16 v[140:143], a[88:91], a[24:27], v[140:143]
s_barrier
v_mfma_f32_16x16x32_bf16 v[160:163], a[64:67], a[32:35], 0
s_add_u32 s24, s23, s27
s_add_u32 s23, s23, 32768
s_cmp_eq_u32 s23, 98304
v_mfma_f32_16x16x32_bf16 v[160:163], a[68:71], a[36:39], v[160:163]
ds_read_b64_tr_b16 a[0:1], v9 offset:32768
v_mfma_f32_16x16x32_bf16 v[192:195], a[68:71], a[44:47], 0
s_cselect_b32 s23, 0, s23
s_add_u32 m0, s25, 16384
v_mfma_f32_16x16x32_bf16 v[192:195], a[64:67], a[40:43], v[192:195]
ds_read_b64_tr_b16 a[2:3], v9 offset:33792
v_mfma_f32_16x16x32_bf16 v[224:227], a[64:67], a[48:51], 0
buffer_load_dwordx4 v5, s[8:11], s21 offen offset:0 lds
v_mfma_f32_16x16x32_bf16 v[224:227], a[68:71], a[52:55], v[224:227]
ds_read_b64_tr_b16 a[4:5], v9 offset:40960
v_mfma_f32_16x16x32_bf16 a[128:131], a[68:71], a[60:63], 0
v_add_u32 v15, s23, v13
v_xor_b32 v14, 64, v15
v_mfma_f32_16x16x32_bf16 a[128:131], a[64:67], a[56:59], a[128:131]
ds_read_b64_tr_b16 a[6:7], v9 offset:41984
v_mfma_f32_16x16x32_bf16 v[164:167], a[72:75], a[32:35], 0
s_bitcmp1_b32 s83, s3
s_cselect_b64 s[44:45], -1, 0
v_mfma_f32_16x16x32_bf16 v[164:167], a[76:79], a[36:39], v[164:167]
ds_read_b64_tr_b16 a[8:9], v10 offset:32768
v_mfma_f32_16x16x32_bf16 v[196:199], a[76:79], a[44:47], 0
buffer_load_dwordx4 v6, s[8:11], s21 offen offset:1024 lds
v_mfma_f32_16x16x32_bf16 v[196:199], a[72:75], a[40:43], v[196:199]
ds_read_b64_tr_b16 a[10:11], v10 offset:33792
v_mfma_f32_16x16x32_bf16 v[228:231], a[72:75], a[48:51], 0
v_cndmask_b32 v18, v20, v22, s[44:45]
v_cndmask_b32 v19, v21, v23, s[44:45]
v_mfma_f32_16x16x32_bf16 v[228:231], a[76:79], a[52:55], v[228:231]
ds_read_b64_tr_b16 a[12:13], v10 offset:40960
v_mfma_f32_16x16x32_bf16 a[132:135], a[76:79], a[60:63], 0
v_cndmask_b32 v22, v22, v24, s[44:45]
v_cndmask_b32 v23, v23, v25, s[44:45]
v_mfma_f32_16x16x32_bf16 a[132:135], a[72:75], a[56:59], a[132:135]
ds_read_b64_tr_b16 a[14:15], v10 offset:41984
v_mfma_f32_16x16x32_bf16 v[168:171], a[80:83], a[32:35], 0
buffer_load_dwordx4 v7, s[8:11], s21 offen offset:2048 lds
v_mfma_f32_16x16x32_bf16 v[168:171], a[84:87], a[36:39], v[168:171]
ds_read_b64_tr_b16 a[16:17], v11 offset:32768
v_mfma_f32_16x16x32_bf16 v[200:203], a[84:87], a[44:47], 0
v_cndmask_b32 v24, v24, v26, s[44:45]
v_cndmask_b32 v25, v25, v27, s[44:45]
v_mfma_f32_16x16x32_bf16 v[200:203], a[80:83], a[40:43], v[200:203]
ds_read_b64_tr_b16 a[18:19], v11 offset:33792
v_mfma_f32_16x16x32_bf16 v[232:235], a[80:83], a[48:51], 0
v_mfma_f32_16x16x32_bf16 v[232:235], a[84:87], a[52:55], v[232:235]
ds_read_b64_tr_b16 a[20:21], v11 offset:40960
v_mfma_f32_16x16x32_bf16 a[136:139], a[84:87], a[60:63], 0
buffer_load_dwordx4 v8, s[8:11], s21 offen offset:3072 lds
v_mfma_f32_16x16x32_bf16 a[136:139], a[80:83], a[56:59], a[136:139]
ds_read_b64_tr_b16 a[22:23], v11 offset:41984
v_mfma_f32_16x16x32_bf16 v[172:175], a[88:91], a[32:35], 0
s_xor_b64 s[8:9], s[8:9], s[80:81]
s_add_u32 s21, s21, s22
v_mfma_f32_16x16x32_bf16 v[172:175], a[92:95], a[36:39], v[172:175]
ds_read_b64_tr_b16 a[24:25], v12 offset:32768
v_mfma_f32_16x16x32_bf16 v[204:207], a[92:95], a[44:47], 0
s_add_u32 m0, s24, 0
v_mfma_f32_16x16x32_bf16 v[204:207], a[88:91], a[40:43], v[204:207]
ds_read_b64_tr_b16 a[26:27], v12 offset:33792
v_mfma_f32_16x16x32_bf16 v[236:239], a[88:91], a[48:51], 0
buffer_load_dwordx4 v1, s[4:7], s19 offen offset:0 lds
v_mfma_f32_16x16x32_bf16 v[236:239], a[92:95], a[52:55], v[236:239]
ds_read_b64_tr_b16 a[28:29], v12 offset:40960
v_mfma_f32_16x16x32_bf16 a[140:143], a[92:95], a[60:63], 0
v_cndmask_b32 v26, v26, v28, s[44:45]
v_cndmask_b32 v27, v27, v29, s[44:45]
v_mfma_f32_16x16x32_bf16 a[140:143], a[88:91], a[56:59], a[140:143]
ds_read_b64_tr_b16 a[30:31], v12 offset:41984
v_mfma_f32_16x16x32_bf16 v[176:179], a[96:99], a[32:35], 0
s_cmp_eq_u32 s3, s46
s_cbranch_scc1 L_pf597_do
L_pf597_back:
v_mfma_f32_16x16x32_bf16 v[176:179], a[100:103], a[36:39], v[176:179]
ds_read_b128 a[64:67], v15 offset:0
v_mfma_f32_16x16x32_bf16 v[208:211], a[100:103], a[44:47], 0
buffer_load_dwordx4 v2, s[4:7], s19 offen offset:1024 lds
v_mfma_f32_16x16x32_bf16 v[208:211], a[96:99], a[40:43], v[208:211]
ds_read_b128 a[68:71], v14 offset:0
v_mfma_f32_16x16x32_bf16 v[240:243], a[96:99], a[48:51], 0
s_add_u32 s3, s3, 1
v_mfma_f32_16x16x32_bf16 v[240:243], a[100:103], a[52:55], v[240:243]
ds_read_b128 a[72:75], v15 offset:2048
v_mfma_f32_16x16x32_bf16 a[144:147], a[100:103], a[60:63], 0
v_mfma_f32_16x16x32_bf16 a[144:147], a[96:99], a[56:59], a[144:147]
ds_read_b128 a[76:79], v14 offset:2048
v_mfma_f32_16x16x32_bf16 v[180:183], a[104:107], a[32:35], 0
buffer_load_dwordx4 v3, s[4:7], s19 offen offset:2048 lds
v_mfma_f32_16x16x32_bf16 v[180:183], a[108:111], a[36:39], v[180:183]
ds_read_b128 a[80:83], v15 offset:4096
v_mfma_f32_16x16x32_bf16 v[212:215], a[108:111], a[44:47], 0
v_mfma_f32_16x16x32_bf16 v[212:215], a[104:107], a[40:43], v[212:215]
ds_read_b128 a[84:87], v14 offset:4096
v_mfma_f32_16x16x32_bf16 v[244:247], a[104:107], a[48:51], 0
v_mfma_f32_16x16x32_bf16 v[244:247], a[108:111], a[52:55], v[244:247]
ds_read_b128 a[88:91], v15 offset:6144
v_mfma_f32_16x16x32_bf16 a[148:151], a[108:111], a[60:63], 0
buffer_load_dwordx4 v4, s[4:7], s19 offen offset:3072 lds
v_mfma_f32_16x16x32_bf16 a[148:151], a[104:107], a[56:59], a[148:151]
ds_read_b128 a[92:95], v14 offset:6144
v_mfma_f32_16x16x32_bf16 v[184:187], a[112:115], a[32:35], 0
s_add_u32 s19, s19, 128
v_mfma_f32_16x16x32_bf16 v[184:187], a[116:119], a[36:39], v[184:187]
v_mfma_f32_16x16x32_bf16 v[216:219], a[116:119], a[44:47], 0
global_load_dword v31, v[18:19], off
v_mfma_f32_16x16x32_bf16 v[216:219], a[112:115], a[40:43], v[216:219]
v_mfma_f32_16x16x32_bf16 v[248:251], a[112:115], a[48:51], 0
v_mfma_f32_16x16x32_bf16 v[248:251], a[116:119], a[52:55], v[248:251]
v_mfma_f32_16x16x32_bf16 a[152:155], a[116:119], a[60:63], 0
v_mfma_f32_16x16x32_bf16 a[152:155], a[112:115], a[56:59], a[152:155]
v_mfma_f32_16x16x32_bf16 v[188:191], a[120:123], a[32:35], 0
v_mfma_f32_16x16x32_bf16 v[188:191], a[124:127], a[36:39], v[188:191]
v_mfma_f32_16x16x32_bf16 v[220:223], a[124:127], a[44:47], 0
v_mfma_f32_16x16x32_bf16 v[220:223], a[120:123], a[40:43], v[220:223]
v_mfma_f32_16x16x32_bf16 v[252:255], a[120:123], a[48:51], 0
s_mov_b32 s26, 0
v_mfma_f32_16x16x32_bf16 v[252:255], a[124:127], a[52:55], v[252:255]
v_mfma_f32_16x16x32_bf16 a[156:159], a[124:127], a[60:63], 0
s_waitcnt vmcnt(18) lgkmcnt(0)
v_mfma_f32_16x16x32_bf16 a[156:159], a[120:123], a[56:59], a[156:159]
s_barrier
s_branch L_k1L_p2
.p2align 6
L_k1L_p0:
v_mfma_f32_16x16x32_bf16 v[48:51], a[96:99], a[0:3], v[48:51]
s_cmp_eq_u32 s26, 7
s_cbranch_scc1 L_k1L_swW
L_k1L_backW:
v_mfma_f32_16x16x32_bf16 v[48:51], a[100:103], a[4:7], v[48:51]
ds_read_b128 a[64:67], v15 offset:0
v_mfma_f32_16x16x32_bf16 v[80:83], a[100:103], a[12:15], v[80:83]
s_add_u32 m0, s25, 0
v_mfma_f32_16x16x32_bf16 v[80:83], a[96:99], a[8:11], v[80:83]
ds_read_b128 a[68:71], v14 offset:0
v_mfma_f32_16x16x32_bf16 v[112:115], a[96:99], a[16:19], v[112:115]
buffer_load_dwordx4 v5, s[8:11], s21 offen offset:0 lds
v_mfma_f32_16x16x32_bf16 v[112:115], a[100:103], a[20:23], v[112:115]
ds_read_b128 a[72:75], v15 offset:2048
v_mfma_f32_16x16x32_bf16 v[144:147], a[100:103], a[28:31], v[144:147]
v_mfma_f32_16x16x32_bf16 v[144:147], a[96:99], a[24:27], v[144:147]
ds_read_b128 a[76:79], v14 offset:2048
v_mfma_f32_16x16x32_bf16 v[52:55], a[104:107], a[0:3], v[52:55]
s_bitcmp1_b32 s83, s3
s_cselect_b64 s[44:45], -1, 0
v_mfma_f32_16x16x32_bf16 v[52:55], a[108:111], a[4:7], v[52:55]
ds_read_b128 a[80:83], v15 offset:4096
v_mfma_f32_16x16x32_bf16 v[84:87], a[108:111], a[12:15], v[84:87]
buffer_load_dwordx4 v6, s[8:11], s21 offen offset:1024 lds
v_mfma_f32_16x16x32_bf16 v[84:87], a[104:107], a[8:11], v[84:87]
ds_read_b128 a[84:87], v14 offset:4096
v_mfma_f32_16x16x32_bf16 v[116:119], a[104:107], a[16:19], v[116:119]
v_cndmask_b32 v18, v20, v22, s[44:45]
v_cndmask_b32 v19, v21, v23, s[44:45]
v_mfma_f32_16x16x32_bf16 v[116:119], a[108:111], a[20:23], v[116:119]
ds_read_b128 a[88:91], v15 offset:6144
v_mfma_f32_16x16x32_bf16 v[148:151], a[108:111], a[28:31], v[148:151]
v_cndmask_b32 v22, v22, v24, s[44:45]
v_cndmask_b32 v23, v23, v25, s[44:45]
v_mfma_f32_16x16x32_bf16 v[148:151], a[104:107], a[24:27], v[148:151]
ds_read_b128 a[92:95], v14 offset:6144
v_mfma_f32_16x16x32_bf16 v[56:59], a[112:115], a[0:3], v[56:59]
buffer_load_dwordx4 v7, s[8:11], s21 offen offset:2048 lds
v_mfma_f32_16x16x32_bf16 v[56:59], a[116:119], a[4:7], v[56:59]
ds_read_b64_tr_b16 a[32:33], v9 offset:16384
v_mfma_f32_16x16x32_bf16 v[88:91], a[116:119], a[12:15], v[88:91]
v_cndmask_b32 v24, v24, v26, s[44:45]
v_cndmask_b32 v25, v25, v27, s[44:45]
v_mfma_f32_16x16x32_bf16 v[88:91], a[112:115], a[8:11], v[88:91]
ds_read_b64_tr_b16 a[34:35], v9 offset:17408
v_mfma_f32_16x16x32_bf16 v[120:123], a[112:115], a[16:19], v[120:123]
v_mfma_f32_16x16x32_bf16 v[120:123], a[116:119], a[20:23], v[120:123]
ds_read_b64_tr_b16 a[36:37], v9 offset:24576
v_mfma_f32_16x16x32_bf16 v[152:155], a[116:119], a[28:31], v[152:155]
buffer_load_dwordx4 v8, s[8:11], s21 offen offset:3072 lds
v_mfma_f32_16x16x32_bf16 v[152:155], a[112:115], a[24:27], v[152:155]
ds_read_b64_tr_b16 a[38:39], v9 offset:25600
v_mfma_f32_16x16x32_bf16 v[60:63], a[120:123], a[0:3], v[60:63]
s_xor_b64 s[8:9], s[8:9], s[80:81]
v_mfma_f32_16x16x32_bf16 v[60:63], a[124:127], a[4:7], v[60:63]
ds_read_b64_tr_b16 a[40:41], v10 offset:16384
v_mfma_f32_16x16x32_bf16 v[92:95], a[124:127], a[12:15], v[92:95]
s_add_u32 m0, s24, 4096
v_mfma_f32_16x16x32_bf16 v[92:95], a[120:123], a[8:11], v[92:95]
ds_read_b64_tr_b16 a[42:43], v10 offset:17408
v_mfma_f32_16x16x32_bf16 v[124:127], a[120:123], a[16:19], v[124:127]
buffer_load_dwordx4 v1, s[4:7], s20 offen offset:0 lds
v_mfma_f32_16x16x32_bf16 v[124:127], a[124:127], a[20:23], v[124:127]
ds_read_b64_tr_b16 a[44:45], v10 offset:24576
v_mfma_f32_16x16x32_bf16 v[156:159], a[124:127], a[28:31], v[156:159]
v_cndmask_b32 v26, v26, v28, s[44:45]
v_cndmask_b32 v27, v27, v29, s[44:45]
v_mfma_f32_16x16x32_bf16 v[156:159], a[120:123], a[24:27], v[156:159]
ds_read_b64_tr_b16 a[46:47], v10 offset:25600
s_waitcnt lgkmcnt(8)
v_mfma_f32_16x16x32_bf16 v[32:35], a[64:67], a[0:3], v[32:35]
s_cmp_eq_u32 s3, s46
s_cbranch_scc1 L_pf725_do
L_pf725_back:
v_mfma_f32_16x16x32_bf16 v[32:35], a[68:71], a[4:7], v[32:35]
ds_read_b64_tr_b16 a[48:49], v11 offset:16384
v_mfma_f32_16x16x32_bf16 v[64:67], a[68:71], a[12:15], v[64:67]
buffer_load_dwordx4 v2, s[4:7], s20 offen offset:1024 lds
v_mfma_f32_16x16x32_bf16 v[64:67], a[64:67], a[8:11], v[64:67]
ds_read_b64_tr_b16 a[50:51], v11 offset:17408
v_mfma_f32_16x16x32_bf16 v[96:99], a[64:67], a[16:19], v[96:99]
s_add_u32 s3, s3, 1
v_mfma_f32_16x16x32_bf16 v[96:99], a[68:71], a[20:23], v[96:99]
ds_read_b64_tr_b16 a[52:53], v11 offset:24576
v_mfma_f32_16x16x32_bf16 v[128:131], a[68:71], a[28:31], v[128:131]
v_mfma_f32_16x16x32_bf16 v[128:131], a[64:67], a[24:27], v[128:131]
ds_read_b64_tr_b16 a[54:55], v11 offset:25600
v_mfma_f32_16x16x32_bf16 v[36:39], a[72:75], a[0:3], v[36:39]
buffer_load_dwordx4 v3, s[4:7], s20 offen offset:2048 lds
v_mfma_f32_16x16x32_bf16 v[36:39], a[76:79], a[4:7], v[36:39]
ds_read_b64_tr_b16 a[56:57], v12 offset:16384
v_mfma_f32_16x16x32_bf16 v[68:71], a[76:79], a[12:15], v[68:71]
v_mfma_f32_16x16x32_bf16 v[68:71], a[72:75], a[8:11], v[68:71]
ds_read_b64_tr_b16 a[58:59], v12 offset:17408
v_mfma_f32_16x16x32_bf16 v[100:103], a[72:75], a[16:19], v[100:103]
v_mfma_f32_16x16x32_bf16 v[100:103], a[76:79], a[20:23], v[100:103]
ds_read_b64_tr_b16 a[60:61], v12 offset:24576
v_mfma_f32_16x16x32_bf16 v[132:135], a[76:79], a[28:31], v[132:135]
buffer_load_dwordx4 v4, s[4:7], s20 offen offset:3072 lds
v_mfma_f32_16x16x32_bf16 v[132:135], a[72:75], a[24:27], v[132:135]
ds_read_b64_tr_b16 a[62:63], v12 offset:25600
v_mfma_f32_16x16x32_bf16 v[40:43], a[80:83], a[0:3], v[40:43]
s_add_u32 s20, s20, 128
v_mfma_f32_16x16x32_bf16 v[40:43], a[84:87], a[4:7], v[40:43]
v_mfma_f32_16x16x32_bf16 v[72:75], a[84:87], a[12:15], v[72:75]
global_load_dword v31, v[18:19], off
v_mfma_f32_16x16x32_bf16 v[72:75], a[80:83], a[8:11], v[72:75]
v_mfma_f32_16x16x32_bf16 v[104:107], a[80:83], a[16:19], v[104:107]
v_mfma_f32_16x16x32_bf16 v[104:107], a[84:87], a[20:23], v[104:107]
v_mfma_f32_16x16x32_bf16 v[136:139], a[84:87], a[28:31], v[136:139]
v_mfma_f32_16x16x32_bf16 v[136:139], a[80:83], a[24:27], v[136:139]
v_mfma_f32_16x16x32_bf16 v[44:47], a[88:91], a[0:3], v[44:47]
v_mfma_f32_16x16x32_bf16 v[44:47], a[92:95], a[4:7], v[44:47]
v_mfma_f32_16x16x32_bf16 v[76:79], a[92:95], a[12:15], v[76:79]
v_mfma_f32_16x16x32_bf16 v[76:79], a[88:91], a[8:11], v[76:79]
v_mfma_f32_16x16x32_bf16 v[108:111], a[88:91], a[16:19], v[108:111]
v_mfma_f32_16x16x32_bf16 v[108:111], a[92:95], a[20:23], v[108:111]
v_mfma_f32_16x16x32_bf16 v[140:143], a[92:95], a[28:31], v[140:143]
s_waitcnt vmcnt(18) lgkmcnt(0)
v_mfma_f32_16x16x32_bf16 v[140:143], a[88:91], a[24:27], v[140:143]
s_barrier
L_k1L_p1:
v_mfma_f32_16x16x32_bf16 v[160:163], a[64:67], a[32:35], v[160:163]
s_add_u32 s24, s23, s27
s_add_u32 s23, s23, 32768
s_cmp_eq_u32 s23, 98304
v_mfma_f32_16x16x32_bf16 v[160:163], a[68:71], a[36:39], v[160:163]
ds_read_b64_tr_b16 a[0:1], v9 offset:32768
v_mfma_f32_16x16x32_bf16 v[192:195], a[68:71], a[44:47], v[192:195]
s_cselect_b32 s23, 0, s23
s_add_u32 m0, s25, 16384
v_mfma_f32_16x16x32_bf16 v[192:195], a[64:67], a[40:43], v[192:195]
ds_read_b64_tr_b16 a[2:3], v9 offset:33792
v_mfma_f32_16x16x32_bf16 v[224:227], a[64:67], a[48:51], v[224:227]
buffer_load_dwordx4 v5, s[8:11], s21 offen offset:0 lds
v_mfma_f32_16x16x32_bf16 v[224:227], a[68:71], a[52:55], v[224:227]
ds_read_b64_tr_b16 a[4:5], v9 offset:40960
v_mfma_f32_16x16x32_bf16 a[128:131], a[68:71], a[60:63], a[128:131]
v_add_u32 v15, s23, v13
v_xor_b32 v14, 64, v15
v_mfma_f32_16x16x32_bf16 a[128:131], a[64:67], a[56:59], a[128:131]
ds_read_b64_tr_b16 a[6:7], v9 offset:41984
v_mfma_f32_16x16x32_bf16 v[164:167], a[72:75], a[32:35], v[164:167]
s_bitcmp1_b32 s83, s3
s_cselect_b64 s[44:45], -1, 0
v_mfma_f32_16x16x32_bf16 v[164:167], a[76:79], a[36:39], v[164:167]
ds_read_b64_tr_b16 a[8:9], v10 offset:32768
v_mfma_f32_16x16x32_bf16 v[196:199], a[76:79], a[44:47], v[196:199]
buffer_load_dwordx4 v6, s[8:11], s21 offen offset:1024 lds
v_mfma_f32_16x16x32_bf16 v[196:199], a[72:75], a[40:43], v[196:199]
ds_read_b64_tr_b16 a[10:11], v10 offset:33792
v_mfma_f32_16x16x32_bf16 v[228:231], a[72:75], a[48:51], v[228:231]
v_cndmask_b32 v18, v20, v22, s[44:45]
v_cndmask_b32 v19, v21, v23, s[44:45]
v_mfma_f32_16x16x32_bf16 v[228:231], a[76:79], a[52:55], v[228:231]
ds_read_b64_tr_b16 a[12:13], v10 offset:40960
v_mfma_f32_16x16x32_bf16 a[132:135], a[76:79], a[60:63], a[132:135]
v_cndmask_b32 v22, v22, v24, s[44:45]
v_cndmask_b32 v23, v23, v25, s[44:45]
v_mfma_f32_16x16x32_bf16 a[132:135], a[72:75], a[56:59], a[132:135]
ds_read_b64_tr_b16 a[14:15], v10 offset:41984
v_mfma_f32_16x16x32_bf16 v[168:171], a[80:83], a[32:35], v[168:171]
buffer_load_dwordx4 v7, s[8:11], s21 offen offset:2048 lds
v_mfma_f32_16x16x32_bf16 v[168:171], a[84:87], a[36:39], v[168:171]
ds_read_b64_tr_b16 a[16:17], v11 offset:32768
v_mfma_f32_16x16x32_bf16 v[200:203], a[84:87], a[44:47], v[200:203]
v_cndmask_b32 v24, v24, v26, s[44:45]
v_cndmask_b32 v25, v25, v27, s[44:45]
v_mfma_f32_16x16x32_bf16 v[200:203], a[80:83], a[40:43], v[200:203]
ds_read_b64_tr_b16 a[18:19], v11 offset:33792
v_mfma_f32_16x16x32_bf16 v[232:235], a[80:83], a[48:51], v[232:235]
v_mfma_f32_16x16x32_bf16 v[232:235], a[84:87], a[52:55], v[232:235]
ds_read_b64_tr_b16 a[20:21], v11 offset:40960
v_mfma_f32_16x16x32_bf16 a[136:139], a[84:87], a[60:63], a[136:139]
buffer_load_dwordx4 v8, s[8:11], s21 offen offset:3072 lds
v_mfma_f32_16x16x32_bf16 a[136:139], a[80:83], a[56:59], a[136:139]
ds_read_b64_tr_b16 a[22:23], v11 offset:41984
v_mfma_f32_16x16x32_bf16 v[172:175], a[88:91], a[32:35], v[172:175]
s_xor_b64 s[8:9], s[8:9], s[80:81]
s_add_u32 s21, s21, s22
v_mfma_f32_16x16x32_bf16 v[172:175], a[92:95], a[36:39], v[172:175]
ds_read_b64_tr_b16 a[24:25], v12 offset:32768
v_mfma_f32_16x16x32_bf16 v[204:207], a[92:95], a[44:47], v[204:207]
s_add_u32 m0, s24, 0
v_mfma_f32_16x16x32_bf16 v[204:207], a[88:91], a[40:43], v[204:207]
ds_read_b64_tr_b16 a[26:27], v12 offset:33792
v_mfma_f32_16x16x32_bf16 v[236:239], a[88:91], a[48:51], v[236:239]
buffer_load_dwordx4 v1, s[4:7], s19 offen offset:0 lds
v_mfma_f32_16x16x32_bf16 v[236:239], a[92:95], a[52:55], v[236:239]
ds_read_b64_tr_b16 a[28:29], v12 offset:40960
v_mfma_f32_16x16x32_bf16 a[140:143], a[92:95], a[60:63], a[140:143]
v_cndmask_b32 v26, v26, v28, s[44:45]
v_cndmask_b32 v27, v27, v29, s[44:45]
v_mfma_f32_16x16x32_bf16 a[140:143], a[88:91], a[56:59], a[140:143]
ds_read_b64_tr_b16 a[30:31], v12 offset:41984
v_mfma_f32_16x16x32_bf16 v[176:179], a[96:99], a[32:35], v[176:179]
s_cmp_eq_u32 s3, s46
s_cbranch_scc1 L_pf847_do
L_pf847_back:
v_mfma_f32_16x16x32_bf16 v[176:179], a[100:103], a[36:39], v[176:179]
ds_read_b128 a[64:67], v15 offset:0
v_mfma_f32_16x16x32_bf16 v[208:211], a[100:103], a[44:47], v[208:211]
buffer_load_dwordx4 v2, s[4:7], s19 offen offset:1024 lds
v_mfma_f32_16x16x32_bf16 v[208:211], a[96:99], a[40:43], v[208:211]
ds_read_b128 a[68:71], v14 offset:0
v_mfma_f32_16x16x32_bf16 v[240:243], a[96:99], a[48:51], v[240:243]
s_add_u32 s3, s3, 1
v_mfma_f32_16x16x32_bf16 v[240:243], a[100:103], a[52:55], v[240:243]
ds_read_b128 a[72:75], v15 offset:2048
v_mfma_f32_16x16x32_bf16 a[144:147], a[100:103], a[60:63], a[144:147]
v_mfma_f32_16x16x32_bf16 a[144:147], a[96:99], a[56:59], a[144:147]
ds_read_b128 a[76:79], v14 offset:2048
v_mfma_f32_16x16x32_bf16 v[180:183], a[104:107], a[32:35], v[180:183]
buffer_load_dwordx4 v3, s[4:7], s19 offen offset:2048 lds
v_mfma_f32_16x16x32_bf16 v[180:183], a[108:111], a[36:39], v[180:183]
ds_read_b128 a[80:83], v15 offset:4096
v_mfma_f32_16x16x32_bf16 v[212:215], a[108:111], a[44:47], v[212:215]
v_mfma_f32_16x16x32_bf16 v[212:215], a[104:107], a[40:43], v[212:215]
ds_read_b128 a[84:87], v14 offset:4096
v_mfma_f32_16x16x32_bf16 v[244:247], a[104:107], a[48:51], v[244:247]
v_mfma_f32_16x16x32_bf16 v[244:247], a[108:111], a[52:55], v[244:247]
ds_read_b128 a[88:91], v15 offset:6144
v_mfma_f32_16x16x32_bf16 a[148:151], a[108:111], a[60:63], a[148:151]
buffer_load_dwordx4 v4, s[4:7], s19 offen offset:3072 lds
v_mfma_f32_16x16x32_bf16 a[148:151], a[104:107], a[56:59], a[148:151]
ds_read_b128 a[92:95], v14 offset:6144
v_mfma_f32_16x16x32_bf16 v[184:187], a[112:115], a[32:35], v[184:187]
s_add_u32 s19, s19, 128
v_mfma_f32_16x16x32_bf16 v[184:187], a[116:119], a[36:39], v[184:187]
v_mfma_f32_16x16x32_bf16 v[216:219], a[116:119], a[44:47], v[216:219]
global_load_dword v31, v[18:19], off
v_mfma_f32_16x16x32_bf16 v[216:219], a[112:115], a[40:43], v[216:219]
v_mfma_f32_16x16x32_bf16 v[248:251], a[112:115], a[48:51], v[248:251]
v_mfma_f32_16x16x32_bf16 v[248:251], a[116:119], a[52:55], v[248:251]
v_mfma_f32_16x16x32_bf16 a[152:155], a[116:119], a[60:63], a[152:155]
v_mfma_f32_16x16x32_bf16 a[152:155], a[112:115], a[56:59], a[152:155]
v_mfma_f32_16x16x32_bf16 v[188:191], a[120:123], a[32:35], v[188:191]
v_mfma_f32_16x16x32_bf16 v[188:191], a[124:127], a[36:39], v[188:191]
v_mfma_f32_16x16x32_bf16 v[220:223], a[124:127], a[44:47], v[220:223]
v_mfma_f32_16x16x32_bf16 v[220:223], a[120:123], a[40:43], v[220:223]
v_mfma_f32_16x16x32_bf16 v[252:255], a[120:123], a[48:51], v[252:255]
v_mfma_f32_16x16x32_bf16 v[252:255], a[124:127], a[52:55], v[252:255]
v_mfma_f32_16x16x32_bf16 a[156:159], a[124:127], a[60:63], a[156:159]
s_waitcnt vmcnt(18) lgkmcnt(0)
v_mfma_f32_16x16x32_bf16 a[156:159], a[120:123], a[56:59], a[156:159]
s_barrier
L_k1L_p2:
v_mfma_f32_16x16x32_bf16 v[32:35], a[64:67], a[0:3], v[32:35]
v_mfma_f32_16x16x32_bf16 v[32:35], a[68:71], a[4:7], v[32:35]
ds_read_b128 a[96:99], v15 offset:8192
v_mfma_f32_16x16x32_bf16 v[64:67], a[68:71], a[12:15], v[64:67]
s_add_u32 m0, s25, 32768
v_mfma_f32_16x16x32_bf16 v[64:67], a[64:67], a[8:11], v[64:67]
ds_read_b128 a[100:103], v14 offset:8192
v_mfma_f32_16x16x32_bf16 v[96:99], a[64:67], a[16:19], v[96:99]
buffer_load_dwordx4 v5, s[8:11], s21 offen offset:0 lds
v_mfma_f32_16x16x32_bf16 v[96:99], a[68:71], a[20:23], v[96:99]
ds_read_b128 a[104:107], v15 offset:10240
v_mfma_f32_16x16x32_bf16 v[128:131], a[68:71], a[28:31], v[128:131]
v_mfma_f32_16x16x32_bf16 v[128:131], a[64:67], a[24:27], v[128:131]
ds_read_b128 a[108:111], v14 offset:10240
v_mfma_f32_16x16x32_bf16 v[36:39], a[72:75], a[0:3], v[36:39]
s_bitcmp1_b32 s83, s3
s_cselect_b64 s[44:45], -1, 0
v_mfma_f32_16x16x32_bf16 v[36:39], a[76:79], a[4:7], v[36:39]
ds_read_b128 a[112:115], v15 offset:12288
v_mfma_f32_16x16x32_bf16 v[68:71], a[76:79], a[12:15], v[68:71]
buffer_load_dwordx4 v6, s[8:11], s21 offen offset:1024 lds
v_mfma_f32_16x16x32_bf16 v[68:71], a[72:75], a[8:11], v[68:71]
ds_read_b128 a[116:119], v14 offset:12288
v_mfma_f32_16x16x32_bf16 v[100:103], a[72:75], a[16:19], v[100:103]
v_cndmask_b32 v18, v20, v22, s[44:45]
v_cndmask_b32 v19, v21, v23, s[44:45]
v_mfma_f32_16x16x32_bf16 v[100:103], a[76:79], a[20:23], v[100:103]
ds_read_b128 a[120:123], v15 offset:14336
v_mfma_f32_16x16x32_bf16 v[132:135], a[76:79], a[28:31], v[132:135]
v_cndmask_b32 v22, v22, v24, s[44:45]
v_cndmask_b32 v23, v23, v25, s[44:45]
v_mfma_f32_16x16x32_bf16 v[132:135], a[72:75], a[24:27], v[132:135]
ds_read_b128 a[124:127], v14 offset:14336
v_mfma_f32_16x16x32_bf16 v[40:43], a[80:83], a[0:3], v[40:43]
buffer_load_dwordx4 v7, s[8:11], s21 offen offset:2048 lds
v_mfma_f32_16x16x32_bf16 v[40:43], a[84:87], a[4:7], v[40:43]
ds_read_b64_tr_b16 a[32:33], v9 offset:49152
v_mfma_f32_16x16x32_bf16 v[72:75], a[84:87], a[12:15], v[72:75]
v_cndmask_b32 v24, v24, v26, s[44:45]
v_cndmask_b32 v25, v25, v27, s[44:45]
v_mfma_f32_16x16x32_bf16 v[72:75], a[80:83], a[8:11], v[72:75]
ds_read_b64_tr_b16 a[34:35], v9 offset:50176
v_mfma_f32_16x16x32_bf16 v[104:107], a[80:83], a[16:19], v[104:107]
v_mfma_f32_16x16x32_bf16 v[104:107], a[84:87], a[20:23], v[104:107]
ds_read_b64_tr_b16 a[36:37], v9 offset:57344
v_mfma_f32_16x16x32_bf16 v[136:139], a[84:87], a[28:31], v[136:139]
buffer_load_dwordx4 v8, s[8:11], s21 offen offset:3072 lds
v_mfma_f32_16x16x32_bf16 v[136:139], a[80:83], a[24:27], v[136:139]
ds_read_b64_tr_b16 a[38:39], v9 offset:58368
v_mfma_f32_16x16x32_bf16 v[44:47], a[88:91], a[0:3], v[44:47]
s_xor_b64 s[8:9], s[8:9], s[80:81]
v_mfma_f32_16x16x32_bf16 v[44:47], a[92:95], a[4:7], v[44:47]
ds_read_b64_tr_b16 a[40:41], v10 offset:49152
v_mfma_f32_16x16x32_bf16 v[76:79], a[92:95], a[12:15], v[76:79]
s_add_u32 m0, s24, 4096
v_mfma_f32_16x16x32_bf16 v[76:79], a[88:91], a[8:11], v[76:79]
ds_read_b64_tr_b16 a[42:43], v10 offset:50176
v_mfma_f32_16x16x32_bf16 v[108:111], a[88:91], a[16:19], v[108:111]
buffer_load_dwordx4 v1, s[4:7], s20 offen offset:0 lds
v_mfma_f32_16x16x32_bf16 v[108:111], a[92:95], a[20:23], v[108:111]
ds_read_b64_tr_b16 a[44:45], v10 offset:57344
v_mfma_f32_16x16x32_bf16 v[140:143], a[92:95], a[28:31], v[140:143]
v_cndmask_b32 v26, v26, v28, s[44:45]
v_cndmask_b32 v27, v27, v29, s[44:45]
v_mfma_f32_16x16x32_bf16 v[140:143], a[88:91], a[24:27], v[140:143]
ds_read_b64_tr_b16 a[46:47], v10 offset:58368
s_waitcnt lgkmcnt(8)
v_mfma_f32_16x16x32_bf16 v[48:51], a[96:99], a[0:3], v[48:51]
s_cmp_eq_u32 s3, s46
s_cbranch_scc1 L_pf972_do
L_pf972_back:
v_mfma_f32_16x16x32_bf16 v[48:51], a[100:103], a[4:7], v[48:51]
ds_read_b64_tr_b16 a[48:49], v11 offset:49152
v_mfma_f32_16x16x32_bf16 v[80:83], a[100:103], a[12:15], v[80:83]
buffer_load_dwordx4 v2, s[4:7], s20 offen offset:1024 lds
v_mfma_f32_16x16x32_bf16 v[80:83], a[96:99], a[8:11], v[80:83]
ds_read_b64_tr_b16 a[50:51], v11 offset:50176
v_mfma_f32_16x16x32_bf16 v[112:115], a[96:99], a[16:19], v[112:115]
s_add_u32 s3, s3, 1
v_mfma_f32_16x16x32_bf16 v[112:115], a[100:103], a[20:23], v[112:115]
ds_read_b64_tr_b16 a[52:53], v11 offset:57344
v_mfma_f32_16x16x32_bf16 v[144:147], a[100:103], a[28:31], v[144:147]
v_mfma_f32_16x16x32_bf16 v[144:147], a[96:99], a[24:27], v[144:147]
ds_read_b64_tr_b16 a[54:55], v11 offset:58368
v_mfma_f32_16x16x32_bf16 v[52:55], a[104:107], a[0:3], v[52:55]
buffer_load_dwordx4 v3, s[4:7], s20 offen offset:2048 lds
v_mfma_f32_16x16x32_bf16 v[52:55], a[108:111], a[4:7], v[52:55]
ds_read_b64_tr_b16 a[56:57], v12 offset:49152
v_mfma_f32_16x16x32_bf16 v[84:87], a[108:111], a[12:15], v[84:87]
v_mfma_f32_16x16x32_bf16 v[84:87], a[104:107], a[8:11], v[84:87]
ds_read_b64_tr_b16 a[58:59], v12 offset:50176
v_mfma_f32_16x16x32_bf16 v[116:119], a[104:107], a[16:19], v[116:119]
v_mfma_f32_16x16x32_bf16 v[116:119], a[108:111], a[20:23], v[116:119]
ds_read_b64_tr_b16 a[60:61], v12 offset:57344
v_mfma_f32_16x16x32_bf16 v[148:151], a[108:111], a[28:31], v[148:151]
buffer_load_dwordx4 v4, s[4:7], s20 offen offset:3072 lds
v_mfma_f32_16x16x32_bf16 v[148:151], a[104:107], a[24:27], v[148:151]
ds_read_b64_tr_b16 a[62:63], v12 offset:58368
v_mfma_f32_16x16x32_bf16 v[56:59], a[112:115], a[0:3], v[56:59]
s_add_u32 s20, s20, 128
v_mfma_f32_16x16x32_bf16 v[56:59], a[116:119], a[4:7], v[56:59]
v_mfma_f32_16x16x32_bf16 v[88:91], a[116:119], a[12:15], v[88:91]
global_load_dword v31, v[18:19], off
v_mfma_f32_16x16x32_bf16 v[88:91], a[112:115], a[8:11], v[88:91]
v_mfma_f32_16x16x32_bf16 v[120:123], a[112:115], a[16:19], v[120:123]
v_mfma_f32_16x16x32_bf16 v[120:123], a[116:119], a[20:23], v[120:123]
v_mfma_f32_16x16x32_bf16 v[152:155], a[116:119], a[28:31], v[152:155]
v_mfma_f32_16x16x32_bf16 v[152:155], a[112:115], a[24:27], v[152:155]
v_mfma_f32_16x16x32_bf16 v[60:63], a[120:123], a[0:3], v[60:63]
v_mfma_f32_16x16x32_bf16 v[60:63], a[124:127], a[4:7], v[60:63]
v_mfma_f32_16x16x32_bf16 v[92:95], a[124:127], a[12:15], v[92:95]
v_mfma_f32_16x16x32_bf16 v[92:95], a[120:123], a[8:11], v[92:95]
v_mfma_f32_16x16x32_bf16 v[124:127], a[120:123], a[16:19], v[124:127]
v_mfma_f32_16x16x32_bf16 v[124:127], a[124:127], a[20:23], v[124:127]
v_mfma_f32_16x16x32_bf16 v[156:159], a[124:127], a[28:31], v[156:159]
s_waitcnt vmcnt(18) lgkmcnt(0)
v_mfma_f32_16x16x32_bf16 v[156:159], a[120:123], a[24:27], v[156:159]
s_barrier
L_k1L_p3:
v_mfma_f32_16x16x32_bf16 v[176:179], a[96:99], a[32:35], v[176:179]
s_add_u32 s24, s23, s27
s_add_u32 s23, s23, 32768
s_cmp_eq_u32 s23, 98304
v_mfma_f32_16x16x32_bf16 v[176:179], a[100:103], a[36:39], v[176:179]
ds_read_b64_tr_b16 a[0:1], v9 offset:0
v_mfma_f32_16x16x32_bf16 v[208:211], a[100:103], a[44:47], v[208:211]
s_cselect_b32 s23, 0, s23
s_add_u32 m0, s25, 49152
v_mfma_f32_16x16x32_bf16 v[208:211], a[96:99], a[40:43], v[208:211]
ds_read_b64_tr_b16 a[2:3], v9 offset:1024
v_mfma_f32_16x16x32_bf16 v[240:243], a[96:99], a[48:51], v[240:243]
buffer_load_dwordx4 v5, s[8:11], s21 offen offset:0 lds
v_mfma_f32_16x16x32_bf16 v[240:243], a[100:103], a[52:55], v[240:243]
ds_read_b64_tr_b16 a[4:5], v9 offset:8192
v_mfma_f32_16x16x32_bf16 a[144:147], a[100:103], a[60:63], a[144:147]
v_add_u32 v15, s23, v13
v_xor_b32 v14, 64, v15
v_mfma_f32_16x16x32_bf16 a[144:147], a[96:99], a[56:59], a[144:147]
ds_read_b64_tr_b16 a[6:7], v9 offset:9216
v_mfma_f32_16x16x32_bf16 v[180:183], a[104:107], a[32:35], v[180:183]
s_bitcmp1_b32 s83, s3
s_cselect_b64 s[44:45], -1, 0
v_mfma_f32_16x16x32_bf16 v[180:183], a[108:111], a[36:39], v[180:183]
ds_read_b64_tr_b16 a[8:9], v10 offset:0
v_mfma_f32_16x16x32_bf16 v[212:215], a[108:111], a[44:47], v[212:215]
buffer_load_dwordx4 v6, s[8:11], s21 offen offset:1024 lds
v_mfma_f32_16x16x32_bf16 v[212:215], a[104:107], a[40:43], v[212:215]
ds_read_b64_tr_b16 a[10:11], v10 offset:1024
v_mfma_f32_16x16x32_bf16 v[244:247], a[104:107], a[48:51], v[244:247]
v_cndmask_b32 v18, v20, v22, s[44:45]
v_cndmask_b32 v19, v21, v23, s[44:45]
v_mfma_f32_16x16x32_bf16 v[244:247], a[108:111], a[52:55], v[244:247]
ds_read_b64_tr_b16 a[12:13], v10 offset:8192
v_mfma_f32_16x16x32_bf16 a[148:151], a[108:111], a[60:63], a[148:151]
v_cndmask_b32 v22, v22, v24, s[44:45]
v_cndmask_b32 v23, v23, v25, s[44:45]
v_mfma_f32_16x16x32_bf16 a[148:151], a[104:107], a[56:59], a[148:151]
ds_read_b64_tr_b16 a[14:15], v10 offset:9216
v_mfma_f32_16x16x32_bf16 v[184:187], a[112:115], a[32:35], v[184:187]
buffer_load_dwordx4 v7, s[8:11], s21 offen offset:2048 lds
v_mfma_f32_16x16x32_bf16 v[184:187], a[116:119], a[36:39], v[184:187]
ds_read_b64_tr_b16 a[16:17], v11 offset:0
v_mfma_f32_16x16x32_bf16 v[216:219], a[116:119], a[44:47], v[216:219]
v_cndmask_b32 v24, v24, v26, s[44:45]
v_cndmask_b32 v25, v25, v27, s[44:45]
v_mfma_f32_16x16x32_bf16 v[216:219], a[112:115], a[40:43], v[216:219]
ds_read_b64_tr_b16 a[18:19], v11 offset:1024
v_mfma_f32_16x16x32_bf16 v[248:251], a[112:115], a[48:51], v[248:251]
s_cmp_eq_u32 s26, 6
s_cbranch_scc1 L_k1L_swA
L_k1L_backA:
v_mfma_f32_16x16x32_bf16 v[248:251], a[116:119], a[52:55], v[248:251]
ds_read_b64_tr_b16 a[20:21], v11 offset:8192
v_mfma_f32_16x16x32_bf16 a[152:155], a[116:119], a[60:63], a[152:155]
buffer_load_dwordx4 v8, s[8:11], s21 offen offset:3072 lds
v_mfma_f32_16x16x32_bf16 a[152:155], a[112:115], a[56:59], a[152:155]
ds_read_b64_tr_b16 a[22:23], v11 offset:9216
v_mfma_f32_16x16x32_bf16 v[188:191], a[120:123], a[32:35], v[188:191]
s_xor_b64 s[8:9], s[8:9], s[80:81]
s_add_u32 s21, s21, s22
v_mfma_f32_16x16x32_bf16 v[188:191], a[124:127], a[36:39], v[188:191]
ds_read_b64_tr_b16 a[24:25], v12 offset:0
v_mfma_f32_16x16x32_bf16 v[220:223], a[124:127], a[44:47], v[220:223]
s_add_u32 m0, s24, 0
v_mfma_f32_16x16x32_bf16 v[220:223], a[120:123], a[40:43], v[220:223]
ds_read_b64_tr_b16 a[26:27], v12 offset:1024
v_mfma_f32_16x16x32_bf16 v[252:255], a[120:123], a[48:51], v[252:255]
buffer_load_dwordx4 v1, s[4:7], s19 offen offset:0 lds
v_mfma_f32_16x16x32_bf16 v[252:255], a[124:127], a[52:55], v[252:255]
ds_read_b64_tr_b16 a[28:29], v12 offset:8192
v_mfma_f32_16x16x32_bf16 a[156:159], a[124:127], a[60:63], a[156:159]
v_cndmask_b32 v26, v26, v28, s[44:45]
v_cndmask_b32 v27, v27, v29, s[44:45]
v_mfma_f32_16x16x32_bf16 a[156:159], a[120:123], a[56:59], a[156:159]
ds_read_b64_tr_b16 a[30:31], v12 offset:9216
v_mfma_f32_16x16x32_bf16 v[160:163], a[64:67], a[32:35], v[160:163]
s_cmp_eq_u32 s3, s46
s_cbranch_scc1 L_pf1091_do
L_pf1091_back:
v_mfma_f32_16x16x32_bf16 v[160:163], a[68:71], a[36:39], v[160:163]
ds_read_b128 a[96:99], v15 offset:8192
v_mfma_f32_16x16x32_bf16 v[192:195], a[68:71], a[44:47], v[192:195]
buffer_load_dwordx4 v2, s[4:7], s19 offen offset:1024 lds
v_mfma_f32_16x16x32_bf16 v[192:195], a[64:67], a[40:43], v[192:195]
ds_read_b128 a[100:103], v14 offset:8192
v_mfma_f32_16x16x32_bf16 v[224:227], a[64:67], a[48:51], v[224:227]
s_add_u32 s3, s3, 1
v_mfma_f32_16x16x32_bf16 v[224:227], a[68:71], a[52:55], v[224:227]
ds_read_b128 a[104:107], v15 offset:10240
v_mfma_f32_16x16x32_bf16 a[128:131], a[68:71], a[60:63], a[128:131]
v_mfma_f32_16x16x32_bf16 a[128:131], a[64:67], a[56:59], a[128:131]
ds_read_b128 a[108:111], v14 offset:10240
v_mfma_f32_16x16x32_bf16 v[164:167], a[72:75], a[32:35], v[164:167]
buffer_load_dwordx4 v3, s[4:7], s19 offen offset:2048 lds
v_mfma_f32_16x16x32_bf16 v[164:167], a[76:79], a[36:39], v[164:167]
ds_read_b128 a[112:115], v15 offset:12288
v_mfma_f32_16x16x32_bf16 v[196:199], a[76:79], a[44:47], v[196:199]
v_mfma_f32_16x16x32_bf16 v[196:199], a[72:75], a[40:43], v[196:199]
ds_read_b128 a[116:119], v14 offset:12288
v_mfma_f32_16x16x32_bf16 v[228:231], a[72:75], a[48:51], v[228:231]
v_mfma_f32_16x16x32_bf16 v[228:231], a[76:79], a[52:55], v[228:231]
ds_read_b128 a[120:123], v15 offset:14336
v_mfma_f32_16x16x32_bf16 a[132:135], a[76:79], a[60:63], a[132:135]
buffer_load_dwordx4 v4, s[4:7], s19 offen offset:3072 lds
v_mfma_f32_16x16x32_bf16 a[132:135], a[72:75], a[56:59], a[132:135]
ds_read_b128 a[124:127], v14 offset:14336
v_mfma_f32_16x16x32_bf16 v[168:171], a[80:83], a[32:35], v[168:171]
s_add_u32 s19, s19, 128
v_mfma_f32_16x16x32_bf16 v[168:171], a[84:87], a[36:39], v[168:171]
v_mfma_f32_16x16x32_bf16 v[200:203], a[84:87], a[44:47], v[200:203]
global_load_dword v31, v[18:19], off
v_mfma_f32_16x16x32_bf16 v[200:203], a[80:83], a[40:43], v[200:203]
v_mfma_f32_16x16x32_bf16 v[232:235], a[80:83], a[48:51], v[232:235]
s_add_u32 s26, s26, 1
v_mfma_f32_16x16x32_bf16 v[232:235], a[84:87], a[52:55], v[232:235]
v_mfma_f32_16x16x32_bf16 a[136:139], a[84:87], a[60:63], a[136:139]
s_cmp_le_u32 s26, 7
v_mfma_f32_16x16x32_bf16 a[136:139], a[80:83], a[56:59], a[136:139]
v_mfma_f32_16x16x32_bf16 v[172:175], a[88:91], a[32:35], v[172:175]
v_mfma_f32_16x16x32_bf16 v[172:175], a[92:95], a[36:39], v[172:175]
v_mfma_f32_16x16x32_bf16 v[204:207], a[92:95], a[44:47], v[204:207]
v_mfma_f32_16x16x32_bf16 v[204:207], a[88:91], a[40:43], v[204:207]
v_mfma_f32_16x16x32_bf16 v[236:239], a[88:91], a[48:51], v[236:239]
v_mfma_f32_16x16x32_bf16 v[236:239], a[92:95], a[52:55], v[236:239]
v_mfma_f32_16x16x32_bf16 a[140:143], a[92:95], a[60:63], a[140:143]
s_waitcnt vmcnt(18) lgkmcnt(0)
v_mfma_f32_16x16x32_bf16 a[140:143], a[88:91], a[56:59], a[140:143]
s_barrier
s_cbranch_scc1 L_k1L_p0
L_k1L_done:
s_cmp_ge_u32 s70, 14
s_cbranch_scc1 L_k1_side
s_nop 7
s_add_u32 m0, s25, 0
s_nop 0
buffer_load_dwordx4 v5, s[8:11], s21 offen offset:0 lds
v_cvt_pk_bf16_f32 v32, v32, v33
v_cvt_pk_bf16_f32 v33, v34, v35
v_cvt_pk_bf16_f32 v34, v36, v37
v_cvt_pk_bf16_f32 v35, v38, v39
v_accvgpr_write_b32 a160, v32
v_accvgpr_write_b32 a161, v33
v_accvgpr_write_b32 a162, v34
v_accvgpr_write_b32 a163, v35
v_cvt_pk_bf16_f32 v64, v64, v65
v_cvt_pk_bf16_f32 v65, v66, v67
v_cvt_pk_bf16_f32 v66, v68, v69
v_cvt_pk_bf16_f32 v67, v70, v71
v_accvgpr_write_b32 a164, v64
v_accvgpr_write_b32 a165, v65
v_accvgpr_write_b32 a166, v66
v_accvgpr_write_b32 a167, v67
v_cvt_pk_bf16_f32 v96, v96, v97
v_cvt_pk_bf16_f32 v97, v98, v99
v_cvt_pk_bf16_f32 v98, v100, v101
v_cvt_pk_bf16_f32 v99, v102, v103
s_add_u32 s30, s28, 0
buffer_store_dwordx4 v[96:99], v16, s[12:15], s30 offen offset:2048 sc0 sc1
v_cvt_pk_bf16_f32 v128, v128, v129
v_cvt_pk_bf16_f32 v129, v130, v131
v_cvt_pk_bf16_f32 v130, v132, v133
v_cvt_pk_bf16_f32 v131, v134, v135
v_accvgpr_write_b32 a168, v128
v_accvgpr_write_b32 a169, v129
v_accvgpr_write_b32 a170, v130
v_accvgpr_write_b32 a171, v131
buffer_load_dwordx4 v6, s[8:11], s21 offen offset:1024 lds
v_cvt_pk_bf16_f32 v160, v160, v161
v_cvt_pk_bf16_f32 v161, v162, v163
v_cvt_pk_bf16_f32 v162, v164, v165
v_cvt_pk_bf16_f32 v163, v166, v167
v_accvgpr_write_b32 a172, v160
v_accvgpr_write_b32 a173, v161
v_accvgpr_write_b32 a174, v162
v_accvgpr_write_b32 a175, v163
v_cvt_pk_bf16_f32 v192, v192, v193
v_cvt_pk_bf16_f32 v193, v194, v195
v_cvt_pk_bf16_f32 v194, v196, v197
v_cvt_pk_bf16_f32 v195, v198, v199
v_accvgpr_write_b32 a176, v192
v_accvgpr_write_b32 a177, v193
v_accvgpr_write_b32 a178, v194
v_accvgpr_write_b32 a179, v195
v_cvt_pk_bf16_f32 v224, v224, v225
v_cvt_pk_bf16_f32 v225, v226, v227
v_cvt_pk_bf16_f32 v226, v228, v229
v_cvt_pk_bf16_f32 v227, v230, v231
s_add_u32 s30, s28, 8192
buffer_store_dwordx4 v[224:227], v16, s[12:15], s30 offen offset:2048 sc0 sc1
v_accvgpr_read_b32 v36, a128
v_accvgpr_read_b32 v37, a129
v_accvgpr_read_b32 v38, a130
v_accvgpr_read_b32 v39, a131
v_accvgpr_read_b32 v68, a132
v_accvgpr_read_b32 v69, a133
v_accvgpr_read_b32 v70, a134
v_accvgpr_read_b32 v71, a135
v_cvt_pk_bf16_f32 v36, v36, v37
v_cvt_pk_bf16_f32 v37, v38, v39
v_cvt_pk_bf16_f32 v38, v68, v69
v_cvt_pk_bf16_f32 v39, v70, v71
v_accvgpr_write_b32 a180, v36
v_accvgpr_write_b32 a181, v37
v_accvgpr_write_b32 a182, v38
v_accvgpr_write_b32 a183, v39
buffer_load_dwordx4 v7, s[8:11], s21 offen offset:2048 lds
v_cvt_pk_bf16_f32 v40, v40, v41
v_cvt_pk_bf16_f32 v41, v42, v43
v_cvt_pk_bf16_f32 v42, v44, v45
v_cvt_pk_bf16_f32 v43, v46, v47
v_accvgpr_write_b32 a184, v40
v_accvgpr_write_b32 a185, v41
v_accvgpr_write_b32 a186, v42
v_accvgpr_write_b32 a187, v43
v_cvt_pk_bf16_f32 v72, v72, v73
v_cvt_pk_bf16_f32 v73, v74, v75
v_cvt_pk_bf16_f32 v74, v76, v77
v_cvt_pk_bf16_f32 v75, v78, v79
v_accvgpr_write_b32 a188, v72
v_accvgpr_write_b32 a189, v73
v_accvgpr_write_b32 a190, v74
v_accvgpr_write_b32 a191, v75
v_cvt_pk_bf16_f32 v104, v104, v105
v_cvt_pk_bf16_f32 v105, v106, v107
v_cvt_pk_bf16_f32 v106, v108, v109
v_cvt_pk_bf16_f32 v107, v110, v111
s_add_u32 s30, s28, 16384
buffer_store_dwordx4 v[104:107], v16, s[12:15], s30 offen offset:2048 sc0 sc1
v_cvt_pk_bf16_f32 v136, v136, v137
v_cvt_pk_bf16_f32 v137, v138, v139
v_cvt_pk_bf16_f32 v138, v140, v141
v_cvt_pk_bf16_f32 v139, v142, v143
v_accvgpr_write_b32 a192, v136
v_accvgpr_write_b32 a193, v137
v_accvgpr_write_b32 a194, v138
v_accvgpr_write_b32 a195, v139
buffer_load_dwordx4 v8, s[8:11], s21 offen offset:3072 lds
v_cvt_pk_bf16_f32 v168, v168, v169
v_cvt_pk_bf16_f32 v169, v170, v171
v_cvt_pk_bf16_f32 v170, v172, v173
v_cvt_pk_bf16_f32 v171, v174, v175
v_accvgpr_write_b32 a196, v168
v_accvgpr_write_b32 a197, v169
v_accvgpr_write_b32 a198, v170
v_accvgpr_write_b32 a199, v171
v_cvt_pk_bf16_f32 v200, v200, v201
v_cvt_pk_bf16_f32 v201, v202, v203
v_cvt_pk_bf16_f32 v202, v204, v205
v_cvt_pk_bf16_f32 v203, v206, v207
v_accvgpr_write_b32 a200, v200
v_accvgpr_write_b32 a201, v201
v_accvgpr_write_b32 a202, v202
v_accvgpr_write_b32 a203, v203
v_cvt_pk_bf16_f32 v232, v232, v233
v_cvt_pk_bf16_f32 v233, v234, v235
v_cvt_pk_bf16_f32 v234, v236, v237
v_cvt_pk_bf16_f32 v235, v238, v239
s_add_u32 s30, s28, 24576
buffer_store_dwordx4 v[232:235], v16, s[12:15], s30 offen offset:2048 sc0 sc1
v_accvgpr_read_b32 v44, a136
v_accvgpr_read_b32 v45, a137
v_accvgpr_read_b32 v46, a138
v_accvgpr_read_b32 v47, a139
v_accvgpr_read_b32 v76, a140
v_accvgpr_read_b32 v77, a141
v_accvgpr_read_b32 v78, a142
v_accvgpr_read_b32 v79, a143
v_cvt_pk_bf16_f32 v44, v44, v45
v_cvt_pk_bf16_f32 v45, v46, v47
v_cvt_pk_bf16_f32 v46, v76, v77
v_cvt_pk_bf16_f32 v47, v78, v79
v_accvgpr_write_b32 a204, v44
v_accvgpr_write_b32 a205, v45
v_accvgpr_write_b32 a206, v46
v_accvgpr_write_b32 a207, v47
s_xor_b64 s[8:9], s[8:9], s[80:81]
s_add_u32 m0, s24, 4096
s_nop 0
buffer_load_dwordx4 v1, s[4:7], s20 offen offset:0 lds
v_cvt_pk_bf16_f32 v48, v48, v49
v_cvt_pk_bf16_f32 v49, v50, v51
v_cvt_pk_bf16_f32 v50, v52, v53
v_cvt_pk_bf16_f32 v51, v54, v55
v_accvgpr_write_b32 a208, v48
v_accvgpr_write_b32 a209, v49
v_accvgpr_write_b32 a210, v50
v_accvgpr_write_b32 a211, v51
v_cvt_pk_bf16_f32 v80, v80, v81
v_cvt_pk_bf16_f32 v81, v82, v83
v_cvt_pk_bf16_f32 v82, v84, v85
v_cvt_pk_bf16_f32 v83, v86, v87
v_accvgpr_write_b32 a212, v80
v_accvgpr_write_b32 a213, v81
v_accvgpr_write_b32 a214, v82
v_accvgpr_write_b32 a215, v83
v_cvt_pk_bf16_f32 v112, v112, v113
v_cvt_pk_bf16_f32 v113, v114, v115
v_cvt_pk_bf16_f32 v114, v116, v117
v_cvt_pk_bf16_f32 v115, v118, v119
s_add_u32 s30, s28, 32768
buffer_store_dwordx4 v[112:115], v16, s[12:15], s30 offen offset:2048 sc0 sc1
v_cvt_pk_bf16_f32 v144, v144, v145
v_cvt_pk_bf16_f32 v145, v146, v147
v_cvt_pk_bf16_f32 v146, v148, v149
v_cvt_pk_bf16_f32 v147, v150, v151
v_accvgpr_write_b32 a216, v144
v_accvgpr_write_b32 a217, v145
v_accvgpr_write_b32 a218, v146
v_accvgpr_write_b32 a219, v147
buffer_load_dwordx4 v2, s[4:7], s20 offen offset:1024 lds
v_cvt_pk_bf16_f32 v176, v176, v177
v_cvt_pk_bf16_f32 v177, v178, v179
v_cvt_pk_bf16_f32 v178, v180, v181
v_cvt_pk_bf16_f32 v179, v182, v183
v_accvgpr_write_b32 a220, v176
v_accvgpr_write_b32 a221, v177
v_accvgpr_write_b32 a222, v178
v_accvgpr_write_b32 a223, v179
v_cvt_pk_bf16_f32 v208, v208, v209
v_cvt_pk_bf16_f32 v209, v210, v211
v_cvt_pk_bf16_f32 v210, v212, v213
v_cvt_pk_bf16_f32 v211, v214, v215
v_accvgpr_write_b32 a224, v208
v_accvgpr_write_b32 a225, v209
v_accvgpr_write_b32 a226, v210
v_accvgpr_write_b32 a227, v211
v_cvt_pk_bf16_f32 v240, v240, v241
v_cvt_pk_bf16_f32 v241, v242, v243
v_cvt_pk_bf16_f32 v242, v244, v245
v_cvt_pk_bf16_f32 v243, v246, v247
s_add_u32 s30, s28, 40960
buffer_store_dwordx4 v[240:243], v16, s[12:15], s30 offen offset:2048 sc0 sc1
v_accvgpr_read_b32 v52, a144
v_accvgpr_read_b32 v53, a145
v_accvgpr_read_b32 v54, a146
v_accvgpr_read_b32 v55, a147
v_accvgpr_read_b32 v84, a148
v_accvgpr_read_b32 v85, a149
v_accvgpr_read_b32 v86, a150
v_accvgpr_read_b32 v87, a151
v_cvt_pk_bf16_f32 v52, v52, v53
v_cvt_pk_bf16_f32 v53, v54, v55
v_cvt_pk_bf16_f32 v54, v84, v85
v_cvt_pk_bf16_f32 v55, v86, v87
v_accvgpr_write_b32 a228, v52
v_accvgpr_write_b32 a229, v53
v_accvgpr_write_b32 a230, v54
v_accvgpr_write_b32 a231, v55
buffer_load_dwordx4 v3, s[4:7], s20 offen offset:2048 lds
v_cvt_pk_bf16_f32 v56, v56, v57
v_cvt_pk_bf16_f32 v57, v58, v59
v_cvt_pk_bf16_f32 v58, v60, v61
v_cvt_pk_bf16_f32 v59, v62, v63
v_accvgpr_write_b32 a232, v56
v_accvgpr_write_b32 a233, v57
v_accvgpr_write_b32 a234, v58
v_accvgpr_write_b32 a235, v59
v_cvt_pk_bf16_f32 v88, v88, v89
v_cvt_pk_bf16_f32 v89, v90, v91
v_cvt_pk_bf16_f32 v90, v92, v93
v_cvt_pk_bf16_f32 v91, v94, v95
v_accvgpr_write_b32 a236, v88
v_accvgpr_write_b32 a237, v89
v_accvgpr_write_b32 a238, v90
v_accvgpr_write_b32 a239, v91
v_cvt_pk_bf16_f32 v120, v120, v121
v_cvt_pk_bf16_f32 v121, v122, v123
v_cvt_pk_bf16_f32 v122, v124, v125
v_cvt_pk_bf16_f32 v123, v126, v127
s_add_u32 s30, s28, 49152
buffer_store_dwordx4 v[120:123], v16, s[12:15], s30 offen offset:2048 sc0 sc1
v_cvt_pk_bf16_f32 v152, v152, v153
v_cvt_pk_bf16_f32 v153, v154, v155
v_cvt_pk_bf16_f32 v154, v156, v157
v_cvt_pk_bf16_f32 v155, v158, v159
v_accvgpr_write_b32 a240, v152
v_accvgpr_write_b32 a241, v153
v_accvgpr_write_b32 a242, v154
v_accvgpr_write_b32 a243, v155
buffer_load_dwordx4 v4, s[4:7], s20 offen offset:3072 lds
s_add_u32 s20, s20, 128
v_cvt_pk_bf16_f32 v184, v184, v185
v_cvt_pk_bf16_f32 v185, v186, v187
v_cvt_pk_bf16_f32 v186, v188, v189
v_cvt_pk_bf16_f32 v187, v190, v191
v_accvgpr_write_b32 a244, v184
v_accvgpr_write_b32 a245, v185
v_accvgpr_write_b32 a246, v186
v_accvgpr_write_b32 a247, v187
v_cvt_pk_bf16_f32 v216, v216, v217
v_cvt_pk_bf16_f32 v217, v218, v219
v_cvt_pk_bf16_f32 v218, v220, v221
v_cvt_pk_bf16_f32 v219, v222, v223
v_accvgpr_write_b32 a248, v216
v_accvgpr_write_b32 a249, v217
v_accvgpr_write_b32 a250, v218
v_accvgpr_write_b32 a251, v219
v_cvt_pk_bf16_f32 v248, v248, v249
v_cvt_pk_bf16_f32 v249, v250, v251
v_cvt_pk_bf16_f32 v250, v252, v253
v_cvt_pk_bf16_f32 v251, v254, v255
s_add_u32 s30, s28, 57344
buffer_store_dwordx4 v[248:251], v16, s[12:15], s30 offen offset:2048 sc0 sc1
v_accvgpr_read_b32 v60, a152
v_accvgpr_read_b32 v61, a153
v_accvgpr_read_b32 v62, a154
v_accvgpr_read_b32 v63, a155
v_accvgpr_read_b32 v92, a156
v_accvgpr_read_b32 v93, a157
v_accvgpr_read_b32 v94, a158
v_accvgpr_read_b32 v95, a159
v_cvt_pk_bf16_f32 v60, v60, v61
v_cvt_pk_bf16_f32 v61, v62, v63
v_cvt_pk_bf16_f32 v62, v92, v93
v_cvt_pk_bf16_f32 v63, v94, v95
v_accvgpr_write_b32 a252, v60
v_accvgpr_write_b32 a253, v61
v_accvgpr_write_b32 a254, v62
v_accvgpr_write_b32 a255, v63
s_nop 1
v_mfma_f32_16x16x32_bf16 v[48:51], a[0:3], a[96:99], 0
v_mfma_f32_16x16x32_bf16 v[48:51], a[4:7], a[100:103], v[48:51]
ds_read_b128 a[64:67], v15 offset:0
v_mfma_f32_16x16x32_bf16 v[52:55], a[4:7], a[108:111], 0
v_mfma_f32_16x16x32_bf16 v[52:55], a[0:3], a[104:107], v[52:55]
ds_read_b128 a[68:71], v14 offset:0
v_mfma_f32_16x16x32_bf16 v[56:59], a[0:3], a[112:115], 0
v_mfma_f32_16x16x32_bf16 v[56:59], a[4:7], a[116:119], v[56:59]
ds_read_b128 a[72:75], v15 offset:2048
v_mfma_f32_16x16x32_bf16 v[60:63], a[4:7], a[124:127], 0
v_mfma_f32_16x16x32_bf16 v[60:63], a[0:3], a[120:123], v[60:63]
ds_read_b128 a[76:79], v14 offset:2048
v_mfma_f32_16x16x32_bf16 v[80:83], a[8:11], a[96:99], 0
v_mfma_f32_16x16x32_bf16 v[80:83], a[12:15], a[100:103], v[80:83]
ds_read_b128 a[80:83], v15 offset:4096
v_mfma_f32_16x16x32_bf16 v[84:87], a[12:15], a[108:111], 0
v_mfma_f32_16x16x32_bf16 v[84:87], a[8:11], a[104:107], v[84:87]
ds_read_b128 a[84:87], v14 offset:4096
v_mfma_f32_16x16x32_bf16 v[88:91], a[8:11], a[112:115], 0
s_add_u32 s30, s28, 0
v_mfma_f32_16x16x32_bf16 v[88:91], a[12:15], a[116:119], v[88:91]
ds_read_b128 a[88:91], v15 offset:6144
v_mfma_f32_16x16x32_bf16 v[92:95], a[12:15], a[124:127], 0
buffer_store_dwordx4 a[160:163], v16, s[12:15], s30 offen offset:0 sc0 sc1
v_mfma_f32_16x16x32_bf16 v[92:95], a[8:11], a[120:123], v[92:95]
ds_read_b128 a[92:95], v14 offset:6144
v_mfma_f32_16x16x32_bf16 v[112:115], a[16:19], a[96:99], 0
v_mfma_f32_16x16x32_bf16 v[112:115], a[20:23], a[100:103], v[112:115]
ds_read_b64_tr_b16 a[32:33], v9 offset:16384
v_mfma_f32_16x16x32_bf16 v[116:119], a[20:23], a[108:111], 0
v_mfma_f32_16x16x32_bf16 v[116:119], a[16:19], a[104:107], v[116:119]
ds_read_b64_tr_b16 a[34:35], v9 offset:17408
v_mfma_f32_16x16x32_bf16 v[120:123], a[16:19], a[112:115], 0
v_mfma_f32_16x16x32_bf16 v[120:123], a[20:23], a[116:119], v[120:123]
ds_read_b64_tr_b16 a[36:37], v9 offset:24576
v_mfma_f32_16x16x32_bf16 v[124:127], a[20:23], a[124:127], 0
v_mfma_f32_16x16x32_bf16 v[124:127], a[16:19], a[120:123], v[124:127]
ds_read_b64_tr_b16 a[38:39], v9 offset:25600
v_mfma_f32_16x16x32_bf16 v[144:147], a[24:27], a[96:99], 0
v_mfma_f32_16x16x32_bf16 v[144:147], a[28:31], a[100:103], v[144:147]
ds_read_b64_tr_b16 a[40:41], v10 offset:16384
v_mfma_f32_16x16x32_bf16 v[148:151], a[28:31], a[108:111], 0
v_mfma_f32_16x16x32_bf16 v[148:151], a[24:27], a[104:107], v[148:151]
ds_read_b64_tr_b16 a[42:43], v10 offset:17408
v_mfma_f32_16x16x32_bf16 v[152:155], a[24:27], a[112:115], 0
v_mfma_f32_16x16x32_bf16 v[152:155], a[28:31], a[116:119], v[152:155]
ds_read_b64_tr_b16 a[44:45], v10 offset:24576
v_mfma_f32_16x16x32_bf16 v[156:159], a[28:31], a[124:127], 0
v_mfma_f32_16x16x32_bf16 v[156:159], a[24:27], a[120:123], v[156:159]
ds_read_b64_tr_b16 a[46:47], v10 offset:25600
s_waitcnt lgkmcnt(8)
v_mfma_f32_16x16x32_bf16 v[32:35], a[0:3], a[64:67], 0
v_mfma_f32_16x16x32_bf16 v[32:35], a[4:7], a[68:71], v[32:35]
ds_read_b64_tr_b16 a[48:49], v11 offset:16384
v_mfma_f32_16x16x32_bf16 v[36:39], a[4:7], a[76:79], 0
v_mfma_f32_16x16x32_bf16 v[36:39], a[0:3], a[72:75], v[36:39]
ds_read_b64_tr_b16 a[50:51], v11 offset:17408
v_mfma_f32_16x16x32_bf16 v[40:43], a[0:3], a[80:83], 0
s_add_u32 s30, s28, 0
v_mfma_f32_16x16x32_bf16 v[40:43], a[4:7], a[84:87], v[40:43]
ds_read_b64_tr_b16 a[52:53], v11 offset:24576
v_mfma_f32_16x16x32_bf16 v[44:47], a[4:7], a[92:95], 0
buffer_store_dwordx4 a[164:167], v16, s[12:15], s30 offen offset:1024 sc0 sc1
v_mfma_f32_16x16x32_bf16 v[44:47], a[0:3], a[88:91], v[44:47]
ds_read_b64_tr_b16 a[54:55], v11 offset:25600
v_mfma_f32_16x16x32_bf16 v[64:67], a[8:11], a[64:67], 0
v_mfma_f32_16x16x32_bf16 v[64:67], a[12:15], a[68:71], v[64:67]
ds_read_b64_tr_b16 a[56:57], v12 offset:16384
v_mfma_f32_16x16x32_bf16 v[68:71], a[12:15], a[76:79], 0
v_mfma_f32_16x16x32_bf16 v[68:71], a[8:11], a[72:75], v[68:71]
ds_read_b64_tr_b16 a[58:59], v12 offset:17408
v_mfma_f32_16x16x32_bf16 v[72:75], a[8:11], a[80:83], 0
v_mfma_f32_16x16x32_bf16 v[72:75], a[12:15], a[84:87], v[72:75]
ds_read_b64_tr_b16 a[60:61], v12 offset:24576
v_mfma_f32_16x16x32_bf16 v[76:79], a[12:15], a[92:95], 0
v_mfma_f32_16x16x32_bf16 v[76:79], a[8:11], a[88:91], v[76:79]
ds_read_b64_tr_b16 a[62:63], v12 offset:25600
v_mfma_f32_16x16x32_bf16 v[96:99], a[16:19], a[64:67], 0
v_mfma_f32_16x16x32_bf16 v[96:99], a[20:23], a[68:71], v[96:99]
v_mfma_f32_16x16x32_bf16 v[100:103], a[20:23], a[76:79], 0
v_mfma_f32_16x16x32_bf16 v[100:103], a[16:19], a[72:75], v[100:103]
v_mfma_f32_16x16x32_bf16 v[104:107], a[16:19], a[80:83], 0
v_mfma_f32_16x16x32_bf16 v[104:107], a[20:23], a[84:87], v[104:107]
v_mfma_f32_16x16x32_bf16 v[108:111], a[20:23], a[92:95], 0
s_add_u32 s30, s28, 0
v_mfma_f32_16x16x32_bf16 v[108:111], a[16:19], a[88:91], v[108:111]
v_mfma_f32_16x16x32_bf16 v[128:131], a[24:27], a[64:67], 0
buffer_store_dwordx4 a[168:171], v16, s[12:15], s30 offen offset:3072 sc0 sc1
v_mfma_f32_16x16x32_bf16 v[128:131], a[28:31], a[68:71], v[128:131]
v_mfma_f32_16x16x32_bf16 v[132:135], a[28:31], a[76:79], 0
v_mfma_f32_16x16x32_bf16 v[132:135], a[24:27], a[72:75], v[132:135]
v_mfma_f32_16x16x32_bf16 v[136:139], a[24:27], a[80:83], 0
v_mfma_f32_16x16x32_bf16 v[136:139], a[28:31], a[84:87], v[136:139]
v_mfma_f32_16x16x32_bf16 v[140:143], a[28:31], a[92:95], 0
s_waitcnt vmcnt(27) lgkmcnt(0)
v_mfma_f32_16x16x32_bf16 v[140:143], a[24:27], a[88:91], v[140:143]
s_barrier
v_mfma_f32_16x16x32_bf16 v[160:163], a[32:35], a[64:67], 0
s_add_u32 s24, s23, s27
s_add_u32 s23, s23, 32768
s_cmp_eq_u32 s23, 98304
v_mfma_f32_16x16x32_bf16 v[160:163], a[36:39], a[68:71], v[160:163]
ds_read_b64_tr_b16 a[0:1], v9 offset:32768
v_mfma_f32_16x16x32_bf16 v[164:167], a[36:39], a[76:79], 0
s_cselect_b32 s23, 0, s23
s_add_u32 m0, s25, 16384
v_mfma_f32_16x16x32_bf16 v[164:167], a[32:35], a[72:75], v[164:167]
ds_read_b64_tr_b16 a[2:3], v9 offset:33792
v_mfma_f32_16x16x32_bf16 v[168:171], a[32:35], a[80:83], 0
buffer_load_dwordx4 v5, s[8:11], s21 offen offset:0 lds
v_mfma_f32_16x16x32_bf16 v[168:171], a[36:39], a[84:87], v[168:171]
ds_read_b64_tr_b16 a[4:5], v9 offset:40960
v_mfma_f32_16x16x32_bf16 v[172:175], a[36:39], a[92:95], 0
v_add_u32 v15, s23, v13
v_xor_b32 v14, 64, v15
v_mfma_f32_16x16x32_bf16 v[172:175], a[32:35], a[88:91], v[172:175]
ds_read_b64_tr_b16 a[6:7], v9 offset:41984
v_mfma_f32_16x16x32_bf16 v[192:195], a[40:43], a[64:67], 0
v_mfma_f32_16x16x32_bf16 v[192:195], a[44:47], a[68:71], v[192:195]
ds_read_b64_tr_b16 a[8:9], v10 offset:32768
v_mfma_f32_16x16x32_bf16 v[196:199], a[44:47], a[76:79], 0
buffer_load_dwordx4 v6, s[8:11], s21 offen offset:1024 lds
v_mfma_f32_16x16x32_bf16 v[196:199], a[40:43], a[72:75], v[196:199]
ds_read_b64_tr_b16 a[10:11], v10 offset:33792
v_mfma_f32_16x16x32_bf16 v[200:203], a[40:43], a[80:83], 0
s_add_u32 s30, s28, 8192
v_mfma_f32_16x16x32_bf16 v[200:203], a[44:47], a[84:87], v[200:203]
ds_read_b64_tr_b16 a[12:13], v10 offset:40960
v_mfma_f32_16x16x32_bf16 v[204:207], a[44:47], a[92:95], 0
buffer_store_dwordx4 a[172:175], v16, s[12:15], s30 offen offset:0 sc0 sc1
v_mfma_f32_16x16x32_bf16 v[204:207], a[40:43], a[88:91], v[204:207]
ds_read_b64_tr_b16 a[14:15], v10 offset:41984
v_mfma_f32_16x16x32_bf16 v[224:227], a[48:51], a[64:67], 0
buffer_load_dwordx4 v7, s[8:11], s21 offen offset:2048 lds
v_mfma_f32_16x16x32_bf16 v[224:227], a[52:55], a[68:71], v[224:227]
ds_read_b64_tr_b16 a[16:17], v11 offset:32768
v_mfma_f32_16x16x32_bf16 v[228:231], a[52:55], a[76:79], 0
v_mfma_f32_16x16x32_bf16 v[228:231], a[48:51], a[72:75], v[228:231]
ds_read_b64_tr_b16 a[18:19], v11 offset:33792
v_mfma_f32_16x16x32_bf16 v[232:235], a[48:51], a[80:83], 0
v_mfma_f32_16x16x32_bf16 v[232:235], a[52:55], a[84:87], v[232:235]
ds_read_b64_tr_b16 a[20:21], v11 offset:40960
v_mfma_f32_16x16x32_bf16 v[236:239], a[52:55], a[92:95], 0
buffer_load_dwordx4 v8, s[8:11], s21 offen offset:3072 lds
v_mfma_f32_16x16x32_bf16 v[236:239], a[48:51], a[88:91], v[236:239]
ds_read_b64_tr_b16 a[22:23], v11 offset:41984
v_mfma_f32_16x16x32_bf16 a[128:131], a[56:59], a[64:67], 0
s_xor_b64 s[8:9], s[8:9], s[80:81]
s_add_u32 s21, s21, s22
v_mfma_f32_16x16x32_bf16 a[128:131], a[60:63], a[68:71], a[128:131]
ds_read_b64_tr_b16 a[24:25], v12 offset:32768
v_mfma_f32_16x16x32_bf16 a[132:135], a[60:63], a[76:79], 0
s_add_u32 m0, s24, 0
v_mfma_f32_16x16x32_bf16 a[132:135], a[56:59], a[72:75], a[132:135]
ds_read_b64_tr_b16 a[26:27], v12 offset:33792
v_mfma_f32_16x16x32_bf16 a[136:139], a[56:59], a[80:83], 0
buffer_load_dwordx4 v1, s[4:7], s19 offen offset:0 lds
v_mfma_f32_16x16x32_bf16 a[136:139], a[60:63], a[84:87], a[136:139]
ds_read_b64_tr_b16 a[28:29], v12 offset:40960
v_mfma_f32_16x16x32_bf16 a[140:143], a[60:63], a[92:95], 0
v_mfma_f32_16x16x32_bf16 a[140:143], a[56:59], a[88:91], a[140:143]
ds_read_b64_tr_b16 a[30:31], v12 offset:41984
v_mfma_f32_16x16x32_bf16 v[176:179], a[32:35], a[96:99], 0
v_mfma_f32_16x16x32_bf16 v[176:179], a[36:39], a[100:103], v[176:179]
ds_read_b128 a[64:67], v15 offset:0
v_mfma_f32_16x16x32_bf16 v[180:183], a[36:39], a[108:111], 0
buffer_load_dwordx4 v2, s[4:7], s19 offen offset:1024 lds
v_mfma_f32_16x16x32_bf16 v[180:183], a[32:35], a[104:107], v[180:183]
ds_read_b128 a[68:71], v14 offset:0
v_mfma_f32_16x16x32_bf16 v[184:187], a[32:35], a[112:115], 0
s_add_u32 s30, s28, 8192
v_mfma_f32_16x16x32_bf16 v[184:187], a[36:39], a[116:119], v[184:187]
ds_read_b128 a[72:75], v15 offset:2048
v_mfma_f32_16x16x32_bf16 v[188:191], a[36:39], a[124:127], 0
buffer_store_dwordx4 a[176:179], v16, s[12:15], s30 offen offset:1024 sc0 sc1
v_mfma_f32_16x16x32_bf16 v[188:191], a[32:35], a[120:123], v[188:191]
ds_read_b128 a[76:79], v14 offset:2048
v_mfma_f32_16x16x32_bf16 v[208:211], a[40:43], a[96:99], 0
buffer_load_dwordx4 v3, s[4:7], s19 offen offset:2048 lds
v_mfma_f32_16x16x32_bf16 v[208:211], a[44:47], a[100:103], v[208:211]
ds_read_b128 a[80:83], v15 offset:4096
v_mfma_f32_16x16x32_bf16 v[212:215], a[44:47], a[108:111], 0
v_mfma_f32_16x16x32_bf16 v[212:215], a[40:43], a[104:107], v[212:215]
ds_read_b128 a[84:87], v14 offset:4096
v_mfma_f32_16x16x32_bf16 v[216:219], a[40:43], a[112:115], 0
v_mfma_f32_16x16x32_bf16 v[216:219], a[44:47], a[116:119], v[216:219]
ds_read_b128 a[88:91], v15 offset:6144
v_mfma_f32_16x16x32_bf16 v[220:223], a[44:47], a[124:127], 0
buffer_load_dwordx4 v4, s[4:7], s19 offen offset:3072 lds
v_mfma_f32_16x16x32_bf16 v[220:223], a[40:43], a[120:123], v[220:223]
ds_read_b128 a[92:95], v14 offset:6144
v_mfma_f32_16x16x32_bf16 v[240:243], a[48:51], a[96:99], 0
s_add_u32 s19, s19, 128
v_mfma_f32_16x16x32_bf16 v[240:243], a[52:55], a[100:103], v[240:243]
v_mfma_f32_16x16x32_bf16 v[244:247], a[52:55], a[108:111], 0
v_mfma_f32_16x16x32_bf16 v[244:247], a[48:51], a[104:107], v[244:247]
v_mfma_f32_16x16x32_bf16 v[248:251], a[48:51], a[112:115], 0
v_mfma_f32_16x16x32_bf16 v[248:251], a[52:55], a[116:119], v[248:251]
v_mfma_f32_16x16x32_bf16 v[252:255], a[52:55], a[124:127], 0
s_add_u32 s30, s28, 8192
v_mfma_f32_16x16x32_bf16 v[252:255], a[48:51], a[120:123], v[252:255]
v_mfma_f32_16x16x32_bf16 a[144:147], a[56:59], a[96:99], 0
buffer_store_dwordx4 a[180:183], v16, s[12:15], s30 offen offset:3072 sc0 sc1
v_mfma_f32_16x16x32_bf16 a[144:147], a[60:63], a[100:103], a[144:147]
v_mfma_f32_16x16x32_bf16 a[148:151], a[60:63], a[108:111], 0
v_mfma_f32_16x16x32_bf16 a[148:151], a[56:59], a[104:107], a[148:151]
v_mfma_f32_16x16x32_bf16 a[152:155], a[56:59], a[112:115], 0
v_mfma_f32_16x16x32_bf16 a[152:155], a[60:63], a[116:119], a[152:155]
v_mfma_f32_16x16x32_bf16 a[156:159], a[60:63], a[124:127], 0
s_waitcnt vmcnt(30) lgkmcnt(0)
v_mfma_f32_16x16x32_bf16 a[156:159], a[56:59], a[120:123], a[156:159]
s_barrier
v_mfma_f32_16x16x32_bf16 v[32:35], a[0:3], a[64:67], v[32:35]
v_mfma_f32_16x16x32_bf16 v[32:35], a[4:7], a[68:71], v[32:35]
ds_read_b128 a[96:99], v15 offset:8192
v_mfma_f32_16x16x32_bf16 v[36:39], a[4:7], a[76:79], v[36:39]
s_add_u32 m0, s25, 32768
v_mfma_f32_16x16x32_bf16 v[36:39], a[0:3], a[72:75], v[36:39]
ds_read_b128 a[100:103], v14 offset:8192
v_mfma_f32_16x16x32_bf16 v[40:43], a[0:3], a[80:83], v[40:43]
buffer_load_dwordx4 v5, s[8:11], s21 offen offset:0 lds
v_mfma_f32_16x16x32_bf16 v[40:43], a[4:7], a[84:87], v[40:43]
ds_read_b128 a[104:107], v15 offset:10240
v_mfma_f32_16x16x32_bf16 v[44:47], a[4:7], a[92:95], v[44:47]
v_mfma_f32_16x16x32_bf16 v[44:47], a[0:3], a[88:91], v[44:47]
ds_read_b128 a[108:111], v14 offset:10240
v_mfma_f32_16x16x32_bf16 v[64:67], a[8:11], a[64:67], v[64:67]
v_mfma_f32_16x16x32_bf16 v[64:67], a[12:15], a[68:71], v[64:67]
ds_read_b128 a[112:115], v15 offset:12288
v_mfma_f32_16x16x32_bf16 v[68:71], a[12:15], a[76:79], v[68:71]
buffer_load_dwordx4 v6, s[8:11], s21 offen offset:1024 lds
v_mfma_f32_16x16x32_bf16 v[68:71], a[8:11], a[72:75], v[68:71]
ds_read_b128 a[116:119], v14 offset:12288
v_mfma_f32_16x16x32_bf16 v[72:75], a[8:11], a[80:83], v[72:75]
s_add_u32 s30, s28, 16384
v_mfma_f32_16x16x32_bf16 v[72:75], a[12:15], a[84:87], v[72:75]
ds_read_b128 a[120:123], v15 offset:14336
v_mfma_f32_16x16x32_bf16 v[76:79], a[12:15], a[92:95], v[76:79]
buffer_store_dwordx4 a[184:187], v16, s[12:15], s30 offen offset:0 sc0 sc1
v_mfma_f32_16x16x32_bf16 v[76:79], a[8:11], a[88:91], v[76:79]
ds_read_b128 a[124:127], v14 offset:14336
v_mfma_f32_16x16x32_bf16 v[96:99], a[16:19], a[64:67], v[96:99]
buffer_load_dwordx4 v7, s[8:11], s21 offen offset:2048 lds
v_mfma_f32_16x16x32_bf16 v[96:99], a[20:23], a[68:71], v[96:99]
ds_read_b64_tr_b16 a[32:33], v9 offset:49152
v_mfma_f32_16x16x32_bf16 v[100:103], a[20:23], a[76:79], v[100:103]
v_mfma_f32_16x16x32_bf16 v[100:103], a[16:19], a[72:75], v[100:103]
ds_read_b64_tr_b16 a[34:35], v9 offset:50176
v_mfma_f32_16x16x32_bf16 v[104:107], a[16:19], a[80:83], v[104:107]
v_mfma_f32_16x16x32_bf16 v[104:107], a[20:23], a[84:87], v[104:107]
ds_read_b64_tr_b16 a[36:37], v9 offset:57344
v_mfma_f32_16x16x32_bf16 v[108:111], a[20:23], a[92:95], v[108:111]
buffer_load_dwordx4 v8, s[8:11], s21 offen offset:3072 lds
v_mfma_f32_16x16x32_bf16 v[108:111], a[16:19], a[88:91], v[108:111]
ds_read_b64_tr_b16 a[38:39], v9 offset:58368
v_mfma_f32_16x16x32_bf16 v[128:131], a[24:27], a[64:67], v[128:131]
s_xor_b64 s[8:9], s[8:9], s[80:81]
v_mfma_f32_16x16x32_bf16 v[128:131], a[28:31], a[68:71], v[128:131]
ds_read_b64_tr_b16 a[40:41], v10 offset:49152
v_mfma_f32_16x16x32_bf16 v[132:135], a[28:31], a[76:79], v[132:135]
s_add_u32 m0, s24, 4096
v_mfma_f32_16x16x32_bf16 v[132:135], a[24:27], a[72:75], v[132:135]
ds_read_b64_tr_b16 a[42:43], v10 offset:50176
v_mfma_f32_16x16x32_bf16 v[136:139], a[24:27], a[80:83], v[136:139]
buffer_load_dwordx4 v1, s[4:7], s20 offen offset:0 lds
v_mfma_f32_16x16x32_bf16 v[136:139], a[28:31], a[84:87], v[136:139]
ds_read_b64_tr_b16 a[44:45], v10 offset:57344
v_mfma_f32_16x16x32_bf16 v[140:143], a[28:31], a[92:95], v[140:143]
v_mfma_f32_16x16x32_bf16 v[140:143], a[24:27], a[88:91], v[140:143]
ds_read_b64_tr_b16 a[46:47], v10 offset:58368
s_waitcnt lgkmcnt(8)
v_mfma_f32_16x16x32_bf16 v[48:51], a[0:3], a[96:99], v[48:51]
v_mfma_f32_16x16x32_bf16 v[48:51], a[4:7], a[100:103], v[48:51]
ds_read_b64_tr_b16 a[48:49], v11 offset:49152
v_mfma_f32_16x16x32_bf16 v[52:55], a[4:7], a[108:111], v[52:55]
buffer_load_dwordx4 v2, s[4:7], s20 offen offset:1024 lds
v_mfma_f32_16x16x32_bf16 v[52:55], a[0:3], a[104:107], v[52:55]
ds_read_b64_tr_b16 a[50:51], v11 offset:50176
v_mfma_f32_16x16x32_bf16 v[56:59], a[0:3], a[112:115], v[56:59]
s_add_u32 s30, s28, 16384
v_mfma_f32_16x16x32_bf16 v[56:59], a[4:7], a[116:119], v[56:59]
ds_read_b64_tr_b16 a[52:53], v11 offset:57344
v_mfma_f32_16x16x32_bf16 v[60:63], a[4:7], a[124:127], v[60:63]
buffer_store_dwordx4 a[188:191], v16, s[12:15], s30 offen offset:1024 sc0 sc1
v_mfma_f32_16x16x32_bf16 v[60:63], a[0:3], a[120:123], v[60:63]
ds_read_b64_tr_b16 a[54:55], v11 offset:58368
v_mfma_f32_16x16x32_bf16 v[80:83], a[8:11], a[96:99], v[80:83]
buffer_load_dwordx4 v3, s[4:7], s20 offen offset:2048 lds
v_mfma_f32_16x16x32_bf16 v[80:83], a[12:15], a[100:103], v[80:83]
ds_read_b64_tr_b16 a[56:57], v12 offset:49152
v_mfma_f32_16x16x32_bf16 v[84:87], a[12:15], a[108:111], v[84:87]
v_mfma_f32_16x16x32_bf16 v[84:87], a[8:11], a[104:107], v[84:87]
ds_read_b64_tr_b16 a[58:59], v12 offset:50176
v_mfma_f32_16x16x32_bf16 v[88:91], a[8:11], a[112:115], v[88:91]
v_mfma_f32_16x16x32_bf16 v[88:91], a[12:15], a[116:119], v[88:91]
ds_read_b64_tr_b16 a[60:61], v12 offset:57344
v_mfma_f32_16x16x32_bf16 v[92:95], a[12:15], a[124:127], v[92:95]
buffer_load_dwordx4 v4, s[4:7], s20 offen offset:3072 lds
v_mfma_f32_16x16x32_bf16 v[92:95], a[8:11], a[120:123], v[92:95]
ds_read_b64_tr_b16 a[62:63], v12 offset:58368
v_mfma_f32_16x16x32_bf16 v[112:115], a[16:19], a[96:99], v[112:115]
s_add_u32 s20, s20, 128
v_mfma_f32_16x16x32_bf16 v[112:115], a[20:23], a[100:103], v[112:115]
v_mfma_f32_16x16x32_bf16 v[116:119], a[20:23], a[108:111], v[116:119]
v_mfma_f32_16x16x32_bf16 v[116:119], a[16:19], a[104:107], v[116:119]
v_mfma_f32_16x16x32_bf16 v[120:123], a[16:19], a[112:115], v[120:123]
v_mfma_f32_16x16x32_bf16 v[120:123], a[20:23], a[116:119], v[120:123]
v_mfma_f32_16x16x32_bf16 v[124:127], a[20:23], a[124:127], v[124:127]
s_add_u32 s30, s28, 16384
v_mfma_f32_16x16x32_bf16 v[124:127], a[16:19], a[120:123], v[124:127]
v_mfma_f32_16x16x32_bf16 v[144:147], a[24:27], a[96:99], v[144:147]
buffer_store_dwordx4 a[192:195], v16, s[12:15], s30 offen offset:3072 sc0 sc1
v_mfma_f32_16x16x32_bf16 v[144:147], a[28:31], a[100:103], v[144:147]
v_mfma_f32_16x16x32_bf16 v[148:151], a[28:31], a[108:111], v[148:151]
v_mfma_f32_16x16x32_bf16 v[148:151], a[24:27], a[104:107], v[148:151]
v_mfma_f32_16x16x32_bf16 v[152:155], a[24:27], a[112:115], v[152:155]
v_mfma_f32_16x16x32_bf16 v[152:155], a[28:31], a[116:119], v[152:155]
v_mfma_f32_16x16x32_bf16 v[156:159], a[28:31], a[124:127], v[156:159]
s_waitcnt vmcnt(26) lgkmcnt(0)
v_mfma_f32_16x16x32_bf16 v[156:159], a[24:27], a[120:123], v[156:159]
s_barrier
v_mfma_f32_16x16x32_bf16 v[176:179], a[32:35], a[96:99], v[176:179]
s_add_u32 s24, s23, s27
s_add_u32 s23, s23, 32768
s_cmp_eq_u32 s23, 98304
v_mfma_f32_16x16x32_bf16 v[176:179], a[36:39], a[100:103], v[176:179]
ds_read_b64_tr_b16 a[0:1], v9 offset:0
v_mfma_f32_16x16x32_bf16 v[180:183], a[36:39], a[108:111], v[180:183]
s_cselect_b32 s23, 0, s23
s_add_u32 m0, s25, 49152
v_mfma_f32_16x16x32_bf16 v[180:183], a[32:35], a[104:107], v[180:183]
ds_read_b64_tr_b16 a[2:3], v9 offset:1024
v_mfma_f32_16x16x32_bf16 v[184:187], a[32:35], a[112:115], v[184:187]
buffer_load_dwordx4 v5, s[8:11], s21 offen offset:0 lds
v_mfma_f32_16x16x32_bf16 v[184:187], a[36:39], a[116:119], v[184:187]
ds_read_b64_tr_b16 a[4:5], v9 offset:8192
v_mfma_f32_16x16x32_bf16 v[188:191], a[36:39], a[124:127], v[188:191]
v_add_u32 v15, s23, v13
v_xor_b32 v14, 64, v15
v_mfma_f32_16x16x32_bf16 v[188:191], a[32:35], a[120:123], v[188:191]
ds_read_b64_tr_b16 a[6:7], v9 offset:9216
v_mfma_f32_16x16x32_bf16 v[208:211], a[40:43], a[96:99], v[208:211]
v_mfma_f32_16x16x32_bf16 v[208:211], a[44:47], a[100:103], v[208:211]
ds_read_b64_tr_b16 a[8:9], v10 offset:0
v_mfma_f32_16x16x32_bf16 v[212:215], a[44:47], a[108:111], v[212:215]
buffer_load_dwordx4 v6, s[8:11], s21 offen offset:1024 lds
v_mfma_f32_16x16x32_bf16 v[212:215], a[40:43], a[104:107], v[212:215]
ds_read_b64_tr_b16 a[10:11], v10 offset:1024
v_mfma_f32_16x16x32_bf16 v[216:219], a[40:43], a[112:115], v[216:219]
s_add_u32 s30, s28, 24576
v_mfma_f32_16x16x32_bf16 v[216:219], a[44:47], a[116:119], v[216:219]
ds_read_b64_tr_b16 a[12:13], v10 offset:8192
v_mfma_f32_16x16x32_bf16 v[220:223], a[44:47], a[124:127], v[220:223]
buffer_store_dwordx4 a[196:199], v16, s[12:15], s30 offen offset:0 sc0 sc1
v_mfma_f32_16x16x32_bf16 v[220:223], a[40:43], a[120:123], v[220:223]
ds_read_b64_tr_b16 a[14:15], v10 offset:9216
v_mfma_f32_16x16x32_bf16 v[240:243], a[48:51], a[96:99], v[240:243]
buffer_load_dwordx4 v7, s[8:11], s21 offen offset:2048 lds
v_mfma_f32_16x16x32_bf16 v[240:243], a[52:55], a[100:103], v[240:243]
ds_read_b64_tr_b16 a[16:17], v11 offset:0
v_mfma_f32_16x16x32_bf16 v[244:247], a[52:55], a[108:111], v[244:247]
v_mfma_f32_16x16x32_bf16 v[244:247], a[48:51], a[104:107], v[244:247]
ds_read_b64_tr_b16 a[18:19], v11 offset:1024
v_mfma_f32_16x16x32_bf16 v[248:251], a[48:51], a[112:115], v[248:251]
v_mfma_f32_16x16x32_bf16 v[248:251], a[52:55], a[116:119], v[248:251]
ds_read_b64_tr_b16 a[20:21], v11 offset:8192
v_mfma_f32_16x16x32_bf16 v[252:255], a[52:55], a[124:127], v[252:255]
buffer_load_dwordx4 v8, s[8:11], s21 offen offset:3072 lds
v_mfma_f32_16x16x32_bf16 v[252:255], a[48:51], a[120:123], v[252:255]
ds_read_b64_tr_b16 a[22:23], v11 offset:9216
v_mfma_f32_16x16x32_bf16 a[144:147], a[56:59], a[96:99], a[144:147]
s_xor_b64 s[8:9], s[8:9], s[80:81]
s_add_u32 s21, s21, s22
v_mfma_f32_16x16x32_bf16 a[144:147], a[60:63], a[100:103], a[144:147]
ds_read_b64_tr_b16 a[24:25], v12 offset:0
v_mfma_f32_16x16x32_bf16 a[148:151], a[60:63], a[108:111], a[148:151]
s_add_u32 m0, s24, 0
v_mfma_f32_16x16x32_bf16 a[148:151], a[56:59], a[104:107], a[148:151]
ds_read_b64_tr_b16 a[26:27], v12 offset:1024
v_mfma_f32_16x16x32_bf16 a[152:155], a[56:59], a[112:115], a[152:155]
buffer_load_dwordx4 v1, s[4:7], s19 offen offset:0 lds
v_mfma_f32_16x16x32_bf16 a[152:155], a[60:63], a[116:119], a[152:155]
ds_read_b64_tr_b16 a[28:29], v12 offset:8192
v_mfma_f32_16x16x32_bf16 a[156:159], a[60:63], a[124:127], a[156:159]
v_mfma_f32_16x16x32_bf16 a[156:159], a[56:59], a[120:123], a[156:159]
ds_read_b64_tr_b16 a[30:31], v12 offset:9216
v_mfma_f32_16x16x32_bf16 v[160:163], a[32:35], a[64:67], v[160:163]
v_mfma_f32_16x16x32_bf16 v[160:163], a[36:39], a[68:71], v[160:163]
ds_read_b128 a[96:99], v15 offset:8192
v_mfma_f32_16x16x32_bf16 v[164:167], a[36:39], a[76:79], v[164:167]
buffer_load_dwordx4 v2, s[4:7], s19 offen offset:1024 lds
v_mfma_f32_16x16x32_bf16 v[164:167], a[32:35], a[72:75], v[164:167]
ds_read_b128 a[100:103], v14 offset:8192
v_mfma_f32_16x16x32_bf16 v[168:171], a[32:35], a[80:83], v[168:171]
s_add_u32 s30, s28, 24576
v_mfma_f32_16x16x32_bf16 v[168:171], a[36:39], a[84:87], v[168:171]
ds_read_b128 a[104:107], v15 offset:10240
v_mfma_f32_16x16x32_bf16 v[172:175], a[36:39], a[92:95], v[172:175]
buffer_store_dwordx4 a[200:203], v16, s[12:15], s30 offen offset:1024 sc0 sc1
v_mfma_f32_16x16x32_bf16 v[172:175], a[32:35], a[88:91], v[172:175]
ds_read_b128 a[108:111], v14 offset:10240
v_mfma_f32_16x16x32_bf16 v[192:195], a[40:43], a[64:67], v[192:195]
buffer_load_dwordx4 v3, s[4:7], s19 offen offset:2048 lds
v_mfma_f32_16x16x32_bf16 v[192:195], a[44:47], a[68:71], v[192:195]
ds_read_b128 a[112:115], v15 offset:12288
v_mfma_f32_16x16x32_bf16 v[196:199], a[44:47], a[76:79], v[196:199]
v_mfma_f32_16x16x32_bf16 v[196:199], a[40:43], a[72:75], v[196:199]
ds_read_b128 a[116:119], v14 offset:12288
v_mfma_f32_16x16x32_bf16 v[200:203], a[40:43], a[80:83], v[200:203]
v_mfma_f32_16x16x32_bf16 v[200:203], a[44:47], a[84:87], v[200:203]
ds_read_b128 a[120:123], v15 offset:14336
v_mfma_f32_16x16x32_bf16 v[204:207], a[44:47], a[92:95], v[204:207]
buffer_load_dwordx4 v4, s[4:7], s19 offen offset:3072 lds
v_mfma_f32_16x16x32_bf16 v[204:207], a[40:43], a[88:91], v[204:207]
ds_read_b128 a[124:127], v14 offset:14336
v_mfma_f32_16x16x32_bf16 v[224:227], a[48:51], a[64:67], v[224:227]
s_add_u32 s19, s19, 128
v_mfma_f32_16x16x32_bf16 v[224:227], a[52:55], a[68:71], v[224:227]
v_mfma_f32_16x16x32_bf16 v[228:231], a[52:55], a[76:79], v[228:231]
v_mfma_f32_16x16x32_bf16 v[228:231], a[48:51], a[72:75], v[228:231]
v_mfma_f32_16x16x32_bf16 v[232:235], a[48:51], a[80:83], v[232:235]
v_mfma_f32_16x16x32_bf16 v[232:235], a[52:55], a[84:87], v[232:235]
v_mfma_f32_16x16x32_bf16 v[236:239], a[52:55], a[92:95], v[236:239]
s_add_u32 s30, s28, 24576
v_mfma_f32_16x16x32_bf16 v[236:239], a[48:51], a[88:91], v[236:239]
v_mfma_f32_16x16x32_bf16 a[128:131], a[56:59], a[64:67], a[128:131]
buffer_store_dwordx4 a[204:207], v16, s[12:15], s30 offen offset:3072 sc0 sc1
v_mfma_f32_16x16x32_bf16 a[128:131], a[60:63], a[68:71], a[128:131]
v_mfma_f32_16x16x32_bf16 a[132:135], a[60:63], a[76:79], a[132:135]
v_mfma_f32_16x16x32_bf16 a[132:135], a[56:59], a[72:75], a[132:135]
v_mfma_f32_16x16x32_bf16 a[136:139], a[56:59], a[80:83], a[136:139]
v_mfma_f32_16x16x32_bf16 a[136:139], a[60:63], a[84:87], a[136:139]
v_mfma_f32_16x16x32_bf16 a[140:143], a[60:63], a[92:95], a[140:143]
s_waitcnt vmcnt(23) lgkmcnt(0)
v_mfma_f32_16x16x32_bf16 a[140:143], a[56:59], a[88:91], a[140:143]
s_barrier
v_mfma_f32_16x16x32_bf16 v[48:51], a[0:3], a[96:99], v[48:51]
v_mfma_f32_16x16x32_bf16 v[48:51], a[4:7], a[100:103], v[48:51]
ds_read_b128 a[64:67], v15 offset:0
v_mfma_f32_16x16x32_bf16 v[52:55], a[4:7], a[108:111], v[52:55]
s_add_u32 m0, s25, 0
v_mfma_f32_16x16x32_bf16 v[52:55], a[0:3], a[104:107], v[52:55]
ds_read_b128 a[68:71], v14 offset:0
v_mfma_f32_16x16x32_bf16 v[56:59], a[0:3], a[112:115], v[56:59]
buffer_load_dwordx4 v5, s[8:11], s21 offen offset:0 lds
v_mfma_f32_16x16x32_bf16 v[56:59], a[4:7], a[116:119], v[56:59]
ds_read_b128 a[72:75], v15 offset:2048
v_mfma_f32_16x16x32_bf16 v[60:63], a[4:7], a[124:127], v[60:63]
v_mfma_f32_16x16x32_bf16 v[60:63], a[0:3], a[120:123], v[60:63]
ds_read_b128 a[76:79], v14 offset:2048
v_mfma_f32_16x16x32_bf16 v[80:83], a[8:11], a[96:99], v[80:83]
v_mfma_f32_16x16x32_bf16 v[80:83], a[12:15], a[100:103], v[80:83]
ds_read_b128 a[80:83], v15 offset:4096
v_mfma_f32_16x16x32_bf16 v[84:87], a[12:15], a[108:111], v[84:87]
buffer_load_dwordx4 v6, s[8:11], s21 offen offset:1024 lds
v_mfma_f32_16x16x32_bf16 v[84:87], a[8:11], a[104:107], v[84:87]
ds_read_b128 a[84:87], v14 offset:4096
v_mfma_f32_16x16x32_bf16 v[88:91], a[8:11], a[112:115], v[88:91]
s_add_u32 s30, s28, 32768
v_mfma_f32_16x16x32_bf16 v[88:91], a[12:15], a[116:119], v[88:91]
ds_read_b128 a[88:91], v15 offset:6144
v_mfma_f32_16x16x32_bf16 v[92:95], a[12:15], a[124:127], v[92:95]
buffer_store_dwordx4 a[208:211], v16, s[12:15], s30 offen offset:0 sc0 sc1
v_mfma_f32_16x16x32_bf16 v[92:95], a[8:11], a[120:123], v[92:95]
ds_read_b128 a[92:95], v14 offset:6144
v_mfma_f32_16x16x32_bf16 v[112:115], a[16:19], a[96:99], v[112:115]
buffer_load_dwordx4 v7, s[8:11], s21 offen offset:2048 lds
v_mfma_f32_16x16x32_bf16 v[112:115], a[20:23], a[100:103], v[112:115]
ds_read_b64_tr_b16 a[32:33], v9 offset:16384
v_mfma_f32_16x16x32_bf16 v[116:119], a[20:23], a[108:111], v[116:119]
v_mfma_f32_16x16x32_bf16 v[116:119], a[16:19], a[104:107], v[116:119]
ds_read_b64_tr_b16 a[34:35], v9 offset:17408
v_mfma_f32_16x16x32_bf16 v[120:123], a[16:19], a[112:115], v[120:123]
v_mfma_f32_16x16x32_bf16 v[120:123], a[20:23], a[116:119], v[120:123]
ds_read_b64_tr_b16 a[36:37], v9 offset:24576
v_mfma_f32_16x16x32_bf16 v[124:127], a[20:23], a[124:127], v[124:127]
buffer_load_dwordx4 v8, s[8:11], s21 offen offset:3072 lds
v_mfma_f32_16x16x32_bf16 v[124:127], a[16:19], a[120:123], v[124:127]
ds_read_b64_tr_b16 a[38:39], v9 offset:25600
v_mfma_f32_16x16x32_bf16 v[144:147], a[24:27], a[96:99], v[144:147]
s_xor_b64 s[8:9], s[8:9], s[80:81]
v_mfma_f32_16x16x32_bf16 v[144:147], a[28:31], a[100:103], v[144:147]
ds_read_b64_tr_b16 a[40:41], v10 offset:16384
v_mfma_f32_16x16x32_bf16 v[148:151], a[28:31], a[108:111], v[148:151]
s_add_u32 m0, s24, 4096
v_mfma_f32_16x16x32_bf16 v[148:151], a[24:27], a[104:107], v[148:151]
ds_read_b64_tr_b16 a[42:43], v10 offset:17408
v_mfma_f32_16x16x32_bf16 v[152:155], a[24:27], a[112:115], v[152:155]
buffer_load_dwordx4 v1, s[4:7], s20 offen offset:0 lds
v_mfma_f32_16x16x32_bf16 v[152:155], a[28:31], a[116:119], v[152:155]
ds_read_b64_tr_b16 a[44:45], v10 offset:24576
v_mfma_f32_16x16x32_bf16 v[156:159], a[28:31], a[124:127], v[156:159]
v_mfma_f32_16x16x32_bf16 v[156:159], a[24:27], a[120:123], v[156:159]
ds_read_b64_tr_b16 a[46:47], v10 offset:25600
s_waitcnt lgkmcnt(8)
v_mfma_f32_16x16x32_bf16 v[32:35], a[0:3], a[64:67], v[32:35]
v_mfma_f32_16x16x32_bf16 v[32:35], a[4:7], a[68:71], v[32:35]
ds_read_b64_tr_b16 a[48:49], v11 offset:16384
v_mfma_f32_16x16x32_bf16 v[36:39], a[4:7], a[76:79], v[36:39]
buffer_load_dwordx4 v2, s[4:7], s20 offen offset:1024 lds
v_mfma_f32_16x16x32_bf16 v[36:39], a[0:3], a[72:75], v[36:39]
ds_read_b64_tr_b16 a[50:51], v11 offset:17408
v_mfma_f32_16x16x32_bf16 v[40:43], a[0:3], a[80:83], v[40:43]
s_add_u32 s30, s28, 32768
v_mfma_f32_16x16x32_bf16 v[40:43], a[4:7], a[84:87], v[40:43]
ds_read_b64_tr_b16 a[52:53], v11 offset:24576
v_mfma_f32_16x16x32_bf16 v[44:47], a[4:7], a[92:95], v[44:47]
buffer_store_dwordx4 a[212:215], v16, s[12:15], s30 offen offset:1024 sc0 sc1
v_mfma_f32_16x16x32_bf16 v[44:47], a[0:3], a[88:91], v[44:47]
ds_read_b64_tr_b16 a[54:55], v11 offset:25600
v_mfma_f32_16x16x32_bf16 v[64:67], a[8:11], a[64:67], v[64:67]
buffer_load_dwordx4 v3, s[4:7], s20 offen offset:2048 lds
v_mfma_f32_16x16x32_bf16 v[64:67], a[12:15], a[68:71], v[64:67]
ds_read_b64_tr_b16 a[56:57], v12 offset:16384
v_mfma_f32_16x16x32_bf16 v[68:71], a[12:15], a[76:79], v[68:71]
v_mfma_f32_16x16x32_bf16 v[68:71], a[8:11], a[72:75], v[68:71]
ds_read_b64_tr_b16 a[58:59], v12 offset:17408
v_mfma_f32_16x16x32_bf16 v[72:75], a[8:11], a[80:83], v[72:75]
v_mfma_f32_16x16x32_bf16 v[72:75], a[12:15], a[84:87], v[72:75]
ds_read_b64_tr_b16 a[60:61], v12 offset:24576
v_mfma_f32_16x16x32_bf16 v[76:79], a[12:15], a[92:95], v[76:79]
buffer_load_dwordx4 v4, s[4:7], s20 offen offset:3072 lds
v_mfma_f32_16x16x32_bf16 v[76:79], a[8:11], a[88:91], v[76:79]
ds_read_b64_tr_b16 a[62:63], v12 offset:25600
v_mfma_f32_16x16x32_bf16 v[96:99], a[16:19], a[64:67], v[96:99]
s_add_u32 s20, s20, 128
v_mfma_f32_16x16x32_bf16 v[96:99], a[20:23], a[68:71], v[96:99]
v_mfma_f32_16x16x32_bf16 v[100:103], a[20:23], a[76:79], v[100:103]
v_mfma_f32_16x16x32_bf16 v[100:103], a[16:19], a[72:75], v[100:103]
v_mfma_f32_16x16x32_bf16 v[104:107], a[16:19], a[80:83], v[104:107]
v_mfma_f32_16x16x32_bf16 v[104:107], a[20:23], a[84:87], v[104:107]
v_mfma_f32_16x16x32_bf16 v[108:111], a[20:23], a[92:95], v[108:111]
s_add_u32 s30, s28, 32768
v_mfma_f32_16x16x32_bf16 v[108:111], a[16:19], a[88:91], v[108:111]
v_mfma_f32_16x16x32_bf16 v[128:131], a[24:27], a[64:67], v[128:131]
buffer_store_dwordx4 a[216:219], v16, s[12:15], s30 offen offset:3072 sc0 sc1
v_mfma_f32_16x16x32_bf16 v[128:131], a[28:31], a[68:71], v[128:131]
v_mfma_f32_16x16x32_bf16 v[132:135], a[28:31], a[76:79], v[132:135]
v_mfma_f32_16x16x32_bf16 v[132:135], a[24:27], a[72:75], v[132:135]
v_mfma_f32_16x16x32_bf16 v[136:139], a[24:27], a[80:83], v[136:139]
v_mfma_f32_16x16x32_bf16 v[136:139], a[28:31], a[84:87], v[136:139]
v_mfma_f32_16x16x32_bf16 v[140:143], a[28:31], a[92:95], v[140:143]
s_waitcnt vmcnt(23) lgkmcnt(0)
v_mfma_f32_16x16x32_bf16 v[140:143], a[24:27], a[88:91], v[140:143]
s_barrier
v_mfma_f32_16x16x32_bf16 v[160:163], a[32:35], a[64:67], v[160:163]
s_add_u32 s24, s23, s27
s_add_u32 s23, s23, 32768
s_cmp_eq_u32 s23, 98304
v_mfma_f32_16x16x32_bf16 v[160:163], a[36:39], a[68:71], v[160:163]
ds_read_b64_tr_b16 a[0:1], v9 offset:32768
v_mfma_f32_16x16x32_bf16 v[164:167], a[36:39], a[76:79], v[164:167]
s_cselect_b32 s23, 0, s23
s_add_u32 m0, s25, 16384
v_mfma_f32_16x16x32_bf16 v[164:167], a[32:35], a[72:75], v[164:167]
ds_read_b64_tr_b16 a[2:3], v9 offset:33792
v_mfma_f32_16x16x32_bf16 v[168:171], a[32:35], a[80:83], v[168:171]
buffer_load_dwordx4 v5, s[8:11], s21 offen offset:0 lds
v_mfma_f32_16x16x32_bf16 v[168:171], a[36:39], a[84:87], v[168:171]
ds_read_b64_tr_b16 a[4:5], v9 offset:40960
v_mfma_f32_16x16x32_bf16 v[172:175], a[36:39], a[92:95], v[172:175]
v_add_u32 v15, s23, v13
v_xor_b32 v14, 64, v15
v_mfma_f32_16x16x32_bf16 v[172:175], a[32:35], a[88:91], v[172:175]
ds_read_b64_tr_b16 a[6:7], v9 offset:41984
v_mfma_f32_16x16x32_bf16 v[192:195], a[40:43], a[64:67], v[192:195]
v_mfma_f32_16x16x32_bf16 v[192:195], a[44:47], a[68:71], v[192:195]
ds_read_b64_tr_b16 a[8:9], v10 offset:32768
v_mfma_f32_16x16x32_bf16 v[196:199], a[44:47], a[76:79], v[196:199]
buffer_load_dwordx4 v6, s[8:11], s21 offen offset:1024 lds
v_mfma_f32_16x16x32_bf16 v[196:199], a[40:43], a[72:75], v[196:199]
ds_read_b64_tr_b16 a[10:11], v10 offset:33792
v_mfma_f32_16x16x32_bf16 v[200:203], a[40:43], a[80:83], v[200:203]
s_add_u32 s30, s28, 40960
v_mfma_f32_16x16x32_bf16 v[200:203], a[44:47], a[84:87], v[200:203]
ds_read_b64_tr_b16 a[12:13], v10 offset:40960
v_mfma_f32_16x16x32_bf16 v[204:207], a[44:47], a[92:95], v[204:207]
buffer_store_dwordx4 a[220:223], v16, s[12:15], s30 offen offset:0 sc0 sc1
v_mfma_f32_16x16x32_bf16 v[204:207], a[40:43], a[88:91], v[204:207]
ds_read_b64_tr_b16 a[14:15], v10 offset:41984
v_mfma_f32_16x16x32_bf16 v[224:227], a[48:51], a[64:67], v[224:227]
buffer_load_dwordx4 v7, s[8:11], s21 offen offset:2048 lds
v_mfma_f32_16x16x32_bf16 v[224:227], a[52:55], a[68:71], v[224:227]
ds_read_b64_tr_b16 a[16:17], v11 offset:32768
v_mfma_f32_16x16x32_bf16 v[228:231], a[52:55], a[76:79], v[228:231]
v_mfma_f32_16x16x32_bf16 v[228:231], a[48:51], a[72:75], v[228:231]
ds_read_b64_tr_b16 a[18:19], v11 offset:33792
v_mfma_f32_16x16x32_bf16 v[232:235], a[48:51], a[80:83], v[232:235]
v_mfma_f32_16x16x32_bf16 v[232:235], a[52:55], a[84:87], v[232:235]
ds_read_b64_tr_b16 a[20:21], v11 offset:40960
v_mfma_f32_16x16x32_bf16 v[236:239], a[52:55], a[92:95], v[236:239]
buffer_load_dwordx4 v8, s[8:11], s21 offen offset:3072 lds
v_mfma_f32_16x16x32_bf16 v[236:239], a[48:51], a[88:91], v[236:239]
ds_read_b64_tr_b16 a[22:23], v11 offset:41984
v_mfma_f32_16x16x32_bf16 a[128:131], a[56:59], a[64:67], a[128:131]
s_xor_b64 s[8:9], s[8:9], s[80:81]
s_add_u32 s21, s21, s22
v_mfma_f32_16x16x32_bf16 a[128:131], a[60:63], a[68:71], a[128:131]
ds_read_b64_tr_b16 a[24:25], v12 offset:32768
v_mfma_f32_16x16x32_bf16 a[132:135], a[60:63], a[76:79], a[132:135]
s_add_u32 m0, s24, 0
v_mfma_f32_16x16x32_bf16 a[132:135], a[56:59], a[72:75], a[132:135]
ds_read_b64_tr_b16 a[26:27], v12 offset:33792
v_mfma_f32_16x16x32_bf16 a[136:139], a[56:59], a[80:83], a[136:139]
buffer_load_dwordx4 v1, s[4:7], s19 offen offset:0 lds
v_mfma_f32_16x16x32_bf16 a[136:139], a[60:63], a[84:87], a[136:139]
ds_read_b64_tr_b16 a[28:29], v12 offset:40960
v_mfma_f32_16x16x32_bf16 a[140:143], a[60:63], a[92:95], a[140:143]
v_mfma_f32_16x16x32_bf16 a[140:143], a[56:59], a[88:91], a[140:143]
ds_read_b64_tr_b16 a[30:31], v12 offset:41984
v_mfma_f32_16x16x32_bf16 v[176:179], a[32:35], a[96:99], v[176:179]
v_mfma_f32_16x16x32_bf16 v[176:179], a[36:39], a[100:103], v[176:179]
ds_read_b128 a[64:67], v15 offset:0
v_mfma_f32_16x16x32_bf16 v[180:183], a[36:39], a[108:111], v[180:183]
buffer_load_dwordx4 v2, s[4:7], s19 offen offset:1024 lds
v_mfma_f32_16x16x32_bf16 v[180:183], a[32:35], a[104:107], v[180:183]
ds_read_b128 a[68:71], v14 offset:0
v_mfma_f32_16x16x32_bf16 v[184:187], a[32:35], a[112:115], v[184:187]
s_add_u32 s30, s28, 40960
v_mfma_f32_16x16x32_bf16 v[184:187], a[36:39], a[116:119], v[184:187]
ds_read_b128 a[72:75], v15 offset:2048
v_mfma_f32_16x16x32_bf16 v[188:191], a[36:39], a[124:127], v[188:191]
buffer_store_dwordx4 a[224:227], v16, s[12:15], s30 offen offset:1024 sc0 sc1
v_mfma_f32_16x16x32_bf16 v[188:191], a[32:35], a[120:123], v[188:191]
ds_read_b128 a[76:79], v14 offset:2048
v_mfma_f32_16x16x32_bf16 v[208:211], a[40:43], a[96:99], v[208:211]
buffer_load_dwordx4 v3, s[4:7], s19 offen offset:2048 lds
v_mfma_f32_16x16x32_bf16 v[208:211], a[44:47], a[100:103], v[208:211]
ds_read_b128 a[80:83], v15 offset:4096
v_mfma_f32_16x16x32_bf16 v[212:215], a[44:47], a[108:111], v[212:215]
v_mfma_f32_16x16x32_bf16 v[212:215], a[40:43], a[104:107], v[212:215]
ds_read_b128 a[84:87], v14 offset:4096
v_mfma_f32_16x16x32_bf16 v[216:219], a[40:43], a[112:115], v[216:219]
v_mfma_f32_16x16x32_bf16 v[216:219], a[44:47], a[116:119], v[216:219]
ds_read_b128 a[88:91], v15 offset:6144
v_mfma_f32_16x16x32_bf16 v[220:223], a[44:47], a[124:127], v[220:223]
buffer_load_dwordx4 v4, s[4:7], s19 offen offset:3072 lds
v_mfma_f32_16x16x32_bf16 v[220:223], a[40:43], a[120:123], v[220:223]
ds_read_b128 a[92:95], v14 offset:6144
v_mfma_f32_16x16x32_bf16 v[240:243], a[48:51], a[96:99], v[240:243]
s_add_u32 s19, s19, 128
v_mfma_f32_16x16x32_bf16 v[240:243], a[52:55], a[100:103], v[240:243]
v_mfma_f32_16x16x32_bf16 v[244:247], a[52:55], a[108:111], v[244:247]
v_mfma_f32_16x16x32_bf16 v[244:247], a[48:51], a[104:107], v[244:247]
v_mfma_f32_16x16x32_bf16 v[248:251], a[48:51], a[112:115], v[248:251]
v_mfma_f32_16x16x32_bf16 v[248:251], a[52:55], a[116:119], v[248:251]
v_mfma_f32_16x16x32_bf16 v[252:255], a[52:55], a[124:127], v[252:255]
s_add_u32 s30, s28, 40960
v_mfma_f32_16x16x32_bf16 v[252:255], a[48:51], a[120:123], v[252:255]
v_mfma_f32_16x16x32_bf16 a[144:147], a[56:59], a[96:99], a[144:147]
buffer_store_dwordx4 a[228:231], v16, s[12:15], s30 offen offset:3072 sc0 sc1
v_mfma_f32_16x16x32_bf16 a[144:147], a[60:63], a[100:103], a[144:147]
v_mfma_f32_16x16x32_bf16 a[148:151], a[60:63], a[108:111], a[148:151]
v_mfma_f32_16x16x32_bf16 a[148:151], a[56:59], a[104:107], a[148:151]
v_mfma_f32_16x16x32_bf16 a[152:155], a[56:59], a[112:115], a[152:155]
v_mfma_f32_16x16x32_bf16 a[152:155], a[60:63], a[116:119], a[152:155]
v_mfma_f32_16x16x32_bf16 a[156:159], a[60:63], a[124:127], a[156:159]
s_waitcnt vmcnt(23) lgkmcnt(0)
v_mfma_f32_16x16x32_bf16 a[156:159], a[56:59], a[120:123], a[156:159]
s_barrier
v_mfma_f32_16x16x32_bf16 v[32:35], a[0:3], a[64:67], v[32:35]
v_mfma_f32_16x16x32_bf16 v[32:35], a[4:7], a[68:71], v[32:35]
ds_read_b128 a[96:99], v15 offset:8192
v_mfma_f32_16x16x32_bf16 v[36:39], a[4:7], a[76:79], v[36:39]
s_add_u32 m0, s25, 32768
v_mfma_f32_16x16x32_bf16 v[36:39], a[0:3], a[72:75], v[36:39]
ds_read_b128 a[100:103], v14 offset:8192
v_mfma_f32_16x16x32_bf16 v[40:43], a[0:3], a[80:83], v[40:43]
buffer_load_dwordx4 v5, s[8:11], s21 offen offset:0 lds
v_mfma_f32_16x16x32_bf16 v[40:43], a[4:7], a[84:87], v[40:43]
ds_read_b128 a[104:107], v15 offset:10240
v_mfma_f32_16x16x32_bf16 v[44:47], a[4:7], a[92:95], v[44:47]
v_mfma_f32_16x16x32_bf16 v[44:47], a[0:3], a[88:91], v[44:47]
ds_read_b128 a[108:111], v14 offset:10240
v_mfma_f32_16x16x32_bf16 v[64:67], a[8:11], a[64:67], v[64:67]
v_mfma_f32_16x16x32_bf16 v[64:67], a[12:15], a[68:71], v[64:67]
ds_read_b128 a[112:115], v15 offset:12288
v_mfma_f32_16x16x32_bf16 v[68:71], a[12:15], a[76:79], v[68:71]
buffer_load_dwordx4 v6, s[8:11], s21 offen offset:1024 lds
v_mfma_f32_16x16x32_bf16 v[68:71], a[8:11], a[72:75], v[68:71]
ds_read_b128 a[116:119], v14 offset:12288
v_mfma_f32_16x16x32_bf16 v[72:75], a[8:11], a[80:83], v[72:75]
s_add_u32 s30, s28, 49152
v_mfma_f32_16x16x32_bf16 v[72:75], a[12:15], a[84:87], v[72:75]
ds_read_b128 a[120:123], v15 offset:14336
v_mfma_f32_16x16x32_bf16 v[76:79], a[12:15], a[92:95], v[76:79]
buffer_store_dwordx4 a[232:235], v16, s[12:15], s30 offen offset:0 sc0 sc1
v_mfma_f32_16x16x32_bf16 v[76:79], a[8:11], a[88:91], v[76:79]
ds_read_b128 a[124:127], v14 offset:14336
v_mfma_f32_16x16x32_bf16 v[96:99], a[16:19], a[64:67], v[96:99]
buffer_load_dwordx4 v7, s[8:11], s21 offen offset:2048 lds
v_mfma_f32_16x16x32_bf16 v[96:99], a[20:23], a[68:71], v[96:99]
ds_read_b64_tr_b16 a[32:33], v9 offset:49152
v_mfma_f32_16x16x32_bf16 v[100:103], a[20:23], a[76:79], v[100:103]
v_mfma_f32_16x16x32_bf16 v[100:103], a[16:19], a[72:75], v[100:103]
ds_read_b64_tr_b16 a[34:35], v9 offset:50176
v_mfma_f32_16x16x32_bf16 v[104:107], a[16:19], a[80:83], v[104:107]
v_mfma_f32_16x16x32_bf16 v[104:107], a[20:23], a[84:87], v[104:107]
ds_read_b64_tr_b16 a[36:37], v9 offset:57344
v_mfma_f32_16x16x32_bf16 v[108:111], a[20:23], a[92:95], v[108:111]
buffer_load_dwordx4 v8, s[8:11], s21 offen offset:3072 lds
v_mfma_f32_16x16x32_bf16 v[108:111], a[16:19], a[88:91], v[108:111]
ds_read_b64_tr_b16 a[38:39], v9 offset:58368
v_mfma_f32_16x16x32_bf16 v[128:131], a[24:27], a[64:67], v[128:131]
s_xor_b64 s[8:9], s[8:9], s[80:81]
v_mfma_f32_16x16x32_bf16 v[128:131], a[28:31], a[68:71], v[128:131]
ds_read_b64_tr_b16 a[40:41], v10 offset:49152
v_mfma_f32_16x16x32_bf16 v[132:135], a[28:31], a[76:79], v[132:135]
s_add_u32 m0, s24, 4096
v_mfma_f32_16x16x32_bf16 v[132:135], a[24:27], a[72:75], v[132:135]
ds_read_b64_tr_b16 a[42:43], v10 offset:50176
v_mfma_f32_16x16x32_bf16 v[136:139], a[24:27], a[80:83], v[136:139]
buffer_load_dwordx4 v1, s[4:7], s20 offen offset:0 lds
v_mfma_f32_16x16x32_bf16 v[136:139], a[28:31], a[84:87], v[136:139]
ds_read_b64_tr_b16 a[44:45], v10 offset:57344
v_mfma_f32_16x16x32_bf16 v[140:143], a[28:31], a[92:95], v[140:143]
v_mfma_f32_16x16x32_bf16 v[140:143], a[24:27], a[88:91], v[140:143]
ds_read_b64_tr_b16 a[46:47], v10 offset:58368
s_waitcnt lgkmcnt(8)
v_mfma_f32_16x16x32_bf16 v[48:51], a[0:3], a[96:99], v[48:51]
v_mfma_f32_16x16x32_bf16 v[48:51], a[4:7], a[100:103], v[48:51]
ds_read_b64_tr_b16 a[48:49], v11 offset:49152
v_mfma_f32_16x16x32_bf16 v[52:55], a[4:7], a[108:111], v[52:55]
buffer_load_dwordx4 v2, s[4:7], s20 offen offset:1024 lds
v_mfma_f32_16x16x32_bf16 v[52:55], a[0:3], a[104:107], v[52:55]
ds_read_b64_tr_b16 a[50:51], v11 offset:50176
v_mfma_f32_16x16x32_bf16 v[56:59], a[0:3], a[112:115], v[56:59]
s_add_u32 s30, s28, 49152
v_mfma_f32_16x16x32_bf16 v[56:59], a[4:7], a[116:119], v[56:59]
ds_read_b64_tr_b16 a[52:53], v11 offset:57344
v_mfma_f32_16x16x32_bf16 v[60:63], a[4:7], a[124:127], v[60:63]
buffer_store_dwordx4 a[236:239], v16, s[12:15], s30 offen offset:1024 sc0 sc1
v_mfma_f32_16x16x32_bf16 v[60:63], a[0:3], a[120:123], v[60:63]
ds_read_b64_tr_b16 a[54:55], v11 offset:58368
v_mfma_f32_16x16x32_bf16 v[80:83], a[8:11], a[96:99], v[80:83]
buffer_load_dwordx4 v3, s[4:7], s20 offen offset:2048 lds
v_mfma_f32_16x16x32_bf16 v[80:83], a[12:15], a[100:103], v[80:83]
ds_read_b64_tr_b16 a[56:57], v12 offset:49152
v_mfma_f32_16x16x32_bf16 v[84:87], a[12:15], a[108:111], v[84:87]
v_mfma_f32_16x16x32_bf16 v[84:87], a[8:11], a[104:107], v[84:87]
ds_read_b64_tr_b16 a[58:59], v12 offset:50176
v_mfma_f32_16x16x32_bf16 v[88:91], a[8:11], a[112:115], v[88:91]
v_mfma_f32_16x16x32_bf16 v[88:91], a[12:15], a[116:119], v[88:91]
ds_read_b64_tr_b16 a[60:61], v12 offset:57344
v_mfma_f32_16x16x32_bf16 v[92:95], a[12:15], a[124:127], v[92:95]
buffer_load_dwordx4 v4, s[4:7], s20 offen offset:3072 lds
v_mfma_f32_16x16x32_bf16 v[92:95], a[8:11], a[120:123], v[92:95]
ds_read_b64_tr_b16 a[62:63], v12 offset:58368
v_mfma_f32_16x16x32_bf16 v[112:115], a[16:19], a[96:99], v[112:115]
s_add_u32 s20, s20, 128
v_mfma_f32_16x16x32_bf16 v[112:115], a[20:23], a[100:103], v[112:115]
v_mfma_f32_16x16x32_bf16 v[116:119], a[20:23], a[108:111], v[116:119]
v_mfma_f32_16x16x32_bf16 v[116:119], a[16:19], a[104:107], v[116:119]
v_mfma_f32_16x16x32_bf16 v[120:123], a[16:19], a[112:115], v[120:123]
v_mfma_f32_16x16x32_bf16 v[120:123], a[20:23], a[116:119], v[120:123]
v_mfma_f32_16x16x32_bf16 v[124:127], a[20:23], a[124:127], v[124:127]
s_add_u32 s30, s28, 49152
v_mfma_f32_16x16x32_bf16 v[124:127], a[16:19], a[120:123], v[124:127]
v_mfma_f32_16x16x32_bf16 v[144:147], a[24:27], a[96:99], v[144:147]
buffer_store_dwordx4 a[240:243], v16, s[12:15], s30 offen offset:3072 sc0 sc1
v_mfma_f32_16x16x32_bf16 v[144:147], a[28:31], a[100:103], v[144:147]
v_mfma_f32_16x16x32_bf16 v[148:151], a[28:31], a[108:111], v[148:151]
v_mfma_f32_16x16x32_bf16 v[148:151], a[24:27], a[104:107], v[148:151]
v_mfma_f32_16x16x32_bf16 v[152:155], a[24:27], a[112:115], v[152:155]
v_mfma_f32_16x16x32_bf16 v[152:155], a[28:31], a[116:119], v[152:155]
v_mfma_f32_16x16x32_bf16 v[156:159], a[28:31], a[124:127], v[156:159]
s_waitcnt vmcnt(23) lgkmcnt(0)
v_mfma_f32_16x16x32_bf16 v[156:159], a[24:27], a[120:123], v[156:159]
s_barrier
v_mfma_f32_16x16x32_bf16 v[176:179], a[32:35], a[96:99], v[176:179]
s_add_u32 s24, s23, s27
s_add_u32 s23, s23, 32768
s_cmp_eq_u32 s23, 98304
v_mfma_f32_16x16x32_bf16 v[176:179], a[36:39], a[100:103], v[176:179]
ds_read_b64_tr_b16 a[0:1], v9 offset:0
v_mfma_f32_16x16x32_bf16 v[180:183], a[36:39], a[108:111], v[180:183]
s_cselect_b32 s23, 0, s23
s_add_u32 m0, s25, 49152
v_mfma_f32_16x16x32_bf16 v[180:183], a[32:35], a[104:107], v[180:183]
ds_read_b64_tr_b16 a[2:3], v9 offset:1024
v_mfma_f32_16x16x32_bf16 v[184:187], a[32:35], a[112:115], v[184:187]
buffer_load_dwordx4 v5, s[8:11], s21 offen offset:0 lds
v_mfma_f32_16x16x32_bf16 v[184:187], a[36:39], a[116:119], v[184:187]
ds_read_b64_tr_b16 a[4:5], v9 offset:8192
v_mfma_f32_16x16x32_bf16 v[188:191], a[36:39], a[124:127], v[188:191]
v_add_u32 v15, s23, v13
v_xor_b32 v14, 64, v15
v_mfma_f32_16x16x32_bf16 v[188:191], a[32:35], a[120:123], v[188:191]
ds_read_b64_tr_b16 a[6:7], v9 offset:9216
v_mfma_f32_16x16x32_bf16 v[208:211], a[40:43], a[96:99], v[208:211]
s_mov_b32 s44, s0
s_mov_b32 s45, s1
v_mfma_f32_16x16x32_bf16 v[208:211], a[44:47], a[100:103], v[208:211]
ds_read_b64_tr_b16 a[8:9], v10 offset:0
v_mfma_f32_16x16x32_bf16 v[212:215], a[44:47], a[108:111], v[212:215]
buffer_load_dwordx4 v6, s[8:11], s21 offen offset:1024 lds
v_mfma_f32_16x16x32_bf16 v[212:215], a[40:43], a[104:107], v[212:215]
ds_read_b64_tr_b16 a[10:11], v10 offset:1024
v_mfma_f32_16x16x32_bf16 v[216:219], a[40:43], a[112:115], v[216:219]
s_add_u32 s30, s28, 57344
v_mfma_f32_16x16x32_bf16 v[216:219], a[44:47], a[116:119], v[216:219]
ds_read_b64_tr_b16 a[12:13], v10 offset:8192
v_mfma_f32_16x16x32_bf16 v[220:223], a[44:47], a[124:127], v[220:223]
buffer_store_dwordx4 a[244:247], v16, s[12:15], s30 offen offset:0 sc0 sc1
v_mfma_f32_16x16x32_bf16 v[220:223], a[40:43], a[120:123], v[220:223]
ds_read_b64_tr_b16 a[14:15], v10 offset:9216
v_mfma_f32_16x16x32_bf16 v[240:243], a[48:51], a[96:99], v[240:243]
buffer_load_dwordx4 v7, s[8:11], s21 offen offset:2048 lds
v_mfma_f32_16x16x32_bf16 v[240:243], a[52:55], a[100:103], v[240:243]
ds_read_b64_tr_b16 a[16:17], v11 offset:0
v_mfma_f32_16x16x32_bf16 v[244:247], a[52:55], a[108:111], v[244:247]
s_mov_b32 s46, L_f_end-L_f_pc
s_mov_b32 s47, 0x20000
v_mfma_f32_16x16x32_bf16 v[244:247], a[48:51], a[104:107], v[244:247]
ds_read_b64_tr_b16 a[18:19], v11 offset:1024
v_mfma_f32_16x16x32_bf16 v[248:251], a[48:51], a[112:115], v[248:251]
s_lshr_b32 s31, s2, 3
s_lshl_b32 s31, s31, 2
v_mfma_f32_16x16x32_bf16 v[248:251], a[52:55], a[116:119], v[248:251]
ds_read_b64_tr_b16 a[20:21], v11 offset:8192
v_mfma_f32_16x16x32_bf16 v[252:255], a[52:55], a[124:127], v[252:255]
buffer_load_dwordx4 v8, s[8:11], s21 offen offset:3072 lds
v_mfma_f32_16x16x32_bf16 v[252:255], a[48:51], a[120:123], v[252:255]
ds_read_b64_tr_b16 a[22:23], v11 offset:9216
v_mfma_f32_16x16x32_bf16 a[144:147], a[56:59], a[96:99], a[144:147]
s_xor_b64 s[8:9], s[8:9], s[80:81]
s_add_u32 s21, s21, s22
v_mfma_f32_16x16x32_bf16 a[144:147], a[60:63], a[100:103], a[144:147]
ds_read_b64_tr_b16 a[24:25], v12 offset:0
v_mfma_f32_16x16x32_bf16 a[148:151], a[60:63], a[108:111], a[148:151]
s_add_u32 m0, s24, 0
v_mfma_f32_16x16x32_bf16 a[148:151], a[56:59], a[104:107], a[148:151]
ds_read_b64_tr_b16 a[26:27], v12 offset:1024
v_mfma_f32_16x16x32_bf16 a[152:155], a[56:59], a[112:115], a[152:155]
buffer_load_dwordx4 v1, s[4:7], s19 offen offset:0 lds
v_mfma_f32_16x16x32_bf16 a[152:155], a[60:63], a[116:119], a[152:155]
ds_read_b64_tr_b16 a[28:29], v12 offset:8192
v_mfma_f32_16x16x32_bf16 a[156:159], a[60:63], a[124:127], a[156:159]
s_add_u32 s31, s31, s16
s_lshl_b32 s31, s31, 10
v_mfma_f32_16x16x32_bf16 a[156:159], a[56:59], a[120:123], a[156:159]
ds_read_b64_tr_b16 a[30:31], v12 offset:9216
v_mfma_f32_16x16x32_bf16 v[160:163], a[32:35], a[64:67], v[160:163]
v_and_b32 v17, 7, v0
v_lshlrev_b32 v17, 7, v17
v_mfma_f32_16x16x32_bf16 v[160:163], a[36:39], a[68:71], v[160:163]
ds_read_b128 a[96:99], v15 offset:8192
v_mfma_f32_16x16x32_bf16 v[164:167], a[36:39], a[76:79], v[164:167]
buffer_load_dwordx4 v2, s[4:7], s19 offen offset:1024 lds
v_mfma_f32_16x16x32_bf16 v[164:167], a[32:35], a[72:75], v[164:167]
ds_read_b128 a[100:103], v14 offset:8192
v_mfma_f32_16x16x32_bf16 v[168:171], a[32:35], a[80:83], v[168:171]
s_add_u32 s30, s28, 57344
v_mfma_f32_16x16x32_bf16 v[168:171], a[36:39], a[84:87], v[168:171]
ds_read_b128 a[104:107], v15 offset:10240
v_mfma_f32_16x16x32_bf16 v[172:175], a[36:39], a[92:95], v[172:175]
buffer_store_dwordx4 a[248:251], v16, s[12:15], s30 offen offset:1024 sc0 sc1
v_mfma_f32_16x16x32_bf16 v[172:175], a[32:35], a[88:91], v[172:175]
ds_read_b128 a[108:111], v14 offset:10240
v_mfma_f32_16x16x32_bf16 v[192:195], a[40:43], a[64:67], v[192:195]
buffer_load_dwordx4 v3, s[4:7], s19 offen offset:2048 lds
v_mfma_f32_16x16x32_bf16 v[192:195], a[44:47], a[68:71], v[192:195]
ds_read_b128 a[112:115], v15 offset:12288
v_mfma_f32_16x16x32_bf16 v[196:199], a[44:47], a[76:79], v[196:199]
v_mfma_f32_16x16x32_bf16 v[196:199], a[40:43], a[72:75], v[196:199]
ds_read_b128 a[116:119], v14 offset:12288
v_mfma_f32_16x16x32_bf16 v[200:203], a[40:43], a[80:83], v[200:203]
v_mfma_f32_16x16x32_bf16 v[200:203], a[44:47], a[84:87], v[200:203]
ds_read_b128 a[120:123], v15 offset:14336
v_mfma_f32_16x16x32_bf16 v[204:207], a[44:47], a[92:95], v[204:207]
buffer_load_dwordx4 v4, s[4:7], s19 offen offset:3072 lds
v_mfma_f32_16x16x32_bf16 v[204:207], a[40:43], a[88:91], v[204:207]
ds_read_b128 a[124:127], v14 offset:14336
v_mfma_f32_16x16x32_bf16 v[224:227], a[48:51], a[64:67], v[224:227]
s_add_u32 s19, s19, 128
v_mfma_f32_16x16x32_bf16 v[224:227], a[52:55], a[68:71], v[224:227]
v_mfma_f32_16x16x32_bf16 v[228:231], a[52:55], a[76:79], v[228:231]
buffer_load_dword v31, v17, s[44:47], s31 offen
v_mfma_f32_16x16x32_bf16 v[228:231], a[48:51], a[72:75], v[228:231]
v_mfma_f32_16x16x32_bf16 v[232:235], a[48:51], a[80:83], v[232:235]
v_mfma_f32_16x16x32_bf16 v[232:235], a[52:55], a[84:87], v[232:235]
v_mfma_f32_16x16x32_bf16 v[236:239], a[52:55], a[92:95], v[236:239]
s_add_u32 s30, s28, 57344
v_mfma_f32_16x16x32_bf16 v[236:239], a[48:51], a[88:91], v[236:239]
v_mfma_f32_16x16x32_bf16 a[128:131], a[56:59], a[64:67], a[128:131]
buffer_store_dwordx4 a[252:255], v16, s[12:15], s30 offen offset:3072 sc0 sc1
v_mfma_f32_16x16x32_bf16 a[128:131], a[60:63], a[68:71], a[128:131]
v_mfma_f32_16x16x32_bf16 a[132:135], a[60:63], a[76:79], a[132:135]
v_mfma_f32_16x16x32_bf16 a[132:135], a[56:59], a[72:75], a[132:135]
v_mfma_f32_16x16x32_bf16 a[136:139], a[56:59], a[80:83], a[136:139]
v_mfma_f32_16x16x32_bf16 a[136:139], a[60:63], a[84:87], a[136:139]
v_mfma_f32_16x16x32_bf16 a[140:143], a[60:63], a[92:95], a[140:143]
s_waitcnt vmcnt(23) lgkmcnt(0)
v_mfma_f32_16x16x32_bf16 a[140:143], a[56:59], a[88:91], a[140:143]
s_barrier
v_mfma_f32_16x16x32_bf16 v[48:51], a[0:3], a[96:99], v[48:51]
v_mfma_f32_16x16x32_bf16 v[48:51], a[4:7], a[100:103], v[48:51]
ds_read_b128 a[64:67], v15 offset:0
v_mfma_f32_16x16x32_bf16 v[52:55], a[4:7], a[108:111], v[52:55]
s_add_u32 m0, s25, 0
v_mfma_f32_16x16x32_bf16 v[52:55], a[0:3], a[104:107], v[52:55]
ds_read_b128 a[68:71], v14 offset:0
v_mfma_f32_16x16x32_bf16 v[56:59], a[0:3], a[112:115], v[56:59]
buffer_load_dwordx4 v5, s[8:11], s21 offen offset:0 lds
v_mfma_f32_16x16x32_bf16 v[56:59], a[4:7], a[116:119], v[56:59]
ds_read_b128 a[72:75], v15 offset:2048
v_mfma_f32_16x16x32_bf16 v[60:63], a[4:7], a[124:127], v[60:63]
v_mfma_f32_16x16x32_bf16 v[60:63], a[0:3], a[120:123], v[60:63]
ds_read_b128 a[76:79], v14 offset:2048
v_mfma_f32_16x16x32_bf16 v[80:83], a[8:11], a[96:99], v[80:83]
v_mfma_f32_16x16x32_bf16 v[80:83], a[12:15], a[100:103], v[80:83]
ds_read_b128 a[80:83], v15 offset:4096
v_mfma_f32_16x16x32_bf16 v[84:87], a[12:15], a[108:111], v[84:87]
buffer_load_dwordx4 v6, s[8:11], s21 offen offset:1024 lds
v_mfma_f32_16x16x32_bf16 v[84:87], a[8:11], a[104:107], v[84:87]
ds_read_b128 a[84:87], v14 offset:4096
v_mfma_f32_16x16x32_bf16 v[88:91], a[8:11], a[112:115], v[88:91]
v_mfma_f32_16x16x32_bf16 v[88:91], a[12:15], a[116:119], v[88:91]
ds_read_b128 a[88:91], v15 offset:6144
v_mfma_f32_16x16x32_bf16 v[92:95], a[12:15], a[124:127], v[92:95]
v_mfma_f32_16x16x32_bf16 v[92:95], a[8:11], a[120:123], v[92:95]
ds_read_b128 a[92:95], v14 offset:6144
v_mfma_f32_16x16x32_bf16 v[112:115], a[16:19], a[96:99], v[112:115]
buffer_load_dwordx4 v7, s[8:11], s21 offen offset:2048 lds
v_mfma_f32_16x16x32_bf16 v[112:115], a[20:23], a[100:103], v[112:115]
ds_read_b64_tr_b16 a[32:33], v9 offset:16384
v_mfma_f32_16x16x32_bf16 v[116:119], a[20:23], a[108:111], v[116:119]
v_mfma_f32_16x16x32_bf16 v[116:119], a[16:19], a[104:107], v[116:119]
ds_read_b64_tr_b16 a[34:35], v9 offset:17408
v_mfma_f32_16x16x32_bf16 v[120:123], a[16:19], a[112:115], v[120:123]
v_mfma_f32_16x16x32_bf16 v[120:123], a[20:23], a[116:119], v[120:123]
ds_read_b64_tr_b16 a[36:37], v9 offset:24576
v_mfma_f32_16x16x32_bf16 v[124:127], a[20:23], a[124:127], v[124:127]
buffer_load_dwordx4 v8, s[8:11], s21 offen offset:3072 lds
v_mfma_f32_16x16x32_bf16 v[124:127], a[16:19], a[120:123], v[124:127]
ds_read_b64_tr_b16 a[38:39], v9 offset:25600
v_mfma_f32_16x16x32_bf16 v[144:147], a[24:27], a[96:99], v[144:147]
s_xor_b64 s[8:9], s[8:9], s[80:81]
v_mfma_f32_16x16x32_bf16 v[144:147], a[28:31], a[100:103], v[144:147]
ds_read_b64_tr_b16 a[40:41], v10 offset:16384
v_mfma_f32_16x16x32_bf16 v[148:151], a[28:31], a[108:111], v[148:151]
s_add_u32 m0, s24, 4096
v_mfma_f32_16x16x32_bf16 v[148:151], a[24:27], a[104:107], v[148:151]
ds_read_b64_tr_b16 a[42:43], v10 offset:17408
v_mfma_f32_16x16x32_bf16 v[152:155], a[24:27], a[112:115], v[152:155]
buffer_load_dwordx4 v1, s[4:7], s20 offen offset:0 lds
v_mfma_f32_16x16x32_bf16 v[152:155], a[28:31], a[116:119], v[152:155]
ds_read_b64_tr_b16 a[44:45], v10 offset:24576
v_mfma_f32_16x16x32_bf16 v[156:159], a[28:31], a[124:127], v[156:159]
v_mfma_f32_16x16x32_bf16 v[156:159], a[24:27], a[120:123], v[156:159]
ds_read_b64_tr_b16 a[46:47], v10 offset:25600
s_waitcnt lgkmcnt(8)
v_mfma_f32_16x16x32_bf16 v[32:35], a[0:3], a[64:67], v[32:35]
v_mfma_f32_16x16x32_bf16 v[32:35], a[4:7], a[68:71], v[32:35]
ds_read_b64_tr_b16 a[48:49], v11 offset:16384
v_mfma_f32_16x16x32_bf16 v[36:39], a[4:7], a[76:79], v[36:39]
buffer_load_dwordx4 v2, s[4:7], s20 offen offset:1024 lds
v_mfma_f32_16x16x32_bf16 v[36:39], a[0:3], a[72:75], v[36:39]
ds_read_b64_tr_b16 a[50:51], v11 offset:17408
v_mfma_f32_16x16x32_bf16 v[40:43], a[0:3], a[80:83], v[40:43]
v_mfma_f32_16x16x32_bf16 v[40:43], a[4:7], a[84:87], v[40:43]
ds_read_b64_tr_b16 a[52:53], v11 offset:24576
v_mfma_f32_16x16x32_bf16 v[44:47], a[4:7], a[92:95], v[44:47]
v_mfma_f32_16x16x32_bf16 v[44:47], a[0:3], a[88:91], v[44:47]
ds_read_b64_tr_b16 a[54:55], v11 offset:25600
v_mfma_f32_16x16x32_bf16 v[64:67], a[8:11], a[64:67], v[64:67]
buffer_load_dwordx4 v3, s[4:7], s20 offen offset:2048 lds
v_mfma_f32_16x16x32_bf16 v[64:67], a[12:15], a[68:71], v[64:67]
ds_read_b64_tr_b16 a[56:57], v12 offset:16384
v_mfma_f32_16x16x32_bf16 v[68:71], a[12:15], a[76:79], v[68:71]
v_mfma_f32_16x16x32_bf16 v[68:71], a[8:11], a[72:75], v[68:71]
ds_read_b64_tr_b16 a[58:59], v12 offset:17408
v_mfma_f32_16x16x32_bf16 v[72:75], a[8:11], a[80:83], v[72:75]
v_mfma_f32_16x16x32_bf16 v[72:75], a[12:15], a[84:87], v[72:75]
ds_read_b64_tr_b16 a[60:61], v12 offset:24576
v_mfma_f32_16x16x32_bf16 v[76:79], a[12:15], a[92:95], v[76:79]
buffer_load_dwordx4 v4, s[4:7], s20 offen offset:3072 lds
v_mfma_f32_16x16x32_bf16 v[76:79], a[8:11], a[88:91], v[76:79]
ds_read_b64_tr_b16 a[62:63], v12 offset:25600
v_mfma_f32_16x16x32_bf16 v[96:99], a[16:19], a[64:67], v[96:99]
s_add_u32 s20, s20, 128
v_mfma_f32_16x16x32_bf16 v[96:99], a[20:23], a[68:71], v[96:99]
v_mfma_f32_16x16x32_bf16 v[100:103], a[20:23], a[76:79], v[100:103]
v_mfma_f32_16x16x32_bf16 v[100:103], a[16:19], a[72:75], v[100:103]
v_mfma_f32_16x16x32_bf16 v[104:107], a[16:19], a[80:83], v[104:107]
v_mfma_f32_16x16x32_bf16 v[104:107], a[20:23], a[84:87], v[104:107]
v_mfma_f32_16x16x32_bf16 v[108:111], a[20:23], a[92:95], v[108:111]
v_mfma_f32_16x16x32_bf16 v[108:111], a[16:19], a[88:91], v[108:111]
v_mfma_f32_16x16x32_bf16 v[128:131], a[24:27], a[64:67], v[128:131]
v_mfma_f32_16x16x32_bf16 v[128:131], a[28:31], a[68:71], v[128:131]
v_mfma_f32_16x16x32_bf16 v[132:135], a[28:31], a[76:79], v[132:135]
v_mfma_f32_16x16x32_bf16 v[132:135], a[24:27], a[72:75], v[132:135]
v_mfma_f32_16x16x32_bf16 v[136:139], a[24:27], a[80:83], v[136:139]
v_mfma_f32_16x16x32_bf16 v[136:139], a[28:31], a[84:87], v[136:139]
v_mfma_f32_16x16x32_bf16 v[140:143], a[28:31], a[92:95], v[140:143]
s_waitcnt vmcnt(20) lgkmcnt(0)
v_mfma_f32_16x16x32_bf16 v[140:143], a[24:27], a[88:91], v[140:143]
s_barrier
v_mfma_f32_16x16x32_bf16 v[160:163], a[32:35], a[64:67], v[160:163]
s_add_u32 s24, s23, s27
s_add_u32 s23, s23, 32768
s_cmp_eq_u32 s23, 98304
v_mfma_f32_16x16x32_bf16 v[160:163], a[36:39], a[68:71], v[160:163]
ds_read_b64_tr_b16 a[0:1], v9 offset:32768
v_mfma_f32_16x16x32_bf16 v[164:167], a[36:39], a[76:79], v[164:167]
s_cselect_b32 s23, 0, s23
s_add_u32 m0, s25, 16384
v_mfma_f32_16x16x32_bf16 v[164:167], a[32:35], a[72:75], v[164:167]
ds_read_b64_tr_b16 a[2:3], v9 offset:33792
v_mfma_f32_16x16x32_bf16 v[168:171], a[32:35], a[80:83], v[168:171]
buffer_load_dwordx4 v5, s[8:11], s21 offen offset:0 lds
v_mfma_f32_16x16x32_bf16 v[168:171], a[36:39], a[84:87], v[168:171]
ds_read_b64_tr_b16 a[4:5], v9 offset:40960
v_mfma_f32_16x16x32_bf16 v[172:175], a[36:39], a[92:95], v[172:175]
v_add_u32 v15, s23, v13
v_xor_b32 v14, 64, v15
v_mfma_f32_16x16x32_bf16 v[172:175], a[32:35], a[88:91], v[172:175]
ds_read_b64_tr_b16 a[6:7], v9 offset:41984
v_mfma_f32_16x16x32_bf16 v[192:195], a[40:43], a[64:67], v[192:195]
v_mfma_f32_16x16x32_bf16 v[192:195], a[44:47], a[68:71], v[192:195]
ds_read_b64_tr_b16 a[8:9], v10 offset:32768
v_mfma_f32_16x16x32_bf16 v[196:199], a[44:47], a[76:79], v[196:199]
buffer_load_dwordx4 v6, s[8:11], s21 offen offset:1024 lds
v_mfma_f32_16x16x32_bf16 v[196:199], a[40:43], a[72:75], v[196:199]
ds_read_b64_tr_b16 a[10:11], v10 offset:33792
v_mfma_f32_16x16x32_bf16 v[200:203], a[40:43], a[80:83], v[200:203]
v_mfma_f32_16x16x32_bf16 v[200:203], a[44:47], a[84:87], v[200:203]
ds_read_b64_tr_b16 a[12:13], v10 offset:40960
v_mfma_f32_16x16x32_bf16 v[204:207], a[44:47], a[92:95], v[204:207]
v_mfma_f32_16x16x32_bf16 v[204:207], a[40:43], a[88:91], v[204:207]
ds_read_b64_tr_b16 a[14:15], v10 offset:41984
v_mfma_f32_16x16x32_bf16 v[224:227], a[48:51], a[64:67], v[224:227]
buffer_load_dwordx4 v7, s[8:11], s21 offen offset:2048 lds
v_mfma_f32_16x16x32_bf16 v[224:227], a[52:55], a[68:71], v[224:227]
ds_read_b64_tr_b16 a[16:17], v11 offset:32768
v_mfma_f32_16x16x32_bf16 v[228:231], a[52:55], a[76:79], v[228:231]
v_mfma_f32_16x16x32_bf16 v[228:231], a[48:51], a[72:75], v[228:231]
ds_read_b64_tr_b16 a[18:19], v11 offset:33792
v_mfma_f32_16x16x32_bf16 v[232:235], a[48:51], a[80:83], v[232:235]
v_mfma_f32_16x16x32_bf16 v[232:235], a[52:55], a[84:87], v[232:235]
ds_read_b64_tr_b16 a[20:21], v11 offset:40960
v_mfma_f32_16x16x32_bf16 v[236:239], a[52:55], a[92:95], v[236:239]
buffer_load_dwordx4 v8, s[8:11], s21 offen offset:3072 lds
v_mfma_f32_16x16x32_bf16 v[236:239], a[48:51], a[88:91], v[236:239]
ds_read_b64_tr_b16 a[22:23], v11 offset:41984
v_mfma_f32_16x16x32_bf16 a[128:131], a[56:59], a[64:67], a[128:131]
s_xor_b64 s[8:9], s[8:9], s[80:81]
s_add_u32 s21, s21, s22
v_mfma_f32_16x16x32_bf16 a[128:131], a[60:63], a[68:71], a[128:131]
ds_read_b64_tr_b16 a[24:25], v12 offset:32768
v_mfma_f32_16x16x32_bf16 a[132:135], a[60:63], a[76:79], a[132:135]
v_mfma_f32_16x16x32_bf16 a[132:135], a[56:59], a[72:75], a[132:135]
ds_read_b64_tr_b16 a[26:27], v12 offset:33792
v_mfma_f32_16x16x32_bf16 a[136:139], a[56:59], a[80:83], a[136:139]
v_mfma_f32_16x16x32_bf16 a[136:139], a[60:63], a[84:87], a[136:139]
ds_read_b64_tr_b16 a[28:29], v12 offset:40960
v_mfma_f32_16x16x32_bf16 a[140:143], a[60:63], a[92:95], a[140:143]
v_mfma_f32_16x16x32_bf16 a[140:143], a[56:59], a[88:91], a[140:143]
ds_read_b64_tr_b16 a[30:31], v12 offset:41984
v_mfma_f32_16x16x32_bf16 v[176:179], a[32:35], a[96:99], v[176:179]
v_mfma_f32_16x16x32_bf16 v[176:179], a[36:39], a[100:103], v[176:179]
ds_read_b128 a[64:67], v15 offset:0
v_mfma_f32_16x16x32_bf16 v[180:183], a[36:39], a[108:111], v[180:183]
v_mfma_f32_16x16x32_bf16 v[180:183], a[32:35], a[104:107], v[180:183]
ds_read_b128 a[68:71], v14 offset:0
v_mfma_f32_16x16x32_bf16 v[184:187], a[32:35], a[112:115], v[184:187]
v_mfma_f32_16x16x32_bf16 v[184:187], a[36:39], a[116:119], v[184:187]
ds_read_b128 a[72:75], v15 offset:2048
v_mfma_f32_16x16x32_bf16 v[188:191], a[36:39], a[124:127], v[188:191]
v_mfma_f32_16x16x32_bf16 v[188:191], a[32:35], a[120:123], v[188:191]
ds_read_b128 a[76:79], v14 offset:2048
v_mfma_f32_16x16x32_bf16 v[208:211], a[40:43], a[96:99], v[208:211]
v_mfma_f32_16x16x32_bf16 v[208:211], a[44:47], a[100:103], v[208:211]
ds_read_b128 a[80:83], v15 offset:4096
v_mfma_f32_16x16x32_bf16 v[212:215], a[44:47], a[108:111], v[212:215]
v_mfma_f32_16x16x32_bf16 v[212:215], a[40:43], a[104:107], v[212:215]
ds_read_b128 a[84:87], v14 offset:4096
v_mfma_f32_16x16x32_bf16 v[216:219], a[40:43], a[112:115], v[216:219]
v_mfma_f32_16x16x32_bf16 v[216:219], a[44:47], a[116:119], v[216:219]
ds_read_b128 a[88:91], v15 offset:6144
v_mfma_f32_16x16x32_bf16 v[220:223], a[44:47], a[124:127], v[220:223]
v_mfma_f32_16x16x32_bf16 v[220:223], a[40:43], a[120:123], v[220:223]
ds_read_b128 a[92:95], v14 offset:6144
v_mfma_f32_16x16x32_bf16 v[240:243], a[48:51], a[96:99], v[240:243]
v_mfma_f32_16x16x32_bf16 v[240:243], a[52:55], a[100:103], v[240:243]
v_mfma_f32_16x16x32_bf16 v[244:247], a[52:55], a[108:111], v[244:247]
v_mfma_f32_16x16x32_bf16 v[244:247], a[48:51], a[104:107], v[244:247]
v_mfma_f32_16x16x32_bf16 v[248:251], a[48:51], a[112:115], v[248:251]
v_mfma_f32_16x16x32_bf16 v[248:251], a[52:55], a[116:119], v[248:251]
v_mfma_f32_16x16x32_bf16 v[252:255], a[52:55], a[124:127], v[252:255]
v_mfma_f32_16x16x32_bf16 v[252:255], a[48:51], a[120:123], v[252:255]
v_mfma_f32_16x16x32_bf16 a[144:147], a[56:59], a[96:99], a[144:147]
v_mfma_f32_16x16x32_bf16 a[144:147], a[60:63], a[100:103], a[144:147]
v_mfma_f32_16x16x32_bf16 a[148:151], a[60:63], a[108:111], a[148:151]
v_mfma_f32_16x16x32_bf16 a[148:151], a[56:59], a[104:107], a[148:151]
v_mfma_f32_16x16x32_bf16 a[152:155], a[56:59], a[112:115], a[152:155]
v_mfma_f32_16x16x32_bf16 a[152:155], a[60:63], a[116:119], a[152:155]
v_mfma_f32_16x16x32_bf16 a[156:159], a[60:63], a[124:127], a[156:159]
s_waitcnt vmcnt(13) lgkmcnt(0)
v_mfma_f32_16x16x32_bf16 a[156:159], a[56:59], a[120:123], a[156:159]
s_barrier
v_mfma_f32_16x16x32_bf16 v[32:35], a[0:3], a[64:67], v[32:35]
v_mfma_f32_16x16x32_bf16 v[32:35], a[4:7], a[68:71], v[32:35]
ds_read_b128 a[96:99], v15 offset:8192
v_mfma_f32_16x16x32_bf16 v[36:39], a[4:7], a[76:79], v[36:39]
v_mfma_f32_16x16x32_bf16 v[36:39], a[0:3], a[72:75], v[36:39]
ds_read_b128 a[100:103], v14 offset:8192
v_mfma_f32_16x16x32_bf16 v[40:43], a[0:3], a[80:83], v[40:43]
v_mfma_f32_16x16x32_bf16 v[40:43], a[4:7], a[84:87], v[40:43]
ds_read_b128 a[104:107], v15 offset:10240
v_mfma_f32_16x16x32_bf16 v[44:47], a[4:7], a[92:95], v[44:47]
v_mfma_f32_16x16x32_bf16 v[44:47], a[0:3], a[88:91], v[44:47]
ds_read_b128 a[108:111], v14 offset:10240
v_mfma_f32_16x16x32_bf16 v[64:67], a[8:11], a[64:67], v[64:67]
s_mov_b32 s4, s42
s_mov_b32 s5, s43
v_mfma_f32_16x16x32_bf16 v[64:67], a[12:15], a[68:71], v[64:67]
ds_read_b128 a[112:115], v15 offset:12288
v_mfma_f32_16x16x32_bf16 v[68:71], a[12:15], a[76:79], v[68:71]
v_mfma_f32_16x16x32_bf16 v[68:71], a[8:11], a[72:75], v[68:71]
ds_read_b128 a[116:119], v14 offset:12288
v_mfma_f32_16x16x32_bf16 v[72:75], a[8:11], a[80:83], v[72:75]
s_mov_b32 s6, 3670016
s_mul_i32 s19, s2, 28672
v_mfma_f32_16x16x32_bf16 v[72:75], a[12:15], a[84:87], v[72:75]
ds_read_b128 a[120:123], v15 offset:14336
v_mfma_f32_16x16x32_bf16 v[76:79], a[12:15], a[92:95], v[76:79]
v_mfma_f32_16x16x32_bf16 v[76:79], a[8:11], a[88:91], v[76:79]
ds_read_b128 a[124:127], v14 offset:14336
v_mfma_f32_16x16x32_bf16 v[96:99], a[16:19], a[64:67], v[96:99]
s_mul_i32 s22, s16, 7168
s_add_u32 s19, s19, s22
v_mfma_f32_16x16x32_bf16 v[96:99], a[20:23], a[68:71], v[96:99]
ds_read_b64_tr_b16 a[32:33], v9 offset:49152
v_mfma_f32_16x16x32_bf16 v[100:103], a[20:23], a[76:79], v[100:103]
v_mfma_f32_16x16x32_bf16 v[100:103], a[16:19], a[72:75], v[100:103]
ds_read_b64_tr_b16 a[34:35], v9 offset:50176
v_mfma_f32_16x16x32_bf16 v[104:107], a[16:19], a[80:83], v[104:107]
s_add_u32 s22, s22, 131072
s_mul_i32 s20, s2, 7168
v_mfma_f32_16x16x32_bf16 v[104:107], a[20:23], a[84:87], v[104:107]
ds_read_b64_tr_b16 a[36:37], v9 offset:57344
v_mfma_f32_16x16x32_bf16 v[108:111], a[20:23], a[92:95], v[108:111]
v_mfma_f32_16x16x32_bf16 v[108:111], a[16:19], a[88:91], v[108:111]
ds_read_b64_tr_b16 a[38:39], v9 offset:58368
v_mfma_f32_16x16x32_bf16 v[128:131], a[24:27], a[64:67], v[128:131]
s_mul_i32 s21, s16, 1318912
s_add_u32 s20, s20, s21
v_mfma_f32_16x16x32_bf16 v[128:131], a[28:31], a[68:71], v[128:131]
ds_read_b64_tr_b16 a[40:41], v10 offset:49152
v_mfma_f32_16x16x32_bf16 v[132:135], a[28:31], a[76:79], v[132:135]
v_mfma_f32_16x16x32_bf16 v[132:135], a[24:27], a[72:75], v[132:135]
ds_read_b64_tr_b16 a[42:43], v10 offset:50176
v_mfma_f32_16x16x32_bf16 v[136:139], a[24:27], a[80:83], v[136:139]
s_add_u32 s20, s20, 75497472
s_mul_i32 s21, s16, 224
v_mfma_f32_16x16x32_bf16 v[136:139], a[28:31], a[84:87], v[136:139]
ds_read_b64_tr_b16 a[44:45], v10 offset:57344
v_mfma_f32_16x16x32_bf16 v[140:143], a[28:31], a[92:95], v[140:143]
v_mfma_f32_16x16x32_bf16 v[140:143], a[24:27], a[88:91], v[140:143]
ds_read_b64_tr_b16 a[46:47], v10 offset:58368
s_waitcnt lgkmcnt(8)
v_mfma_f32_16x16x32_bf16 v[48:51], a[0:3], a[96:99], v[48:51]
s_add_u32 s21, s21, 131072
v_lshrrev_b32 v17, 2, v0
v_mfma_f32_16x16x32_bf16 v[48:51], a[4:7], a[100:103], v[48:51]
ds_read_b64_tr_b16 a[48:49], v11 offset:49152
v_mfma_f32_16x16x32_bf16 v[52:55], a[4:7], a[108:111], v[52:55]
v_mfma_f32_16x16x32_bf16 v[52:55], a[0:3], a[104:107], v[52:55]
ds_read_b64_tr_b16 a[50:51], v11 offset:50176
v_mfma_f32_16x16x32_bf16 v[56:59], a[0:3], a[112:115], v[56:59]
v_mul_u32_u24 v17, 896, v17
v_and_b32 v18, 3, v0
v_mfma_f32_16x16x32_bf16 v[56:59], a[4:7], a[116:119], v[56:59]
ds_read_b64_tr_b16 a[52:53], v11 offset:57344
v_mfma_f32_16x16x32_bf16 v[60:63], a[4:7], a[124:127], v[60:63]
v_mfma_f32_16x16x32_bf16 v[60:63], a[0:3], a[120:123], v[60:63]
ds_read_b64_tr_b16 a[54:55], v11 offset:58368
v_mfma_f32_16x16x32_bf16 v[80:83], a[8:11], a[96:99], v[80:83]
v_lshl_add_u32 v17, v18, 3, v17
v_add_u32 v19, s21, v17
v_mfma_f32_16x16x32_bf16 v[80:83], a[12:15], a[100:103], v[80:83]
ds_read_b64_tr_b16 a[56:57], v12 offset:49152
v_mfma_f32_16x16x32_bf16 v[84:87], a[12:15], a[108:111], v[84:87]
v_mfma_f32_16x16x32_bf16 v[84:87], a[8:11], a[104:107], v[84:87]
ds_read_b64_tr_b16 a[58:59], v12 offset:50176
v_mfma_f32_16x16x32_bf16 v[88:91], a[8:11], a[112:115], v[88:91]
v_mfma_f32_16x16x32_bf16 v[88:91], a[12:15], a[116:119], v[88:91]
ds_read_b64_tr_b16 a[60:61], v12 offset:57344
v_mfma_f32_16x16x32_bf16 v[92:95], a[12:15], a[124:127], v[92:95]
v_mfma_f32_16x16x32_bf16 v[92:95], a[8:11], a[120:123], v[92:95]
ds_read_b64_tr_b16 a[62:63], v12 offset:58368
v_mfma_f32_16x16x32_bf16 v[112:115], a[16:19], a[96:99], v[112:115]
v_mfma_f32_16x16x32_bf16 v[112:115], a[20:23], a[100:103], v[112:115]
v_mfma_f32_16x16x32_bf16 v[116:119], a[20:23], a[108:111], v[116:119]
v_mfma_f32_16x16x32_bf16 v[116:119], a[16:19], a[104:107], v[116:119]
v_mfma_f32_16x16x32_bf16 v[120:123], a[16:19], a[112:115], v[120:123]
v_mfma_f32_16x16x32_bf16 v[120:123], a[20:23], a[116:119], v[120:123]
v_mfma_f32_16x16x32_bf16 v[124:127], a[20:23], a[124:127], v[124:127]
v_mfma_f32_16x16x32_bf16 v[124:127], a[16:19], a[120:123], v[124:127]
v_mfma_f32_16x16x32_bf16 v[144:147], a[24:27], a[96:99], v[144:147]
v_mfma_f32_16x16x32_bf16 v[144:147], a[28:31], a[100:103], v[144:147]
v_mfma_f32_16x16x32_bf16 v[148:151], a[28:31], a[108:111], v[148:151]
v_mfma_f32_16x16x32_bf16 v[148:151], a[24:27], a[104:107], v[148:151]
v_mfma_f32_16x16x32_bf16 v[152:155], a[24:27], a[112:115], v[152:155]
v_mfma_f32_16x16x32_bf16 v[152:155], a[28:31], a[116:119], v[152:155]
v_mfma_f32_16x16x32_bf16 v[156:159], a[28:31], a[124:127], v[156:159]
s_waitcnt vmcnt(4) lgkmcnt(0)
v_mfma_f32_16x16x32_bf16 v[156:159], a[24:27], a[120:123], v[156:159]
s_barrier
s_cmp_eq_u32 s16, 0
s_cbranch_scc0 L_sig1
s_lshl_b32 s31, s2, 8
s_add_u32 s31, s31, 82903040
v_mov_b32 v23, 1
v_mov_b32 v24, 0
s_mov_b64 exec, 1
buffer_store_dword v23, v24, s[12:15], s31 offen sc0 sc1
s_mov_b64 exec, -1
L_sig1:
v_mfma_f32_16x16x32_bf16 v[176:179], a[32:35], a[96:99], v[176:179]
s_add_u32 s24, s23, s27
s_add_u32 s23, s23, 32768
s_cmp_eq_u32 s23, 98304
v_mfma_f32_16x16x32_bf16 v[176:179], a[36:39], a[100:103], v[176:179]
ds_read_b64_tr_b16 a[0:1], v9 offset:0
v_mfma_f32_16x16x32_bf16 v[180:183], a[36:39], a[108:111], v[180:183]
s_cselect_b32 s23, 0, s23
v_mfma_f32_16x16x32_bf16 v[180:183], a[32:35], a[104:107], v[180:183]
ds_read_b64_tr_b16 a[2:3], v9 offset:1024
v_mfma_f32_16x16x32_bf16 v[184:187], a[32:35], a[112:115], v[184:187]
v_mfma_f32_16x16x32_bf16 v[184:187], a[36:39], a[116:119], v[184:187]
ds_read_b64_tr_b16 a[4:5], v9 offset:8192
v_mfma_f32_16x16x32_bf16 v[188:191], a[36:39], a[124:127], v[188:191]
v_add_u32 v15, s23, v13
v_xor_b32 v14, 64, v15
v_mfma_f32_16x16x32_bf16 v[188:191], a[32:35], a[120:123], v[188:191]
ds_read_b64_tr_b16 a[6:7], v9 offset:9216
v_mfma_f32_16x16x32_bf16 v[208:211], a[40:43], a[96:99], v[208:211]
s_mov_b32 m0, s22
v_mfma_f32_16x16x32_bf16 v[208:211], a[44:47], a[100:103], v[208:211]
ds_read_b64_tr_b16 a[8:9], v10 offset:0
v_mfma_f32_16x16x32_bf16 v[212:215], a[44:47], a[108:111], v[212:215]
v_mfma_f32_16x16x32_bf16 v[212:215], a[40:43], a[104:107], v[212:215]
ds_read_b64_tr_b16 a[10:11], v10 offset:1024
v_mfma_f32_16x16x32_bf16 v[216:219], a[40:43], a[112:115], v[216:219]
buffer_load_dwordx4 v16, s[4:7], s19 offen offset:0 lds
v_mfma_f32_16x16x32_bf16 v[216:219], a[44:47], a[116:119], v[216:219]
ds_read_b64_tr_b16 a[12:13], v10 offset:8192
v_mfma_f32_16x16x32_bf16 v[220:223], a[44:47], a[124:127], v[220:223]
v_mfma_f32_16x16x32_bf16 v[220:223], a[40:43], a[120:123], v[220:223]
ds_read_b64_tr_b16 a[14:15], v10 offset:9216
v_mfma_f32_16x16x32_bf16 v[240:243], a[48:51], a[96:99], v[240:243]
buffer_load_dwordx4 v16, s[4:7], s19 offen offset:1024 lds
v_mfma_f32_16x16x32_bf16 v[240:243], a[52:55], a[100:103], v[240:243]
ds_read_b64_tr_b16 a[16:17], v11 offset:0
v_mfma_f32_16x16x32_bf16 v[244:247], a[52:55], a[108:111], v[244:247]
v_mfma_f32_16x16x32_bf16 v[244:247], a[48:51], a[104:107], v[244:247]
ds_read_b64_tr_b16 a[18:19], v11 offset:1024
v_mfma_f32_16x16x32_bf16 v[248:251], a[48:51], a[112:115], v[248:251]
buffer_load_dwordx4 v16, s[4:7], s19 offen offset:2048 lds
v_mfma_f32_16x16x32_bf16 v[248:251], a[52:55], a[116:119], v[248:251]
ds_read_b64_tr_b16 a[20:21], v11 offset:8192
v_mfma_f32_16x16x32_bf16 v[252:255], a[52:55], a[124:127], v[252:255]
v_mfma_f32_16x16x32_bf16 v[252:255], a[48:51], a[120:123], v[252:255]
ds_read_b64_tr_b16 a[22:23], v11 offset:9216
v_mfma_f32_16x16x32_bf16 a[144:147], a[56:59], a[96:99], a[144:147]
buffer_load_dwordx4 v16, s[4:7], s19 offen offset:3072 lds
v_mfma_f32_16x16x32_bf16 a[144:147], a[60:63], a[100:103], a[144:147]
ds_read_b64_tr_b16 a[24:25], v12 offset:0
v_mfma_f32_16x16x32_bf16 a[148:151], a[60:63], a[108:111], a[148:151]
v_mfma_f32_16x16x32_bf16 a[148:151], a[56:59], a[104:107], a[148:151]
ds_read_b64_tr_b16 a[26:27], v12 offset:1024
v_mfma_f32_16x16x32_bf16 a[152:155], a[56:59], a[112:115], a[152:155]
s_add_u32 m0, m0, 4096
s_add_u32 s19, s19, 4096
v_mfma_f32_16x16x32_bf16 a[152:155], a[60:63], a[116:119], a[152:155]
ds_read_b64_tr_b16 a[28:29], v12 offset:8192
v_mfma_f32_16x16x32_bf16 a[156:159], a[60:63], a[124:127], a[156:159]
v_mfma_f32_16x16x32_bf16 a[156:159], a[56:59], a[120:123], a[156:159]
ds_read_b64_tr_b16 a[30:31], v12 offset:9216
v_mfma_f32_16x16x32_bf16 v[160:163], a[32:35], a[64:67], v[160:163]
buffer_load_dwordx4 v16, s[4:7], s19 offen offset:0 lds
v_mfma_f32_16x16x32_bf16 v[160:163], a[36:39], a[68:71], v[160:163]
ds_read_b128 a[96:99], v15 offset:8192
v_mfma_f32_16x16x32_bf16 v[164:167], a[36:39], a[76:79], v[164:167]
v_mfma_f32_16x16x32_bf16 v[164:167], a[32:35], a[72:75], v[164:167]
ds_read_b128 a[100:103], v14 offset:8192
v_mfma_f32_16x16x32_bf16 v[168:171], a[32:35], a[80:83], v[168:171]
buffer_load_dwordx4 v16, s[4:7], s19 offen offset:1024 lds
v_mfma_f32_16x16x32_bf16 v[168:171], a[36:39], a[84:87], v[168:171]
ds_read_b128 a[104:107], v15 offset:10240
v_mfma_f32_16x16x32_bf16 v[172:175], a[36:39], a[92:95], v[172:175]
v_mfma_f32_16x16x32_bf16 v[172:175], a[32:35], a[88:91], v[172:175]
ds_read_b128 a[108:111], v14 offset:10240
v_mfma_f32_16x16x32_bf16 v[192:195], a[40:43], a[64:67], v[192:195]
buffer_load_dwordx4 v16, s[4:7], s19 offen offset:2048 lds
v_mfma_f32_16x16x32_bf16 v[192:195], a[44:47], a[68:71], v[192:195]
ds_read_b128 a[112:115], v15 offset:12288
v_mfma_f32_16x16x32_bf16 v[196:199], a[44:47], a[76:79], v[196:199]
v_mfma_f32_16x16x32_bf16 v[196:199], a[40:43], a[72:75], v[196:199]
ds_read_b128 a[116:119], v14 offset:12288
v_mfma_f32_16x16x32_bf16 v[200:203], a[40:43], a[80:83], v[200:203]
v_mfma_f32_16x16x32_bf16 v[200:203], a[44:47], a[84:87], v[200:203]
ds_read_b128 a[120:123], v15 offset:14336
v_mfma_f32_16x16x32_bf16 v[204:207], a[44:47], a[92:95], v[204:207]
v_mfma_f32_16x16x32_bf16 v[204:207], a[40:43], a[88:91], v[204:207]
ds_read_b128 a[124:127], v14 offset:14336
v_mfma_f32_16x16x32_bf16 v[224:227], a[48:51], a[64:67], v[224:227]
v_mfma_f32_16x16x32_bf16 v[224:227], a[52:55], a[68:71], v[224:227]
v_mfma_f32_16x16x32_bf16 v[228:231], a[52:55], a[76:79], v[228:231]
v_mfma_f32_16x16x32_bf16 v[228:231], a[48:51], a[72:75], v[228:231]
v_mfma_f32_16x16x32_bf16 v[232:235], a[48:51], a[80:83], v[232:235]
v_mfma_f32_16x16x32_bf16 v[232:235], a[52:55], a[84:87], v[232:235]
v_mfma_f32_16x16x32_bf16 v[236:239], a[52:55], a[92:95], v[236:239]
v_mfma_f32_16x16x32_bf16 v[236:239], a[48:51], a[88:91], v[236:239]
v_mfma_f32_16x16x32_bf16 a[128:131], a[56:59], a[64:67], a[128:131]
v_mfma_f32_16x16x32_bf16 a[128:131], a[60:63], a[68:71], a[128:131]
v_mfma_f32_16x16x32_bf16 a[132:135], a[60:63], a[76:79], a[132:135]
v_mfma_f32_16x16x32_bf16 a[132:135], a[56:59], a[72:75], a[132:135]
v_mfma_f32_16x16x32_bf16 a[136:139], a[56:59], a[80:83], a[136:139]
v_mfma_f32_16x16x32_bf16 a[136:139], a[60:63], a[84:87], a[136:139]
v_mfma_f32_16x16x32_bf16 a[140:143], a[60:63], a[92:95], a[140:143]
s_waitcnt vmcnt(7) lgkmcnt(0)
v_mfma_f32_16x16x32_bf16 a[140:143], a[56:59], a[88:91], a[140:143]
s_barrier
v_mfma_f32_16x16x32_bf16 v[48:51], a[0:3], a[96:99], v[48:51]
v_and_b32 v21, 7, v0
v_lshlrev_b32 v21, 11, v21
v_bfe_u32 v22, v0, 3, 1
v_mfma_f32_16x16x32_bf16 v[48:51], a[4:7], a[100:103], v[48:51]
ds_read_b128 a[64:67], v15 offset:0
v_mfma_f32_16x16x32_bf16 v[52:55], a[4:7], a[108:111], v[52:55]
v_lshl_add_u32 v21, v22, 15, v21
s_and_b32 s47, s2, 0x47
s_lshl_b32 s47, s47, 8
v_mfma_f32_16x16x32_bf16 v[52:55], a[0:3], a[104:107], v[52:55]
ds_read_b128 a[68:71], v14 offset:0
v_mfma_f32_16x16x32_bf16 v[56:59], a[0:3], a[112:115], v[56:59]
s_add_u32 s47, s47, 82903040
s_mov_b32 s4, s29
s_mov_b32 s5, s20
s_mov_b32 s8, s18
v_mfma_f32_16x16x32_bf16 v[56:59], a[4:7], a[116:119], v[56:59]
ds_read_b128 a[72:75], v15 offset:2048
v_mfma_f32_16x16x32_bf16 v[60:63], a[4:7], a[124:127], v[60:63]
s_mov_b32 s9, s17
s_bfe_u32 s34, s2, 0x10002
s_lshl_b32 s34, s34, 1
v_mfma_f32_16x16x32_bf16 v[60:63], a[0:3], a[120:123], v[60:63]
ds_read_b128 a[76:79], v14 offset:2048
v_mfma_f32_16x16x32_bf16 v[80:83], a[8:11], a[96:99], v[80:83]
s_and_b32 s41, s2, 1
s_add_u32 s34, s34, s41
s_and_b32 s41, s2, 2
s_lshl_b32 s32, s41, 1
v_mfma_f32_16x16x32_bf16 v[80:83], a[12:15], a[100:103], v[80:83]
ds_read_b128 a[80:83], v15 offset:4096
v_mfma_f32_16x16x32_bf16 v[84:87], a[12:15], a[108:111], v[84:87]
s_and_b32 s44, s2, 5
s_bfe_u32 s42, s2, 0x20005
s_add_u32 s32, s32, s42
v_mfma_f32_16x16x32_bf16 v[84:87], a[8:11], a[104:107], v[84:87]
ds_read_b128 a[84:87], v14 offset:4096
v_mfma_f32_16x16x32_bf16 v[88:91], a[8:11], a[112:115], v[88:91]
s_lshr_b32 s42, s2, 7
s_xor_b32 s42, s42, 1
s_lshl_b32 s42, s42, 3
v_mfma_f32_16x16x32_bf16 v[88:91], a[12:15], a[116:119], v[88:91]
ds_read_b128 a[88:91], v15 offset:6144
v_mfma_f32_16x16x32_bf16 v[92:95], a[12:15], a[124:127], v[92:95]
s_add_u32 s32, s32, s42
s_bfe_u32 s33, s2, 0x20003
v_mov_b32 v26, v16
v_add_u32 v27, 188416, v16
v_mfma_f32_16x16x32_bf16 v[92:95], a[8:11], a[120:123], v[92:95]
ds_read_b128 a[92:95], v14 offset:6144
v_mfma_f32_16x16x32_bf16 v[112:115], a[16:19], a[96:99], v[112:115]
s_lshl_b32 s41, s32, 2
s_add_u32 s41, s41, s16
s_mul_i32 s41, s41, 376832
v_mfma_f32_16x16x32_bf16 v[112:115], a[20:23], a[100:103], v[112:115]
ds_read_b64_tr_b16 a[32:33], v9 offset:16384
v_mfma_f32_16x16x32_bf16 v[116:119], a[20:23], a[108:111], v[116:119]
s_add_u32 s41, s41, 50331648
s_mul_i32 s42, s34, 14336
s_add_u32 s35, s41, s42
s_add_u32 s35, s35, 131072
v_mfma_f32_16x16x32_bf16 v[116:119], a[16:19], a[104:107], v[116:119]
ds_read_b64_tr_b16 a[34:35], v9 offset:17408
v_mfma_f32_16x16x32_bf16 v[120:123], a[16:19], a[112:115], v[120:123]
s_lshl_b32 s42, s44, 14
s_add_u32 s36, s41, s42
s_mul_i32 s41, s33, 1318912
v_mfma_f32_16x16x32_bf16 v[120:123], a[20:23], a[116:119], v[120:123]
ds_read_b64_tr_b16 a[36:37], v9 offset:24576
v_mfma_f32_16x16x32_bf16 v[124:127], a[20:23], a[124:127], v[124:127]
s_lshl_b32 s42, s16, 12
s_add_u32 s41, s41, s42
s_cmp_eq_u32 s16, 3
v_mfma_f32_16x16x32_bf16 v[124:127], a[16:19], a[120:123], v[124:127]
ds_read_b64_tr_b16 a[38:39], v9 offset:25600
v_mfma_f32_16x16x32_bf16 v[144:147], a[24:27], a[96:99], v[144:147]
s_cselect_b32 s42, 1024, 0
s_sub_u32 s41, s41, s42
s_add_u32 s41, s41, 75497472
s_mul_i32 s42, s34, 100352
v_mfma_f32_16x16x32_bf16 v[144:147], a[28:31], a[100:103], v[144:147]
ds_read_b64_tr_b16 a[40:41], v10 offset:16384
v_mfma_f32_16x16x32_bf16 v[148:151], a[28:31], a[108:111], v[148:151]
s_add_u32 s37, s41, s42
s_add_u32 s37, s37, 917504
s_mul_i32 s42, s44, 114688
v_mfma_f32_16x16x32_bf16 v[148:151], a[24:27], a[104:107], v[148:151]
ds_read_b64_tr_b16 a[42:43], v10 offset:17408
v_mfma_f32_16x16x32_bf16 v[152:155], a[24:27], a[112:115], v[152:155]
s_add_u32 s38, s41, s42
s_cmp_ge_u32 s16, 2
s_cselect_b32 s39, 0x40000000, 0
s_lshl_b32 s40, s16, 12
v_mfma_f32_16x16x32_bf16 v[152:155], a[28:31], a[116:119], v[152:155]
ds_read_b64_tr_b16 a[44:45], v10 offset:24576
v_mfma_f32_16x16x32_bf16 v[156:159], a[28:31], a[124:127], v[156:159]
s_lshl_b32 s41, s44, 4
s_mul_i32 s42, s34, 14
s_add_u32 s43, s42, 416
v_mfma_f32_16x16x32_bf16 v[156:159], a[24:27], a[120:123], v[156:159]
ds_read_b64_tr_b16 a[46:47], v10 offset:25600
s_waitcnt lgkmcnt(8)
v_mfma_f32_16x16x32_bf16 v[32:35], a[0:3], a[64:67], v[32:35]
v_and_b32 v28, 16, v0
v_add3_u32 v29, v28, v0, s41
v_min_u32 v28, 45, v0
v_mfma_f32_16x16x32_bf16 v[32:35], a[4:7], a[68:71], v[32:35]
ds_read_b64_tr_b16 a[48:49], v11 offset:16384
v_mfma_f32_16x16x32_bf16 v[36:39], a[4:7], a[76:79], v[36:39]
v_add_u32 v28, s43, v28
v_cmp_gt_u32 vcc, 32, v0
v_lshrrev_b32 v28, 2, v28
s_and_b32 s41, s41, 64
v_mfma_f32_16x16x32_bf16 v[36:39], a[0:3], a[72:75], v[36:39]
ds_read_b64_tr_b16 a[50:51], v11 offset:17408
v_mfma_f32_16x16x32_bf16 v[40:43], a[0:3], a[80:83], v[40:43]
v_cndmask_b32 v29, v28, v29, vcc
v_cmp_gt_u32 vcc, 56, v0
v_add_u32 v28, s41, v0
v_mfma_f32_16x16x32_bf16 v[40:43], a[4:7], a[84:87], v[40:43]
ds_read_b64_tr_b16 a[52:53], v11 offset:24576
v_mfma_f32_16x16x32_bf16 v[44:47], a[4:7], a[92:95], v[44:47]
s_nop 0
v_cndmask_b32 v29, v28, v29, vcc
s_lshr_b32 s42, s42, 2
s_add_u32 s41, s42, 0
v_mfma_f32_16x16x32_bf16 v[44:47], a[0:3], a[88:91], v[44:47]
ds_read_b64_tr_b16 a[54:55], v11 offset:25600
v_mfma_f32_16x16x32_bf16 v[64:67], a[8:11], a[64:67], v[64:67]
s_min_u32 s41, s41, 13
s_lshl_b32 s41, s41, 3
s_lshr_b32 s43, s32, 1
v_mfma_f32_16x16x32_bf16 v[64:67], a[12:15], a[68:71], v[64:67]
ds_read_b64_tr_b16 a[56:57], v12 offset:16384
v_mfma_f32_16x16x32_bf16 v[68:71], a[12:15], a[76:79], v[68:71]
s_add_u32 s41, s41, s43
s_mul_i32 s43, s41, 4682
s_lshr_b32 s43, s43, 16
v_mfma_f32_16x16x32_bf16 v[68:71], a[8:11], a[72:75], v[68:71]
ds_read_b64_tr_b16 a[58:59], v12 offset:17408
v_mfma_f32_16x16x32_bf16 v[72:75], a[8:11], a[80:83], v[72:75]
s_lshl_b32 s41, s41, 3
s_mul_i32 s43, s43, 111
s_sub_u32 s41, s41, s43
v_writelane_b32 v29, s41, 46
v_mfma_f32_16x16x32_bf16 v[72:75], a[12:15], a[84:87], v[72:75]
ds_read_b64_tr_b16 a[60:61], v12 offset:24576
v_mfma_f32_16x16x32_bf16 v[76:79], a[12:15], a[92:95], v[76:79]
s_add_u32 s41, s42, 1
s_min_u32 s41, s41, 13
s_lshl_b32 s41, s41, 3
v_mfma_f32_16x16x32_bf16 v[76:79], a[8:11], a[88:91], v[76:79]
ds_read_b64_tr_b16 a[62:63], v12 offset:25600
v_mfma_f32_16x16x32_bf16 v[96:99], a[16:19], a[64:67], v[96:99]
s_lshr_b32 s43, s32, 1
s_add_u32 s41, s41, s43
s_mul_i32 s43, s41, 4682
s_lshr_b32 s43, s43, 16
v_mfma_f32_16x16x32_bf16 v[96:99], a[20:23], a[68:71], v[96:99]
s_lshl_b32 s41, s41, 3
s_mul_i32 s43, s43, 111
s_sub_u32 s41, s41, s43
v_mfma_f32_16x16x32_bf16 v[100:103], a[20:23], a[76:79], v[100:103]
v_writelane_b32 v29, s41, 47
s_add_u32 s41, s42, 2
s_min_u32 s41, s41, 13
v_mfma_f32_16x16x32_bf16 v[100:103], a[16:19], a[72:75], v[100:103]
s_lshl_b32 s41, s41, 3
s_lshr_b32 s43, s32, 1
s_add_u32 s41, s41, s43
s_mul_i32 s43, s41, 4682
v_mfma_f32_16x16x32_bf16 v[104:107], a[16:19], a[80:83], v[104:107]
s_lshr_b32 s43, s43, 16
s_lshl_b32 s41, s41, 3
s_mul_i32 s43, s43, 111
v_mfma_f32_16x16x32_bf16 v[104:107], a[20:23], a[84:87], v[104:107]
s_sub_u32 s41, s41, s43
v_writelane_b32 v29, s41, 48
s_add_u32 s41, s42, 3
s_min_u32 s41, s41, 13
v_mfma_f32_16x16x32_bf16 v[108:111], a[20:23], a[92:95], v[108:111]
s_lshl_b32 s41, s41, 3
s_lshr_b32 s43, s32, 1
s_add_u32 s41, s41, s43
v_mfma_f32_16x16x32_bf16 v[108:111], a[16:19], a[88:91], v[108:111]
s_mul_i32 s43, s41, 4682
s_lshr_b32 s43, s43, 16
s_lshl_b32 s41, s41, 3
v_mfma_f32_16x16x32_bf16 v[128:131], a[24:27], a[64:67], v[128:131]
s_mul_i32 s43, s43, 111
s_sub_u32 s41, s41, s43
v_writelane_b32 v29, s41, 49
s_add_u32 s41, s42, 4
v_mfma_f32_16x16x32_bf16 v[128:131], a[28:31], a[68:71], v[128:131]
s_min_u32 s41, s41, 13
s_lshl_b32 s41, s41, 3
s_lshr_b32 s43, s32, 1
v_mfma_f32_16x16x32_bf16 v[132:135], a[28:31], a[76:79], v[132:135]
s_add_u32 s41, s41, s43
s_mul_i32 s43, s41, 4682
s_lshr_b32 s43, s43, 16
s_lshl_b32 s41, s41, 3
v_mfma_f32_16x16x32_bf16 v[132:135], a[24:27], a[72:75], v[132:135]
s_mul_i32 s43, s43, 111
s_sub_u32 s41, s41, s43
v_writelane_b32 v29, s41, 50
v_mfma_f32_16x16x32_bf16 v[136:139], a[24:27], a[80:83], v[136:139]
s_add_u32 s41, s32, 112
v_writelane_b32 v29, s41, 51
v_lshlrev_b32 v29, 8, v29
s_mov_b32 s45, 82903056
v_mfma_f32_16x16x32_bf16 v[136:139], a[28:31], a[84:87], v[136:139]
v_mfma_f32_16x16x32_bf16 v[140:143], a[28:31], a[92:95], v[140:143]
s_waitcnt vmcnt(0) lgkmcnt(0)
v_mfma_f32_16x16x32_bf16 v[140:143], a[24:27], a[88:91], v[140:143]
s_barrier
v_mfma_f32_16x16x32_bf16 v[160:163], a[32:35], a[64:67], v[160:163]
v_lshlrev_b32 v1, 4, v0
v_mfma_f32_16x16x32_bf16 v[160:163], a[36:39], a[68:71], v[160:163]
ds_read_b64_tr_b16 a[224:225], v19 offset:0
v_mfma_f32_16x16x32_bf16 v[164:167], a[36:39], a[76:79], v[164:167]
s_lshl_b32 s17, s16, 13
v_mfma_f32_16x16x32_bf16 v[164:167], a[32:35], a[72:75], v[164:167]
ds_read_b64_tr_b16 a[226:227], v19 offset:14336
v_mfma_f32_16x16x32_bf16 v[168:171], a[32:35], a[80:83], v[168:171]
s_and_b32 s29, s2, 7
s_lshr_b32 s30, s2, 3
v_mfma_f32_16x16x32_bf16 v[168:171], a[36:39], a[84:87], v[168:171]
ds_read_b64_tr_b16 a[228:229], v19 offset:32
v_mfma_f32_16x16x32_bf16 v[172:175], a[36:39], a[92:95], v[172:175]
s_lshl_b32 s65, s29, 1
v_mfma_f32_16x16x32_bf16 v[172:175], a[32:35], a[88:91], v[172:175]
ds_read_b64_tr_b16 a[230:231], v19 offset:14368
v_mfma_f32_16x16x32_bf16 v[192:195], a[40:43], a[64:67], v[192:195]
s_bfe_u32 s29, s30, 0x10003
v_mfma_f32_16x16x32_bf16 v[192:195], a[44:47], a[68:71], v[192:195]
ds_read_b64_tr_b16 a[232:233], v19 offset:64
v_mfma_f32_16x16x32_bf16 v[196:199], a[44:47], a[76:79], v[196:199]
s_add_u32 s65, s65, s29
s_lshr_b32 s25, s30, 4
v_mfma_f32_16x16x32_bf16 v[196:199], a[40:43], a[72:75], v[196:199]
ds_read_b64_tr_b16 a[234:235], v19 offset:14400
v_mfma_f32_16x16x32_bf16 v[200:203], a[40:43], a[80:83], v[200:203]
s_and_b32 s66, s30, 7
v_mfma_f32_16x16x32_bf16 v[200:203], a[44:47], a[84:87], v[200:203]
ds_read_b64_tr_b16 a[236:237], v19 offset:96
v_mfma_f32_16x16x32_bf16 v[204:207], a[44:47], a[92:95], v[204:207]
s_sub_u32 s67, 15, s66
s_lshl_b32 s31, s66, 1
v_mfma_f32_16x16x32_bf16 v[204:207], a[40:43], a[88:91], v[204:207]
ds_read_b64_tr_b16 a[238:239], v19 offset:14432
v_mfma_f32_16x16x32_bf16 v[224:227], a[48:51], a[64:67], v[224:227]
s_sub_u32 s31, 15, s31
v_mfma_f32_16x16x32_bf16 v[224:227], a[52:55], a[68:71], v[224:227]
ds_read_b64_tr_b16 a[240:241], v19 offset:128
v_mfma_f32_16x16x32_bf16 v[228:231], a[52:55], a[76:79], v[228:231]
s_lshl_b32 s29, s65, 20
v_mfma_f32_16x16x32_bf16 v[228:231], a[48:51], a[72:75], v[228:231]
ds_read_b64_tr_b16 a[242:243], v19 offset:14464
v_mfma_f32_16x16x32_bf16 v[232:235], a[48:51], a[80:83], v[232:235]
s_lshl_b32 s30, s67, 16
s_add_u32 s26, s29, s30
v_mfma_f32_16x16x32_bf16 v[232:235], a[52:55], a[84:87], v[232:235]
ds_read_b64_tr_b16 a[244:245], v19 offset:160
v_mfma_f32_16x16x32_bf16 v[236:239], a[52:55], a[92:95], v[236:239]
s_add_u32 s29, s29, s17
v_mfma_f32_16x16x32_bf16 v[236:239], a[48:51], a[88:91], v[236:239]
ds_read_b64_tr_b16 a[246:247], v19 offset:14496
v_mfma_f32_16x16x32_bf16 a[128:131], a[56:59], a[64:67], a[128:131]
s_sub_u32 s69, 16, s31
s_mov_b32 s10, 28672
v_mfma_f32_16x16x32_bf16 a[128:131], a[60:63], a[68:71], a[128:131]
ds_read_b64_tr_b16 a[248:249], v19 offset:192
v_mfma_f32_16x16x32_bf16 a[132:135], a[60:63], a[76:79], a[132:135]
s_cmp_eq_u32 s25, 0
v_mfma_f32_16x16x32_bf16 a[132:135], a[56:59], a[72:75], a[132:135]
ds_read_b64_tr_b16 a[250:251], v19 offset:14528
v_mfma_f32_16x16x32_bf16 a[136:139], a[56:59], a[80:83], a[136:139]
s_cselect_b32 s30, 32768, 0
v_mfma_f32_16x16x32_bf16 a[136:139], a[60:63], a[84:87], a[136:139]
v_mfma_f32_16x16x32_bf16 a[140:143], a[60:63], a[92:95], a[140:143]
s_cselect_b32 s23, 0x7fff, s31
s_cselect_b32 s69, s69, s31
v_mfma_f32_16x16x32_bf16 a[140:143], a[56:59], a[88:91], a[140:143]
v_mfma_f32_16x16x32_bf16 v[176:179], a[32:35], a[96:99], v[176:179]
v_mfma_f32_16x16x32_bf16 v[176:179], a[36:39], a[100:103], v[176:179]
buffer_load_dword v22, v21, s[12:15], s47 offen sc0 sc1
v_mfma_f32_16x16x32_bf16 v[180:183], a[36:39], a[108:111], v[180:183]
s_cselect_b32 s10, 4294930432, s10
v_mfma_f32_16x16x32_bf16 v[180:183], a[32:35], a[104:107], v[180:183]
s_mov_b32 s11, s10
s_lshl_b32 s31, s30, 4
v_mfma_f32_16x16x32_bf16 v[184:187], a[32:35], a[112:115], v[184:187]
s_add_u32 s29, s29, s31
v_mfma_f32_16x16x32_bf16 v[184:187], a[36:39], a[116:119], v[184:187]
s_add_u32 s72, s29, 16777216
v_mfma_f32_16x16x32_bf16 v[188:191], a[36:39], a[124:127], v[188:191]
s_add_u32 s73, s29, 33554432
s_sub_u32 s20, s72, s30
v_mfma_f32_16x16x32_bf16 v[188:191], a[32:35], a[120:123], v[188:191]
s_sub_u32 s21, s73, s30
v_mfma_f32_16x16x32_bf16 v[208:211], a[40:43], a[96:99], v[208:211]
s_mov_b32 s60, s56
s_mov_b32 s61, s57
v_mfma_f32_16x16x32_bf16 v[208:211], a[44:47], a[100:103], v[208:211]
s_mov_b32 s62, 256
v_mfma_f32_16x16x32_bf16 v[212:215], a[44:47], a[108:111], v[212:215]
s_mov_b32 s63, 0x20000
v_mfma_f32_16x16x32_bf16 v[212:215], a[40:43], a[104:107], v[212:215]
s_or_b32 s71, s2, 128
s_lshl_b32 s71, s71, 8
v_mfma_f32_16x16x32_bf16 v[216:219], a[40:43], a[112:115], v[216:219]
s_add_u32 s71, s71, 82903040
v_mfma_f32_16x16x32_bf16 v[216:219], a[44:47], a[116:119], v[216:219]
v_and_b32 v4, 15, v0
v_lshrrev_b32 v14, 4, v0
v_mfma_f32_16x16x32_bf16 v[220:223], a[44:47], a[124:127], v[220:223]
v_lshlrev_b32 v14, 2, v14
v_mfma_f32_16x16x32_bf16 v[220:223], a[40:43], a[120:123], v[220:223]
v_sub_u32 v4, v4, v14
v_mfma_f32_16x16x32_bf16 v[240:243], a[48:51], a[96:99], v[240:243]
s_mov_b32 s27, 0x3db8aa3b
s_mov_b32 s28, 1149239296
v_mfma_f32_16x16x32_bf16 v[240:243], a[52:55], a[100:103], v[240:243]
s_lshl_b32 s29, s65, 3
v_mfma_f32_16x16x32_bf16 v[244:247], a[52:55], a[108:111], v[244:247]
s_add_u32 s29, s29, s66
s_mul_i32 s70, s29, 69632
v_mfma_f32_16x16x32_bf16 v[244:247], a[48:51], a[104:107], v[244:247]
s_mul_i32 s30, s16, 17408
v_mfma_f32_16x16x32_bf16 v[248:251], a[48:51], a[112:115], v[248:251]
s_add_u32 s70, s70, s30
v_mfma_f32_16x16x32_bf16 v[248:251], a[52:55], a[116:119], v[248:251]
s_add_u32 s70, s70, 83886080
s_sub_u32 s83, s23, 1
v_mfma_f32_16x16x32_bf16 v[252:255], a[52:55], a[124:127], v[252:255]
s_lshl_b32 s24, 3, s83
v_mfma_f32_16x16x32_bf16 v[252:255], a[48:51], a[120:123], v[252:255]
s_cmp_eq_u32 s25, 0
s_cselect_b32 s24, 0, s24
v_mfma_f32_16x16x32_bf16 a[144:147], a[56:59], a[96:99], a[144:147]
s_cselect_b32 s68, 340, s24
v_mfma_f32_16x16x32_bf16 a[144:147], a[60:63], a[100:103], a[144:147]
s_or_b32 s68, s68, 20480
v_mfma_f32_16x16x32_bf16 a[148:151], a[60:63], a[108:111], a[148:151]
v_mov_b32 v8, 0
v_mov_b32 v9, 0
v_mfma_f32_16x16x32_bf16 a[148:151], a[56:59], a[104:107], a[148:151]
s_mov_b32 s22, 0
v_mfma_f32_16x16x32_bf16 a[152:155], a[56:59], a[112:115], a[152:155]
v_add_u32 v3, 131072, v1
v_add_u32 v2, 0, v1
v_mfma_f32_16x16x32_bf16 a[152:155], a[60:63], a[116:119], a[152:155]
v_mfma_f32_16x16x32_bf16 a[156:159], a[60:63], a[124:127], a[156:159]
s_waitcnt vmcnt(0) lgkmcnt(0)
v_mfma_f32_16x16x32_bf16 a[156:159], a[56:59], a[120:123], a[156:159]
s_barrier
s_mov_b32 s31, 256
v_cmp_gt_u32 vcc, s31, v30
v_mov_b32 v5, 0
s_nop 3
s_cbranch_vccnz L_kv2_s
v_cmp_ne_u32 vcc, 1, v22
s_nop 4
s_cbranch_vccz L_kv2_ok
s_branch L_kv2_p
L_kv2_s:
s_mov_b32 s30, 0
L_poll3:
buffer_load_dword v14, v5, s[60:63], 0 offen sc0 sc1
s_waitcnt vmcnt(0)
v_cmp_gt_u32 vcc, s31, v14
s_nop 4
s_cbranch_vccnz L_poll3_r
s_branch L_poll3_ok
L_poll3_r:
s_add_u32 s30, s30, 1
s_cmp_lt_u32 s30, 32768
s_sleep 32
s_cbranch_scc1 L_poll3
L_poll3_ok:
L_kv2_p:
s_mov_b32 s30, 0
L_poll4:
buffer_load_dword v22, v21, s[12:15], s47 offen sc0 sc1
s_waitcnt vmcnt(0)
v_cmp_ne_u32 vcc, 1, v22
s_nop 4
s_cbranch_vccnz L_poll4_r
s_branch L_poll4_ok
L_poll4_r:
s_add_u32 s30, s30, 1
s_cmp_lt_u32 s30, 32768
s_sleep 4
s_cbranch_scc1 L_poll4
L_poll4_ok:
L_kv2_ok:
s_nop 7
s_mov_b32 s7, 0xbfb8aa3b
v_pk_mul_f32 v[32:33], v[32:33], s[6:7] op_sel:[0,1] op_sel_hi:[1,1]
v_pk_mul_f32 v[34:35], v[34:35], s[6:7] op_sel:[0,1] op_sel_hi:[1,1]
v_exp_f32 v32, v32
v_exp_f32 v33, v33
v_exp_f32 v34, v34
v_exp_f32 v35, v35
s_add_u32 m0, s17, 131072
s_nop 0
buffer_load_dwordx4 v1, s[12:15], s20 offen offset:0 lds
v_pk_add_f32 v[32:33], v[32:33], 1.0 op_sel:[0,0] op_sel_hi:[1,0]
v_pk_add_f32 v[34:35], v[34:35], 1.0 op_sel:[0,0] op_sel_hi:[1,0]
v_rcp_f32 v32, v32
v_rcp_f32 v33, v33
v_rcp_f32 v34, v34
v_rcp_f32 v35, v35
buffer_load_dwordx4 v1, s[12:15], s20 offen offset:1024 lds
v_pk_mul_f32 v[32:33], v[32:33], v[160:161] op_sel:[0,0] op_sel_hi:[1,1]
v_pk_mul_f32 v[34:35], v[34:35], v[162:163] op_sel:[0,0] op_sel_hi:[1,1]
v_pk_mul_f32 v[64:65], v[64:65], s[6:7] op_sel:[0,1] op_sel_hi:[1,1]
v_pk_mul_f32 v[66:67], v[66:67], s[6:7] op_sel:[0,1] op_sel_hi:[1,1]
v_exp_f32 v64, v64
v_exp_f32 v65, v65
v_exp_f32 v66, v66
v_exp_f32 v67, v67
buffer_load_dwordx4 v1, s[12:15], s20 offen offset:2048 lds
v_pk_add_f32 v[64:65], v[64:65], 1.0 op_sel:[0,0] op_sel_hi:[1,0]
v_pk_add_f32 v[66:67], v[66:67], 1.0 op_sel:[0,0] op_sel_hi:[1,0]
v_rcp_f32 v64, v64
v_rcp_f32 v65, v65
v_rcp_f32 v66, v66
v_rcp_f32 v67, v67
buffer_load_dwordx4 v1, s[12:15], s20 offen offset:3072 lds
s_add_u32 s20, s20, 4096
s_add_u32 m0, s17, 135168
s_nop 0
v_pk_mul_f32 v[64:65], v[64:65], v[192:193] op_sel:[0,0] op_sel_hi:[1,1]
v_pk_mul_f32 v[66:67], v[66:67], v[194:195] op_sel:[0,0] op_sel_hi:[1,1]
v_cvt_pk_bf16_f32 v32, v32, v33
v_cvt_pk_bf16_f32 v33, v34, v35
v_cvt_pk_bf16_f32 v34, v64, v65
v_cvt_pk_bf16_f32 v35, v66, v67
v_accvgpr_write_b32 a160, v32
v_accvgpr_write_b32 a161, v33
v_accvgpr_write_b32 a162, v34
v_accvgpr_write_b32 a163, v35
v_pk_mul_f32 v[96:97], v[96:97], s[6:7] op_sel:[0,1] op_sel_hi:[1,1]
v_pk_mul_f32 v[98:99], v[98:99], s[6:7] op_sel:[0,1] op_sel_hi:[1,1]
v_exp_f32 v96, v96
v_exp_f32 v97, v97
v_exp_f32 v98, v98
v_exp_f32 v99, v99
buffer_load_dwordx4 v1, s[12:15], s20 offen offset:0 lds
v_pk_add_f32 v[96:97], v[96:97], 1.0 op_sel:[0,0] op_sel_hi:[1,0]
v_pk_add_f32 v[98:99], v[98:99], 1.0 op_sel:[0,0] op_sel_hi:[1,0]
v_rcp_f32 v96, v96
v_rcp_f32 v97, v97
v_rcp_f32 v98, v98
v_rcp_f32 v99, v99
buffer_load_dwordx4 v1, s[12:15], s20 offen offset:1024 lds
v_pk_mul_f32 v[96:97], v[96:97], v[224:225] op_sel:[0,0] op_sel_hi:[1,1]
v_pk_mul_f32 v[98:99], v[98:99], v[226:227] op_sel:[0,0] op_sel_hi:[1,1]
v_accvgpr_read_b32 v160, a128
v_accvgpr_read_b32 v161, a129
v_accvgpr_read_b32 v162, a130
v_accvgpr_read_b32 v163, a131
v_pk_mul_f32 v[128:129], v[128:129], s[6:7] op_sel:[0,1] op_sel_hi:[1,1]
v_pk_mul_f32 v[130:131], v[130:131], s[6:7] op_sel:[0,1] op_sel_hi:[1,1]
v_exp_f32 v128, v128
v_exp_f32 v129, v129
v_exp_f32 v130, v130
v_exp_f32 v131, v131
buffer_load_dwordx4 v1, s[12:15], s20 offen offset:2048 lds
v_pk_add_f32 v[128:129], v[128:129], 1.0 op_sel:[0,0] op_sel_hi:[1,0]
v_pk_add_f32 v[130:131], v[130:131], 1.0 op_sel:[0,0] op_sel_hi:[1,0]
v_rcp_f32 v128, v128
v_rcp_f32 v129, v129
v_rcp_f32 v130, v130
v_rcp_f32 v131, v131
buffer_load_dwordx4 v1, s[12:15], s20 offen offset:3072 lds
s_add_u32 s20, s20, s10
s_cmp_eq_u32 s69, 1
s_cselect_b32 s20, s72, s20
s_cselect_b32 s10, 28672, s10
s_add_u32 m0, s17, 0
s_nop 0
v_pk_mul_f32 v[128:129], v[128:129], v[160:161] op_sel:[0,0] op_sel_hi:[1,1]
v_pk_mul_f32 v[130:131], v[130:131], v[162:163] op_sel:[0,0] op_sel_hi:[1,1]
v_cvt_pk_bf16_f32 v96, v96, v97
v_cvt_pk_bf16_f32 v97, v98, v99
v_cvt_pk_bf16_f32 v98, v128, v129
v_cvt_pk_bf16_f32 v99, v130, v131
v_accvgpr_write_b32 a164, v96
v_accvgpr_write_b32 a165, v97
v_accvgpr_write_b32 a166, v98
v_accvgpr_write_b32 a167, v99
v_pk_mul_f32 v[36:37], v[36:37], s[6:7] op_sel:[0,1] op_sel_hi:[1,1]
v_pk_mul_f32 v[38:39], v[38:39], s[6:7] op_sel:[0,1] op_sel_hi:[1,1]
v_exp_f32 v36, v36
v_exp_f32 v37, v37
v_exp_f32 v38, v38
v_exp_f32 v39, v39
buffer_load_dwordx4 v1, s[12:15], s20 offen offset:0 lds
v_pk_add_f32 v[36:37], v[36:37], 1.0 op_sel:[0,0] op_sel_hi:[1,0]
v_pk_add_f32 v[38:39], v[38:39], 1.0 op_sel:[0,0] op_sel_hi:[1,0]
v_rcp_f32 v36, v36
v_rcp_f32 v37, v37
v_rcp_f32 v38, v38
v_rcp_f32 v39, v39
buffer_load_dwordx4 v1, s[12:15], s20 offen offset:1024 lds
v_pk_mul_f32 v[36:37], v[36:37], v[164:165] op_sel:[0,0] op_sel_hi:[1,1]
v_pk_mul_f32 v[38:39], v[38:39], v[166:167] op_sel:[0,0] op_sel_hi:[1,1]
v_pk_mul_f32 v[68:69], v[68:69], s[6:7] op_sel:[0,1] op_sel_hi:[1,1]
v_pk_mul_f32 v[70:71], v[70:71], s[6:7] op_sel:[0,1] op_sel_hi:[1,1]
v_exp_f32 v68, v68
v_exp_f32 v69, v69
v_exp_f32 v70, v70
v_exp_f32 v71, v71
buffer_load_dwordx4 v1, s[12:15], s20 offen offset:2048 lds
v_pk_add_f32 v[68:69], v[68:69], 1.0 op_sel:[0,0] op_sel_hi:[1,0]
v_pk_add_f32 v[70:71], v[70:71], 1.0 op_sel:[0,0] op_sel_hi:[1,0]
v_rcp_f32 v68, v68
v_rcp_f32 v69, v69
v_rcp_f32 v70, v70
v_rcp_f32 v71, v71
buffer_load_dwordx4 v1, s[12:15], s20 offen offset:3072 lds
s_add_u32 s20, s20, 4096
s_add_u32 m0, s17, 4096
s_nop 0
v_pk_mul_f32 v[68:69], v[68:69], v[196:197] op_sel:[0,0] op_sel_hi:[1,1]
v_pk_mul_f32 v[70:71], v[70:71], v[198:199] op_sel:[0,0] op_sel_hi:[1,1]
v_cvt_pk_bf16_f32 v36, v36, v37
v_cvt_pk_bf16_f32 v37, v38, v39
v_cvt_pk_bf16_f32 v38, v68, v69
v_cvt_pk_bf16_f32 v39, v70, v71
v_accvgpr_write_b32 a168, v36
v_accvgpr_write_b32 a169, v37
v_accvgpr_write_b32 a170, v38
v_accvgpr_write_b32 a171, v39
v_pk_mul_f32 v[100:101], v[100:101], s[6:7] op_sel:[0,1] op_sel_hi:[1,1]
v_pk_mul_f32 v[102:103], v[102:103], s[6:7] op_sel:[0,1] op_sel_hi:[1,1]
v_exp_f32 v100, v100
v_exp_f32 v101, v101
v_exp_f32 v102, v102
v_exp_f32 v103, v103
buffer_load_dwordx4 v1, s[12:15], s20 offen offset:0 lds
v_pk_add_f32 v[100:101], v[100:101], 1.0 op_sel:[0,0] op_sel_hi:[1,0]
v_pk_add_f32 v[102:103], v[102:103], 1.0 op_sel:[0,0] op_sel_hi:[1,0]
v_rcp_f32 v100, v100
v_rcp_f32 v101, v101
v_rcp_f32 v102, v102
v_rcp_f32 v103, v103
buffer_load_dwordx4 v1, s[12:15], s20 offen offset:1024 lds
v_pk_mul_f32 v[100:101], v[100:101], v[228:229] op_sel:[0,0] op_sel_hi:[1,1]
v_pk_mul_f32 v[102:103], v[102:103], v[230:231] op_sel:[0,0] op_sel_hi:[1,1]
v_accvgpr_read_b32 v164, a132
v_accvgpr_read_b32 v165, a133
v_accvgpr_read_b32 v166, a134
v_accvgpr_read_b32 v167, a135
v_pk_mul_f32 v[132:133], v[132:133], s[6:7] op_sel:[0,1] op_sel_hi:[1,1]
v_pk_mul_f32 v[134:135], v[134:135], s[6:7] op_sel:[0,1] op_sel_hi:[1,1]
v_exp_f32 v132, v132
v_exp_f32 v133, v133
v_exp_f32 v134, v134
v_exp_f32 v135, v135
buffer_load_dwordx4 v1, s[12:15], s20 offen offset:2048 lds
v_pk_add_f32 v[132:133], v[132:133], 1.0 op_sel:[0,0] op_sel_hi:[1,0]
v_pk_add_f32 v[134:135], v[134:135], 1.0 op_sel:[0,0] op_sel_hi:[1,0]
v_rcp_f32 v132, v132
v_rcp_f32 v133, v133
v_rcp_f32 v134, v134
v_rcp_f32 v135, v135
buffer_load_dwordx4 v1, s[12:15], s20 offen offset:3072 lds
s_add_u32 s20, s20, s10
s_add_u32 m0, s17, 32768
s_nop 0
v_pk_mul_f32 v[132:133], v[132:133], v[164:165] op_sel:[0,0] op_sel_hi:[1,1]
v_pk_mul_f32 v[134:135], v[134:135], v[166:167] op_sel:[0,0] op_sel_hi:[1,1]
v_cvt_pk_bf16_f32 v100, v100, v101
v_cvt_pk_bf16_f32 v101, v102, v103
v_cvt_pk_bf16_f32 v102, v132, v133
v_cvt_pk_bf16_f32 v103, v134, v135
v_accvgpr_write_b32 a172, v100
v_accvgpr_write_b32 a173, v101
v_accvgpr_write_b32 a174, v102
v_accvgpr_write_b32 a175, v103
v_pk_mul_f32 v[40:41], v[40:41], s[6:7] op_sel:[0,1] op_sel_hi:[1,1]
v_pk_mul_f32 v[42:43], v[42:43], s[6:7] op_sel:[0,1] op_sel_hi:[1,1]
v_exp_f32 v40, v40
v_exp_f32 v41, v41
v_exp_f32 v42, v42
v_exp_f32 v43, v43
buffer_load_dwordx4 v1, s[12:15], s21 offen offset:0 lds
v_pk_add_f32 v[40:41], v[40:41], 1.0 op_sel:[0,0] op_sel_hi:[1,0]
v_pk_add_f32 v[42:43], v[42:43], 1.0 op_sel:[0,0] op_sel_hi:[1,0]
v_rcp_f32 v40, v40
v_rcp_f32 v41, v41
v_rcp_f32 v42, v42
v_rcp_f32 v43, v43
buffer_load_dwordx4 v1, s[12:15], s21 offen offset:1024 lds
v_pk_mul_f32 v[40:41], v[40:41], v[168:169] op_sel:[0,0] op_sel_hi:[1,1]
v_pk_mul_f32 v[42:43], v[42:43], v[170:171] op_sel:[0,0] op_sel_hi:[1,1]
v_pk_mul_f32 v[72:73], v[72:73], s[6:7] op_sel:[0,1] op_sel_hi:[1,1]
v_pk_mul_f32 v[74:75], v[74:75], s[6:7] op_sel:[0,1] op_sel_hi:[1,1]
v_exp_f32 v72, v72
v_exp_f32 v73, v73
v_exp_f32 v74, v74
v_exp_f32 v75, v75
buffer_load_dwordx4 v1, s[12:15], s21 offen offset:2048 lds
v_pk_add_f32 v[72:73], v[72:73], 1.0 op_sel:[0,0] op_sel_hi:[1,0]
v_pk_add_f32 v[74:75], v[74:75], 1.0 op_sel:[0,0] op_sel_hi:[1,0]
v_rcp_f32 v72, v72
v_rcp_f32 v73, v73
v_rcp_f32 v74, v74
v_rcp_f32 v75, v75
buffer_load_dwordx4 v1, s[12:15], s21 offen offset:3072 lds
s_add_u32 s21, s21, 4096
s_add_u32 m0, s17, 36864
s_nop 0
v_pk_mul_f32 v[72:73], v[72:73], v[200:201] op_sel:[0,0] op_sel_hi:[1,1]
v_pk_mul_f32 v[74:75], v[74:75], v[202:203] op_sel:[0,0] op_sel_hi:[1,1]
v_cvt_pk_bf16_f32 v40, v40, v41
v_cvt_pk_bf16_f32 v41, v42, v43
v_cvt_pk_bf16_f32 v42, v72, v73
v_cvt_pk_bf16_f32 v43, v74, v75
v_accvgpr_write_b32 a176, v40
v_accvgpr_write_b32 a177, v41
v_accvgpr_write_b32 a178, v42
v_accvgpr_write_b32 a179, v43
v_pk_mul_f32 v[104:105], v[104:105], s[6:7] op_sel:[0,1] op_sel_hi:[1,1]
v_pk_mul_f32 v[106:107], v[106:107], s[6:7] op_sel:[0,1] op_sel_hi:[1,1]
v_exp_f32 v104, v104
v_exp_f32 v105, v105
v_exp_f32 v106, v106
v_exp_f32 v107, v107
buffer_load_dwordx4 v1, s[12:15], s21 offen offset:0 lds
v_pk_add_f32 v[104:105], v[104:105], 1.0 op_sel:[0,0] op_sel_hi:[1,0]
v_pk_add_f32 v[106:107], v[106:107], 1.0 op_sel:[0,0] op_sel_hi:[1,0]
v_rcp_f32 v104, v104
v_rcp_f32 v105, v105
v_rcp_f32 v106, v106
v_rcp_f32 v107, v107
buffer_load_dwordx4 v1, s[12:15], s21 offen offset:1024 lds
v_pk_mul_f32 v[104:105], v[104:105], v[232:233] op_sel:[0,0] op_sel_hi:[1,1]
v_pk_mul_f32 v[106:107], v[106:107], v[234:235] op_sel:[0,0] op_sel_hi:[1,1]
v_accvgpr_read_b32 v168, a136
v_accvgpr_read_b32 v169, a137
v_accvgpr_read_b32 v170, a138
v_accvgpr_read_b32 v171, a139
v_pk_mul_f32 v[136:137], v[136:137], s[6:7] op_sel:[0,1] op_sel_hi:[1,1]
v_pk_mul_f32 v[138:139], v[138:139], s[6:7] op_sel:[0,1] op_sel_hi:[1,1]
v_exp_f32 v136, v136
v_exp_f32 v137, v137
v_exp_f32 v138, v138
v_exp_f32 v139, v139
buffer_load_dwordx4 v1, s[12:15], s21 offen offset:2048 lds
v_pk_add_f32 v[136:137], v[136:137], 1.0 op_sel:[0,0] op_sel_hi:[1,0]
v_pk_add_f32 v[138:139], v[138:139], 1.0 op_sel:[0,0] op_sel_hi:[1,0]
v_rcp_f32 v136, v136
v_rcp_f32 v137, v137
v_rcp_f32 v138, v138
v_rcp_f32 v139, v139
buffer_load_dwordx4 v1, s[12:15], s21 offen offset:3072 lds
s_add_u32 s21, s21, s11
v_pk_mul_f32 v[136:137], v[136:137], v[168:169] op_sel:[0,0] op_sel_hi:[1,1]
v_pk_mul_f32 v[138:139], v[138:139], v[170:171] op_sel:[0,0] op_sel_hi:[1,1]
v_cvt_pk_bf16_f32 v104, v104, v105
v_cvt_pk_bf16_f32 v105, v106, v107
v_cvt_pk_bf16_f32 v106, v136, v137
v_cvt_pk_bf16_f32 v107, v138, v139
v_accvgpr_write_b32 a180, v104
v_accvgpr_write_b32 a181, v105
v_accvgpr_write_b32 a182, v106
v_accvgpr_write_b32 a183, v107
v_pk_mul_f32 v[44:45], v[44:45], s[6:7] op_sel:[0,1] op_sel_hi:[1,1]
v_pk_mul_f32 v[46:47], v[46:47], s[6:7] op_sel:[0,1] op_sel_hi:[1,1]
v_exp_f32 v44, v44
v_exp_f32 v45, v45
v_exp_f32 v46, v46
v_exp_f32 v47, v47
s_nop 0
v_pk_add_f32 v[44:45], v[44:45], 1.0 op_sel:[0,0] op_sel_hi:[1,0]
v_pk_add_f32 v[46:47], v[46:47], 1.0 op_sel:[0,0] op_sel_hi:[1,0]
v_rcp_f32 v44, v44
v_rcp_f32 v45, v45
v_rcp_f32 v46, v46
v_rcp_f32 v47, v47
v_pk_mul_f32 v[44:45], v[44:45], v[172:173] op_sel:[0,0] op_sel_hi:[1,1]
v_pk_mul_f32 v[46:47], v[46:47], v[174:175] op_sel:[0,0] op_sel_hi:[1,1]
v_pk_mul_f32 v[76:77], v[76:77], s[6:7] op_sel:[0,1] op_sel_hi:[1,1]
v_pk_mul_f32 v[78:79], v[78:79], s[6:7] op_sel:[0,1] op_sel_hi:[1,1]
v_exp_f32 v76, v76
v_exp_f32 v77, v77
v_exp_f32 v78, v78
v_exp_f32 v79, v79
s_nop 0
v_pk_add_f32 v[76:77], v[76:77], 1.0 op_sel:[0,0] op_sel_hi:[1,0]
v_pk_add_f32 v[78:79], v[78:79], 1.0 op_sel:[0,0] op_sel_hi:[1,0]
v_rcp_f32 v76, v76
v_rcp_f32 v77, v77
v_rcp_f32 v78, v78
v_rcp_f32 v79, v79
v_pk_mul_f32 v[76:77], v[76:77], v[204:205] op_sel:[0,0] op_sel_hi:[1,1]
v_pk_mul_f32 v[78:79], v[78:79], v[206:207] op_sel:[0,0] op_sel_hi:[1,1]
v_cvt_pk_bf16_f32 v44, v44, v45
v_cvt_pk_bf16_f32 v45, v46, v47
v_cvt_pk_bf16_f32 v46, v76, v77
v_cvt_pk_bf16_f32 v47, v78, v79
v_accvgpr_write_b32 a184, v44
v_accvgpr_write_b32 a185, v45
v_accvgpr_write_b32 a186, v46
v_accvgpr_write_b32 a187, v47
v_pk_mul_f32 v[108:109], v[108:109], s[6:7] op_sel:[0,1] op_sel_hi:[1,1]
v_pk_mul_f32 v[110:111], v[110:111], s[6:7] op_sel:[0,1] op_sel_hi:[1,1]
v_exp_f32 v108, v108
v_exp_f32 v109, v109
v_exp_f32 v110, v110
v_exp_f32 v111, v111
s_nop 0
v_pk_add_f32 v[108:109], v[108:109], 1.0 op_sel:[0,0] op_sel_hi:[1,0]
v_pk_add_f32 v[110:111], v[110:111], 1.0 op_sel:[0,0] op_sel_hi:[1,0]
v_rcp_f32 v108, v108
v_rcp_f32 v109, v109
v_rcp_f32 v110, v110
v_rcp_f32 v111, v111
v_pk_mul_f32 v[108:109], v[108:109], v[236:237] op_sel:[0,0] op_sel_hi:[1,1]
v_pk_mul_f32 v[110:111], v[110:111], v[238:239] op_sel:[0,0] op_sel_hi:[1,1]
v_accvgpr_read_b32 v172, a140
v_accvgpr_read_b32 v173, a141
v_accvgpr_read_b32 v174, a142
v_accvgpr_read_b32 v175, a143
v_pk_mul_f32 v[140:141], v[140:141], s[6:7] op_sel:[0,1] op_sel_hi:[1,1]
v_pk_mul_f32 v[142:143], v[142:143], s[6:7] op_sel:[0,1] op_sel_hi:[1,1]
v_exp_f32 v140, v140
v_exp_f32 v141, v141
v_exp_f32 v142, v142
v_exp_f32 v143, v143
s_nop 0
v_pk_add_f32 v[140:141], v[140:141], 1.0 op_sel:[0,0] op_sel_hi:[1,0]
v_pk_add_f32 v[142:143], v[142:143], 1.0 op_sel:[0,0] op_sel_hi:[1,0]
v_rcp_f32 v140, v140
v_rcp_f32 v141, v141
v_rcp_f32 v142, v142
v_rcp_f32 v143, v143
v_pk_mul_f32 v[140:141], v[140:141], v[172:173] op_sel:[0,0] op_sel_hi:[1,1]
v_pk_mul_f32 v[142:143], v[142:143], v[174:175] op_sel:[0,0] op_sel_hi:[1,1]
v_cvt_pk_bf16_f32 v108, v108, v109
v_cvt_pk_bf16_f32 v109, v110, v111
v_cvt_pk_bf16_f32 v110, v140, v141
v_cvt_pk_bf16_f32 v111, v142, v143
v_accvgpr_write_b32 a188, v108
v_accvgpr_write_b32 a189, v109
v_accvgpr_write_b32 a190, v110
v_accvgpr_write_b32 a191, v111
v_mov_b32 v15, 0
s_mov_b32 s30, 0
L_poll5:
buffer_load_dword v14, v15, s[12:15], s71 offen offset:4 sc0 sc1
s_waitcnt vmcnt(0)
v_cmp_ne_u32 vcc, 1, v14
s_nop 4
s_cbranch_vccnz L_poll5_r
s_branch L_poll5_ok
L_poll5_r:
s_add_u32 s30, s30, 1
s_cmp_lt_u32 s30, 32768
s_sleep 4
s_cbranch_scc1 L_poll5
L_poll5_ok:
s_add_u32 s30, s26, s17
s_sub_u32 s29, s26, s17
s_add_u32 s29, s29, 57344
buffer_load_dwordx4 a[0:3], v1, s[12:15], s30 offen offset:0
buffer_load_dwordx4 a[32:35], v1, s[12:15], s29 offen offset:0
buffer_load_dwordx4 a[4:7], v1, s[12:15], s30 offen offset:1024
buffer_load_dwordx4 a[36:39], v1, s[12:15], s29 offen offset:1024
buffer_load_dwordx4 a[8:11], v1, s[12:15], s30 offen offset:2048
buffer_load_dwordx4 a[40:43], v1, s[12:15], s29 offen offset:2048
buffer_load_dwordx4 a[12:15], v1, s[12:15], s30 offen offset:3072
buffer_load_dwordx4 a[44:47], v1, s[12:15], s29 offen offset:3072
s_add_u32 s30, s30, 4096
s_add_u32 s29, s29, 4096
buffer_load_dwordx4 a[16:19], v1, s[12:15], s30 offen offset:0
buffer_load_dwordx4 a[48:51], v1, s[12:15], s29 offen offset:0
buffer_load_dwordx4 a[20:23], v1, s[12:15], s30 offen offset:1024
buffer_load_dwordx4 a[52:55], v1, s[12:15], s29 offen offset:1024
buffer_load_dwordx4 a[24:27], v1, s[12:15], s30 offen offset:2048
buffer_load_dwordx4 a[56:59], v1, s[12:15], s29 offen offset:2048
buffer_load_dwordx4 a[28:31], v1, s[12:15], s30 offen offset:3072
buffer_load_dwordx4 a[60:63], v1, s[12:15], s29 offen offset:3072
v_pk_mul_f32 v[48:49], v[48:49], s[6:7] op_sel:[0,1] op_sel_hi:[1,1]
v_pk_mul_f32 v[50:51], v[50:51], s[6:7] op_sel:[0,1] op_sel_hi:[1,1]
v_exp_f32 v48, v48
v_exp_f32 v49, v49
v_exp_f32 v50, v50
v_exp_f32 v51, v51
s_nop 0
v_pk_add_f32 v[48:49], v[48:49], 1.0 op_sel:[0,0] op_sel_hi:[1,0]
v_pk_add_f32 v[50:51], v[50:51], 1.0 op_sel:[0,0] op_sel_hi:[1,0]
v_rcp_f32 v48, v48
v_rcp_f32 v49, v49
v_rcp_f32 v50, v50
v_rcp_f32 v51, v51
v_pk_mul_f32 v[48:49], v[48:49], v[176:177] op_sel:[0,0] op_sel_hi:[1,1]
v_pk_mul_f32 v[50:51], v[50:51], v[178:179] op_sel:[0,0] op_sel_hi:[1,1]
v_pk_mul_f32 v[80:81], v[80:81], s[6:7] op_sel:[0,1] op_sel_hi:[1,1]
v_pk_mul_f32 v[82:83], v[82:83], s[6:7] op_sel:[0,1] op_sel_hi:[1,1]
v_exp_f32 v80, v80
v_exp_f32 v81, v81
v_exp_f32 v82, v82
v_exp_f32 v83, v83
s_nop 0
v_pk_add_f32 v[80:81], v[80:81], 1.0 op_sel:[0,0] op_sel_hi:[1,0]
v_pk_add_f32 v[82:83], v[82:83], 1.0 op_sel:[0,0] op_sel_hi:[1,0]
v_rcp_f32 v80, v80
v_rcp_f32 v81, v81
v_rcp_f32 v82, v82
v_rcp_f32 v83, v83
v_pk_mul_f32 v[80:81], v[80:81], v[208:209] op_sel:[0,0] op_sel_hi:[1,1]
v_pk_mul_f32 v[82:83], v[82:83], v[210:211] op_sel:[0,0] op_sel_hi:[1,1]
v_cvt_pk_bf16_f32 v48, v48, v49
v_cvt_pk_bf16_f32 v49, v50, v51
v_cvt_pk_bf16_f32 v50, v80, v81
v_cvt_pk_bf16_f32 v51, v82, v83
v_accvgpr_write_b32 a192, v48
v_accvgpr_write_b32 a193, v49
v_accvgpr_write_b32 a194, v50
v_accvgpr_write_b32 a195, v51
v_pk_mul_f32 v[112:113], v[112:113], s[6:7] op_sel:[0,1] op_sel_hi:[1,1]
v_pk_mul_f32 v[114:115], v[114:115], s[6:7] op_sel:[0,1] op_sel_hi:[1,1]
v_exp_f32 v112, v112
v_exp_f32 v113, v113
v_exp_f32 v114, v114
v_exp_f32 v115, v115
s_nop 0
v_pk_add_f32 v[112:113], v[112:113], 1.0 op_sel:[0,0] op_sel_hi:[1,0]
v_pk_add_f32 v[114:115], v[114:115], 1.0 op_sel:[0,0] op_sel_hi:[1,0]
v_rcp_f32 v112, v112
v_rcp_f32 v113, v113
v_rcp_f32 v114, v114
v_rcp_f32 v115, v115
v_pk_mul_f32 v[112:113], v[112:113], v[240:241] op_sel:[0,0] op_sel_hi:[1,1]
v_pk_mul_f32 v[114:115], v[114:115], v[242:243] op_sel:[0,0] op_sel_hi:[1,1]
v_accvgpr_read_b32 v176, a144
v_accvgpr_read_b32 v177, a145
v_accvgpr_read_b32 v178, a146
v_accvgpr_read_b32 v179, a147
v_pk_mul_f32 v[144:145], v[144:145], s[6:7] op_sel:[0,1] op_sel_hi:[1,1]
v_pk_mul_f32 v[146:147], v[146:147], s[6:7] op_sel:[0,1] op_sel_hi:[1,1]
v_exp_f32 v144, v144
v_exp_f32 v145, v145
v_exp_f32 v146, v146
v_exp_f32 v147, v147
s_nop 0
v_pk_add_f32 v[144:145], v[144:145], 1.0 op_sel:[0,0] op_sel_hi:[1,0]
v_pk_add_f32 v[146:147], v[146:147], 1.0 op_sel:[0,0] op_sel_hi:[1,0]
v_rcp_f32 v144, v144
v_rcp_f32 v145, v145
v_rcp_f32 v146, v146
v_rcp_f32 v147, v147
v_pk_mul_f32 v[144:145], v[144:145], v[176:177] op_sel:[0,0] op_sel_hi:[1,1]
v_pk_mul_f32 v[146:147], v[146:147], v[178:179] op_sel:[0,0] op_sel_hi:[1,1]
v_cvt_pk_bf16_f32 v112, v112, v113
v_cvt_pk_bf16_f32 v113, v114, v115
v_cvt_pk_bf16_f32 v114, v144, v145
v_cvt_pk_bf16_f32 v115, v146, v147
v_accvgpr_write_b32 a196, v112
v_accvgpr_write_b32 a197, v113
v_accvgpr_write_b32 a198, v114
v_accvgpr_write_b32 a199, v115
v_pk_mul_f32 v[52:53], v[52:53], s[6:7] op_sel:[0,1] op_sel_hi:[1,1]
v_pk_mul_f32 v[54:55], v[54:55], s[6:7] op_sel:[0,1] op_sel_hi:[1,1]
v_exp_f32 v52, v52
v_exp_f32 v53, v53
v_exp_f32 v54, v54
v_exp_f32 v55, v55
s_nop 0
v_pk_add_f32 v[52:53], v[52:53], 1.0 op_sel:[0,0] op_sel_hi:[1,0]
v_pk_add_f32 v[54:55], v[54:55], 1.0 op_sel:[0,0] op_sel_hi:[1,0]
v_rcp_f32 v52, v52
v_rcp_f32 v53, v53
v_rcp_f32 v54, v54
v_rcp_f32 v55, v55
v_pk_mul_f32 v[52:53], v[52:53], v[180:181] op_sel:[0,0] op_sel_hi:[1,1]
v_pk_mul_f32 v[54:55], v[54:55], v[182:183] op_sel:[0,0] op_sel_hi:[1,1]
v_pk_mul_f32 v[84:85], v[84:85], s[6:7] op_sel:[0,1] op_sel_hi:[1,1]
v_pk_mul_f32 v[86:87], v[86:87], s[6:7] op_sel:[0,1] op_sel_hi:[1,1]
v_exp_f32 v84, v84
v_exp_f32 v85, v85
v_exp_f32 v86, v86
v_exp_f32 v87, v87
s_nop 0
v_pk_add_f32 v[84:85], v[84:85], 1.0 op_sel:[0,0] op_sel_hi:[1,0]
v_pk_add_f32 v[86:87], v[86:87], 1.0 op_sel:[0,0] op_sel_hi:[1,0]
v_rcp_f32 v84, v84
v_rcp_f32 v85, v85
v_rcp_f32 v86, v86
v_rcp_f32 v87, v87
v_pk_mul_f32 v[84:85], v[84:85], v[212:213] op_sel:[0,0] op_sel_hi:[1,1]
v_pk_mul_f32 v[86:87], v[86:87], v[214:215] op_sel:[0,0] op_sel_hi:[1,1]
v_cvt_pk_bf16_f32 v52, v52, v53
v_cvt_pk_bf16_f32 v53, v54, v55
v_cvt_pk_bf16_f32 v54, v84, v85
v_cvt_pk_bf16_f32 v55, v86, v87
v_accvgpr_write_b32 a200, v52
v_accvgpr_write_b32 a201, v53
v_accvgpr_write_b32 a202, v54
v_accvgpr_write_b32 a203, v55
v_pk_mul_f32 v[116:117], v[116:117], s[6:7] op_sel:[0,1] op_sel_hi:[1,1]
v_pk_mul_f32 v[118:119], v[118:119], s[6:7] op_sel:[0,1] op_sel_hi:[1,1]
v_exp_f32 v116, v116
v_exp_f32 v117, v117
v_exp_f32 v118, v118
v_exp_f32 v119, v119
s_nop 0
v_pk_add_f32 v[116:117], v[116:117], 1.0 op_sel:[0,0] op_sel_hi:[1,0]
v_pk_add_f32 v[118:119], v[118:119], 1.0 op_sel:[0,0] op_sel_hi:[1,0]
v_rcp_f32 v116, v116
v_rcp_f32 v117, v117
v_rcp_f32 v118, v118
v_rcp_f32 v119, v119
v_pk_mul_f32 v[116:117], v[116:117], v[244:245] op_sel:[0,0] op_sel_hi:[1,1]
v_pk_mul_f32 v[118:119], v[118:119], v[246:247] op_sel:[0,0] op_sel_hi:[1,1]
v_accvgpr_read_b32 v180, a148
v_accvgpr_read_b32 v181, a149
v_accvgpr_read_b32 v182, a150
v_accvgpr_read_b32 v183, a151
v_pk_mul_f32 v[148:149], v[148:149], s[6:7] op_sel:[0,1] op_sel_hi:[1,1]
v_pk_mul_f32 v[150:151], v[150:151], s[6:7] op_sel:[0,1] op_sel_hi:[1,1]
v_exp_f32 v148, v148
v_exp_f32 v149, v149
v_exp_f32 v150, v150
v_exp_f32 v151, v151
s_nop 0
v_pk_add_f32 v[148:149], v[148:149], 1.0 op_sel:[0,0] op_sel_hi:[1,0]
v_pk_add_f32 v[150:151], v[150:151], 1.0 op_sel:[0,0] op_sel_hi:[1,0]
v_rcp_f32 v148, v148
v_rcp_f32 v149, v149
v_rcp_f32 v150, v150
v_rcp_f32 v151, v151
v_pk_mul_f32 v[148:149], v[148:149], v[180:181] op_sel:[0,0] op_sel_hi:[1,1]
v_pk_mul_f32 v[150:151], v[150:151], v[182:183] op_sel:[0,0] op_sel_hi:[1,1]
v_cvt_pk_bf16_f32 v116, v116, v117
v_cvt_pk_bf16_f32 v117, v118, v119
v_cvt_pk_bf16_f32 v118, v148, v149
v_cvt_pk_bf16_f32 v119, v150, v151
v_accvgpr_write_b32 a204, v116
v_accvgpr_write_b32 a205, v117
v_accvgpr_write_b32 a206, v118
v_accvgpr_write_b32 a207, v119
v_pk_mul_f32 v[56:57], v[56:57], s[6:7] op_sel:[0,1] op_sel_hi:[1,1]
v_pk_mul_f32 v[58:59], v[58:59], s[6:7] op_sel:[0,1] op_sel_hi:[1,1]
v_exp_f32 v56, v56
v_exp_f32 v57, v57
v_exp_f32 v58, v58
v_exp_f32 v59, v59
s_nop 0
v_pk_add_f32 v[56:57], v[56:57], 1.0 op_sel:[0,0] op_sel_hi:[1,0]
v_pk_add_f32 v[58:59], v[58:59], 1.0 op_sel:[0,0] op_sel_hi:[1,0]
v_rcp_f32 v56, v56
v_rcp_f32 v57, v57
v_rcp_f32 v58, v58
v_rcp_f32 v59, v59
v_pk_mul_f32 v[56:57], v[56:57], v[184:185] op_sel:[0,0] op_sel_hi:[1,1]
v_pk_mul_f32 v[58:59], v[58:59], v[186:187] op_sel:[0,0] op_sel_hi:[1,1]
v_pk_mul_f32 v[88:89], v[88:89], s[6:7] op_sel:[0,1] op_sel_hi:[1,1]
v_pk_mul_f32 v[90:91], v[90:91], s[6:7] op_sel:[0,1] op_sel_hi:[1,1]
v_exp_f32 v88, v88
v_exp_f32 v89, v89
v_exp_f32 v90, v90
v_exp_f32 v91, v91
s_nop 0
v_pk_add_f32 v[88:89], v[88:89], 1.0 op_sel:[0,0] op_sel_hi:[1,0]
v_pk_add_f32 v[90:91], v[90:91], 1.0 op_sel:[0,0] op_sel_hi:[1,0]
v_rcp_f32 v88, v88
v_rcp_f32 v89, v89
v_rcp_f32 v90, v90
v_rcp_f32 v91, v91
v_pk_mul_f32 v[88:89], v[88:89], v[216:217] op_sel:[0,0] op_sel_hi:[1,1]
v_pk_mul_f32 v[90:91], v[90:91], v[218:219] op_sel:[0,0] op_sel_hi:[1,1]
v_cvt_pk_bf16_f32 v56, v56, v57
v_cvt_pk_bf16_f32 v57, v58, v59
v_cvt_pk_bf16_f32 v58, v88, v89
v_cvt_pk_bf16_f32 v59, v90, v91
v_accvgpr_write_b32 a208, v56
v_accvgpr_write_b32 a209, v57
v_accvgpr_write_b32 a210, v58
v_accvgpr_write_b32 a211, v59
v_pk_mul_f32 v[120:121], v[120:121], s[6:7] op_sel:[0,1] op_sel_hi:[1,1]
v_pk_mul_f32 v[122:123], v[122:123], s[6:7] op_sel:[0,1] op_sel_hi:[1,1]
v_exp_f32 v120, v120
v_exp_f32 v121, v121
v_exp_f32 v122, v122
v_exp_f32 v123, v123
s_nop 0
v_pk_add_f32 v[120:121], v[120:121], 1.0 op_sel:[0,0] op_sel_hi:[1,0]
v_pk_add_f32 v[122:123], v[122:123], 1.0 op_sel:[0,0] op_sel_hi:[1,0]
v_rcp_f32 v120, v120
v_rcp_f32 v121, v121
v_rcp_f32 v122, v122
v_rcp_f32 v123, v123
v_pk_mul_f32 v[120:121], v[120:121], v[248:249] op_sel:[0,0] op_sel_hi:[1,1]
v_pk_mul_f32 v[122:123], v[122:123], v[250:251] op_sel:[0,0] op_sel_hi:[1,1]
v_accvgpr_read_b32 v184, a152
v_accvgpr_read_b32 v185, a153
v_accvgpr_read_b32 v186, a154
v_accvgpr_read_b32 v187, a155
v_pk_mul_f32 v[152:153], v[152:153], s[6:7] op_sel:[0,1] op_sel_hi:[1,1]
v_pk_mul_f32 v[154:155], v[154:155], s[6:7] op_sel:[0,1] op_sel_hi:[1,1]
v_exp_f32 v152, v152
v_exp_f32 v153, v153
v_exp_f32 v154, v154
v_exp_f32 v155, v155
s_nop 0
v_pk_add_f32 v[152:153], v[152:153], 1.0 op_sel:[0,0] op_sel_hi:[1,0]
v_pk_add_f32 v[154:155], v[154:155], 1.0 op_sel:[0,0] op_sel_hi:[1,0]
v_rcp_f32 v152, v152
v_rcp_f32 v153, v153
v_rcp_f32 v154, v154
v_rcp_f32 v155, v155
v_pk_mul_f32 v[152:153], v[152:153], v[184:185] op_sel:[0,0] op_sel_hi:[1,1]
v_pk_mul_f32 v[154:155], v[154:155], v[186:187] op_sel:[0,0] op_sel_hi:[1,1]
v_cvt_pk_bf16_f32 v120, v120, v121
v_cvt_pk_bf16_f32 v121, v122, v123
v_cvt_pk_bf16_f32 v122, v152, v153
v_cvt_pk_bf16_f32 v123, v154, v155
v_accvgpr_write_b32 a212, v120
v_accvgpr_write_b32 a213, v121
v_accvgpr_write_b32 a214, v122
v_accvgpr_write_b32 a215, v123
v_pk_mul_f32 v[60:61], v[60:61], s[6:7] op_sel:[0,1] op_sel_hi:[1,1]
v_pk_mul_f32 v[62:63], v[62:63], s[6:7] op_sel:[0,1] op_sel_hi:[1,1]
v_exp_f32 v60, v60
v_exp_f32 v61, v61
v_exp_f32 v62, v62
v_exp_f32 v63, v63
s_nop 0
v_pk_add_f32 v[60:61], v[60:61], 1.0 op_sel:[0,0] op_sel_hi:[1,0]
v_pk_add_f32 v[62:63], v[62:63], 1.0 op_sel:[0,0] op_sel_hi:[1,0]
v_rcp_f32 v60, v60
v_rcp_f32 v61, v61
v_rcp_f32 v62, v62
v_rcp_f32 v63, v63
v_pk_mul_f32 v[60:61], v[60:61], v[188:189] op_sel:[0,0] op_sel_hi:[1,1]
v_pk_mul_f32 v[62:63], v[62:63], v[190:191] op_sel:[0,0] op_sel_hi:[1,1]
v_pk_mul_f32 v[92:93], v[92:93], s[6:7] op_sel:[0,1] op_sel_hi:[1,1]
v_pk_mul_f32 v[94:95], v[94:95], s[6:7] op_sel:[0,1] op_sel_hi:[1,1]
v_exp_f32 v92, v92
v_exp_f32 v93, v93
v_exp_f32 v94, v94
v_exp_f32 v95, v95
s_nop 0
v_pk_add_f32 v[92:93], v[92:93], 1.0 op_sel:[0,0] op_sel_hi:[1,0]
v_pk_add_f32 v[94:95], v[94:95], 1.0 op_sel:[0,0] op_sel_hi:[1,0]
v_rcp_f32 v92, v92
v_rcp_f32 v93, v93
v_rcp_f32 v94, v94
v_rcp_f32 v95, v95
v_pk_mul_f32 v[92:93], v[92:93], v[220:221] op_sel:[0,0] op_sel_hi:[1,1]
v_pk_mul_f32 v[94:95], v[94:95], v[222:223] op_sel:[0,0] op_sel_hi:[1,1]
v_cvt_pk_bf16_f32 v60, v60, v61
v_cvt_pk_bf16_f32 v61, v62, v63
v_cvt_pk_bf16_f32 v62, v92, v93
v_cvt_pk_bf16_f32 v63, v94, v95
v_accvgpr_write_b32 a216, v60
v_accvgpr_write_b32 a217, v61
v_accvgpr_write_b32 a218, v62
v_accvgpr_write_b32 a219, v63
v_pk_mul_f32 v[124:125], v[124:125], s[6:7] op_sel:[0,1] op_sel_hi:[1,1]
v_pk_mul_f32 v[126:127], v[126:127], s[6:7] op_sel:[0,1] op_sel_hi:[1,1]
v_exp_f32 v124, v124
v_exp_f32 v125, v125
v_exp_f32 v126, v126
v_exp_f32 v127, v127
s_nop 0
v_pk_add_f32 v[124:125], v[124:125], 1.0 op_sel:[0,0] op_sel_hi:[1,0]
v_pk_add_f32 v[126:127], v[126:127], 1.0 op_sel:[0,0] op_sel_hi:[1,0]
v_rcp_f32 v124, v124
v_rcp_f32 v125, v125
v_rcp_f32 v126, v126
v_rcp_f32 v127, v127
v_pk_mul_f32 v[124:125], v[124:125], v[252:253] op_sel:[0,0] op_sel_hi:[1,1]
v_pk_mul_f32 v[126:127], v[126:127], v[254:255] op_sel:[0,0] op_sel_hi:[1,1]
v_accvgpr_read_b32 v188, a156
v_accvgpr_read_b32 v189, a157
v_accvgpr_read_b32 v190, a158
v_accvgpr_read_b32 v191, a159
v_pk_mul_f32 v[156:157], v[156:157], s[6:7] op_sel:[0,1] op_sel_hi:[1,1]
v_pk_mul_f32 v[158:159], v[158:159], s[6:7] op_sel:[0,1] op_sel_hi:[1,1]
v_exp_f32 v156, v156
v_exp_f32 v157, v157
v_exp_f32 v158, v158
v_exp_f32 v159, v159
s_nop 0
v_pk_add_f32 v[156:157], v[156:157], 1.0 op_sel:[0,0] op_sel_hi:[1,0]
v_pk_add_f32 v[158:159], v[158:159], 1.0 op_sel:[0,0] op_sel_hi:[1,0]
v_rcp_f32 v156, v156
v_rcp_f32 v157, v157
v_rcp_f32 v158, v158
v_rcp_f32 v159, v159
v_pk_mul_f32 v[156:157], v[156:157], v[188:189] op_sel:[0,0] op_sel_hi:[1,1]
v_pk_mul_f32 v[158:159], v[158:159], v[190:191] op_sel:[0,0] op_sel_hi:[1,1]
v_cvt_pk_bf16_f32 v124, v124, v125
v_cvt_pk_bf16_f32 v125, v126, v127
v_cvt_pk_bf16_f32 v126, v156, v157
v_cvt_pk_bf16_f32 v127, v158, v159
v_accvgpr_write_b32 a220, v124
v_accvgpr_write_b32 a221, v125
v_accvgpr_write_b32 a222, v126
v_accvgpr_write_b32 a223, v127
s_branch L_f_p0
L_k1L_swW:
s_mov_b32 s8, s65
s_mov_b32 s9, s66
s_mov_b32 s10, s67
s_mov_b32 s21, s68
s_mov_b32 s22, s69
s_mov_b64 s[80:81], s[74:75]
v_accvgpr_read_b32 v5, a164
v_accvgpr_read_b32 v6, a165
v_accvgpr_read_b32 v7, a166
v_accvgpr_read_b32 v8, a167
s_branch L_k1L_backW
L_k1L_swA:
s_mov_b32 s4, s60
s_mov_b32 s5, s61
s_mov_b32 s6, s62
s_mov_b32 s19, s63
s_mov_b32 s20, s64
v_accvgpr_read_b32 v1, a160
v_accvgpr_read_b32 v2, a161
v_accvgpr_read_b32 v3, a162
v_accvgpr_read_b32 v4, a163
v_mov_b32 v17, 0
global_load_dword v30, v17, s[56:57]
s_branch L_k1L_backA
L_k1H_swW:
s_mov_b32 s8, s65
s_mov_b32 s9, s66
s_mov_b32 s10, s67
s_mov_b32 s21, s68
s_mov_b32 s22, s69
s_mov_b64 s[80:81], s[74:75]
v_accvgpr_read_b32 v5, a164
v_accvgpr_read_b32 v6, a165
v_accvgpr_read_b32 v7, a166
v_accvgpr_read_b32 v8, a167
s_branch L_k1H_backW
L_k1H_swA:
s_mov_b32 s4, s60
s_mov_b32 s5, s61
s_mov_b32 s6, s62
s_mov_b32 s19, s63
s_mov_b32 s20, s64
v_accvgpr_read_b32 v1, a160
v_accvgpr_read_b32 v2, a161
v_accvgpr_read_b32 v3, a162
v_accvgpr_read_b32 v4, a163
v_mov_b32 v17, 0
global_load_dword v30, v17, s[56:57]
s_branch L_k1H_backA
L_pf479_do:
v_mov_b32 v17, 1
v_mov_b32 v30, 0
s_mov_b64 exec, 1
global_atomic_add v30, v17, s[56:57] sc1
s_mov_b64 exec, -1
s_branch L_pf479_back
L_pf597_do:
v_mov_b32 v17, 1
v_mov_b32 v30, 0
s_mov_b64 exec, 1
global_atomic_add v30, v17, s[56:57] sc1
s_mov_b64 exec, -1
s_branch L_pf597_back
L_pf725_do:
v_mov_b32 v17, 1
v_mov_b32 v30, 0
s_mov_b64 exec, 1
global_atomic_add v30, v17, s[56:57] sc1
s_mov_b64 exec, -1
s_branch L_pf725_back
L_pf847_do:
v_mov_b32 v17, 1
v_mov_b32 v30, 0
s_mov_b64 exec, 1
global_atomic_add v30, v17, s[56:57] sc1
s_mov_b64 exec, -1
s_branch L_pf847_back
L_pf972_do:
v_mov_b32 v17, 1
v_mov_b32 v30, 0
s_mov_b64 exec, 1
global_atomic_add v30, v17, s[56:57] sc1
s_mov_b64 exec, -1
s_branch L_pf972_back
L_pf1091_do:
v_mov_b32 v17, 1
v_mov_b32 v30, 0
s_mov_b64 exec, 1
global_atomic_add v30, v17, s[56:57] sc1
s_mov_b64 exec, -1
s_branch L_pf1091_back
L_k1_hi:
v_mfma_f32_16x16x32_bf16 v[48:51], a[0:3], a[96:99], 0
v_mfma_f32_16x16x32_bf16 v[48:51], a[4:7], a[100:103], v[48:51]
ds_read_b128 a[64:67], v15 offset:0
v_mfma_f32_16x16x32_bf16 v[52:55], a[4:7], a[108:111], 0
s_add_u32 m0, s25, 0
v_mfma_f32_16x16x32_bf16 v[52:55], a[0:3], a[104:107], v[52:55]
ds_read_b128 a[68:71], v14 offset:0
v_mfma_f32_16x16x32_bf16 v[56:59], a[0:3], a[112:115], 0
buffer_load_dwordx4 v5, s[8:11], s21 offen offset:0 lds
v_mfma_f32_16x16x32_bf16 v[56:59], a[4:7], a[116:119], v[56:59]
ds_read_b128 a[72:75], v15 offset:2048
v_mfma_f32_16x16x32_bf16 v[60:63], a[4:7], a[124:127], 0
v_mfma_f32_16x16x32_bf16 v[60:63], a[0:3], a[120:123], v[60:63]
ds_read_b128 a[76:79], v14 offset:2048
v_mfma_f32_16x16x32_bf16 v[80:83], a[8:11], a[96:99], 0
s_bitcmp1_b32 s83, s3
s_cselect_b64 s[44:45], -1, 0
v_mfma_f32_16x16x32_bf16 v[80:83], a[12:15], a[100:103], v[80:83]
ds_read_b128 a[80:83], v15 offset:4096
v_mfma_f32_16x16x32_bf16 v[84:87], a[12:15], a[108:111], 0
buffer_load_dwordx4 v6, s[8:11], s21 offen offset:1024 lds
v_mfma_f32_16x16x32_bf16 v[84:87], a[8:11], a[104:107], v[84:87]
ds_read_b128 a[84:87], v14 offset:4096
v_mfma_f32_16x16x32_bf16 v[88:91], a[8:11], a[112:115], 0
v_cndmask_b32 v18, v20, v22, s[44:45]
v_cndmask_b32 v19, v21, v23, s[44:45]
v_mfma_f32_16x16x32_bf16 v[88:91], a[12:15], a[116:119], v[88:91]
ds_read_b128 a[88:91], v15 offset:6144
v_mfma_f32_16x16x32_bf16 v[92:95], a[12:15], a[124:127], 0
v_cndmask_b32 v22, v22, v24, s[44:45]
v_cndmask_b32 v23, v23, v25, s[44:45]
v_mfma_f32_16x16x32_bf16 v[92:95], a[8:11], a[120:123], v[92:95]
ds_read_b128 a[92:95], v14 offset:6144
v_mfma_f32_16x16x32_bf16 v[112:115], a[16:19], a[96:99], 0
buffer_load_dwordx4 v7, s[8:11], s21 offen offset:2048 lds
v_mfma_f32_16x16x32_bf16 v[112:115], a[20:23], a[100:103], v[112:115]
ds_read_b64_tr_b16 a[32:33], v9 offset:16384
v_mfma_f32_16x16x32_bf16 v[116:119], a[20:23], a[108:111], 0
v_cndmask_b32 v24, v24, v26, s[44:45]
v_cndmask_b32 v25, v25, v27, s[44:45]
v_mfma_f32_16x16x32_bf16 v[116:119], a[16:19], a[104:107], v[116:119]
ds_read_b64_tr_b16 a[34:35], v9 offset:17408
v_mfma_f32_16x16x32_bf16 v[120:123], a[16:19], a[112:115], 0
v_mfma_f32_16x16x32_bf16 v[120:123], a[20:23], a[116:119], v[120:123]
ds_read_b64_tr_b16 a[36:37], v9 offset:24576
v_mfma_f32_16x16x32_bf16 v[124:127], a[20:23], a[124:127], 0
buffer_load_dwordx4 v8, s[8:11], s21 offen offset:3072 lds
v_mfma_f32_16x16x32_bf16 v[124:127], a[16:19], a[120:123], v[124:127]
ds_read_b64_tr_b16 a[38:39], v9 offset:25600
v_mfma_f32_16x16x32_bf16 v[144:147], a[24:27], a[96:99], 0
s_xor_b64 s[8:9], s[8:9], s[80:81]
v_mfma_f32_16x16x32_bf16 v[144:147], a[28:31], a[100:103], v[144:147]
ds_read_b64_tr_b16 a[40:41], v10 offset:16384
v_mfma_f32_16x16x32_bf16 v[148:151], a[28:31], a[108:111], 0
s_add_u32 m0, s24, 4096
v_mfma_f32_16x16x32_bf16 v[148:151], a[24:27], a[104:107], v[148:151]
ds_read_b64_tr_b16 a[42:43], v10 offset:17408
v_mfma_f32_16x16x32_bf16 v[152:155], a[24:27], a[112:115], 0
buffer_load_dwordx4 v1, s[4:7], s20 offen offset:0 lds
v_mfma_f32_16x16x32_bf16 v[152:155], a[28:31], a[116:119], v[152:155]
ds_read_b64_tr_b16 a[44:45], v10 offset:24576
v_mfma_f32_16x16x32_bf16 v[156:159], a[28:31], a[124:127], 0
v_cndmask_b32 v26, v26, v28, s[44:45]
v_cndmask_b32 v27, v27, v29, s[44:45]
v_mfma_f32_16x16x32_bf16 v[156:159], a[24:27], a[120:123], v[156:159]
ds_read_b64_tr_b16 a[46:47], v10 offset:25600
s_waitcnt lgkmcnt(8)
v_mfma_f32_16x16x32_bf16 v[32:35], a[0:3], a[64:67], 0
s_cmp_eq_u32 s3, s46
s_cbranch_scc1 L_pf4041_do
L_pf4041_back:
v_mfma_f32_16x16x32_bf16 v[32:35], a[4:7], a[68:71], v[32:35]
ds_read_b64_tr_b16 a[48:49], v11 offset:16384
v_mfma_f32_16x16x32_bf16 v[36:39], a[4:7], a[76:79], 0
buffer_load_dwordx4 v2, s[4:7], s20 offen offset:1024 lds
v_mfma_f32_16x16x32_bf16 v[36:39], a[0:3], a[72:75], v[36:39]
ds_read_b64_tr_b16 a[50:51], v11 offset:17408
v_mfma_f32_16x16x32_bf16 v[40:43], a[0:3], a[80:83], 0
s_add_u32 s3, s3, 1
v_mfma_f32_16x16x32_bf16 v[40:43], a[4:7], a[84:87], v[40:43]
ds_read_b64_tr_b16 a[52:53], v11 offset:24576
v_mfma_f32_16x16x32_bf16 v[44:47], a[4:7], a[92:95], 0
v_mfma_f32_16x16x32_bf16 v[44:47], a[0:3], a[88:91], v[44:47]
ds_read_b64_tr_b16 a[54:55], v11 offset:25600
v_mfma_f32_16x16x32_bf16 v[64:67], a[8:11], a[64:67], 0
buffer_load_dwordx4 v3, s[4:7], s20 offen offset:2048 lds
v_mfma_f32_16x16x32_bf16 v[64:67], a[12:15], a[68:71], v[64:67]
ds_read_b64_tr_b16 a[56:57], v12 offset:16384
v_mfma_f32_16x16x32_bf16 v[68:71], a[12:15], a[76:79], 0
v_mfma_f32_16x16x32_bf16 v[68:71], a[8:11], a[72:75], v[68:71]
ds_read_b64_tr_b16 a[58:59], v12 offset:17408
v_mfma_f32_16x16x32_bf16 v[72:75], a[8:11], a[80:83], 0
v_mfma_f32_16x16x32_bf16 v[72:75], a[12:15], a[84:87], v[72:75]
ds_read_b64_tr_b16 a[60:61], v12 offset:24576
v_mfma_f32_16x16x32_bf16 v[76:79], a[12:15], a[92:95], 0
buffer_load_dwordx4 v4, s[4:7], s20 offen offset:3072 lds
v_mfma_f32_16x16x32_bf16 v[76:79], a[8:11], a[88:91], v[76:79]
ds_read_b64_tr_b16 a[62:63], v12 offset:25600
v_mfma_f32_16x16x32_bf16 v[96:99], a[16:19], a[64:67], 0
s_add_u32 s20, s20, 128
v_mfma_f32_16x16x32_bf16 v[96:99], a[20:23], a[68:71], v[96:99]
v_mfma_f32_16x16x32_bf16 v[100:103], a[20:23], a[76:79], 0
global_load_dword v31, v[18:19], off
v_mfma_f32_16x16x32_bf16 v[100:103], a[16:19], a[72:75], v[100:103]
v_mfma_f32_16x16x32_bf16 v[104:107], a[16:19], a[80:83], 0
v_mfma_f32_16x16x32_bf16 v[104:107], a[20:23], a[84:87], v[104:107]
v_mfma_f32_16x16x32_bf16 v[108:111], a[20:23], a[92:95], 0
v_mfma_f32_16x16x32_bf16 v[108:111], a[16:19], a[88:91], v[108:111]
v_mfma_f32_16x16x32_bf16 v[128:131], a[24:27], a[64:67], 0
v_mfma_f32_16x16x32_bf16 v[128:131], a[28:31], a[68:71], v[128:131]
v_mfma_f32_16x16x32_bf16 v[132:135], a[28:31], a[76:79], 0
v_mfma_f32_16x16x32_bf16 v[132:135], a[24:27], a[72:75], v[132:135]
v_mfma_f32_16x16x32_bf16 v[136:139], a[24:27], a[80:83], 0
v_mfma_f32_16x16x32_bf16 v[136:139], a[28:31], a[84:87], v[136:139]
v_mfma_f32_16x16x32_bf16 v[140:143], a[28:31], a[92:95], 0
s_waitcnt vmcnt(17) lgkmcnt(0)
v_mfma_f32_16x16x32_bf16 v[140:143], a[24:27], a[88:91], v[140:143]
s_barrier
v_mfma_f32_16x16x32_bf16 v[160:163], a[32:35], a[64:67], 0
s_add_u32 s24, s23, s27
s_add_u32 s23, s23, 32768
s_cmp_eq_u32 s23, 98304
v_mfma_f32_16x16x32_bf16 v[160:163], a[36:39], a[68:71], v[160:163]
ds_read_b64_tr_b16 a[0:1], v9 offset:32768
v_mfma_f32_16x16x32_bf16 v[164:167], a[36:39], a[76:79], 0
s_cselect_b32 s23, 0, s23
s_add_u32 m0, s25, 16384
v_mfma_f32_16x16x32_bf16 v[164:167], a[32:35], a[72:75], v[164:167]
ds_read_b64_tr_b16 a[2:3], v9 offset:33792
v_mfma_f32_16x16x32_bf16 v[168:171], a[32:35], a[80:83], 0
buffer_load_dwordx4 v5, s[8:11], s21 offen offset:0 lds
v_mfma_f32_16x16x32_bf16 v[168:171], a[36:39], a[84:87], v[168:171]
ds_read_b64_tr_b16 a[4:5], v9 offset:40960
v_mfma_f32_16x16x32_bf16 v[172:175], a[36:39], a[92:95], 0
v_add_u32 v15, s23, v13
v_xor_b32 v14, 64, v15
v_mfma_f32_16x16x32_bf16 v[172:175], a[32:35], a[88:91], v[172:175]
ds_read_b64_tr_b16 a[6:7], v9 offset:41984
v_mfma_f32_16x16x32_bf16 v[192:195], a[40:43], a[64:67], 0
s_bitcmp1_b32 s83, s3
s_cselect_b64 s[44:45], -1, 0
v_mfma_f32_16x16x32_bf16 v[192:195], a[44:47], a[68:71], v[192:195]
ds_read_b64_tr_b16 a[8:9], v10 offset:32768
v_mfma_f32_16x16x32_bf16 v[196:199], a[44:47], a[76:79], 0
buffer_load_dwordx4 v6, s[8:11], s21 offen offset:1024 lds
v_mfma_f32_16x16x32_bf16 v[196:199], a[40:43], a[72:75], v[196:199]
ds_read_b64_tr_b16 a[10:11], v10 offset:33792
v_mfma_f32_16x16x32_bf16 v[200:203], a[40:43], a[80:83], 0
v_cndmask_b32 v18, v20, v22, s[44:45]
v_cndmask_b32 v19, v21, v23, s[44:45]
v_mfma_f32_16x16x32_bf16 v[200:203], a[44:47], a[84:87], v[200:203]
ds_read_b64_tr_b16 a[12:13], v10 offset:40960
v_mfma_f32_16x16x32_bf16 v[204:207], a[44:47], a[92:95], 0
v_cndmask_b32 v22, v22, v24, s[44:45]
v_cndmask_b32 v23, v23, v25, s[44:45]
v_mfma_f32_16x16x32_bf16 v[204:207], a[40:43], a[88:91], v[204:207]
ds_read_b64_tr_b16 a[14:15], v10 offset:41984
v_mfma_f32_16x16x32_bf16 v[224:227], a[48:51], a[64:67], 0
buffer_load_dwordx4 v7, s[8:11], s21 offen offset:2048 lds
v_mfma_f32_16x16x32_bf16 v[224:227], a[52:55], a[68:71], v[224:227]
ds_read_b64_tr_b16 a[16:17], v11 offset:32768
v_mfma_f32_16x16x32_bf16 v[228:231], a[52:55], a[76:79], 0
v_cndmask_b32 v24, v24, v26, s[44:45]
v_cndmask_b32 v25, v25, v27, s[44:45]
v_mfma_f32_16x16x32_bf16 v[228:231], a[48:51], a[72:75], v[228:231]
ds_read_b64_tr_b16 a[18:19], v11 offset:33792
v_mfma_f32_16x16x32_bf16 v[232:235], a[48:51], a[80:83], 0
v_mfma_f32_16x16x32_bf16 v[232:235], a[52:55], a[84:87], v[232:235]
ds_read_b64_tr_b16 a[20:21], v11 offset:40960
v_mfma_f32_16x16x32_bf16 v[236:239], a[52:55], a[92:95], 0
buffer_load_dwordx4 v8, s[8:11], s21 offen offset:3072 lds
v_mfma_f32_16x16x32_bf16 v[236:239], a[48:51], a[88:91], v[236:239]
ds_read_b64_tr_b16 a[22:23], v11 offset:41984
v_mfma_f32_16x16x32_bf16 a[128:131], a[56:59], a[64:67], 0
s_xor_b64 s[8:9], s[8:9], s[80:81]
s_add_u32 s21, s21, s22
v_mfma_f32_16x16x32_bf16 a[128:131], a[60:63], a[68:71], a[128:131]
ds_read_b64_tr_b16 a[24:25], v12 offset:32768
v_mfma_f32_16x16x32_bf16 a[132:135], a[60:63], a[76:79], 0
s_add_u32 m0, s24, 0
v_mfma_f32_16x16x32_bf16 a[132:135], a[56:59], a[72:75], a[132:135]
ds_read_b64_tr_b16 a[26:27], v12 offset:33792
v_mfma_f32_16x16x32_bf16 a[136:139], a[56:59], a[80:83], 0
buffer_load_dwordx4 v1, s[4:7], s19 offen offset:0 lds
v_mfma_f32_16x16x32_bf16 a[136:139], a[60:63], a[84:87], a[136:139]
ds_read_b64_tr_b16 a[28:29], v12 offset:40960
v_mfma_f32_16x16x32_bf16 a[140:143], a[60:63], a[92:95], 0
v_cndmask_b32 v26, v26, v28, s[44:45]
v_cndmask_b32 v27, v27, v29, s[44:45]
v_mfma_f32_16x16x32_bf16 a[140:143], a[56:59], a[88:91], a[140:143]
ds_read_b64_tr_b16 a[30:31], v12 offset:41984
v_mfma_f32_16x16x32_bf16 v[176:179], a[32:35], a[96:99], 0
s_cmp_eq_u32 s3, s46
s_cbranch_scc1 L_pf4159_do
L_pf4159_back:
v_mfma_f32_16x16x32_bf16 v[176:179], a[36:39], a[100:103], v[176:179]
ds_read_b128 a[64:67], v15 offset:0
v_mfma_f32_16x16x32_bf16 v[180:183], a[36:39], a[108:111], 0
buffer_load_dwordx4 v2, s[4:7], s19 offen offset:1024 lds
v_mfma_f32_16x16x32_bf16 v[180:183], a[32:35], a[104:107], v[180:183]
ds_read_b128 a[68:71], v14 offset:0
v_mfma_f32_16x16x32_bf16 v[184:187], a[32:35], a[112:115], 0
s_add_u32 s3, s3, 1
v_mfma_f32_16x16x32_bf16 v[184:187], a[36:39], a[116:119], v[184:187]
ds_read_b128 a[72:75], v15 offset:2048
v_mfma_f32_16x16x32_bf16 v[188:191], a[36:39], a[124:127], 0
v_mfma_f32_16x16x32_bf16 v[188:191], a[32:35], a[120:123], v[188:191]
ds_read_b128 a[76:79], v14 offset:2048
v_mfma_f32_16x16x32_bf16 v[208:211], a[40:43], a[96:99], 0
buffer_load_dwordx4 v3, s[4:7], s19 offen offset:2048 lds
v_mfma_f32_16x16x32_bf16 v[208:211], a[44:47], a[100:103], v[208:211]
ds_read_b128 a[80:83], v15 offset:4096
v_mfma_f32_16x16x32_bf16 v[212:215], a[44:47], a[108:111], 0
v_mfma_f32_16x16x32_bf16 v[212:215], a[40:43], a[104:107], v[212:215]
ds_read_b128 a[84:87], v14 offset:4096
v_mfma_f32_16x16x32_bf16 v[216:219], a[40:43], a[112:115], 0
v_mfma_f32_16x16x32_bf16 v[216:219], a[44:47], a[116:119], v[216:219]
ds_read_b128 a[88:91], v15 offset:6144
v_mfma_f32_16x16x32_bf16 v[220:223], a[44:47], a[124:127], 0
buffer_load_dwordx4 v4, s[4:7], s19 offen offset:3072 lds
v_mfma_f32_16x16x32_bf16 v[220:223], a[40:43], a[120:123], v[220:223]
ds_read_b128 a[92:95], v14 offset:6144
v_mfma_f32_16x16x32_bf16 v[240:243], a[48:51], a[96:99], 0
s_add_u32 s19, s19, 128
v_mfma_f32_16x16x32_bf16 v[240:243], a[52:55], a[100:103], v[240:243]
v_mfma_f32_16x16x32_bf16 v[244:247], a[52:55], a[108:111], 0
global_load_dword v31, v[18:19], off
v_mfma_f32_16x16x32_bf16 v[244:247], a[48:51], a[104:107], v[244:247]
v_mfma_f32_16x16x32_bf16 v[248:251], a[48:51], a[112:115], 0
v_mfma_f32_16x16x32_bf16 v[248:251], a[52:55], a[116:119], v[248:251]
v_mfma_f32_16x16x32_bf16 v[252:255], a[52:55], a[124:127], 0
v_mfma_f32_16x16x32_bf16 v[252:255], a[48:51], a[120:123], v[252:255]
v_mfma_f32_16x16x32_bf16 a[144:147], a[56:59], a[96:99], 0
v_mfma_f32_16x16x32_bf16 a[144:147], a[60:63], a[100:103], a[144:147]
v_mfma_f32_16x16x32_bf16 a[148:151], a[60:63], a[108:111], 0
v_mfma_f32_16x16x32_bf16 a[148:151], a[56:59], a[104:107], a[148:151]
v_mfma_f32_16x16x32_bf16 a[152:155], a[56:59], a[112:115], 0
s_mov_b32 s26, 0
v_mfma_f32_16x16x32_bf16 a[152:155], a[60:63], a[116:119], a[152:155]
v_mfma_f32_16x16x32_bf16 a[156:159], a[60:63], a[124:127], 0
s_waitcnt vmcnt(18) lgkmcnt(0)
v_mfma_f32_16x16x32_bf16 a[156:159], a[56:59], a[120:123], a[156:159]
s_barrier
s_branch L_k1H_p2
.p2align 6
L_k1H_p0:
v_mfma_f32_16x16x32_bf16 v[48:51], a[0:3], a[96:99], v[48:51]
s_cmp_eq_u32 s26, 7
s_cbranch_scc1 L_k1H_swW
L_k1H_backW:
v_mfma_f32_16x16x32_bf16 v[48:51], a[4:7], a[100:103], v[48:51]
ds_read_b128 a[64:67], v15 offset:0
v_mfma_f32_16x16x32_bf16 v[52:55], a[4:7], a[108:111], v[52:55]
s_add_u32 m0, s25, 0
v_mfma_f32_16x16x32_bf16 v[52:55], a[0:3], a[104:107], v[52:55]
ds_read_b128 a[68:71], v14 offset:0
v_mfma_f32_16x16x32_bf16 v[56:59], a[0:3], a[112:115], v[56:59]
buffer_load_dwordx4 v5, s[8:11], s21 offen offset:0 lds
v_mfma_f32_16x16x32_bf16 v[56:59], a[4:7], a[116:119], v[56:59]
ds_read_b128 a[72:75], v15 offset:2048
v_mfma_f32_16x16x32_bf16 v[60:63], a[4:7], a[124:127], v[60:63]
v_mfma_f32_16x16x32_bf16 v[60:63], a[0:3], a[120:123], v[60:63]
ds_read_b128 a[76:79], v14 offset:2048
v_mfma_f32_16x16x32_bf16 v[80:83], a[8:11], a[96:99], v[80:83]
s_bitcmp1_b32 s83, s3
s_cselect_b64 s[44:45], -1, 0
v_mfma_f32_16x16x32_bf16 v[80:83], a[12:15], a[100:103], v[80:83]
ds_read_b128 a[80:83], v15 offset:4096
v_mfma_f32_16x16x32_bf16 v[84:87], a[12:15], a[108:111], v[84:87]
buffer_load_dwordx4 v6, s[8:11], s21 offen offset:1024 lds
v_mfma_f32_16x16x32_bf16 v[84:87], a[8:11], a[104:107], v[84:87]
ds_read_b128 a[84:87], v14 offset:4096
v_mfma_f32_16x16x32_bf16 v[88:91], a[8:11], a[112:115], v[88:91]
v_cndmask_b32 v18, v20, v22, s[44:45]
v_cndmask_b32 v19, v21, v23, s[44:45]
v_mfma_f32_16x16x32_bf16 v[88:91], a[12:15], a[116:119], v[88:91]
ds_read_b128 a[88:91], v15 offset:6144
v_mfma_f32_16x16x32_bf16 v[92:95], a[12:15], a[124:127], v[92:95]
v_cndmask_b32 v22, v22, v24, s[44:45]
v_cndmask_b32 v23, v23, v25, s[44:45]
v_mfma_f32_16x16x32_bf16 v[92:95], a[8:11], a[120:123], v[92:95]
ds_read_b128 a[92:95], v14 offset:6144
v_mfma_f32_16x16x32_bf16 v[112:115], a[16:19], a[96:99], v[112:115]
buffer_load_dwordx4 v7, s[8:11], s21 offen offset:2048 lds
v_mfma_f32_16x16x32_bf16 v[112:115], a[20:23], a[100:103], v[112:115]
ds_read_b64_tr_b16 a[32:33], v9 offset:16384
v_mfma_f32_16x16x32_bf16 v[116:119], a[20:23], a[108:111], v[116:119]
v_cndmask_b32 v24, v24, v26, s[44:45]
v_cndmask_b32 v25, v25, v27, s[44:45]
v_mfma_f32_16x16x32_bf16 v[116:119], a[16:19], a[104:107], v[116:119]
ds_read_b64_tr_b16 a[34:35], v9 offset:17408
v_mfma_f32_16x16x32_bf16 v[120:123], a[16:19], a[112:115], v[120:123]
v_mfma_f32_16x16x32_bf16 v[120:123], a[20:23], a[116:119], v[120:123]
ds_read_b64_tr_b16 a[36:37], v9 offset:24576
v_mfma_f32_16x16x32_bf16 v[124:127], a[20:23], a[124:127], v[124:127]
buffer_load_dwordx4 v8, s[8:11], s21 offen offset:3072 lds
v_mfma_f32_16x16x32_bf16 v[124:127], a[16:19], a[120:123], v[124:127]
ds_read_b64_tr_b16 a[38:39], v9 offset:25600
v_mfma_f32_16x16x32_bf16 v[144:147], a[24:27], a[96:99], v[144:147]
s_xor_b64 s[8:9], s[8:9], s[80:81]
v_mfma_f32_16x16x32_bf16 v[144:147], a[28:31], a[100:103], v[144:147]
ds_read_b64_tr_b16 a[40:41], v10 offset:16384
v_mfma_f32_16x16x32_bf16 v[148:151], a[28:31], a[108:111], v[148:151]
s_add_u32 m0, s24, 4096
v_mfma_f32_16x16x32_bf16 v[148:151], a[24:27], a[104:107], v[148:151]
ds_read_b64_tr_b16 a[42:43], v10 offset:17408
v_mfma_f32_16x16x32_bf16 v[152:155], a[24:27], a[112:115], v[152:155]
buffer_load_dwordx4 v1, s[4:7], s20 offen offset:0 lds
v_mfma_f32_16x16x32_bf16 v[152:155], a[28:31], a[116:119], v[152:155]
ds_read_b64_tr_b16 a[44:45], v10 offset:24576
v_mfma_f32_16x16x32_bf16 v[156:159], a[28:31], a[124:127], v[156:159]
v_cndmask_b32 v26, v26, v28, s[44:45]
v_cndmask_b32 v27, v27, v29, s[44:45]
v_mfma_f32_16x16x32_bf16 v[156:159], a[24:27], a[120:123], v[156:159]
ds_read_b64_tr_b16 a[46:47], v10 offset:25600
s_waitcnt lgkmcnt(8)
v_mfma_f32_16x16x32_bf16 v[32:35], a[0:3], a[64:67], v[32:35]
s_cmp_eq_u32 s3, s46
s_cbranch_scc1 L_pf4287_do
L_pf4287_back:
v_mfma_f32_16x16x32_bf16 v[32:35], a[4:7], a[68:71], v[32:35]
ds_read_b64_tr_b16 a[48:49], v11 offset:16384
v_mfma_f32_16x16x32_bf16 v[36:39], a[4:7], a[76:79], v[36:39]
buffer_load_dwordx4 v2, s[4:7], s20 offen offset:1024 lds
v_mfma_f32_16x16x32_bf16 v[36:39], a[0:3], a[72:75], v[36:39]
ds_read_b64_tr_b16 a[50:51], v11 offset:17408
v_mfma_f32_16x16x32_bf16 v[40:43], a[0:3], a[80:83], v[40:43]
s_add_u32 s3, s3, 1
v_mfma_f32_16x16x32_bf16 v[40:43], a[4:7], a[84:87], v[40:43]
ds_read_b64_tr_b16 a[52:53], v11 offset:24576
v_mfma_f32_16x16x32_bf16 v[44:47], a[4:7], a[92:95], v[44:47]
v_mfma_f32_16x16x32_bf16 v[44:47], a[0:3], a[88:91], v[44:47]
ds_read_b64_tr_b16 a[54:55], v11 offset:25600
v_mfma_f32_16x16x32_bf16 v[64:67], a[8:11], a[64:67], v[64:67]
buffer_load_dwordx4 v3, s[4:7], s20 offen offset:2048 lds
v_mfma_f32_16x16x32_bf16 v[64:67], a[12:15], a[68:71], v[64:67]
ds_read_b64_tr_b16 a[56:57], v12 offset:16384
v_mfma_f32_16x16x32_bf16 v[68:71], a[12:15], a[76:79], v[68:71]
v_mfma_f32_16x16x32_bf16 v[68:71], a[8:11], a[72:75], v[68:71]
ds_read_b64_tr_b16 a[58:59], v12 offset:17408
v_mfma_f32_16x16x32_bf16 v[72:75], a[8:11], a[80:83], v[72:75]
v_mfma_f32_16x16x32_bf16 v[72:75], a[12:15], a[84:87], v[72:75]
ds_read_b64_tr_b16 a[60:61], v12 offset:24576
v_mfma_f32_16x16x32_bf16 v[76:79], a[12:15], a[92:95], v[76:79]
buffer_load_dwordx4 v4, s[4:7], s20 offen offset:3072 lds
v_mfma_f32_16x16x32_bf16 v[76:79], a[8:11], a[88:91], v[76:79]
ds_read_b64_tr_b16 a[62:63], v12 offset:25600
v_mfma_f32_16x16x32_bf16 v[96:99], a[16:19], a[64:67], v[96:99]
s_add_u32 s20, s20, 128
v_mfma_f32_16x16x32_bf16 v[96:99], a[20:23], a[68:71], v[96:99]
v_mfma_f32_16x16x32_bf16 v[100:103], a[20:23], a[76:79], v[100:103]
global_load_dword v31, v[18:19], off
v_mfma_f32_16x16x32_bf16 v[100:103], a[16:19], a[72:75], v[100:103]
v_mfma_f32_16x16x32_bf16 v[104:107], a[16:19], a[80:83], v[104:107]
v_mfma_f32_16x16x32_bf16 v[104:107], a[20:23], a[84:87], v[104:107]
v_mfma_f32_16x16x32_bf16 v[108:111], a[20:23], a[92:95], v[108:111]
v_mfma_f32_16x16x32_bf16 v[108:111], a[16:19], a[88:91], v[108:111]
v_mfma_f32_16x16x32_bf16 v[128:131], a[24:27], a[64:67], v[128:131]
v_mfma_f32_16x16x32_bf16 v[128:131], a[28:31], a[68:71], v[128:131]
v_mfma_f32_16x16x32_bf16 v[132:135], a[28:31], a[76:79], v[132:135]
v_mfma_f32_16x16x32_bf16 v[132:135], a[24:27], a[72:75], v[132:135]
v_mfma_f32_16x16x32_bf16 v[136:139], a[24:27], a[80:83], v[136:139]
v_mfma_f32_16x16x32_bf16 v[136:139], a[28:31], a[84:87], v[136:139]
v_mfma_f32_16x16x32_bf16 v[140:143], a[28:31], a[92:95], v[140:143]
s_waitcnt vmcnt(18) lgkmcnt(0)
v_mfma_f32_16x16x32_bf16 v[140:143], a[24:27], a[88:91], v[140:143]
s_barrier
L_k1H_p1:
v_mfma_f32_16x16x32_bf16 v[160:163], a[32:35], a[64:67], v[160:163]
s_add_u32 s24, s23, s27
s_add_u32 s23, s23, 32768
s_cmp_eq_u32 s23, 98304
v_mfma_f32_16x16x32_bf16 v[160:163], a[36:39], a[68:71], v[160:163]
ds_read_b64_tr_b16 a[0:1], v9 offset:32768
v_mfma_f32_16x16x32_bf16 v[164:167], a[36:39], a[76:79], v[164:167]
s_cselect_b32 s23, 0, s23
s_add_u32 m0, s25, 16384
v_mfma_f32_16x16x32_bf16 v[164:167], a[32:35], a[72:75], v[164:167]
ds_read_b64_tr_b16 a[2:3], v9 offset:33792
v_mfma_f32_16x16x32_bf16 v[168:171], a[32:35], a[80:83], v[168:171]
buffer_load_dwordx4 v5, s[8:11], s21 offen offset:0 lds
v_mfma_f32_16x16x32_bf16 v[168:171], a[36:39], a[84:87], v[168:171]
ds_read_b64_tr_b16 a[4:5], v9 offset:40960
v_mfma_f32_16x16x32_bf16 v[172:175], a[36:39], a[92:95], v[172:175]
v_add_u32 v15, s23, v13
v_xor_b32 v14, 64, v15
v_mfma_f32_16x16x32_bf16 v[172:175], a[32:35], a[88:91], v[172:175]
ds_read_b64_tr_b16 a[6:7], v9 offset:41984
v_mfma_f32_16x16x32_bf16 v[192:195], a[40:43], a[64:67], v[192:195]
s_bitcmp1_b32 s83, s3
s_cselect_b64 s[44:45], -1, 0
v_mfma_f32_16x16x32_bf16 v[192:195], a[44:47], a[68:71], v[192:195]
ds_read_b64_tr_b16 a[8:9], v10 offset:32768
v_mfma_f32_16x16x32_bf16 v[196:199], a[44:47], a[76:79], v[196:199]
buffer_load_dwordx4 v6, s[8:11], s21 offen offset:1024 lds
v_mfma_f32_16x16x32_bf16 v[196:199], a[40:43], a[72:75], v[196:199]
ds_read_b64_tr_b16 a[10:11], v10 offset:33792
v_mfma_f32_16x16x32_bf16 v[200:203], a[40:43], a[80:83], v[200:203]
v_cndmask_b32 v18, v20, v22, s[44:45]
v_cndmask_b32 v19, v21, v23, s[44:45]
v_mfma_f32_16x16x32_bf16 v[200:203], a[44:47], a[84:87], v[200:203]
ds_read_b64_tr_b16 a[12:13], v10 offset:40960
v_mfma_f32_16x16x32_bf16 v[204:207], a[44:47], a[92:95], v[204:207]
v_cndmask_b32 v22, v22, v24, s[44:45]
v_cndmask_b32 v23, v23, v25, s[44:45]
v_mfma_f32_16x16x32_bf16 v[204:207], a[40:43], a[88:91], v[204:207]
ds_read_b64_tr_b16 a[14:15], v10 offset:41984
v_mfma_f32_16x16x32_bf16 v[224:227], a[48:51], a[64:67], v[224:227]
buffer_load_dwordx4 v7, s[8:11], s21 offen offset:2048 lds
v_mfma_f32_16x16x32_bf16 v[224:227], a[52:55], a[68:71], v[224:227]
ds_read_b64_tr_b16 a[16:17], v11 offset:32768
v_mfma_f32_16x16x32_bf16 v[228:231], a[52:55], a[76:79], v[228:231]
v_cndmask_b32 v24, v24, v26, s[44:45]
v_cndmask_b32 v25, v25, v27, s[44:45]
v_mfma_f32_16x16x32_bf16 v[228:231], a[48:51], a[72:75], v[228:231]
ds_read_b64_tr_b16 a[18:19], v11 offset:33792
v_mfma_f32_16x16x32_bf16 v[232:235], a[48:51], a[80:83], v[232:235]
v_mfma_f32_16x16x32_bf16 v[232:235], a[52:55], a[84:87], v[232:235]
ds_read_b64_tr_b16 a[20:21], v11 offset:40960
v_mfma_f32_16x16x32_bf16 v[236:239], a[52:55], a[92:95], v[236:239]
buffer_load_dwordx4 v8, s[8:11], s21 offen offset:3072 lds
v_mfma_f32_16x16x32_bf16 v[236:239], a[48:51], a[88:91], v[236:239]
ds_read_b64_tr_b16 a[22:23], v11 offset:41984
v_mfma_f32_16x16x32_bf16 a[128:131], a[56:59], a[64:67], a[128:131]
s_xor_b64 s[8:9], s[8:9], s[80:81]
s_add_u32 s21, s21, s22
v_mfma_f32_16x16x32_bf16 a[128:131], a[60:63], a[68:71], a[128:131]
ds_read_b64_tr_b16 a[24:25], v12 offset:32768
v_mfma_f32_16x16x32_bf16 a[132:135], a[60:63], a[76:79], a[132:135]
s_add_u32 m0, s24, 0
v_mfma_f32_16x16x32_bf16 a[132:135], a[56:59], a[72:75], a[132:135]
ds_read_b64_tr_b16 a[26:27], v12 offset:33792
v_mfma_f32_16x16x32_bf16 a[136:139], a[56:59], a[80:83], a[136:139]
buffer_load_dwordx4 v1, s[4:7], s19 offen offset:0 lds
v_mfma_f32_16x16x32_bf16 a[136:139], a[60:63], a[84:87], a[136:139]
ds_read_b64_tr_b16 a[28:29], v12 offset:40960
v_mfma_f32_16x16x32_bf16 a[140:143], a[60:63], a[92:95], a[140:143]
v_cndmask_b32 v26, v26, v28, s[44:45]
v_cndmask_b32 v27, v27, v29, s[44:45]
v_mfma_f32_16x16x32_bf16 a[140:143], a[56:59], a[88:91], a[140:143]
ds_read_b64_tr_b16 a[30:31], v12 offset:41984
v_mfma_f32_16x16x32_bf16 v[176:179], a[32:35], a[96:99], v[176:179]
s_cmp_eq_u32 s3, s46
s_cbranch_scc1 L_pf4409_do
L_pf4409_back:
v_mfma_f32_16x16x32_bf16 v[176:179], a[36:39], a[100:103], v[176:179]
ds_read_b128 a[64:67], v15 offset:0
v_mfma_f32_16x16x32_bf16 v[180:183], a[36:39], a[108:111], v[180:183]
buffer_load_dwordx4 v2, s[4:7], s19 offen offset:1024 lds
v_mfma_f32_16x16x32_bf16 v[180:183], a[32:35], a[104:107], v[180:183]
ds_read_b128 a[68:71], v14 offset:0
v_mfma_f32_16x16x32_bf16 v[184:187], a[32:35], a[112:115], v[184:187]
s_add_u32 s3, s3, 1
v_mfma_f32_16x16x32_bf16 v[184:187], a[36:39], a[116:119], v[184:187]
ds_read_b128 a[72:75], v15 offset:2048
v_mfma_f32_16x16x32_bf16 v[188:191], a[36:39], a[124:127], v[188:191]
v_mfma_f32_16x16x32_bf16 v[188:191], a[32:35], a[120:123], v[188:191]
ds_read_b128 a[76:79], v14 offset:2048
v_mfma_f32_16x16x32_bf16 v[208:211], a[40:43], a[96:99], v[208:211]
buffer_load_dwordx4 v3, s[4:7], s19 offen offset:2048 lds
v_mfma_f32_16x16x32_bf16 v[208:211], a[44:47], a[100:103], v[208:211]
ds_read_b128 a[80:83], v15 offset:4096
v_mfma_f32_16x16x32_bf16 v[212:215], a[44:47], a[108:111], v[212:215]
v_mfma_f32_16x16x32_bf16 v[212:215], a[40:43], a[104:107], v[212:215]
ds_read_b128 a[84:87], v14 offset:4096
v_mfma_f32_16x16x32_bf16 v[216:219], a[40:43], a[112:115], v[216:219]
v_mfma_f32_16x16x32_bf16 v[216:219], a[44:47], a[116:119], v[216:219]
ds_read_b128 a[88:91], v15 offset:6144
v_mfma_f32_16x16x32_bf16 v[220:223], a[44:47], a[124:127], v[220:223]
buffer_load_dwordx4 v4, s[4:7], s19 offen offset:3072 lds
v_mfma_f32_16x16x32_bf16 v[220:223], a[40:43], a[120:123], v[220:223]
ds_read_b128 a[92:95], v14 offset:6144
v_mfma_f32_16x16x32_bf16 v[240:243], a[48:51], a[96:99], v[240:243]
s_add_u32 s19, s19, 128
v_mfma_f32_16x16x32_bf16 v[240:243], a[52:55], a[100:103], v[240:243]
v_mfma_f32_16x16x32_bf16 v[244:247], a[52:55], a[108:111], v[244:247]
global_load_dword v31, v[18:19], off
v_mfma_f32_16x16x32_bf16 v[244:247], a[48:51], a[104:107], v[244:247]
v_mfma_f32_16x16x32_bf16 v[248:251], a[48:51], a[112:115], v[248:251]
v_mfma_f32_16x16x32_bf16 v[248:251], a[52:55], a[116:119], v[248:251]
v_mfma_f32_16x16x32_bf16 v[252:255], a[52:55], a[124:127], v[252:255]
v_mfma_f32_16x16x32_bf16 v[252:255], a[48:51], a[120:123], v[252:255]
v_mfma_f32_16x16x32_bf16 a[144:147], a[56:59], a[96:99], a[144:147]
v_mfma_f32_16x16x32_bf16 a[144:147], a[60:63], a[100:103], a[144:147]
v_mfma_f32_16x16x32_bf16 a[148:151], a[60:63], a[108:111], a[148:151]
v_mfma_f32_16x16x32_bf16 a[148:151], a[56:59], a[104:107], a[148:151]
v_mfma_f32_16x16x32_bf16 a[152:155], a[56:59], a[112:115], a[152:155]
v_mfma_f32_16x16x32_bf16 a[152:155], a[60:63], a[116:119], a[152:155]
v_mfma_f32_16x16x32_bf16 a[156:159], a[60:63], a[124:127], a[156:159]
s_waitcnt vmcnt(18) lgkmcnt(0)
v_mfma_f32_16x16x32_bf16 a[156:159], a[56:59], a[120:123], a[156:159]
s_barrier
L_k1H_p2:
v_mfma_f32_16x16x32_bf16 v[32:35], a[0:3], a[64:67], v[32:35]
v_mfma_f32_16x16x32_bf16 v[32:35], a[4:7], a[68:71], v[32:35]
ds_read_b128 a[96:99], v15 offset:8192
v_mfma_f32_16x16x32_bf16 v[36:39], a[4:7], a[76:79], v[36:39]
s_add_u32 m0, s25, 32768
v_mfma_f32_16x16x32_bf16 v[36:39], a[0:3], a[72:75], v[36:39]
ds_read_b128 a[100:103], v14 offset:8192
v_mfma_f32_16x16x32_bf16 v[40:43], a[0:3], a[80:83], v[40:43]
buffer_load_dwordx4 v5, s[8:11], s21 offen offset:0 lds
v_mfma_f32_16x16x32_bf16 v[40:43], a[4:7], a[84:87], v[40:43]
ds_read_b128 a[104:107], v15 offset:10240
v_mfma_f32_16x16x32_bf16 v[44:47], a[4:7], a[92:95], v[44:47]
v_mfma_f32_16x16x32_bf16 v[44:47], a[0:3], a[88:91], v[44:47]
ds_read_b128 a[108:111], v14 offset:10240
v_mfma_f32_16x16x32_bf16 v[64:67], a[8:11], a[64:67], v[64:67]
s_bitcmp1_b32 s83, s3
s_cselect_b64 s[44:45], -1, 0
v_mfma_f32_16x16x32_bf16 v[64:67], a[12:15], a[68:71], v[64:67]
ds_read_b128 a[112:115], v15 offset:12288
v_mfma_f32_16x16x32_bf16 v[68:71], a[12:15], a[76:79], v[68:71]
buffer_load_dwordx4 v6, s[8:11], s21 offen offset:1024 lds
v_mfma_f32_16x16x32_bf16 v[68:71], a[8:11], a[72:75], v[68:71]
ds_read_b128 a[116:119], v14 offset:12288
v_mfma_f32_16x16x32_bf16 v[72:75], a[8:11], a[80:83], v[72:75]
v_cndmask_b32 v18, v20, v22, s[44:45]
v_cndmask_b32 v19, v21, v23, s[44:45]
v_mfma_f32_16x16x32_bf16 v[72:75], a[12:15], a[84:87], v[72:75]
ds_read_b128 a[120:123], v15 offset:14336
v_mfma_f32_16x16x32_bf16 v[76:79], a[12:15], a[92:95], v[76:79]
v_cndmask_b32 v22, v22, v24, s[44:45]
v_cndmask_b32 v23, v23, v25, s[44:45]
v_mfma_f32_16x16x32_bf16 v[76:79], a[8:11], a[88:91], v[76:79]
ds_read_b128 a[124:127], v14 offset:14336
v_mfma_f32_16x16x32_bf16 v[96:99], a[16:19], a[64:67], v[96:99]
buffer_load_dwordx4 v7, s[8:11], s21 offen offset:2048 lds
v_mfma_f32_16x16x32_bf16 v[96:99], a[20:23], a[68:71], v[96:99]
ds_read_b64_tr_b16 a[32:33], v9 offset:49152
v_mfma_f32_16x16x32_bf16 v[100:103], a[20:23], a[76:79], v[100:103]
v_cndmask_b32 v24, v24, v26, s[44:45]
v_cndmask_b32 v25, v25, v27, s[44:45]
v_mfma_f32_16x16x32_bf16 v[100:103], a[16:19], a[72:75], v[100:103]
ds_read_b64_tr_b16 a[34:35], v9 offset:50176
v_mfma_f32_16x16x32_bf16 v[104:107], a[16:19], a[80:83], v[104:107]
v_mfma_f32_16x16x32_bf16 v[104:107], a[20:23], a[84:87], v[104:107]
ds_read_b64_tr_b16 a[36:37], v9 offset:57344
v_mfma_f32_16x16x32_bf16 v[108:111], a[20:23], a[92:95], v[108:111]
buffer_load_dwordx4 v8, s[8:11], s21 offen offset:3072 lds
v_mfma_f32_16x16x32_bf16 v[108:111], a[16:19], a[88:91], v[108:111]
ds_read_b64_tr_b16 a[38:39], v9 offset:58368
v_mfma_f32_16x16x32_bf16 v[128:131], a[24:27], a[64:67], v[128:131]
s_xor_b64 s[8:9], s[8:9], s[80:81]
v_mfma_f32_16x16x32_bf16 v[128:131], a[28:31], a[68:71], v[128:131]
ds_read_b64_tr_b16 a[40:41], v10 offset:49152
v_mfma_f32_16x16x32_bf16 v[132:135], a[28:31], a[76:79], v[132:135]
s_add_u32 m0, s24, 4096
v_mfma_f32_16x16x32_bf16 v[132:135], a[24:27], a[72:75], v[132:135]
ds_read_b64_tr_b16 a[42:43], v10 offset:50176
v_mfma_f32_16x16x32_bf16 v[136:139], a[24:27], a[80:83], v[136:139]
buffer_load_dwordx4 v1, s[4:7], s20 offen offset:0 lds
v_mfma_f32_16x16x32_bf16 v[136:139], a[28:31], a[84:87], v[136:139]
ds_read_b64_tr_b16 a[44:45], v10 offset:57344
v_mfma_f32_16x16x32_bf16 v[140:143], a[28:31], a[92:95], v[140:143]
v_cndmask_b32 v26, v26, v28, s[44:45]
v_cndmask_b32 v27, v27, v29, s[44:45]
v_mfma_f32_16x16x32_bf16 v[140:143], a[24:27], a[88:91], v[140:143]
ds_read_b64_tr_b16 a[46:47], v10 offset:58368
s_waitcnt lgkmcnt(8)
v_mfma_f32_16x16x32_bf16 v[48:51], a[0:3], a[96:99], v[48:51]
s_cmp_eq_u32 s3, s46
s_cbranch_scc1 L_pf4534_do
L_pf4534_back:
v_mfma_f32_16x16x32_bf16 v[48:51], a[4:7], a[100:103], v[48:51]
ds_read_b64_tr_b16 a[48:49], v11 offset:49152
v_mfma_f32_16x16x32_bf16 v[52:55], a[4:7], a[108:111], v[52:55]
buffer_load_dwordx4 v2, s[4:7], s20 offen offset:1024 lds
v_mfma_f32_16x16x32_bf16 v[52:55], a[0:3], a[104:107], v[52:55]
ds_read_b64_tr_b16 a[50:51], v11 offset:50176
v_mfma_f32_16x16x32_bf16 v[56:59], a[0:3], a[112:115], v[56:59]
s_add_u32 s3, s3, 1
v_mfma_f32_16x16x32_bf16 v[56:59], a[4:7], a[116:119], v[56:59]
ds_read_b64_tr_b16 a[52:53], v11 offset:57344
v_mfma_f32_16x16x32_bf16 v[60:63], a[4:7], a[124:127], v[60:63]
v_mfma_f32_16x16x32_bf16 v[60:63], a[0:3], a[120:123], v[60:63]
ds_read_b64_tr_b16 a[54:55], v11 offset:58368
v_mfma_f32_16x16x32_bf16 v[80:83], a[8:11], a[96:99], v[80:83]
buffer_load_dwordx4 v3, s[4:7], s20 offen offset:2048 lds
v_mfma_f32_16x16x32_bf16 v[80:83], a[12:15], a[100:103], v[80:83]
ds_read_b64_tr_b16 a[56:57], v12 offset:49152
v_mfma_f32_16x16x32_bf16 v[84:87], a[12:15], a[108:111], v[84:87]
v_mfma_f32_16x16x32_bf16 v[84:87], a[8:11], a[104:107], v[84:87]
ds_read_b64_tr_b16 a[58:59], v12 offset:50176
v_mfma_f32_16x16x32_bf16 v[88:91], a[8:11], a[112:115], v[88:91]
v_mfma_f32_16x16x32_bf16 v[88:91], a[12:15], a[116:119], v[88:91]
ds_read_b64_tr_b16 a[60:61], v12 offset:57344
v_mfma_f32_16x16x32_bf16 v[92:95], a[12:15], a[124:127], v[92:95]
buffer_load_dwordx4 v4, s[4:7], s20 offen offset:3072 lds
v_mfma_f32_16x16x32_bf16 v[92:95], a[8:11], a[120:123], v[92:95]
ds_read_b64_tr_b16 a[62:63], v12 offset:58368
v_mfma_f32_16x16x32_bf16 v[112:115], a[16:19], a[96:99], v[112:115]
s_add_u32 s20, s20, 128
v_mfma_f32_16x16x32_bf16 v[112:115], a[20:23], a[100:103], v[112:115]
v_mfma_f32_16x16x32_bf16 v[116:119], a[20:23], a[108:111], v[116:119]
global_load_dword v31, v[18:19], off
v_mfma_f32_16x16x32_bf16 v[116:119], a[16:19], a[104:107], v[116:119]
v_mfma_f32_16x16x32_bf16 v[120:123], a[16:19], a[112:115], v[120:123]
v_mfma_f32_16x16x32_bf16 v[120:123], a[20:23], a[116:119], v[120:123]
v_mfma_f32_16x16x32_bf16 v[124:127], a[20:23], a[124:127], v[124:127]
v_mfma_f32_16x16x32_bf16 v[124:127], a[16:19], a[120:123], v[124:127]
v_mfma_f32_16x16x32_bf16 v[144:147], a[24:27], a[96:99], v[144:147]
v_mfma_f32_16x16x32_bf16 v[144:147], a[28:31], a[100:103], v[144:147]
v_mfma_f32_16x16x32_bf16 v[148:151], a[28:31], a[108:111], v[148:151]
v_mfma_f32_16x16x32_bf16 v[148:151], a[24:27], a[104:107], v[148:151]
v_mfma_f32_16x16x32_bf16 v[152:155], a[24:27], a[112:115], v[152:155]
v_mfma_f32_16x16x32_bf16 v[152:155], a[28:31], a[116:119], v[152:155]
v_mfma_f32_16x16x32_bf16 v[156:159], a[28:31], a[124:127], v[156:159]
s_waitcnt vmcnt(18) lgkmcnt(0)
v_mfma_f32_16x16x32_bf16 v[156:159], a[24:27], a[120:123], v[156:159]
s_barrier
L_k1H_p3:
v_mfma_f32_16x16x32_bf16 v[176:179], a[32:35], a[96:99], v[176:179]
s_add_u32 s24, s23, s27
s_add_u32 s23, s23, 32768
s_cmp_eq_u32 s23, 98304
v_mfma_f32_16x16x32_bf16 v[176:179], a[36:39], a[100:103], v[176:179]
ds_read_b64_tr_b16 a[0:1], v9 offset:0
v_mfma_f32_16x16x32_bf16 v[180:183], a[36:39], a[108:111], v[180:183]
s_cselect_b32 s23, 0, s23
s_add_u32 m0, s25, 49152
v_mfma_f32_16x16x32_bf16 v[180:183], a[32:35], a[104:107], v[180:183]
ds_read_b64_tr_b16 a[2:3], v9 offset:1024
v_mfma_f32_16x16x32_bf16 v[184:187], a[32:35], a[112:115], v[184:187]
buffer_load_dwordx4 v5, s[8:11], s21 offen offset:0 lds
v_mfma_f32_16x16x32_bf16 v[184:187], a[36:39], a[116:119], v[184:187]
ds_read_b64_tr_b16 a[4:5], v9 offset:8192
v_mfma_f32_16x16x32_bf16 v[188:191], a[36:39], a[124:127], v[188:191]
v_add_u32 v15, s23, v13
v_xor_b32 v14, 64, v15
v_mfma_f32_16x16x32_bf16 v[188:191], a[32:35], a[120:123], v[188:191]
ds_read_b64_tr_b16 a[6:7], v9 offset:9216
v_mfma_f32_16x16x32_bf16 v[208:211], a[40:43], a[96:99], v[208:211]
s_bitcmp1_b32 s83, s3
s_cselect_b64 s[44:45], -1, 0
v_mfma_f32_16x16x32_bf16 v[208:211], a[44:47], a[100:103], v[208:211]
ds_read_b64_tr_b16 a[8:9], v10 offset:0
v_mfma_f32_16x16x32_bf16 v[212:215], a[44:47], a[108:111], v[212:215]
buffer_load_dwordx4 v6, s[8:11], s21 offen offset:1024 lds
v_mfma_f32_16x16x32_bf16 v[212:215], a[40:43], a[104:107], v[212:215]
ds_read_b64_tr_b16 a[10:11], v10 offset:1024
v_mfma_f32_16x16x32_bf16 v[216:219], a[40:43], a[112:115], v[216:219]
v_cndmask_b32 v18, v20, v22, s[44:45]
v_cndmask_b32 v19, v21, v23, s[44:45]
v_mfma_f32_16x16x32_bf16 v[216:219], a[44:47], a[116:119], v[216:219]
ds_read_b64_tr_b16 a[12:13], v10 offset:8192
v_mfma_f32_16x16x32_bf16 v[220:223], a[44:47], a[124:127], v[220:223]
v_cndmask_b32 v22, v22, v24, s[44:45]
v_cndmask_b32 v23, v23, v25, s[44:45]
v_mfma_f32_16x16x32_bf16 v[220:223], a[40:43], a[120:123], v[220:223]
ds_read_b64_tr_b16 a[14:15], v10 offset:9216
v_mfma_f32_16x16x32_bf16 v[240:243], a[48:51], a[96:99], v[240:243]
buffer_load_dwordx4 v7, s[8:11], s21 offen offset:2048 lds
v_mfma_f32_16x16x32_bf16 v[240:243], a[52:55], a[100:103], v[240:243]
ds_read_b64_tr_b16 a[16:17], v11 offset:0
v_mfma_f32_16x16x32_bf16 v[244:247], a[52:55], a[108:111], v[244:247]
v_cndmask_b32 v24, v24, v26, s[44:45]
v_cndmask_b32 v25, v25, v27, s[44:45]
v_mfma_f32_16x16x32_bf16 v[244:247], a[48:51], a[104:107], v[244:247]
ds_read_b64_tr_b16 a[18:19], v11 offset:1024
v_mfma_f32_16x16x32_bf16 v[248:251], a[48:51], a[112:115], v[248:251]
s_cmp_eq_u32 s26, 6
s_cbranch_scc1 L_k1H_swA
L_k1H_backA:
v_mfma_f32_16x16x32_bf16 v[248:251], a[52:55], a[116:119], v[248:251]
ds_read_b64_tr_b16 a[20:21], v11 offset:8192
v_mfma_f32_16x16x32_bf16 v[252:255], a[52:55], a[124:127], v[252:255]
buffer_load_dwordx4 v8, s[8:11], s21 offen offset:3072 lds
v_mfma_f32_16x16x32_bf16 v[252:255], a[48:51], a[120:123], v[252:255]
ds_read_b64_tr_b16 a[22:23], v11 offset:9216
v_mfma_f32_16x16x32_bf16 a[144:147], a[56:59], a[96:99], a[144:147]
s_xor_b64 s[8:9], s[8:9], s[80:81]
s_add_u32 s21, s21, s22
v_mfma_f32_16x16x32_bf16 a[144:147], a[60:63], a[100:103], a[144:147]
ds_read_b64_tr_b16 a[24:25], v12 offset:0
v_mfma_f32_16x16x32_bf16 a[148:151], a[60:63], a[108:111], a[148:151]
s_add_u32 m0, s24, 0
v_mfma_f32_16x16x32_bf16 a[148:151], a[56:59], a[104:107], a[148:151]
ds_read_b64_tr_b16 a[26:27], v12 offset:1024
v_mfma_f32_16x16x32_bf16 a[152:155], a[56:59], a[112:115], a[152:155]
buffer_load_dwordx4 v1, s[4:7], s19 offen offset:0 lds
v_mfma_f32_16x16x32_bf16 a[152:155], a[60:63], a[116:119], a[152:155]
ds_read_b64_tr_b16 a[28:29], v12 offset:8192
v_mfma_f32_16x16x32_bf16 a[156:159], a[60:63], a[124:127], a[156:159]
v_cndmask_b32 v26, v26, v28, s[44:45]
v_cndmask_b32 v27, v27, v29, s[44:45]
v_mfma_f32_16x16x32_bf16 a[156:159], a[56:59], a[120:123], a[156:159]
ds_read_b64_tr_b16 a[30:31], v12 offset:9216
v_mfma_f32_16x16x32_bf16 v[160:163], a[32:35], a[64:67], v[160:163]
s_cmp_eq_u32 s3, s46
s_cbranch_scc1 L_pf4653_do
L_pf4653_back:
v_mfma_f32_16x16x32_bf16 v[160:163], a[36:39], a[68:71], v[160:163]
ds_read_b128 a[96:99], v15 offset:8192
v_mfma_f32_16x16x32_bf16 v[164:167], a[36:39], a[76:79], v[164:167]
buffer_load_dwordx4 v2, s[4:7], s19 offen offset:1024 lds
v_mfma_f32_16x16x32_bf16 v[164:167], a[32:35], a[72:75], v[164:167]
ds_read_b128 a[100:103], v14 offset:8192
v_mfma_f32_16x16x32_bf16 v[168:171], a[32:35], a[80:83], v[168:171]
s_add_u32 s3, s3, 1
v_mfma_f32_16x16x32_bf16 v[168:171], a[36:39], a[84:87], v[168:171]
ds_read_b128 a[104:107], v15 offset:10240
v_mfma_f32_16x16x32_bf16 v[172:175], a[36:39], a[92:95], v[172:175]
v_mfma_f32_16x16x32_bf16 v[172:175], a[32:35], a[88:91], v[172:175]
ds_read_b128 a[108:111], v14 offset:10240
v_mfma_f32_16x16x32_bf16 v[192:195], a[40:43], a[64:67], v[192:195]
buffer_load_dwordx4 v3, s[4:7], s19 offen offset:2048 lds
v_mfma_f32_16x16x32_bf16 v[192:195], a[44:47], a[68:71], v[192:195]
ds_read_b128 a[112:115], v15 offset:12288
v_mfma_f32_16x16x32_bf16 v[196:199], a[44:47], a[76:79], v[196:199]
v_mfma_f32_16x16x32_bf16 v[196:199], a[40:43], a[72:75], v[196:199]
ds_read_b128 a[116:119], v14 offset:12288
v_mfma_f32_16x16x32_bf16 v[200:203], a[40:43], a[80:83], v[200:203]
v_mfma_f32_16x16x32_bf16 v[200:203], a[44:47], a[84:87], v[200:203]
ds_read_b128 a[120:123], v15 offset:14336
v_mfma_f32_16x16x32_bf16 v[204:207], a[44:47], a[92:95], v[204:207]
buffer_load_dwordx4 v4, s[4:7], s19 offen offset:3072 lds
v_mfma_f32_16x16x32_bf16 v[204:207], a[40:43], a[88:91], v[204:207]
ds_read_b128 a[124:127], v14 offset:14336
v_mfma_f32_16x16x32_bf16 v[224:227], a[48:51], a[64:67], v[224:227]
s_add_u32 s19, s19, 128
v_mfma_f32_16x16x32_bf16 v[224:227], a[52:55], a[68:71], v[224:227]
v_mfma_f32_16x16x32_bf16 v[228:231], a[52:55], a[76:79], v[228:231]
global_load_dword v31, v[18:19], off
v_mfma_f32_16x16x32_bf16 v[228:231], a[48:51], a[72:75], v[228:231]
v_mfma_f32_16x16x32_bf16 v[232:235], a[48:51], a[80:83], v[232:235]
s_add_u32 s26, s26, 1
v_mfma_f32_16x16x32_bf16 v[232:235], a[52:55], a[84:87], v[232:235]
v_mfma_f32_16x16x32_bf16 v[236:239], a[52:55], a[92:95], v[236:239]
s_cmp_le_u32 s26, 7
v_mfma_f32_16x16x32_bf16 v[236:239], a[48:51], a[88:91], v[236:239]
v_mfma_f32_16x16x32_bf16 a[128:131], a[56:59], a[64:67], a[128:131]
v_mfma_f32_16x16x32_bf16 a[128:131], a[60:63], a[68:71], a[128:131]
v_mfma_f32_16x16x32_bf16 a[132:135], a[60:63], a[76:79], a[132:135]
v_mfma_f32_16x16x32_bf16 a[132:135], a[56:59], a[72:75], a[132:135]
v_mfma_f32_16x16x32_bf16 a[136:139], a[56:59], a[80:83], a[136:139]
v_mfma_f32_16x16x32_bf16 a[136:139], a[60:63], a[84:87], a[136:139]
v_mfma_f32_16x16x32_bf16 a[140:143], a[60:63], a[92:95], a[140:143]
s_waitcnt vmcnt(18) lgkmcnt(0)
v_mfma_f32_16x16x32_bf16 a[140:143], a[56:59], a[88:91], a[140:143]
s_barrier
s_cbranch_scc1 L_k1H_p0
L_k1H_done:
s_nop 7
s_add_u32 m0, s25, 0
s_nop 0
buffer_load_dwordx4 v5, s[8:11], s21 offen offset:0 lds
v_cvt_pk_bf16_f32 v32, v32, v33
v_cvt_pk_bf16_f32 v33, v34, v35
v_cvt_pk_bf16_f32 v34, v64, v65
v_cvt_pk_bf16_f32 v35, v66, v67
v_accvgpr_write_b32 a160, v32
v_accvgpr_write_b32 a161, v33
v_accvgpr_write_b32 a162, v34
v_accvgpr_write_b32 a163, v35
v_cvt_pk_bf16_f32 v96, v96, v97
v_cvt_pk_bf16_f32 v97, v98, v99
v_cvt_pk_bf16_f32 v98, v128, v129
v_cvt_pk_bf16_f32 v99, v130, v131
v_accvgpr_write_b32 a164, v96
v_accvgpr_write_b32 a165, v97
v_accvgpr_write_b32 a166, v98
v_accvgpr_write_b32 a167, v99
v_cvt_pk_bf16_f32 v160, v160, v161
v_cvt_pk_bf16_f32 v161, v162, v163
v_cvt_pk_bf16_f32 v162, v192, v193
v_cvt_pk_bf16_f32 v163, v194, v195
s_add_u32 s30, s28, 4096
buffer_store_dwordx4 v[160:163], v16, s[12:15], s30 offen offset:0 sc0 sc1
v_accvgpr_read_b32 v64, a128
v_accvgpr_read_b32 v65, a129
v_accvgpr_read_b32 v66, a130
v_accvgpr_read_b32 v67, a131
v_cvt_pk_bf16_f32 v224, v224, v225
v_cvt_pk_bf16_f32 v225, v226, v227
v_cvt_pk_bf16_f32 v226, v64, v65
v_cvt_pk_bf16_f32 v227, v66, v67
v_accvgpr_write_b32 a168, v224
v_accvgpr_write_b32 a169, v225
v_accvgpr_write_b32 a170, v226
v_accvgpr_write_b32 a171, v227
buffer_load_dwordx4 v6, s[8:11], s21 offen offset:1024 lds
v_cvt_pk_bf16_f32 v36, v36, v37
v_cvt_pk_bf16_f32 v37, v38, v39
v_cvt_pk_bf16_f32 v38, v68, v69
v_cvt_pk_bf16_f32 v39, v70, v71
v_accvgpr_write_b32 a172, v36
v_accvgpr_write_b32 a173, v37
v_accvgpr_write_b32 a174, v38
v_accvgpr_write_b32 a175, v39
v_cvt_pk_bf16_f32 v100, v100, v101
v_cvt_pk_bf16_f32 v101, v102, v103
v_cvt_pk_bf16_f32 v102, v132, v133
v_cvt_pk_bf16_f32 v103, v134, v135
v_accvgpr_write_b32 a176, v100
v_accvgpr_write_b32 a177, v101
v_accvgpr_write_b32 a178, v102
v_accvgpr_write_b32 a179, v103
v_cvt_pk_bf16_f32 v164, v164, v165
v_cvt_pk_bf16_f32 v165, v166, v167
v_cvt_pk_bf16_f32 v166, v196, v197
v_cvt_pk_bf16_f32 v167, v198, v199
s_add_u32 s30, s28, 12288
buffer_store_dwordx4 v[164:167], v16, s[12:15], s30 offen offset:0 sc0 sc1
v_accvgpr_read_b32 v68, a132
v_accvgpr_read_b32 v69, a133
v_accvgpr_read_b32 v70, a134
v_accvgpr_read_b32 v71, a135
v_cvt_pk_bf16_f32 v228, v228, v229
v_cvt_pk_bf16_f32 v229, v230, v231
v_cvt_pk_bf16_f32 v230, v68, v69
v_cvt_pk_bf16_f32 v231, v70, v71
v_accvgpr_write_b32 a180, v228
v_accvgpr_write_b32 a181, v229
v_accvgpr_write_b32 a182, v230
v_accvgpr_write_b32 a183, v231
buffer_load_dwordx4 v7, s[8:11], s21 offen offset:2048 lds
v_cvt_pk_bf16_f32 v40, v40, v41
v_cvt_pk_bf16_f32 v41, v42, v43
v_cvt_pk_bf16_f32 v42, v72, v73
v_cvt_pk_bf16_f32 v43, v74, v75
v_accvgpr_write_b32 a184, v40
v_accvgpr_write_b32 a185, v41
v_accvgpr_write_b32 a186, v42
v_accvgpr_write_b32 a187, v43
v_cvt_pk_bf16_f32 v104, v104, v105
v_cvt_pk_bf16_f32 v105, v106, v107
v_cvt_pk_bf16_f32 v106, v136, v137
v_cvt_pk_bf16_f32 v107, v138, v139
v_accvgpr_write_b32 a188, v104
v_accvgpr_write_b32 a189, v105
v_accvgpr_write_b32 a190, v106
v_accvgpr_write_b32 a191, v107
v_cvt_pk_bf16_f32 v168, v168, v169
v_cvt_pk_bf16_f32 v169, v170, v171
v_cvt_pk_bf16_f32 v170, v200, v201
v_cvt_pk_bf16_f32 v171, v202, v203
s_add_u32 s30, s28, 20480
buffer_store_dwordx4 v[168:171], v16, s[12:15], s30 offen offset:0 sc0 sc1
v_accvgpr_read_b32 v72, a136
v_accvgpr_read_b32 v73, a137
v_accvgpr_read_b32 v74, a138
v_accvgpr_read_b32 v75, a139
v_cvt_pk_bf16_f32 v232, v232, v233
v_cvt_pk_bf16_f32 v233, v234, v235
v_cvt_pk_bf16_f32 v234, v72, v73
v_cvt_pk_bf16_f32 v235, v74, v75
v_accvgpr_write_b32 a192, v232
v_accvgpr_write_b32 a193, v233
v_accvgpr_write_b32 a194, v234
v_accvgpr_write_b32 a195, v235
buffer_load_dwordx4 v8, s[8:11], s21 offen offset:3072 lds
v_cvt_pk_bf16_f32 v44, v44, v45
v_cvt_pk_bf16_f32 v45, v46, v47
v_cvt_pk_bf16_f32 v46, v76, v77
v_cvt_pk_bf16_f32 v47, v78, v79
v_accvgpr_write_b32 a196, v44
v_accvgpr_write_b32 a197, v45
v_accvgpr_write_b32 a198, v46
v_accvgpr_write_b32 a199, v47
v_cvt_pk_bf16_f32 v108, v108, v109
v_cvt_pk_bf16_f32 v109, v110, v111
v_cvt_pk_bf16_f32 v110, v140, v141
v_cvt_pk_bf16_f32 v111, v142, v143
v_accvgpr_write_b32 a200, v108
v_accvgpr_write_b32 a201, v109
v_accvgpr_write_b32 a202, v110
v_accvgpr_write_b32 a203, v111
v_cvt_pk_bf16_f32 v172, v172, v173
v_cvt_pk_bf16_f32 v173, v174, v175
v_cvt_pk_bf16_f32 v174, v204, v205
v_cvt_pk_bf16_f32 v175, v206, v207
s_add_u32 s30, s28, 28672
buffer_store_dwordx4 v[172:175], v16, s[12:15], s30 offen offset:0 sc0 sc1
v_accvgpr_read_b32 v76, a140
v_accvgpr_read_b32 v77, a141
v_accvgpr_read_b32 v78, a142
v_accvgpr_read_b32 v79, a143
v_cvt_pk_bf16_f32 v236, v236, v237
v_cvt_pk_bf16_f32 v237, v238, v239
v_cvt_pk_bf16_f32 v238, v76, v77
v_cvt_pk_bf16_f32 v239, v78, v79
v_accvgpr_write_b32 a204, v236
v_accvgpr_write_b32 a205, v237
v_accvgpr_write_b32 a206, v238
v_accvgpr_write_b32 a207, v239
s_xor_b64 s[8:9], s[8:9], s[80:81]
s_add_u32 m0, s24, 4096
s_nop 0
buffer_load_dwordx4 v1, s[4:7], s20 offen offset:0 lds
v_cvt_pk_bf16_f32 v48, v48, v49
v_cvt_pk_bf16_f32 v49, v50, v51
v_cvt_pk_bf16_f32 v50, v80, v81
v_cvt_pk_bf16_f32 v51, v82, v83
v_accvgpr_write_b32 a208, v48
v_accvgpr_write_b32 a209, v49
v_accvgpr_write_b32 a210, v50
v_accvgpr_write_b32 a211, v51
v_cvt_pk_bf16_f32 v112, v112, v113
v_cvt_pk_bf16_f32 v113, v114, v115
v_cvt_pk_bf16_f32 v114, v144, v145
v_cvt_pk_bf16_f32 v115, v146, v147
v_accvgpr_write_b32 a212, v112
v_accvgpr_write_b32 a213, v113
v_accvgpr_write_b32 a214, v114
v_accvgpr_write_b32 a215, v115
v_cvt_pk_bf16_f32 v176, v176, v177
v_cvt_pk_bf16_f32 v177, v178, v179
v_cvt_pk_bf16_f32 v178, v208, v209
v_cvt_pk_bf16_f32 v179, v210, v211
s_add_u32 s30, s28, 36864
buffer_store_dwordx4 v[176:179], v16, s[12:15], s30 offen offset:0 sc0 sc1
v_accvgpr_read_b32 v80, a144
v_accvgpr_read_b32 v81, a145
v_accvgpr_read_b32 v82, a146
v_accvgpr_read_b32 v83, a147
v_cvt_pk_bf16_f32 v240, v240, v241
v_cvt_pk_bf16_f32 v241, v242, v243
v_cvt_pk_bf16_f32 v242, v80, v81
v_cvt_pk_bf16_f32 v243, v82, v83
v_accvgpr_write_b32 a216, v240
v_accvgpr_write_b32 a217, v241
v_accvgpr_write_b32 a218, v242
v_accvgpr_write_b32 a219, v243
buffer_load_dwordx4 v2, s[4:7], s20 offen offset:1024 lds
v_cvt_pk_bf16_f32 v52, v52, v53
v_cvt_pk_bf16_f32 v53, v54, v55
v_cvt_pk_bf16_f32 v54, v84, v85
v_cvt_pk_bf16_f32 v55, v86, v87
v_accvgpr_write_b32 a220, v52
v_accvgpr_write_b32 a221, v53
v_accvgpr_write_b32 a222, v54
v_accvgpr_write_b32 a223, v55
v_cvt_pk_bf16_f32 v116, v116, v117
v_cvt_pk_bf16_f32 v117, v118, v119
v_cvt_pk_bf16_f32 v118, v148, v149
v_cvt_pk_bf16_f32 v119, v150, v151
v_accvgpr_write_b32 a224, v116
v_accvgpr_write_b32 a225, v117
v_accvgpr_write_b32 a226, v118
v_accvgpr_write_b32 a227, v119
v_cvt_pk_bf16_f32 v180, v180, v181
v_cvt_pk_bf16_f32 v181, v182, v183
v_cvt_pk_bf16_f32 v182, v212, v213
v_cvt_pk_bf16_f32 v183, v214, v215
s_add_u32 s30, s28, 45056
buffer_store_dwordx4 v[180:183], v16, s[12:15], s30 offen offset:0 sc0 sc1
v_accvgpr_read_b32 v84, a148
v_accvgpr_read_b32 v85, a149
v_accvgpr_read_b32 v86, a150
v_accvgpr_read_b32 v87, a151
v_cvt_pk_bf16_f32 v244, v244, v245
v_cvt_pk_bf16_f32 v245, v246, v247
v_cvt_pk_bf16_f32 v246, v84, v85
v_cvt_pk_bf16_f32 v247, v86, v87
v_accvgpr_write_b32 a228, v244
v_accvgpr_write_b32 a229, v245
v_accvgpr_write_b32 a230, v246
v_accvgpr_write_b32 a231, v247
buffer_load_dwordx4 v3, s[4:7], s20 offen offset:2048 lds
v_cvt_pk_bf16_f32 v56, v56, v57
v_cvt_pk_bf16_f32 v57, v58, v59
v_cvt_pk_bf16_f32 v58, v88, v89
v_cvt_pk_bf16_f32 v59, v90, v91
v_accvgpr_write_b32 a232, v56
v_accvgpr_write_b32 a233, v57
v_accvgpr_write_b32 a234, v58
v_accvgpr_write_b32 a235, v59
v_cvt_pk_bf16_f32 v120, v120, v121
v_cvt_pk_bf16_f32 v121, v122, v123
v_cvt_pk_bf16_f32 v122, v152, v153
v_cvt_pk_bf16_f32 v123, v154, v155
v_accvgpr_write_b32 a236, v120
v_accvgpr_write_b32 a237, v121
v_accvgpr_write_b32 a238, v122
v_accvgpr_write_b32 a239, v123
v_cvt_pk_bf16_f32 v184, v184, v185
v_cvt_pk_bf16_f32 v185, v186, v187
v_cvt_pk_bf16_f32 v186, v216, v217
v_cvt_pk_bf16_f32 v187, v218, v219
s_add_u32 s30, s28, 53248
buffer_store_dwordx4 v[184:187], v16, s[12:15], s30 offen offset:0 sc0 sc1
v_accvgpr_read_b32 v88, a152
v_accvgpr_read_b32 v89, a153
v_accvgpr_read_b32 v90, a154
v_accvgpr_read_b32 v91, a155
v_cvt_pk_bf16_f32 v248, v248, v249
v_cvt_pk_bf16_f32 v249, v250, v251
v_cvt_pk_bf16_f32 v250, v88, v89
v_cvt_pk_bf16_f32 v251, v90, v91
v_accvgpr_write_b32 a240, v248
v_accvgpr_write_b32 a241, v249
v_accvgpr_write_b32 a242, v250
v_accvgpr_write_b32 a243, v251
buffer_load_dwordx4 v4, s[4:7], s20 offen offset:3072 lds
s_add_u32 s20, s20, 128
v_cvt_pk_bf16_f32 v60, v60, v61
v_cvt_pk_bf16_f32 v61, v62, v63
v_cvt_pk_bf16_f32 v62, v92, v93
v_cvt_pk_bf16_f32 v63, v94, v95
v_accvgpr_write_b32 a244, v60
v_accvgpr_write_b32 a245, v61
v_accvgpr_write_b32 a246, v62
v_accvgpr_write_b32 a247, v63
v_cvt_pk_bf16_f32 v124, v124, v125
v_cvt_pk_bf16_f32 v125, v126, v127
v_cvt_pk_bf16_f32 v126, v156, v157
v_cvt_pk_bf16_f32 v127, v158, v159
v_accvgpr_write_b32 a248, v124
v_accvgpr_write_b32 a249, v125
v_accvgpr_write_b32 a250, v126
v_accvgpr_write_b32 a251, v127
v_cvt_pk_bf16_f32 v188, v188, v189
v_cvt_pk_bf16_f32 v189, v190, v191
v_cvt_pk_bf16_f32 v190, v220, v221
v_cvt_pk_bf16_f32 v191, v222, v223
s_add_u32 s30, s28, 61440
buffer_store_dwordx4 v[188:191], v16, s[12:15], s30 offen offset:0 sc0 sc1
v_accvgpr_read_b32 v92, a156
v_accvgpr_read_b32 v93, a157
v_accvgpr_read_b32 v94, a158
v_accvgpr_read_b32 v95, a159
v_cvt_pk_bf16_f32 v252, v252, v253
v_cvt_pk_bf16_f32 v253, v254, v255
v_cvt_pk_bf16_f32 v254, v92, v93
v_cvt_pk_bf16_f32 v255, v94, v95
v_accvgpr_write_b32 a252, v252
v_accvgpr_write_b32 a253, v253
v_accvgpr_write_b32 a254, v254
v_accvgpr_write_b32 a255, v255
s_nop 1
v_mfma_f32_16x16x32_bf16 v[48:51], a[0:3], a[96:99], 0
v_mfma_f32_16x16x32_bf16 v[48:51], a[4:7], a[100:103], v[48:51]
ds_read_b128 a[64:67], v15 offset:0
v_mfma_f32_16x16x32_bf16 v[52:55], a[4:7], a[108:111], 0
v_mfma_f32_16x16x32_bf16 v[52:55], a[0:3], a[104:107], v[52:55]
ds_read_b128 a[68:71], v14 offset:0
v_mfma_f32_16x16x32_bf16 v[56:59], a[0:3], a[112:115], 0
v_mfma_f32_16x16x32_bf16 v[56:59], a[4:7], a[116:119], v[56:59]
ds_read_b128 a[72:75], v15 offset:2048
v_mfma_f32_16x16x32_bf16 v[60:63], a[4:7], a[124:127], 0
v_mfma_f32_16x16x32_bf16 v[60:63], a[0:3], a[120:123], v[60:63]
ds_read_b128 a[76:79], v14 offset:2048
v_mfma_f32_16x16x32_bf16 v[80:83], a[8:11], a[96:99], 0
v_mfma_f32_16x16x32_bf16 v[80:83], a[12:15], a[100:103], v[80:83]
ds_read_b128 a[80:83], v15 offset:4096
v_mfma_f32_16x16x32_bf16 v[84:87], a[12:15], a[108:111], 0
v_mfma_f32_16x16x32_bf16 v[84:87], a[8:11], a[104:107], v[84:87]
ds_read_b128 a[84:87], v14 offset:4096
v_mfma_f32_16x16x32_bf16 v[88:91], a[8:11], a[112:115], 0
s_add_u32 s30, s28, 0
v_mfma_f32_16x16x32_bf16 v[88:91], a[12:15], a[116:119], v[88:91]
ds_read_b128 a[88:91], v15 offset:6144
v_mfma_f32_16x16x32_bf16 v[92:95], a[12:15], a[124:127], 0
buffer_store_dwordx4 a[160:163], v16, s[12:15], s30 offen offset:0 sc0 sc1
v_mfma_f32_16x16x32_bf16 v[92:95], a[8:11], a[120:123], v[92:95]
ds_read_b128 a[92:95], v14 offset:6144
v_mfma_f32_16x16x32_bf16 v[112:115], a[16:19], a[96:99], 0
v_mfma_f32_16x16x32_bf16 v[112:115], a[20:23], a[100:103], v[112:115]
ds_read_b64_tr_b16 a[32:33], v9 offset:16384
v_mfma_f32_16x16x32_bf16 v[116:119], a[20:23], a[108:111], 0
v_mfma_f32_16x16x32_bf16 v[116:119], a[16:19], a[104:107], v[116:119]
ds_read_b64_tr_b16 a[34:35], v9 offset:17408
v_mfma_f32_16x16x32_bf16 v[120:123], a[16:19], a[112:115], 0
v_mfma_f32_16x16x32_bf16 v[120:123], a[20:23], a[116:119], v[120:123]
ds_read_b64_tr_b16 a[36:37], v9 offset:24576
v_mfma_f32_16x16x32_bf16 v[124:127], a[20:23], a[124:127], 0
v_mfma_f32_16x16x32_bf16 v[124:127], a[16:19], a[120:123], v[124:127]
ds_read_b64_tr_b16 a[38:39], v9 offset:25600
v_mfma_f32_16x16x32_bf16 v[144:147], a[24:27], a[96:99], 0
v_mfma_f32_16x16x32_bf16 v[144:147], a[28:31], a[100:103], v[144:147]
ds_read_b64_tr_b16 a[40:41], v10 offset:16384
v_mfma_f32_16x16x32_bf16 v[148:151], a[28:31], a[108:111], 0
v_mfma_f32_16x16x32_bf16 v[148:151], a[24:27], a[104:107], v[148:151]
ds_read_b64_tr_b16 a[42:43], v10 offset:17408
v_mfma_f32_16x16x32_bf16 v[152:155], a[24:27], a[112:115], 0
v_mfma_f32_16x16x32_bf16 v[152:155], a[28:31], a[116:119], v[152:155]
ds_read_b64_tr_b16 a[44:45], v10 offset:24576
v_mfma_f32_16x16x32_bf16 v[156:159], a[28:31], a[124:127], 0
v_mfma_f32_16x16x32_bf16 v[156:159], a[24:27], a[120:123], v[156:159]
ds_read_b64_tr_b16 a[46:47], v10 offset:25600
s_waitcnt lgkmcnt(8)
v_mfma_f32_16x16x32_bf16 v[32:35], a[0:3], a[64:67], 0
v_mfma_f32_16x16x32_bf16 v[32:35], a[4:7], a[68:71], v[32:35]
ds_read_b64_tr_b16 a[48:49], v11 offset:16384
v_mfma_f32_16x16x32_bf16 v[36:39], a[4:7], a[76:79], 0
v_mfma_f32_16x16x32_bf16 v[36:39], a[0:3], a[72:75], v[36:39]
ds_read_b64_tr_b16 a[50:51], v11 offset:17408
v_mfma_f32_16x16x32_bf16 v[40:43], a[0:3], a[80:83], 0
s_add_u32 s30, s28, 0
v_mfma_f32_16x16x32_bf16 v[40:43], a[4:7], a[84:87], v[40:43]
ds_read_b64_tr_b16 a[52:53], v11 offset:24576
v_mfma_f32_16x16x32_bf16 v[44:47], a[4:7], a[92:95], 0
buffer_store_dwordx4 a[164:167], v16, s[12:15], s30 offen offset:1024 sc0 sc1
v_mfma_f32_16x16x32_bf16 v[44:47], a[0:3], a[88:91], v[44:47]
ds_read_b64_tr_b16 a[54:55], v11 offset:25600
v_mfma_f32_16x16x32_bf16 v[64:67], a[8:11], a[64:67], 0
v_mfma_f32_16x16x32_bf16 v[64:67], a[12:15], a[68:71], v[64:67]
ds_read_b64_tr_b16 a[56:57], v12 offset:16384
v_mfma_f32_16x16x32_bf16 v[68:71], a[12:15], a[76:79], 0
v_mfma_f32_16x16x32_bf16 v[68:71], a[8:11], a[72:75], v[68:71]
ds_read_b64_tr_b16 a[58:59], v12 offset:17408
v_mfma_f32_16x16x32_bf16 v[72:75], a[8:11], a[80:83], 0
v_mfma_f32_16x16x32_bf16 v[72:75], a[12:15], a[84:87], v[72:75]
ds_read_b64_tr_b16 a[60:61], v12 offset:24576
v_mfma_f32_16x16x32_bf16 v[76:79], a[12:15], a[92:95], 0
v_mfma_f32_16x16x32_bf16 v[76:79], a[8:11], a[88:91], v[76:79]
ds_read_b64_tr_b16 a[62:63], v12 offset:25600
v_mfma_f32_16x16x32_bf16 v[96:99], a[16:19], a[64:67], 0
v_mfma_f32_16x16x32_bf16 v[96:99], a[20:23], a[68:71], v[96:99]
v_mfma_f32_16x16x32_bf16 v[100:103], a[20:23], a[76:79], 0
v_mfma_f32_16x16x32_bf16 v[100:103], a[16:19], a[72:75], v[100:103]
v_mfma_f32_16x16x32_bf16 v[104:107], a[16:19], a[80:83], 0
v_mfma_f32_16x16x32_bf16 v[104:107], a[20:23], a[84:87], v[104:107]
v_mfma_f32_16x16x32_bf16 v[108:111], a[20:23], a[92:95], 0
s_add_u32 s30, s28, 4096
v_mfma_f32_16x16x32_bf16 v[108:111], a[16:19], a[88:91], v[108:111]
v_mfma_f32_16x16x32_bf16 v[128:131], a[24:27], a[64:67], 0
buffer_store_dwordx4 a[168:171], v16, s[12:15], s30 offen offset:1024 sc0 sc1
v_mfma_f32_16x16x32_bf16 v[128:131], a[28:31], a[68:71], v[128:131]
v_mfma_f32_16x16x32_bf16 v[132:135], a[28:31], a[76:79], 0
v_mfma_f32_16x16x32_bf16 v[132:135], a[24:27], a[72:75], v[132:135]
v_mfma_f32_16x16x32_bf16 v[136:139], a[24:27], a[80:83], 0
v_mfma_f32_16x16x32_bf16 v[136:139], a[28:31], a[84:87], v[136:139]
v_mfma_f32_16x16x32_bf16 v[140:143], a[28:31], a[92:95], 0
s_waitcnt vmcnt(27) lgkmcnt(0)
v_mfma_f32_16x16x32_bf16 v[140:143], a[24:27], a[88:91], v[140:143]
s_barrier
v_mfma_f32_16x16x32_bf16 v[160:163], a[32:35], a[64:67], 0
s_add_u32 s24, s23, s27
s_add_u32 s23, s23, 32768
s_cmp_eq_u32 s23, 98304
v_mfma_f32_16x16x32_bf16 v[160:163], a[36:39], a[68:71], v[160:163]
ds_read_b64_tr_b16 a[0:1], v9 offset:32768
v_mfma_f32_16x16x32_bf16 v[164:167], a[36:39], a[76:79], 0
s_cselect_b32 s23, 0, s23
s_add_u32 m0, s25, 16384
v_mfma_f32_16x16x32_bf16 v[164:167], a[32:35], a[72:75], v[164:167]
ds_read_b64_tr_b16 a[2:3], v9 offset:33792
v_mfma_f32_16x16x32_bf16 v[168:171], a[32:35], a[80:83], 0
buffer_load_dwordx4 v5, s[8:11], s21 offen offset:0 lds
v_mfma_f32_16x16x32_bf16 v[168:171], a[36:39], a[84:87], v[168:171]
ds_read_b64_tr_b16 a[4:5], v9 offset:40960
v_mfma_f32_16x16x32_bf16 v[172:175], a[36:39], a[92:95], 0
v_add_u32 v15, s23, v13
v_xor_b32 v14, 64, v15
v_mfma_f32_16x16x32_bf16 v[172:175], a[32:35], a[88:91], v[172:175]
ds_read_b64_tr_b16 a[6:7], v9 offset:41984
v_mfma_f32_16x16x32_bf16 v[192:195], a[40:43], a[64:67], 0
v_mfma_f32_16x16x32_bf16 v[192:195], a[44:47], a[68:71], v[192:195]
ds_read_b64_tr_b16 a[8:9], v10 offset:32768
v_mfma_f32_16x16x32_bf16 v[196:199], a[44:47], a[76:79], 0
buffer_load_dwordx4 v6, s[8:11], s21 offen offset:1024 lds
v_mfma_f32_16x16x32_bf16 v[196:199], a[40:43], a[72:75], v[196:199]
ds_read_b64_tr_b16 a[10:11], v10 offset:33792
v_mfma_f32_16x16x32_bf16 v[200:203], a[40:43], a[80:83], 0
s_add_u32 s30, s28, 8192
v_mfma_f32_16x16x32_bf16 v[200:203], a[44:47], a[84:87], v[200:203]
ds_read_b64_tr_b16 a[12:13], v10 offset:40960
v_mfma_f32_16x16x32_bf16 v[204:207], a[44:47], a[92:95], 0
buffer_store_dwordx4 a[172:175], v16, s[12:15], s30 offen offset:0 sc0 sc1
v_mfma_f32_16x16x32_bf16 v[204:207], a[40:43], a[88:91], v[204:207]
ds_read_b64_tr_b16 a[14:15], v10 offset:41984
v_mfma_f32_16x16x32_bf16 v[224:227], a[48:51], a[64:67], 0
buffer_load_dwordx4 v7, s[8:11], s21 offen offset:2048 lds
v_mfma_f32_16x16x32_bf16 v[224:227], a[52:55], a[68:71], v[224:227]
ds_read_b64_tr_b16 a[16:17], v11 offset:32768
v_mfma_f32_16x16x32_bf16 v[228:231], a[52:55], a[76:79], 0
v_mfma_f32_16x16x32_bf16 v[228:231], a[48:51], a[72:75], v[228:231]
ds_read_b64_tr_b16 a[18:19], v11 offset:33792
v_mfma_f32_16x16x32_bf16 v[232:235], a[48:51], a[80:83], 0
v_mfma_f32_16x16x32_bf16 v[232:235], a[52:55], a[84:87], v[232:235]
ds_read_b64_tr_b16 a[20:21], v11 offset:40960
v_mfma_f32_16x16x32_bf16 v[236:239], a[52:55], a[92:95], 0
buffer_load_dwordx4 v8, s[8:11], s21 offen offset:3072 lds
v_mfma_f32_16x16x32_bf16 v[236:239], a[48:51], a[88:91], v[236:239]
ds_read_b64_tr_b16 a[22:23], v11 offset:41984
v_mfma_f32_16x16x32_bf16 a[128:131], a[56:59], a[64:67], 0
s_xor_b64 s[8:9], s[8:9], s[80:81]
s_add_u32 s21, s21, s22
v_mfma_f32_16x16x32_bf16 a[128:131], a[60:63], a[68:71], a[128:131]
ds_read_b64_tr_b16 a[24:25], v12 offset:32768
v_mfma_f32_16x16x32_bf16 a[132:135], a[60:63], a[76:79], 0
s_add_u32 m0, s24, 0
v_mfma_f32_16x16x32_bf16 a[132:135], a[56:59], a[72:75], a[132:135]
ds_read_b64_tr_b16 a[26:27], v12 offset:33792
v_mfma_f32_16x16x32_bf16 a[136:139], a[56:59], a[80:83], 0
buffer_load_dwordx4 v1, s[4:7], s19 offen offset:0 lds
v_mfma_f32_16x16x32_bf16 a[136:139], a[60:63], a[84:87], a[136:139]
ds_read_b64_tr_b16 a[28:29], v12 offset:40960
v_mfma_f32_16x16x32_bf16 a[140:143], a[60:63], a[92:95], 0
v_mfma_f32_16x16x32_bf16 a[140:143], a[56:59], a[88:91], a[140:143]
ds_read_b64_tr_b16 a[30:31], v12 offset:41984
v_mfma_f32_16x16x32_bf16 v[176:179], a[32:35], a[96:99], 0
v_mfma_f32_16x16x32_bf16 v[176:179], a[36:39], a[100:103], v[176:179]
ds_read_b128 a[64:67], v15 offset:0
v_mfma_f32_16x16x32_bf16 v[180:183], a[36:39], a[108:111], 0
buffer_load_dwordx4 v2, s[4:7], s19 offen offset:1024 lds
v_mfma_f32_16x16x32_bf16 v[180:183], a[32:35], a[104:107], v[180:183]
ds_read_b128 a[68:71], v14 offset:0
v_mfma_f32_16x16x32_bf16 v[184:187], a[32:35], a[112:115], 0
s_add_u32 s30, s28, 8192
v_mfma_f32_16x16x32_bf16 v[184:187], a[36:39], a[116:119], v[184:187]
ds_read_b128 a[72:75], v15 offset:2048
v_mfma_f32_16x16x32_bf16 v[188:191], a[36:39], a[124:127], 0
buffer_store_dwordx4 a[176:179], v16, s[12:15], s30 offen offset:1024 sc0 sc1
v_mfma_f32_16x16x32_bf16 v[188:191], a[32:35], a[120:123], v[188:191]
ds_read_b128 a[76:79], v14 offset:2048
v_mfma_f32_16x16x32_bf16 v[208:211], a[40:43], a[96:99], 0
buffer_load_dwordx4 v3, s[4:7], s19 offen offset:2048 lds
v_mfma_f32_16x16x32_bf16 v[208:211], a[44:47], a[100:103], v[208:211]
ds_read_b128 a[80:83], v15 offset:4096
v_mfma_f32_16x16x32_bf16 v[212:215], a[44:47], a[108:111], 0
v_mfma_f32_16x16x32_bf16 v[212:215], a[40:43], a[104:107], v[212:215]
ds_read_b128 a[84:87], v14 offset:4096
v_mfma_f32_16x16x32_bf16 v[216:219], a[40:43], a[112:115], 0
v_mfma_f32_16x16x32_bf16 v[216:219], a[44:47], a[116:119], v[216:219]
ds_read_b128 a[88:91], v15 offset:6144
v_mfma_f32_16x16x32_bf16 v[220:223], a[44:47], a[124:127], 0
buffer_load_dwordx4 v4, s[4:7], s19 offen offset:3072 lds
v_mfma_f32_16x16x32_bf16 v[220:223], a[40:43], a[120:123], v[220:223]
ds_read_b128 a[92:95], v14 offset:6144
v_mfma_f32_16x16x32_bf16 v[240:243], a[48:51], a[96:99], 0
s_add_u32 s19, s19, 128
v_mfma_f32_16x16x32_bf16 v[240:243], a[52:55], a[100:103], v[240:243]
v_mfma_f32_16x16x32_bf16 v[244:247], a[52:55], a[108:111], 0
v_mfma_f32_16x16x32_bf16 v[244:247], a[48:51], a[104:107], v[244:247]
v_mfma_f32_16x16x32_bf16 v[248:251], a[48:51], a[112:115], 0
v_mfma_f32_16x16x32_bf16 v[248:251], a[52:55], a[116:119], v[248:251]
v_mfma_f32_16x16x32_bf16 v[252:255], a[52:55], a[124:127], 0
s_add_u32 s30, s28, 12288
v_mfma_f32_16x16x32_bf16 v[252:255], a[48:51], a[120:123], v[252:255]
v_mfma_f32_16x16x32_bf16 a[144:147], a[56:59], a[96:99], 0
buffer_store_dwordx4 a[180:183], v16, s[12:15], s30 offen offset:1024 sc0 sc1
v_mfma_f32_16x16x32_bf16 a[144:147], a[60:63], a[100:103], a[144:147]
v_mfma_f32_16x16x32_bf16 a[148:151], a[60:63], a[108:111], 0
v_mfma_f32_16x16x32_bf16 a[148:151], a[56:59], a[104:107], a[148:151]
v_mfma_f32_16x16x32_bf16 a[152:155], a[56:59], a[112:115], 0
v_mfma_f32_16x16x32_bf16 a[152:155], a[60:63], a[116:119], a[152:155]
v_mfma_f32_16x16x32_bf16 a[156:159], a[60:63], a[124:127], 0
s_waitcnt vmcnt(30) lgkmcnt(0)
v_mfma_f32_16x16x32_bf16 a[156:159], a[56:59], a[120:123], a[156:159]
s_barrier
v_mfma_f32_16x16x32_bf16 v[32:35], a[0:3], a[64:67], v[32:35]
v_mfma_f32_16x16x32_bf16 v[32:35], a[4:7], a[68:71], v[32:35]
ds_read_b128 a[96:99], v15 offset:8192
v_mfma_f32_16x16x32_bf16 v[36:39], a[4:7], a[76:79], v[36:39]
s_add_u32 m0, s25, 32768
v_mfma_f32_16x16x32_bf16 v[36:39], a[0:3], a[72:75], v[36:39]
ds_read_b128 a[100:103], v14 offset:8192
v_mfma_f32_16x16x32_bf16 v[40:43], a[0:3], a[80:83], v[40:43]
buffer_load_dwordx4 v5, s[8:11], s21 offen offset:0 lds
v_mfma_f32_16x16x32_bf16 v[40:43], a[4:7], a[84:87], v[40:43]
ds_read_b128 a[104:107], v15 offset:10240
v_mfma_f32_16x16x32_bf16 v[44:47], a[4:7], a[92:95], v[44:47]
v_mfma_f32_16x16x32_bf16 v[44:47], a[0:3], a[88:91], v[44:47]
ds_read_b128 a[108:111], v14 offset:10240
v_mfma_f32_16x16x32_bf16 v[64:67], a[8:11], a[64:67], v[64:67]
v_mfma_f32_16x16x32_bf16 v[64:67], a[12:15], a[68:71], v[64:67]
ds_read_b128 a[112:115], v15 offset:12288
v_mfma_f32_16x16x32_bf16 v[68:71], a[12:15], a[76:79], v[68:71]
buffer_load_dwordx4 v6, s[8:11], s21 offen offset:1024 lds
v_mfma_f32_16x16x32_bf16 v[68:71], a[8:11], a[72:75], v[68:71]
ds_read_b128 a[116:119], v14 offset:12288
v_mfma_f32_16x16x32_bf16 v[72:75], a[8:11], a[80:83], v[72:75]
s_add_u32 s30, s28, 16384
v_mfma_f32_16x16x32_bf16 v[72:75], a[12:15], a[84:87], v[72:75]
ds_read_b128 a[120:123], v15 offset:14336
v_mfma_f32_16x16x32_bf16 v[76:79], a[12:15], a[92:95], v[76:79]
buffer_store_dwordx4 a[184:187], v16, s[12:15], s30 offen offset:0 sc0 sc1
v_mfma_f32_16x16x32_bf16 v[76:79], a[8:11], a[88:91], v[76:79]
ds_read_b128 a[124:127], v14 offset:14336
v_mfma_f32_16x16x32_bf16 v[96:99], a[16:19], a[64:67], v[96:99]
buffer_load_dwordx4 v7, s[8:11], s21 offen offset:2048 lds
v_mfma_f32_16x16x32_bf16 v[96:99], a[20:23], a[68:71], v[96:99]
ds_read_b64_tr_b16 a[32:33], v9 offset:49152
v_mfma_f32_16x16x32_bf16 v[100:103], a[20:23], a[76:79], v[100:103]
v_mfma_f32_16x16x32_bf16 v[100:103], a[16:19], a[72:75], v[100:103]
ds_read_b64_tr_b16 a[34:35], v9 offset:50176
v_mfma_f32_16x16x32_bf16 v[104:107], a[16:19], a[80:83], v[104:107]
v_mfma_f32_16x16x32_bf16 v[104:107], a[20:23], a[84:87], v[104:107]
ds_read_b64_tr_b16 a[36:37], v9 offset:57344
v_mfma_f32_16x16x32_bf16 v[108:111], a[20:23], a[92:95], v[108:111]
buffer_load_dwordx4 v8, s[8:11], s21 offen offset:3072 lds
v_mfma_f32_16x16x32_bf16 v[108:111], a[16:19], a[88:91], v[108:111]
ds_read_b64_tr_b16 a[38:39], v9 offset:58368
v_mfma_f32_16x16x32_bf16 v[128:131], a[24:27], a[64:67], v[128:131]
s_xor_b64 s[8:9], s[8:9], s[80:81]
v_mfma_f32_16x16x32_bf16 v[128:131], a[28:31], a[68:71], v[128:131]
ds_read_b64_tr_b16 a[40:41], v10 offset:49152
v_mfma_f32_16x16x32_bf16 v[132:135], a[28:31], a[76:79], v[132:135]
s_add_u32 m0, s24, 4096
v_mfma_f32_16x16x32_bf16 v[132:135], a[24:27], a[72:75], v[132:135]
ds_read_b64_tr_b16 a[42:43], v10 offset:50176
v_mfma_f32_16x16x32_bf16 v[136:139], a[24:27], a[80:83], v[136:139]
buffer_load_dwordx4 v1, s[4:7], s20 offen offset:0 lds
v_mfma_f32_16x16x32_bf16 v[136:139], a[28:31], a[84:87], v[136:139]
ds_read_b64_tr_b16 a[44:45], v10 offset:57344
v_mfma_f32_16x16x32_bf16 v[140:143], a[28:31], a[92:95], v[140:143]
v_mfma_f32_16x16x32_bf16 v[140:143], a[24:27], a[88:91], v[140:143]
ds_read_b64_tr_b16 a[46:47], v10 offset:58368
s_waitcnt lgkmcnt(8)
v_mfma_f32_16x16x32_bf16 v[48:51], a[0:3], a[96:99], v[48:51]
v_mfma_f32_16x16x32_bf16 v[48:51], a[4:7], a[100:103], v[48:51]
ds_read_b64_tr_b16 a[48:49], v11 offset:49152
v_mfma_f32_16x16x32_bf16 v[52:55], a[4:7], a[108:111], v[52:55]
buffer_load_dwordx4 v2, s[4:7], s20 offen offset:1024 lds
v_mfma_f32_16x16x32_bf16 v[52:55], a[0:3], a[104:107], v[52:55]
ds_read_b64_tr_b16 a[50:51], v11 offset:50176
v_mfma_f32_16x16x32_bf16 v[56:59], a[0:3], a[112:115], v[56:59]
s_add_u32 s30, s28, 16384
v_mfma_f32_16x16x32_bf16 v[56:59], a[4:7], a[116:119], v[56:59]
ds_read_b64_tr_b16 a[52:53], v11 offset:57344
v_mfma_f32_16x16x32_bf16 v[60:63], a[4:7], a[124:127], v[60:63]
buffer_store_dwordx4 a[188:191], v16, s[12:15], s30 offen offset:1024 sc0 sc1
v_mfma_f32_16x16x32_bf16 v[60:63], a[0:3], a[120:123], v[60:63]
ds_read_b64_tr_b16 a[54:55], v11 offset:58368
v_mfma_f32_16x16x32_bf16 v[80:83], a[8:11], a[96:99], v[80:83]
buffer_load_dwordx4 v3, s[4:7], s20 offen offset:2048 lds
v_mfma_f32_16x16x32_bf16 v[80:83], a[12:15], a[100:103], v[80:83]
ds_read_b64_tr_b16 a[56:57], v12 offset:49152
v_mfma_f32_16x16x32_bf16 v[84:87], a[12:15], a[108:111], v[84:87]
v_mfma_f32_16x16x32_bf16 v[84:87], a[8:11], a[104:107], v[84:87]
ds_read_b64_tr_b16 a[58:59], v12 offset:50176
v_mfma_f32_16x16x32_bf16 v[88:91], a[8:11], a[112:115], v[88:91]
v_mfma_f32_16x16x32_bf16 v[88:91], a[12:15], a[116:119], v[88:91]
ds_read_b64_tr_b16 a[60:61], v12 offset:57344
v_mfma_f32_16x16x32_bf16 v[92:95], a[12:15], a[124:127], v[92:95]
buffer_load_dwordx4 v4, s[4:7], s20 offen offset:3072 lds
v_mfma_f32_16x16x32_bf16 v[92:95], a[8:11], a[120:123], v[92:95]
ds_read_b64_tr_b16 a[62:63], v12 offset:58368
v_mfma_f32_16x16x32_bf16 v[112:115], a[16:19], a[96:99], v[112:115]
s_add_u32 s20, s20, 128
v_mfma_f32_16x16x32_bf16 v[112:115], a[20:23], a[100:103], v[112:115]
v_mfma_f32_16x16x32_bf16 v[116:119], a[20:23], a[108:111], v[116:119]
v_mfma_f32_16x16x32_bf16 v[116:119], a[16:19], a[104:107], v[116:119]
v_mfma_f32_16x16x32_bf16 v[120:123], a[16:19], a[112:115], v[120:123]
v_mfma_f32_16x16x32_bf16 v[120:123], a[20:23], a[116:119], v[120:123]
v_mfma_f32_16x16x32_bf16 v[124:127], a[20:23], a[124:127], v[124:127]
s_add_u32 s30, s28, 20480
v_mfma_f32_16x16x32_bf16 v[124:127], a[16:19], a[120:123], v[124:127]
v_mfma_f32_16x16x32_bf16 v[144:147], a[24:27], a[96:99], v[144:147]
buffer_store_dwordx4 a[192:195], v16, s[12:15], s30 offen offset:1024 sc0 sc1
v_mfma_f32_16x16x32_bf16 v[144:147], a[28:31], a[100:103], v[144:147]
v_mfma_f32_16x16x32_bf16 v[148:151], a[28:31], a[108:111], v[148:151]
v_mfma_f32_16x16x32_bf16 v[148:151], a[24:27], a[104:107], v[148:151]
v_mfma_f32_16x16x32_bf16 v[152:155], a[24:27], a[112:115], v[152:155]
v_mfma_f32_16x16x32_bf16 v[152:155], a[28:31], a[116:119], v[152:155]
v_mfma_f32_16x16x32_bf16 v[156:159], a[28:31], a[124:127], v[156:159]
s_waitcnt vmcnt(26) lgkmcnt(0)
v_mfma_f32_16x16x32_bf16 v[156:159], a[24:27], a[120:123], v[156:159]
s_barrier
v_mfma_f32_16x16x32_bf16 v[176:179], a[32:35], a[96:99], v[176:179]
s_add_u32 s24, s23, s27
s_add_u32 s23, s23, 32768
s_cmp_eq_u32 s23, 98304
v_mfma_f32_16x16x32_bf16 v[176:179], a[36:39], a[100:103], v[176:179]
ds_read_b64_tr_b16 a[0:1], v9 offset:0
v_mfma_f32_16x16x32_bf16 v[180:183], a[36:39], a[108:111], v[180:183]
s_cselect_b32 s23, 0, s23
s_add_u32 m0, s25, 49152
v_mfma_f32_16x16x32_bf16 v[180:183], a[32:35], a[104:107], v[180:183]
ds_read_b64_tr_b16 a[2:3], v9 offset:1024
v_mfma_f32_16x16x32_bf16 v[184:187], a[32:35], a[112:115], v[184:187]
buffer_load_dwordx4 v5, s[8:11], s21 offen offset:0 lds
v_mfma_f32_16x16x32_bf16 v[184:187], a[36:39], a[116:119], v[184:187]
ds_read_b64_tr_b16 a[4:5], v9 offset:8192
v_mfma_f32_16x16x32_bf16 v[188:191], a[36:39], a[124:127], v[188:191]
v_add_u32 v15, s23, v13
v_xor_b32 v14, 64, v15
v_mfma_f32_16x16x32_bf16 v[188:191], a[32:35], a[120:123], v[188:191]
ds_read_b64_tr_b16 a[6:7], v9 offset:9216
v_mfma_f32_16x16x32_bf16 v[208:211], a[40:43], a[96:99], v[208:211]
v_mfma_f32_16x16x32_bf16 v[208:211], a[44:47], a[100:103], v[208:211]
ds_read_b64_tr_b16 a[8:9], v10 offset:0
v_mfma_f32_16x16x32_bf16 v[212:215], a[44:47], a[108:111], v[212:215]
buffer_load_dwordx4 v6, s[8:11], s21 offen offset:1024 lds
v_mfma_f32_16x16x32_bf16 v[212:215], a[40:43], a[104:107], v[212:215]
ds_read_b64_tr_b16 a[10:11], v10 offset:1024
v_mfma_f32_16x16x32_bf16 v[216:219], a[40:43], a[112:115], v[216:219]
s_add_u32 s30, s28, 24576
v_mfma_f32_16x16x32_bf16 v[216:219], a[44:47], a[116:119], v[216:219]
ds_read_b64_tr_b16 a[12:13], v10 offset:8192
v_mfma_f32_16x16x32_bf16 v[220:223], a[44:47], a[124:127], v[220:223]
buffer_store_dwordx4 a[196:199], v16, s[12:15], s30 offen offset:0 sc0 sc1
v_mfma_f32_16x16x32_bf16 v[220:223], a[40:43], a[120:123], v[220:223]
ds_read_b64_tr_b16 a[14:15], v10 offset:9216
v_mfma_f32_16x16x32_bf16 v[240:243], a[48:51], a[96:99], v[240:243]
buffer_load_dwordx4 v7, s[8:11], s21 offen offset:2048 lds
v_mfma_f32_16x16x32_bf16 v[240:243], a[52:55], a[100:103], v[240:243]
ds_read_b64_tr_b16 a[16:17], v11 offset:0
v_mfma_f32_16x16x32_bf16 v[244:247], a[52:55], a[108:111], v[244:247]
v_mfma_f32_16x16x32_bf16 v[244:247], a[48:51], a[104:107], v[244:247]
ds_read_b64_tr_b16 a[18:19], v11 offset:1024
v_mfma_f32_16x16x32_bf16 v[248:251], a[48:51], a[112:115], v[248:251]
v_mfma_f32_16x16x32_bf16 v[248:251], a[52:55], a[116:119], v[248:251]
ds_read_b64_tr_b16 a[20:21], v11 offset:8192
v_mfma_f32_16x16x32_bf16 v[252:255], a[52:55], a[124:127], v[252:255]
buffer_load_dwordx4 v8, s[8:11], s21 offen offset:3072 lds
v_mfma_f32_16x16x32_bf16 v[252:255], a[48:51], a[120:123], v[252:255]
ds_read_b64_tr_b16 a[22:23], v11 offset:9216
v_mfma_f32_16x16x32_bf16 a[144:147], a[56:59], a[96:99], a[144:147]
s_xor_b64 s[8:9], s[8:9], s[80:81]
s_add_u32 s21, s21, s22
v_mfma_f32_16x16x32_bf16 a[144:147], a[60:63], a[100:103], a[144:147]
ds_read_b64_tr_b16 a[24:25], v12 offset:0
v_mfma_f32_16x16x32_bf16 a[148:151], a[60:63], a[108:111], a[148:151]
s_add_u32 m0, s24, 0
v_mfma_f32_16x16x32_bf16 a[148:151], a[56:59], a[104:107], a[148:151]
ds_read_b64_tr_b16 a[26:27], v12 offset:1024
v_mfma_f32_16x16x32_bf16 a[152:155], a[56:59], a[112:115], a[152:155]
buffer_load_dwordx4 v1, s[4:7], s19 offen offset:0 lds
v_mfma_f32_16x16x32_bf16 a[152:155], a[60:63], a[116:119], a[152:155]
ds_read_b64_tr_b16 a[28:29], v12 offset:8192
v_mfma_f32_16x16x32_bf16 a[156:159], a[60:63], a[124:127], a[156:159]
v_mfma_f32_16x16x32_bf16 a[156:159], a[56:59], a[120:123], a[156:159]
ds_read_b64_tr_b16 a[30:31], v12 offset:9216
v_mfma_f32_16x16x32_bf16 v[160:163], a[32:35], a[64:67], v[160:163]
v_mfma_f32_16x16x32_bf16 v[160:163], a[36:39], a[68:71], v[160:163]
ds_read_b128 a[96:99], v15 offset:8192
v_mfma_f32_16x16x32_bf16 v[164:167], a[36:39], a[76:79], v[164:167]
buffer_load_dwordx4 v2, s[4:7], s19 offen offset:1024 lds
v_mfma_f32_16x16x32_bf16 v[164:167], a[32:35], a[72:75], v[164:167]
ds_read_b128 a[100:103], v14 offset:8192
v_mfma_f32_16x16x32_bf16 v[168:171], a[32:35], a[80:83], v[168:171]
s_add_u32 s30, s28, 24576
v_mfma_f32_16x16x32_bf16 v[168:171], a[36:39], a[84:87], v[168:171]
ds_read_b128 a[104:107], v15 offset:10240
v_mfma_f32_16x16x32_bf16 v[172:175], a[36:39], a[92:95], v[172:175]
buffer_store_dwordx4 a[200:203], v16, s[12:15], s30 offen offset:1024 sc0 sc1
v_mfma_f32_16x16x32_bf16 v[172:175], a[32:35], a[88:91], v[172:175]
ds_read_b128 a[108:111], v14 offset:10240
v_mfma_f32_16x16x32_bf16 v[192:195], a[40:43], a[64:67], v[192:195]
buffer_load_dwordx4 v3, s[4:7], s19 offen offset:2048 lds
v_mfma_f32_16x16x32_bf16 v[192:195], a[44:47], a[68:71], v[192:195]
ds_read_b128 a[112:115], v15 offset:12288
v_mfma_f32_16x16x32_bf16 v[196:199], a[44:47], a[76:79], v[196:199]
v_mfma_f32_16x16x32_bf16 v[196:199], a[40:43], a[72:75], v[196:199]
ds_read_b128 a[116:119], v14 offset:12288
v_mfma_f32_16x16x32_bf16 v[200:203], a[40:43], a[80:83], v[200:203]
v_mfma_f32_16x16x32_bf16 v[200:203], a[44:47], a[84:87], v[200:203]
ds_read_b128 a[120:123], v15 offset:14336
v_mfma_f32_16x16x32_bf16 v[204:207], a[44:47], a[92:95], v[204:207]
buffer_load_dwordx4 v4, s[4:7], s19 offen offset:3072 lds
v_mfma_f32_16x16x32_bf16 v[204:207], a[40:43], a[88:91], v[204:207]
ds_read_b128 a[124:127], v14 offset:14336
v_mfma_f32_16x16x32_bf16 v[224:227], a[48:51], a[64:67], v[224:227]
s_add_u32 s19, s19, 128
v_mfma_f32_16x16x32_bf16 v[224:227], a[52:55], a[68:71], v[224:227]
v_mfma_f32_16x16x32_bf16 v[228:231], a[52:55], a[76:79], v[228:231]
v_mfma_f32_16x16x32_bf16 v[228:231], a[48:51], a[72:75], v[228:231]
v_mfma_f32_16x16x32_bf16 v[232:235], a[48:51], a[80:83], v[232:235]
v_mfma_f32_16x16x32_bf16 v[232:235], a[52:55], a[84:87], v[232:235]
v_mfma_f32_16x16x32_bf16 v[236:239], a[52:55], a[92:95], v[236:239]
s_add_u32 s30, s28, 28672
v_mfma_f32_16x16x32_bf16 v[236:239], a[48:51], a[88:91], v[236:239]
v_mfma_f32_16x16x32_bf16 a[128:131], a[56:59], a[64:67], a[128:131]
buffer_store_dwordx4 a[204:207], v16, s[12:15], s30 offen offset:1024 sc0 sc1
v_mfma_f32_16x16x32_bf16 a[128:131], a[60:63], a[68:71], a[128:131]
v_mfma_f32_16x16x32_bf16 a[132:135], a[60:63], a[76:79], a[132:135]
v_mfma_f32_16x16x32_bf16 a[132:135], a[56:59], a[72:75], a[132:135]
v_mfma_f32_16x16x32_bf16 a[136:139], a[56:59], a[80:83], a[136:139]
v_mfma_f32_16x16x32_bf16 a[136:139], a[60:63], a[84:87], a[136:139]
v_mfma_f32_16x16x32_bf16 a[140:143], a[60:63], a[92:95], a[140:143]
s_waitcnt vmcnt(23) lgkmcnt(0)
v_mfma_f32_16x16x32_bf16 a[140:143], a[56:59], a[88:91], a[140:143]
s_barrier
v_mfma_f32_16x16x32_bf16 v[48:51], a[0:3], a[96:99], v[48:51]
v_mfma_f32_16x16x32_bf16 v[48:51], a[4:7], a[100:103], v[48:51]
ds_read_b128 a[64:67], v15 offset:0
v_mfma_f32_16x16x32_bf16 v[52:55], a[4:7], a[108:111], v[52:55]
s_add_u32 m0, s25, 0
v_mfma_f32_16x16x32_bf16 v[52:55], a[0:3], a[104:107], v[52:55]
ds_read_b128 a[68:71], v14 offset:0
v_mfma_f32_16x16x32_bf16 v[56:59], a[0:3], a[112:115], v[56:59]
buffer_load_dwordx4 v5, s[8:11], s21 offen offset:0 lds
v_mfma_f32_16x16x32_bf16 v[56:59], a[4:7], a[116:119], v[56:59]
ds_read_b128 a[72:75], v15 offset:2048
v_mfma_f32_16x16x32_bf16 v[60:63], a[4:7], a[124:127], v[60:63]
v_mfma_f32_16x16x32_bf16 v[60:63], a[0:3], a[120:123], v[60:63]
ds_read_b128 a[76:79], v14 offset:2048
v_mfma_f32_16x16x32_bf16 v[80:83], a[8:11], a[96:99], v[80:83]
v_mfma_f32_16x16x32_bf16 v[80:83], a[12:15], a[100:103], v[80:83]
ds_read_b128 a[80:83], v15 offset:4096
v_mfma_f32_16x16x32_bf16 v[84:87], a[12:15], a[108:111], v[84:87]
buffer_load_dwordx4 v6, s[8:11], s21 offen offset:1024 lds
v_mfma_f32_16x16x32_bf16 v[84:87], a[8:11], a[104:107], v[84:87]
ds_read_b128 a[84:87], v14 offset:4096
v_mfma_f32_16x16x32_bf16 v[88:91], a[8:11], a[112:115], v[88:91]
s_add_u32 s30, s28, 32768
v_mfma_f32_16x16x32_bf16 v[88:91], a[12:15], a[116:119], v[88:91]
ds_read_b128 a[88:91], v15 offset:6144
v_mfma_f32_16x16x32_bf16 v[92:95], a[12:15], a[124:127], v[92:95]
buffer_store_dwordx4 a[208:211], v16, s[12:15], s30 offen offset:0 sc0 sc1
v_mfma_f32_16x16x32_bf16 v[92:95], a[8:11], a[120:123], v[92:95]
ds_read_b128 a[92:95], v14 offset:6144
v_mfma_f32_16x16x32_bf16 v[112:115], a[16:19], a[96:99], v[112:115]
buffer_load_dwordx4 v7, s[8:11], s21 offen offset:2048 lds
v_mfma_f32_16x16x32_bf16 v[112:115], a[20:23], a[100:103], v[112:115]
ds_read_b64_tr_b16 a[32:33], v9 offset:16384
v_mfma_f32_16x16x32_bf16 v[116:119], a[20:23], a[108:111], v[116:119]
v_mfma_f32_16x16x32_bf16 v[116:119], a[16:19], a[104:107], v[116:119]
ds_read_b64_tr_b16 a[34:35], v9 offset:17408
v_mfma_f32_16x16x32_bf16 v[120:123], a[16:19], a[112:115], v[120:123]
v_mfma_f32_16x16x32_bf16 v[120:123], a[20:23], a[116:119], v[120:123]
ds_read_b64_tr_b16 a[36:37], v9 offset:24576
v_mfma_f32_16x16x32_bf16 v[124:127], a[20:23], a[124:127], v[124:127]
buffer_load_dwordx4 v8, s[8:11], s21 offen offset:3072 lds
v_mfma_f32_16x16x32_bf16 v[124:127], a[16:19], a[120:123], v[124:127]
ds_read_b64_tr_b16 a[38:39], v9 offset:25600
v_mfma_f32_16x16x32_bf16 v[144:147], a[24:27], a[96:99], v[144:147]
s_xor_b64 s[8:9], s[8:9], s[80:81]
v_mfma_f32_16x16x32_bf16 v[144:147], a[28:31], a[100:103], v[144:147]
ds_read_b64_tr_b16 a[40:41], v10 offset:16384
v_mfma_f32_16x16x32_bf16 v[148:151], a[28:31], a[108:111], v[148:151]
s_add_u32 m0, s24, 4096
v_mfma_f32_16x16x32_bf16 v[148:151], a[24:27], a[104:107], v[148:151]
ds_read_b64_tr_b16 a[42:43], v10 offset:17408
v_mfma_f32_16x16x32_bf16 v[152:155], a[24:27], a[112:115], v[152:155]
buffer_load_dwordx4 v1, s[4:7], s20 offen offset:0 lds
v_mfma_f32_16x16x32_bf16 v[152:155], a[28:31], a[116:119], v[152:155]
ds_read_b64_tr_b16 a[44:45], v10 offset:24576
v_mfma_f32_16x16x32_bf16 v[156:159], a[28:31], a[124:127], v[156:159]
v_mfma_f32_16x16x32_bf16 v[156:159], a[24:27], a[120:123], v[156:159]
ds_read_b64_tr_b16 a[46:47], v10 offset:25600
s_waitcnt lgkmcnt(8)
v_mfma_f32_16x16x32_bf16 v[32:35], a[0:3], a[64:67], v[32:35]
v_mfma_f32_16x16x32_bf16 v[32:35], a[4:7], a[68:71], v[32:35]
ds_read_b64_tr_b16 a[48:49], v11 offset:16384
v_mfma_f32_16x16x32_bf16 v[36:39], a[4:7], a[76:79], v[36:39]
buffer_load_dwordx4 v2, s[4:7], s20 offen offset:1024 lds
v_mfma_f32_16x16x32_bf16 v[36:39], a[0:3], a[72:75], v[36:39]
ds_read_b64_tr_b16 a[50:51], v11 offset:17408
v_mfma_f32_16x16x32_bf16 v[40:43], a[0:3], a[80:83], v[40:43]
s_add_u32 s30, s28, 32768
v_mfma_f32_16x16x32_bf16 v[40:43], a[4:7], a[84:87], v[40:43]
ds_read_b64_tr_b16 a[52:53], v11 offset:24576
v_mfma_f32_16x16x32_bf16 v[44:47], a[4:7], a[92:95], v[44:47]
buffer_store_dwordx4 a[212:215], v16, s[12:15], s30 offen offset:1024 sc0 sc1
v_mfma_f32_16x16x32_bf16 v[44:47], a[0:3], a[88:91], v[44:47]
ds_read_b64_tr_b16 a[54:55], v11 offset:25600
v_mfma_f32_16x16x32_bf16 v[64:67], a[8:11], a[64:67], v[64:67]
buffer_load_dwordx4 v3, s[4:7], s20 offen offset:2048 lds
v_mfma_f32_16x16x32_bf16 v[64:67], a[12:15], a[68:71], v[64:67]
ds_read_b64_tr_b16 a[56:57], v12 offset:16384
v_mfma_f32_16x16x32_bf16 v[68:71], a[12:15], a[76:79], v[68:71]
v_mfma_f32_16x16x32_bf16 v[68:71], a[8:11], a[72:75], v[68:71]
ds_read_b64_tr_b16 a[58:59], v12 offset:17408
v_mfma_f32_16x16x32_bf16 v[72:75], a[8:11], a[80:83], v[72:75]
v_mfma_f32_16x16x32_bf16 v[72:75], a[12:15], a[84:87], v[72:75]
ds_read_b64_tr_b16 a[60:61], v12 offset:24576
v_mfma_f32_16x16x32_bf16 v[76:79], a[12:15], a[92:95], v[76:79]
buffer_load_dwordx4 v4, s[4:7], s20 offen offset:3072 lds
v_mfma_f32_16x16x32_bf16 v[76:79], a[8:11], a[88:91], v[76:79]
ds_read_b64_tr_b16 a[62:63], v12 offset:25600
v_mfma_f32_16x16x32_bf16 v[96:99], a[16:19], a[64:67], v[96:99]
s_add_u32 s20, s20, 128
v_mfma_f32_16x16x32_bf16 v[96:99], a[20:23], a[68:71], v[96:99]
v_mfma_f32_16x16x32_bf16 v[100:103], a[20:23], a[76:79], v[100:103]
v_mfma_f32_16x16x32_bf16 v[100:103], a[16:19], a[72:75], v[100:103]
v_mfma_f32_16x16x32_bf16 v[104:107], a[16:19], a[80:83], v[104:107]
v_mfma_f32_16x16x32_bf16 v[104:107], a[20:23], a[84:87], v[104:107]
v_mfma_f32_16x16x32_bf16 v[108:111], a[20:23], a[92:95], v[108:111]
s_add_u32 s30, s28, 36864
v_mfma_f32_16x16x32_bf16 v[108:111], a[16:19], a[88:91], v[108:111]
v_mfma_f32_16x16x32_bf16 v[128:131], a[24:27], a[64:67], v[128:131]
buffer_store_dwordx4 a[216:219], v16, s[12:15], s30 offen offset:1024 sc0 sc1
v_mfma_f32_16x16x32_bf16 v[128:131], a[28:31], a[68:71], v[128:131]
v_mfma_f32_16x16x32_bf16 v[132:135], a[28:31], a[76:79], v[132:135]
v_mfma_f32_16x16x32_bf16 v[132:135], a[24:27], a[72:75], v[132:135]
v_mfma_f32_16x16x32_bf16 v[136:139], a[24:27], a[80:83], v[136:139]
v_mfma_f32_16x16x32_bf16 v[136:139], a[28:31], a[84:87], v[136:139]
v_mfma_f32_16x16x32_bf16 v[140:143], a[28:31], a[92:95], v[140:143]
s_waitcnt vmcnt(23) lgkmcnt(0)
v_mfma_f32_16x16x32_bf16 v[140:143], a[24:27], a[88:91], v[140:143]
s_barrier
v_mfma_f32_16x16x32_bf16 v[160:163], a[32:35], a[64:67], v[160:163]
s_add_u32 s24, s23, s27
s_add_u32 s23, s23, 32768
s_cmp_eq_u32 s23, 98304
v_mfma_f32_16x16x32_bf16 v[160:163], a[36:39], a[68:71], v[160:163]
ds_read_b64_tr_b16 a[0:1], v9 offset:32768
v_mfma_f32_16x16x32_bf16 v[164:167], a[36:39], a[76:79], v[164:167]
s_cselect_b32 s23, 0, s23
s_add_u32 m0, s25, 16384
v_mfma_f32_16x16x32_bf16 v[164:167], a[32:35], a[72:75], v[164:167]
ds_read_b64_tr_b16 a[2:3], v9 offset:33792
v_mfma_f32_16x16x32_bf16 v[168:171], a[32:35], a[80:83], v[168:171]
buffer_load_dwordx4 v5, s[8:11], s21 offen offset:0 lds
v_mfma_f32_16x16x32_bf16 v[168:171], a[36:39], a[84:87], v[168:171]
ds_read_b64_tr_b16 a[4:5], v9 offset:40960
v_mfma_f32_16x16x32_bf16 v[172:175], a[36:39], a[92:95], v[172:175]
v_add_u32 v15, s23, v13
v_xor_b32 v14, 64, v15
v_mfma_f32_16x16x32_bf16 v[172:175], a[32:35], a[88:91], v[172:175]
ds_read_b64_tr_b16 a[6:7], v9 offset:41984
v_mfma_f32_16x16x32_bf16 v[192:195], a[40:43], a[64:67], v[192:195]
v_mfma_f32_16x16x32_bf16 v[192:195], a[44:47], a[68:71], v[192:195]
ds_read_b64_tr_b16 a[8:9], v10 offset:32768
v_mfma_f32_16x16x32_bf16 v[196:199], a[44:47], a[76:79], v[196:199]
buffer_load_dwordx4 v6, s[8:11], s21 offen offset:1024 lds
v_mfma_f32_16x16x32_bf16 v[196:199], a[40:43], a[72:75], v[196:199]
ds_read_b64_tr_b16 a[10:11], v10 offset:33792
v_mfma_f32_16x16x32_bf16 v[200:203], a[40:43], a[80:83], v[200:203]
s_add_u32 s30, s28, 40960
v_mfma_f32_16x16x32_bf16 v[200:203], a[44:47], a[84:87], v[200:203]
ds_read_b64_tr_b16 a[12:13], v10 offset:40960
v_mfma_f32_16x16x32_bf16 v[204:207], a[44:47], a[92:95], v[204:207]
buffer_store_dwordx4 a[220:223], v16, s[12:15], s30 offen offset:0 sc0 sc1
v_mfma_f32_16x16x32_bf16 v[204:207], a[40:43], a[88:91], v[204:207]
ds_read_b64_tr_b16 a[14:15], v10 offset:41984
v_mfma_f32_16x16x32_bf16 v[224:227], a[48:51], a[64:67], v[224:227]
buffer_load_dwordx4 v7, s[8:11], s21 offen offset:2048 lds
v_mfma_f32_16x16x32_bf16 v[224:227], a[52:55], a[68:71], v[224:227]
ds_read_b64_tr_b16 a[16:17], v11 offset:32768
v_mfma_f32_16x16x32_bf16 v[228:231], a[52:55], a[76:79], v[228:231]
v_mfma_f32_16x16x32_bf16 v[228:231], a[48:51], a[72:75], v[228:231]
ds_read_b64_tr_b16 a[18:19], v11 offset:33792
v_mfma_f32_16x16x32_bf16 v[232:235], a[48:51], a[80:83], v[232:235]
v_mfma_f32_16x16x32_bf16 v[232:235], a[52:55], a[84:87], v[232:235]
ds_read_b64_tr_b16 a[20:21], v11 offset:40960
v_mfma_f32_16x16x32_bf16 v[236:239], a[52:55], a[92:95], v[236:239]
buffer_load_dwordx4 v8, s[8:11], s21 offen offset:3072 lds
v_mfma_f32_16x16x32_bf16 v[236:239], a[48:51], a[88:91], v[236:239]
ds_read_b64_tr_b16 a[22:23], v11 offset:41984
v_mfma_f32_16x16x32_bf16 a[128:131], a[56:59], a[64:67], a[128:131]
s_xor_b64 s[8:9], s[8:9], s[80:81]
s_add_u32 s21, s21, s22
v_mfma_f32_16x16x32_bf16 a[128:131], a[60:63], a[68:71], a[128:131]
ds_read_b64_tr_b16 a[24:25], v12 offset:32768
v_mfma_f32_16x16x32_bf16 a[132:135], a[60:63], a[76:79], a[132:135]
s_add_u32 m0, s24, 0
v_mfma_f32_16x16x32_bf16 a[132:135], a[56:59], a[72:75], a[132:135]
ds_read_b64_tr_b16 a[26:27], v12 offset:33792
v_mfma_f32_16x16x32_bf16 a[136:139], a[56:59], a[80:83], a[136:139]
buffer_load_dwordx4 v1, s[4:7], s19 offen offset:0 lds
v_mfma_f32_16x16x32_bf16 a[136:139], a[60:63], a[84:87], a[136:139]
ds_read_b64_tr_b16 a[28:29], v12 offset:40960
v_mfma_f32_16x16x32_bf16 a[140:143], a[60:63], a[92:95], a[140:143]
v_mfma_f32_16x16x32_bf16 a[140:143], a[56:59], a[88:91], a[140:143]
ds_read_b64_tr_b16 a[30:31], v12 offset:41984
v_mfma_f32_16x16x32_bf16 v[176:179], a[32:35], a[96:99], v[176:179]
v_mfma_f32_16x16x32_bf16 v[176:179], a[36:39], a[100:103], v[176:179]
ds_read_b128 a[64:67], v15 offset:0
v_mfma_f32_16x16x32_bf16 v[180:183], a[36:39], a[108:111], v[180:183]
buffer_load_dwordx4 v2, s[4:7], s19 offen offset:1024 lds
v_mfma_f32_16x16x32_bf16 v[180:183], a[32:35], a[104:107], v[180:183]
ds_read_b128 a[68:71], v14 offset:0
v_mfma_f32_16x16x32_bf16 v[184:187], a[32:35], a[112:115], v[184:187]
s_add_u32 s30, s28, 40960
v_mfma_f32_16x16x32_bf16 v[184:187], a[36:39], a[116:119], v[184:187]
ds_read_b128 a[72:75], v15 offset:2048
v_mfma_f32_16x16x32_bf16 v[188:191], a[36:39], a[124:127], v[188:191]
buffer_store_dwordx4 a[224:227], v16, s[12:15], s30 offen offset:1024 sc0 sc1
v_mfma_f32_16x16x32_bf16 v[188:191], a[32:35], a[120:123], v[188:191]
ds_read_b128 a[76:79], v14 offset:2048
v_mfma_f32_16x16x32_bf16 v[208:211], a[40:43], a[96:99], v[208:211]
buffer_load_dwordx4 v3, s[4:7], s19 offen offset:2048 lds
v_mfma_f32_16x16x32_bf16 v[208:211], a[44:47], a[100:103], v[208:211]
ds_read_b128 a[80:83], v15 offset:4096
v_mfma_f32_16x16x32_bf16 v[212:215], a[44:47], a[108:111], v[212:215]
v_mfma_f32_16x16x32_bf16 v[212:215], a[40:43], a[104:107], v[212:215]
ds_read_b128 a[84:87], v14 offset:4096
v_mfma_f32_16x16x32_bf16 v[216:219], a[40:43], a[112:115], v[216:219]
v_mfma_f32_16x16x32_bf16 v[216:219], a[44:47], a[116:119], v[216:219]
ds_read_b128 a[88:91], v15 offset:6144
v_mfma_f32_16x16x32_bf16 v[220:223], a[44:47], a[124:127], v[220:223]
buffer_load_dwordx4 v4, s[4:7], s19 offen offset:3072 lds
v_mfma_f32_16x16x32_bf16 v[220:223], a[40:43], a[120:123], v[220:223]
ds_read_b128 a[92:95], v14 offset:6144
v_mfma_f32_16x16x32_bf16 v[240:243], a[48:51], a[96:99], v[240:243]
s_add_u32 s19, s19, 128
v_mfma_f32_16x16x32_bf16 v[240:243], a[52:55], a[100:103], v[240:243]
v_mfma_f32_16x16x32_bf16 v[244:247], a[52:55], a[108:111], v[244:247]
v_mfma_f32_16x16x32_bf16 v[244:247], a[48:51], a[104:107], v[244:247]
v_mfma_f32_16x16x32_bf16 v[248:251], a[48:51], a[112:115], v[248:251]
v_mfma_f32_16x16x32_bf16 v[248:251], a[52:55], a[116:119], v[248:251]
v_mfma_f32_16x16x32_bf16 v[252:255], a[52:55], a[124:127], v[252:255]
s_add_u32 s30, s28, 45056
v_mfma_f32_16x16x32_bf16 v[252:255], a[48:51], a[120:123], v[252:255]
v_mfma_f32_16x16x32_bf16 a[144:147], a[56:59], a[96:99], a[144:147]
buffer_store_dwordx4 a[228:231], v16, s[12:15], s30 offen offset:1024 sc0 sc1
v_mfma_f32_16x16x32_bf16 a[144:147], a[60:63], a[100:103], a[144:147]
v_mfma_f32_16x16x32_bf16 a[148:151], a[60:63], a[108:111], a[148:151]
v_mfma_f32_16x16x32_bf16 a[148:151], a[56:59], a[104:107], a[148:151]
v_mfma_f32_16x16x32_bf16 a[152:155], a[56:59], a[112:115], a[152:155]
v_mfma_f32_16x16x32_bf16 a[152:155], a[60:63], a[116:119], a[152:155]
v_mfma_f32_16x16x32_bf16 a[156:159], a[60:63], a[124:127], a[156:159]
s_waitcnt vmcnt(23) lgkmcnt(0)
v_mfma_f32_16x16x32_bf16 a[156:159], a[56:59], a[120:123], a[156:159]
s_barrier
v_mfma_f32_16x16x32_bf16 v[32:35], a[0:3], a[64:67], v[32:35]
v_mfma_f32_16x16x32_bf16 v[32:35], a[4:7], a[68:71], v[32:35]
ds_read_b128 a[96:99], v15 offset:8192
v_mfma_f32_16x16x32_bf16 v[36:39], a[4:7], a[76:79], v[36:39]
s_add_u32 m0, s25, 32768
v_mfma_f32_16x16x32_bf16 v[36:39], a[0:3], a[72:75], v[36:39]
ds_read_b128 a[100:103], v14 offset:8192
v_mfma_f32_16x16x32_bf16 v[40:43], a[0:3], a[80:83], v[40:43]
buffer_load_dwordx4 v5, s[8:11], s21 offen offset:0 lds
v_mfma_f32_16x16x32_bf16 v[40:43], a[4:7], a[84:87], v[40:43]
ds_read_b128 a[104:107], v15 offset:10240
v_mfma_f32_16x16x32_bf16 v[44:47], a[4:7], a[92:95], v[44:47]
v_mfma_f32_16x16x32_bf16 v[44:47], a[0:3], a[88:91], v[44:47]
ds_read_b128 a[108:111], v14 offset:10240
v_mfma_f32_16x16x32_bf16 v[64:67], a[8:11], a[64:67], v[64:67]
v_mfma_f32_16x16x32_bf16 v[64:67], a[12:15], a[68:71], v[64:67]
ds_read_b128 a[112:115], v15 offset:12288
v_mfma_f32_16x16x32_bf16 v[68:71], a[12:15], a[76:79], v[68:71]
buffer_load_dwordx4 v6, s[8:11], s21 offen offset:1024 lds
v_mfma_f32_16x16x32_bf16 v[68:71], a[8:11], a[72:75], v[68:71]
ds_read_b128 a[116:119], v14 offset:12288
v_mfma_f32_16x16x32_bf16 v[72:75], a[8:11], a[80:83], v[72:75]
s_add_u32 s30, s28, 49152
v_mfma_f32_16x16x32_bf16 v[72:75], a[12:15], a[84:87], v[72:75]
ds_read_b128 a[120:123], v15 offset:14336
v_mfma_f32_16x16x32_bf16 v[76:79], a[12:15], a[92:95], v[76:79]
buffer_store_dwordx4 a[232:235], v16, s[12:15], s30 offen offset:0 sc0 sc1
v_mfma_f32_16x16x32_bf16 v[76:79], a[8:11], a[88:91], v[76:79]
ds_read_b128 a[124:127], v14 offset:14336
v_mfma_f32_16x16x32_bf16 v[96:99], a[16:19], a[64:67], v[96:99]
buffer_load_dwordx4 v7, s[8:11], s21 offen offset:2048 lds
v_mfma_f32_16x16x32_bf16 v[96:99], a[20:23], a[68:71], v[96:99]
ds_read_b64_tr_b16 a[32:33], v9 offset:49152
v_mfma_f32_16x16x32_bf16 v[100:103], a[20:23], a[76:79], v[100:103]
v_mfma_f32_16x16x32_bf16 v[100:103], a[16:19], a[72:75], v[100:103]
ds_read_b64_tr_b16 a[34:35], v9 offset:50176
v_mfma_f32_16x16x32_bf16 v[104:107], a[16:19], a[80:83], v[104:107]
v_mfma_f32_16x16x32_bf16 v[104:107], a[20:23], a[84:87], v[104:107]
ds_read_b64_tr_b16 a[36:37], v9 offset:57344
v_mfma_f32_16x16x32_bf16 v[108:111], a[20:23], a[92:95], v[108:111]
buffer_load_dwordx4 v8, s[8:11], s21 offen offset:3072 lds
v_mfma_f32_16x16x32_bf16 v[108:111], a[16:19], a[88:91], v[108:111]
ds_read_b64_tr_b16 a[38:39], v9 offset:58368
v_mfma_f32_16x16x32_bf16 v[128:131], a[24:27], a[64:67], v[128:131]
s_xor_b64 s[8:9], s[8:9], s[80:81]
v_mfma_f32_16x16x32_bf16 v[128:131], a[28:31], a[68:71], v[128:131]
ds_read_b64_tr_b16 a[40:41], v10 offset:49152
v_mfma_f32_16x16x32_bf16 v[132:135], a[28:31], a[76:79], v[132:135]
s_add_u32 m0, s24, 4096
v_mfma_f32_16x16x32_bf16 v[132:135], a[24:27], a[72:75], v[132:135]
ds_read_b64_tr_b16 a[42:43], v10 offset:50176
v_mfma_f32_16x16x32_bf16 v[136:139], a[24:27], a[80:83], v[136:139]
buffer_load_dwordx4 v1, s[4:7], s20 offen offset:0 lds
v_mfma_f32_16x16x32_bf16 v[136:139], a[28:31], a[84:87], v[136:139]
ds_read_b64_tr_b16 a[44:45], v10 offset:57344
v_mfma_f32_16x16x32_bf16 v[140:143], a[28:31], a[92:95], v[140:143]
v_mfma_f32_16x16x32_bf16 v[140:143], a[24:27], a[88:91], v[140:143]
ds_read_b64_tr_b16 a[46:47], v10 offset:58368
s_waitcnt lgkmcnt(8)
v_mfma_f32_16x16x32_bf16 v[48:51], a[0:3], a[96:99], v[48:51]
v_mfma_f32_16x16x32_bf16 v[48:51], a[4:7], a[100:103], v[48:51]
ds_read_b64_tr_b16 a[48:49], v11 offset:49152
v_mfma_f32_16x16x32_bf16 v[52:55], a[4:7], a[108:111], v[52:55]
buffer_load_dwordx4 v2, s[4:7], s20 offen offset:1024 lds
v_mfma_f32_16x16x32_bf16 v[52:55], a[0:3], a[104:107], v[52:55]
ds_read_b64_tr_b16 a[50:51], v11 offset:50176
v_mfma_f32_16x16x32_bf16 v[56:59], a[0:3], a[112:115], v[56:59]
s_add_u32 s30, s28, 49152
v_mfma_f32_16x16x32_bf16 v[56:59], a[4:7], a[116:119], v[56:59]
ds_read_b64_tr_b16 a[52:53], v11 offset:57344
v_mfma_f32_16x16x32_bf16 v[60:63], a[4:7], a[124:127], v[60:63]
buffer_store_dwordx4 a[236:239], v16, s[12:15], s30 offen offset:1024 sc0 sc1
v_mfma_f32_16x16x32_bf16 v[60:63], a[0:3], a[120:123], v[60:63]
ds_read_b64_tr_b16 a[54:55], v11 offset:58368
v_mfma_f32_16x16x32_bf16 v[80:83], a[8:11], a[96:99], v[80:83]
buffer_load_dwordx4 v3, s[4:7], s20 offen offset:2048 lds
v_mfma_f32_16x16x32_bf16 v[80:83], a[12:15], a[100:103], v[80:83]
ds_read_b64_tr_b16 a[56:57], v12 offset:49152
v_mfma_f32_16x16x32_bf16 v[84:87], a[12:15], a[108:111], v[84:87]
v_mfma_f32_16x16x32_bf16 v[84:87], a[8:11], a[104:107], v[84:87]
ds_read_b64_tr_b16 a[58:59], v12 offset:50176
v_mfma_f32_16x16x32_bf16 v[88:91], a[8:11], a[112:115], v[88:91]
v_mfma_f32_16x16x32_bf16 v[88:91], a[12:15], a[116:119], v[88:91]
ds_read_b64_tr_b16 a[60:61], v12 offset:57344
v_mfma_f32_16x16x32_bf16 v[92:95], a[12:15], a[124:127], v[92:95]
buffer_load_dwordx4 v4, s[4:7], s20 offen offset:3072 lds
v_mfma_f32_16x16x32_bf16 v[92:95], a[8:11], a[120:123], v[92:95]
ds_read_b64_tr_b16 a[62:63], v12 offset:58368
v_mfma_f32_16x16x32_bf16 v[112:115], a[16:19], a[96:99], v[112:115]
s_add_u32 s20, s20, 128
v_mfma_f32_16x16x32_bf16 v[112:115], a[20:23], a[100:103], v[112:115]
v_mfma_f32_16x16x32_bf16 v[116:119], a[20:23], a[108:111], v[116:119]
v_mfma_f32_16x16x32_bf16 v[116:119], a[16:19], a[104:107], v[116:119]
v_mfma_f32_16x16x32_bf16 v[120:123], a[16:19], a[112:115], v[120:123]
v_mfma_f32_16x16x32_bf16 v[120:123], a[20:23], a[116:119], v[120:123]
v_mfma_f32_16x16x32_bf16 v[124:127], a[20:23], a[124:127], v[124:127]
s_add_u32 s30, s28, 53248
v_mfma_f32_16x16x32_bf16 v[124:127], a[16:19], a[120:123], v[124:127]
v_mfma_f32_16x16x32_bf16 v[144:147], a[24:27], a[96:99], v[144:147]
buffer_store_dwordx4 a[240:243], v16, s[12:15], s30 offen offset:1024 sc0 sc1
v_mfma_f32_16x16x32_bf16 v[144:147], a[28:31], a[100:103], v[144:147]
v_mfma_f32_16x16x32_bf16 v[148:151], a[28:31], a[108:111], v[148:151]
v_mfma_f32_16x16x32_bf16 v[148:151], a[24:27], a[104:107], v[148:151]
v_mfma_f32_16x16x32_bf16 v[152:155], a[24:27], a[112:115], v[152:155]
v_mfma_f32_16x16x32_bf16 v[152:155], a[28:31], a[116:119], v[152:155]
v_mfma_f32_16x16x32_bf16 v[156:159], a[28:31], a[124:127], v[156:159]
s_waitcnt vmcnt(23) lgkmcnt(0)
v_mfma_f32_16x16x32_bf16 v[156:159], a[24:27], a[120:123], v[156:159]
s_barrier
v_mfma_f32_16x16x32_bf16 v[176:179], a[32:35], a[96:99], v[176:179]
s_add_u32 s24, s23, s27
s_add_u32 s23, s23, 32768
s_cmp_eq_u32 s23, 98304
v_mfma_f32_16x16x32_bf16 v[176:179], a[36:39], a[100:103], v[176:179]
ds_read_b64_tr_b16 a[0:1], v9 offset:0
v_mfma_f32_16x16x32_bf16 v[180:183], a[36:39], a[108:111], v[180:183]
s_cselect_b32 s23, 0, s23
s_add_u32 m0, s25, 49152
v_mfma_f32_16x16x32_bf16 v[180:183], a[32:35], a[104:107], v[180:183]
ds_read_b64_tr_b16 a[2:3], v9 offset:1024
v_mfma_f32_16x16x32_bf16 v[184:187], a[32:35], a[112:115], v[184:187]
buffer_load_dwordx4 v5, s[8:11], s21 offen offset:0 lds
v_mfma_f32_16x16x32_bf16 v[184:187], a[36:39], a[116:119], v[184:187]
ds_read_b64_tr_b16 a[4:5], v9 offset:8192
v_mfma_f32_16x16x32_bf16 v[188:191], a[36:39], a[124:127], v[188:191]
v_add_u32 v15, s23, v13
v_xor_b32 v14, 64, v15
v_mfma_f32_16x16x32_bf16 v[188:191], a[32:35], a[120:123], v[188:191]
ds_read_b64_tr_b16 a[6:7], v9 offset:9216
v_mfma_f32_16x16x32_bf16 v[208:211], a[40:43], a[96:99], v[208:211]
s_mov_b32 s44, s0
s_mov_b32 s45, s1
v_mfma_f32_16x16x32_bf16 v[208:211], a[44:47], a[100:103], v[208:211]
ds_read_b64_tr_b16 a[8:9], v10 offset:0
v_mfma_f32_16x16x32_bf16 v[212:215], a[44:47], a[108:111], v[212:215]
buffer_load_dwordx4 v6, s[8:11], s21 offen offset:1024 lds
v_mfma_f32_16x16x32_bf16 v[212:215], a[40:43], a[104:107], v[212:215]
ds_read_b64_tr_b16 a[10:11], v10 offset:1024
v_mfma_f32_16x16x32_bf16 v[216:219], a[40:43], a[112:115], v[216:219]
s_add_u32 s30, s28, 57344
v_mfma_f32_16x16x32_bf16 v[216:219], a[44:47], a[116:119], v[216:219]
ds_read_b64_tr_b16 a[12:13], v10 offset:8192
v_mfma_f32_16x16x32_bf16 v[220:223], a[44:47], a[124:127], v[220:223]
buffer_store_dwordx4 a[244:247], v16, s[12:15], s30 offen offset:0 sc0 sc1
v_mfma_f32_16x16x32_bf16 v[220:223], a[40:43], a[120:123], v[220:223]
ds_read_b64_tr_b16 a[14:15], v10 offset:9216
v_mfma_f32_16x16x32_bf16 v[240:243], a[48:51], a[96:99], v[240:243]
buffer_load_dwordx4 v7, s[8:11], s21 offen offset:2048 lds
v_mfma_f32_16x16x32_bf16 v[240:243], a[52:55], a[100:103], v[240:243]
ds_read_b64_tr_b16 a[16:17], v11 offset:0
v_mfma_f32_16x16x32_bf16 v[244:247], a[52:55], a[108:111], v[244:247]
s_mov_b32 s46, L_f_end-L_f_pc
s_mov_b32 s47, 0x20000
v_mfma_f32_16x16x32_bf16 v[244:247], a[48:51], a[104:107], v[244:247]
ds_read_b64_tr_b16 a[18:19], v11 offset:1024
v_mfma_f32_16x16x32_bf16 v[248:251], a[48:51], a[112:115], v[248:251]
s_lshr_b32 s31, s2, 3
s_lshl_b32 s31, s31, 2
v_mfma_f32_16x16x32_bf16 v[248:251], a[52:55], a[116:119], v[248:251]
ds_read_b64_tr_b16 a[20:21], v11 offset:8192
v_mfma_f32_16x16x32_bf16 v[252:255], a[52:55], a[124:127], v[252:255]
buffer_load_dwordx4 v8, s[8:11], s21 offen offset:3072 lds
v_mfma_f32_16x16x32_bf16 v[252:255], a[48:51], a[120:123], v[252:255]
ds_read_b64_tr_b16 a[22:23], v11 offset:9216
v_mfma_f32_16x16x32_bf16 a[144:147], a[56:59], a[96:99], a[144:147]
s_xor_b64 s[8:9], s[8:9], s[80:81]
s_add_u32 s21, s21, s22
v_mfma_f32_16x16x32_bf16 a[144:147], a[60:63], a[100:103], a[144:147]
ds_read_b64_tr_b16 a[24:25], v12 offset:0
v_mfma_f32_16x16x32_bf16 a[148:151], a[60:63], a[108:111], a[148:151]
s_add_u32 m0, s24, 0
v_mfma_f32_16x16x32_bf16 a[148:151], a[56:59], a[104:107], a[148:151]
ds_read_b64_tr_b16 a[26:27], v12 offset:1024
v_mfma_f32_16x16x32_bf16 a[152:155], a[56:59], a[112:115], a[152:155]
buffer_load_dwordx4 v1, s[4:7], s19 offen offset:0 lds
v_mfma_f32_16x16x32_bf16 a[152:155], a[60:63], a[116:119], a[152:155]
ds_read_b64_tr_b16 a[28:29], v12 offset:8192
v_mfma_f32_16x16x32_bf16 a[156:159], a[60:63], a[124:127], a[156:159]
s_add_u32 s31, s31, s16
s_lshl_b32 s31, s31, 10
v_mfma_f32_16x16x32_bf16 a[156:159], a[56:59], a[120:123], a[156:159]
ds_read_b64_tr_b16 a[30:31], v12 offset:9216
v_mfma_f32_16x16x32_bf16 v[160:163], a[32:35], a[64:67], v[160:163]
v_and_b32 v17, 7, v0
v_lshlrev_b32 v17, 7, v17
v_mfma_f32_16x16x32_bf16 v[160:163], a[36:39], a[68:71], v[160:163]
ds_read_b128 a[96:99], v15 offset:8192
v_mfma_f32_16x16x32_bf16 v[164:167], a[36:39], a[76:79], v[164:167]
buffer_load_dwordx4 v2, s[4:7], s19 offen offset:1024 lds
v_mfma_f32_16x16x32_bf16 v[164:167], a[32:35], a[72:75], v[164:167]
ds_read_b128 a[100:103], v14 offset:8192
v_mfma_f32_16x16x32_bf16 v[168:171], a[32:35], a[80:83], v[168:171]
s_add_u32 s30, s28, 57344
v_mfma_f32_16x16x32_bf16 v[168:171], a[36:39], a[84:87], v[168:171]
ds_read_b128 a[104:107], v15 offset:10240
v_mfma_f32_16x16x32_bf16 v[172:175], a[36:39], a[92:95], v[172:175]
buffer_store_dwordx4 a[248:251], v16, s[12:15], s30 offen offset:1024 sc0 sc1
v_mfma_f32_16x16x32_bf16 v[172:175], a[32:35], a[88:91], v[172:175]
ds_read_b128 a[108:111], v14 offset:10240
v_mfma_f32_16x16x32_bf16 v[192:195], a[40:43], a[64:67], v[192:195]
buffer_load_dwordx4 v3, s[4:7], s19 offen offset:2048 lds
v_mfma_f32_16x16x32_bf16 v[192:195], a[44:47], a[68:71], v[192:195]
ds_read_b128 a[112:115], v15 offset:12288
v_mfma_f32_16x16x32_bf16 v[196:199], a[44:47], a[76:79], v[196:199]
v_mfma_f32_16x16x32_bf16 v[196:199], a[40:43], a[72:75], v[196:199]
ds_read_b128 a[116:119], v14 offset:12288
v_mfma_f32_16x16x32_bf16 v[200:203], a[40:43], a[80:83], v[200:203]
v_mfma_f32_16x16x32_bf16 v[200:203], a[44:47], a[84:87], v[200:203]
ds_read_b128 a[120:123], v15 offset:14336
v_mfma_f32_16x16x32_bf16 v[204:207], a[44:47], a[92:95], v[204:207]
buffer_load_dwordx4 v4, s[4:7], s19 offen offset:3072 lds
v_mfma_f32_16x16x32_bf16 v[204:207], a[40:43], a[88:91], v[204:207]
ds_read_b128 a[124:127], v14 offset:14336
v_mfma_f32_16x16x32_bf16 v[224:227], a[48:51], a[64:67], v[224:227]
s_add_u32 s19, s19, 128
v_mfma_f32_16x16x32_bf16 v[224:227], a[52:55], a[68:71], v[224:227]
v_mfma_f32_16x16x32_bf16 v[228:231], a[52:55], a[76:79], v[228:231]
buffer_load_dword v31, v17, s[44:47], s31 offen
v_mfma_f32_16x16x32_bf16 v[228:231], a[48:51], a[72:75], v[228:231]
v_mfma_f32_16x16x32_bf16 v[232:235], a[48:51], a[80:83], v[232:235]
v_mfma_f32_16x16x32_bf16 v[232:235], a[52:55], a[84:87], v[232:235]
v_mfma_f32_16x16x32_bf16 v[236:239], a[52:55], a[92:95], v[236:239]
s_add_u32 s30, s28, 61440
v_mfma_f32_16x16x32_bf16 v[236:239], a[48:51], a[88:91], v[236:239]
v_mfma_f32_16x16x32_bf16 a[128:131], a[56:59], a[64:67], a[128:131]
buffer_store_dwordx4 a[252:255], v16, s[12:15], s30 offen offset:1024 sc0 sc1
v_mfma_f32_16x16x32_bf16 a[128:131], a[60:63], a[68:71], a[128:131]
v_mfma_f32_16x16x32_bf16 a[132:135], a[60:63], a[76:79], a[132:135]
v_mfma_f32_16x16x32_bf16 a[132:135], a[56:59], a[72:75], a[132:135]
v_mfma_f32_16x16x32_bf16 a[136:139], a[56:59], a[80:83], a[136:139]
v_mfma_f32_16x16x32_bf16 a[136:139], a[60:63], a[84:87], a[136:139]
v_mfma_f32_16x16x32_bf16 a[140:143], a[60:63], a[92:95], a[140:143]
s_waitcnt vmcnt(23) lgkmcnt(0)
v_mfma_f32_16x16x32_bf16 a[140:143], a[56:59], a[88:91], a[140:143]
s_barrier
v_mfma_f32_16x16x32_bf16 v[48:51], a[0:3], a[96:99], v[48:51]
v_mfma_f32_16x16x32_bf16 v[48:51], a[4:7], a[100:103], v[48:51]
ds_read_b128 a[64:67], v15 offset:0
v_mfma_f32_16x16x32_bf16 v[52:55], a[4:7], a[108:111], v[52:55]
s_add_u32 m0, s25, 0
v_mfma_f32_16x16x32_bf16 v[52:55], a[0:3], a[104:107], v[52:55]
ds_read_b128 a[68:71], v14 offset:0
v_mfma_f32_16x16x32_bf16 v[56:59], a[0:3], a[112:115], v[56:59]
buffer_load_dwordx4 v5, s[8:11], s21 offen offset:0 lds
v_mfma_f32_16x16x32_bf16 v[56:59], a[4:7], a[116:119], v[56:59]
ds_read_b128 a[72:75], v15 offset:2048
v_mfma_f32_16x16x32_bf16 v[60:63], a[4:7], a[124:127], v[60:63]
v_mfma_f32_16x16x32_bf16 v[60:63], a[0:3], a[120:123], v[60:63]
ds_read_b128 a[76:79], v14 offset:2048
v_mfma_f32_16x16x32_bf16 v[80:83], a[8:11], a[96:99], v[80:83]
v_mfma_f32_16x16x32_bf16 v[80:83], a[12:15], a[100:103], v[80:83]
ds_read_b128 a[80:83], v15 offset:4096
v_mfma_f32_16x16x32_bf16 v[84:87], a[12:15], a[108:111], v[84:87]
buffer_load_dwordx4 v6, s[8:11], s21 offen offset:1024 lds
v_mfma_f32_16x16x32_bf16 v[84:87], a[8:11], a[104:107], v[84:87]
ds_read_b128 a[84:87], v14 offset:4096
v_mfma_f32_16x16x32_bf16 v[88:91], a[8:11], a[112:115], v[88:91]
v_mfma_f32_16x16x32_bf16 v[88:91], a[12:15], a[116:119], v[88:91]
ds_read_b128 a[88:91], v15 offset:6144
v_mfma_f32_16x16x32_bf16 v[92:95], a[12:15], a[124:127], v[92:95]
v_mfma_f32_16x16x32_bf16 v[92:95], a[8:11], a[120:123], v[92:95]
ds_read_b128 a[92:95], v14 offset:6144
v_mfma_f32_16x16x32_bf16 v[112:115], a[16:19], a[96:99], v[112:115]
buffer_load_dwordx4 v7, s[8:11], s21 offen offset:2048 lds
v_mfma_f32_16x16x32_bf16 v[112:115], a[20:23], a[100:103], v[112:115]
ds_read_b64_tr_b16 a[32:33], v9 offset:16384
v_mfma_f32_16x16x32_bf16 v[116:119], a[20:23], a[108:111], v[116:119]
v_mfma_f32_16x16x32_bf16 v[116:119], a[16:19], a[104:107], v[116:119]
ds_read_b64_tr_b16 a[34:35], v9 offset:17408
v_mfma_f32_16x16x32_bf16 v[120:123], a[16:19], a[112:115], v[120:123]
v_mfma_f32_16x16x32_bf16 v[120:123], a[20:23], a[116:119], v[120:123]
ds_read_b64_tr_b16 a[36:37], v9 offset:24576
v_mfma_f32_16x16x32_bf16 v[124:127], a[20:23], a[124:127], v[124:127]
buffer_load_dwordx4 v8, s[8:11], s21 offen offset:3072 lds
v_mfma_f32_16x16x32_bf16 v[124:127], a[16:19], a[120:123], v[124:127]
ds_read_b64_tr_b16 a[38:39], v9 offset:25600
v_mfma_f32_16x16x32_bf16 v[144:147], a[24:27], a[96:99], v[144:147]
s_xor_b64 s[8:9], s[8:9], s[80:81]
v_mfma_f32_16x16x32_bf16 v[144:147], a[28:31], a[100:103], v[144:147]
ds_read_b64_tr_b16 a[40:41], v10 offset:16384
v_mfma_f32_16x16x32_bf16 v[148:151], a[28:31], a[108:111], v[148:151]
s_add_u32 m0, s24, 4096
v_mfma_f32_16x16x32_bf16 v[148:151], a[24:27], a[104:107], v[148:151]
ds_read_b64_tr_b16 a[42:43], v10 offset:17408
v_mfma_f32_16x16x32_bf16 v[152:155], a[24:27], a[112:115], v[152:155]
buffer_load_dwordx4 v1, s[4:7], s20 offen offset:0 lds
v_mfma_f32_16x16x32_bf16 v[152:155], a[28:31], a[116:119], v[152:155]
ds_read_b64_tr_b16 a[44:45], v10 offset:24576
v_mfma_f32_16x16x32_bf16 v[156:159], a[28:31], a[124:127], v[156:159]
v_mfma_f32_16x16x32_bf16 v[156:159], a[24:27], a[120:123], v[156:159]
ds_read_b64_tr_b16 a[46:47], v10 offset:25600
s_waitcnt lgkmcnt(8)
v_mfma_f32_16x16x32_bf16 v[32:35], a[0:3], a[64:67], v[32:35]
v_mfma_f32_16x16x32_bf16 v[32:35], a[4:7], a[68:71], v[32:35]
ds_read_b64_tr_b16 a[48:49], v11 offset:16384
v_mfma_f32_16x16x32_bf16 v[36:39], a[4:7], a[76:79], v[36:39]
buffer_load_dwordx4 v2, s[4:7], s20 offen offset:1024 lds
v_mfma_f32_16x16x32_bf16 v[36:39], a[0:3], a[72:75], v[36:39]
ds_read_b64_tr_b16 a[50:51], v11 offset:17408
v_mfma_f32_16x16x32_bf16 v[40:43], a[0:3], a[80:83], v[40:43]
v_mfma_f32_16x16x32_bf16 v[40:43], a[4:7], a[84:87], v[40:43]
ds_read_b64_tr_b16 a[52:53], v11 offset:24576
v_mfma_f32_16x16x32_bf16 v[44:47], a[4:7], a[92:95], v[44:47]
v_mfma_f32_16x16x32_bf16 v[44:47], a[0:3], a[88:91], v[44:47]
ds_read_b64_tr_b16 a[54:55], v11 offset:25600
v_mfma_f32_16x16x32_bf16 v[64:67], a[8:11], a[64:67], v[64:67]
buffer_load_dwordx4 v3, s[4:7], s20 offen offset:2048 lds
v_mfma_f32_16x16x32_bf16 v[64:67], a[12:15], a[68:71], v[64:67]
ds_read_b64_tr_b16 a[56:57], v12 offset:16384
v_mfma_f32_16x16x32_bf16 v[68:71], a[12:15], a[76:79], v[68:71]
v_mfma_f32_16x16x32_bf16 v[68:71], a[8:11], a[72:75], v[68:71]
ds_read_b64_tr_b16 a[58:59], v12 offset:17408
v_mfma_f32_16x16x32_bf16 v[72:75], a[8:11], a[80:83], v[72:75]
v_mfma_f32_16x16x32_bf16 v[72:75], a[12:15], a[84:87], v[72:75]
ds_read_b64_tr_b16 a[60:61], v12 offset:24576
v_mfma_f32_16x16x32_bf16 v[76:79], a[12:15], a[92:95], v[76:79]
buffer_load_dwordx4 v4, s[4:7], s20 offen offset:3072 lds
v_mfma_f32_16x16x32_bf16 v[76:79], a[8:11], a[88:91], v[76:79]
ds_read_b64_tr_b16 a[62:63], v12 offset:25600
v_mfma_f32_16x16x32_bf16 v[96:99], a[16:19], a[64:67], v[96:99]
s_add_u32 s20, s20, 128
v_mfma_f32_16x16x32_bf16 v[96:99], a[20:23], a[68:71], v[96:99]
v_mfma_f32_16x16x32_bf16 v[100:103], a[20:23], a[76:79], v[100:103]
v_mfma_f32_16x16x32_bf16 v[100:103], a[16:19], a[72:75], v[100:103]
v_mfma_f32_16x16x32_bf16 v[104:107], a[16:19], a[80:83], v[104:107]
v_mfma_f32_16x16x32_bf16 v[104:107], a[20:23], a[84:87], v[104:107]
v_mfma_f32_16x16x32_bf16 v[108:111], a[20:23], a[92:95], v[108:111]
v_mfma_f32_16x16x32_bf16 v[108:111], a[16:19], a[88:91], v[108:111]
v_mfma_f32_16x16x32_bf16 v[128:131], a[24:27], a[64:67], v[128:131]
v_mfma_f32_16x16x32_bf16 v[128:131], a[28:31], a[68:71], v[128:131]
v_mfma_f32_16x16x32_bf16 v[132:135], a[28:31], a[76:79], v[132:135]
v_mfma_f32_16x16x32_bf16 v[132:135], a[24:27], a[72:75], v[132:135]
v_mfma_f32_16x16x32_bf16 v[136:139], a[24:27], a[80:83], v[136:139]
v_mfma_f32_16x16x32_bf16 v[136:139], a[28:31], a[84:87], v[136:139]
v_mfma_f32_16x16x32_bf16 v[140:143], a[28:31], a[92:95], v[140:143]
s_waitcnt vmcnt(20) lgkmcnt(0)
v_mfma_f32_16x16x32_bf16 v[140:143], a[24:27], a[88:91], v[140:143]
s_barrier
v_mfma_f32_16x16x32_bf16 v[160:163], a[32:35], a[64:67], v[160:163]
s_add_u32 s24, s23, s27
s_add_u32 s23, s23, 32768
s_cmp_eq_u32 s23, 98304
v_mfma_f32_16x16x32_bf16 v[160:163], a[36:39], a[68:71], v[160:163]
ds_read_b64_tr_b16 a[0:1], v9 offset:32768
v_mfma_f32_16x16x32_bf16 v[164:167], a[36:39], a[76:79], v[164:167]
s_cselect_b32 s23, 0, s23
s_add_u32 m0, s25, 16384
v_mfma_f32_16x16x32_bf16 v[164:167], a[32:35], a[72:75], v[164:167]
ds_read_b64_tr_b16 a[2:3], v9 offset:33792
v_mfma_f32_16x16x32_bf16 v[168:171], a[32:35], a[80:83], v[168:171]
buffer_load_dwordx4 v5, s[8:11], s21 offen offset:0 lds
v_mfma_f32_16x16x32_bf16 v[168:171], a[36:39], a[84:87], v[168:171]
ds_read_b64_tr_b16 a[4:5], v9 offset:40960
v_mfma_f32_16x16x32_bf16 v[172:175], a[36:39], a[92:95], v[172:175]
v_add_u32 v15, s23, v13
v_xor_b32 v14, 64, v15
v_mfma_f32_16x16x32_bf16 v[172:175], a[32:35], a[88:91], v[172:175]
ds_read_b64_tr_b16 a[6:7], v9 offset:41984
v_mfma_f32_16x16x32_bf16 v[192:195], a[40:43], a[64:67], v[192:195]
v_mfma_f32_16x16x32_bf16 v[192:195], a[44:47], a[68:71], v[192:195]
ds_read_b64_tr_b16 a[8:9], v10 offset:32768
v_mfma_f32_16x16x32_bf16 v[196:199], a[44:47], a[76:79], v[196:199]
buffer_load_dwordx4 v6, s[8:11], s21 offen offset:1024 lds
v_mfma_f32_16x16x32_bf16 v[196:199], a[40:43], a[72:75], v[196:199]
ds_read_b64_tr_b16 a[10:11], v10 offset:33792
v_mfma_f32_16x16x32_bf16 v[200:203], a[40:43], a[80:83], v[200:203]
v_mfma_f32_16x16x32_bf16 v[200:203], a[44:47], a[84:87], v[200:203]
ds_read_b64_tr_b16 a[12:13], v10 offset:40960
v_mfma_f32_16x16x32_bf16 v[204:207], a[44:47], a[92:95], v[204:207]
v_mfma_f32_16x16x32_bf16 v[204:207], a[40:43], a[88:91], v[204:207]
ds_read_b64_tr_b16 a[14:15], v10 offset:41984
v_mfma_f32_16x16x32_bf16 v[224:227], a[48:51], a[64:67], v[224:227]
buffer_load_dwordx4 v7, s[8:11], s21 offen offset:2048 lds
v_mfma_f32_16x16x32_bf16 v[224:227], a[52:55], a[68:71], v[224:227]
ds_read_b64_tr_b16 a[16:17], v11 offset:32768
v_mfma_f32_16x16x32_bf16 v[228:231], a[52:55], a[76:79], v[228:231]
v_mfma_f32_16x16x32_bf16 v[228:231], a[48:51], a[72:75], v[228:231]
ds_read_b64_tr_b16 a[18:19], v11 offset:33792
v_mfma_f32_16x16x32_bf16 v[232:235], a[48:51], a[80:83], v[232:235]
v_mfma_f32_16x16x32_bf16 v[232:235], a[52:55], a[84:87], v[232:235]
ds_read_b64_tr_b16 a[20:21], v11 offset:40960
v_mfma_f32_16x16x32_bf16 v[236:239], a[52:55], a[92:95], v[236:239]
buffer_load_dwordx4 v8, s[8:11], s21 offen offset:3072 lds
v_mfma_f32_16x16x32_bf16 v[236:239], a[48:51], a[88:91], v[236:239]
ds_read_b64_tr_b16 a[22:23], v11 offset:41984
v_mfma_f32_16x16x32_bf16 a[128:131], a[56:59], a[64:67], a[128:131]
s_xor_b64 s[8:9], s[8:9], s[80:81]
s_add_u32 s21, s21, s22
v_mfma_f32_16x16x32_bf16 a[128:131], a[60:63], a[68:71], a[128:131]
ds_read_b64_tr_b16 a[24:25], v12 offset:32768
v_mfma_f32_16x16x32_bf16 a[132:135], a[60:63], a[76:79], a[132:135]
v_mfma_f32_16x16x32_bf16 a[132:135], a[56:59], a[72:75], a[132:135]
ds_read_b64_tr_b16 a[26:27], v12 offset:33792
v_mfma_f32_16x16x32_bf16 a[136:139], a[56:59], a[80:83], a[136:139]
v_mfma_f32_16x16x32_bf16 a[136:139], a[60:63], a[84:87], a[136:139]
ds_read_b64_tr_b16 a[28:29], v12 offset:40960
v_mfma_f32_16x16x32_bf16 a[140:143], a[60:63], a[92:95], a[140:143]
v_mfma_f32_16x16x32_bf16 a[140:143], a[56:59], a[88:91], a[140:143]
ds_read_b64_tr_b16 a[30:31], v12 offset:41984
v_mfma_f32_16x16x32_bf16 v[176:179], a[32:35], a[96:99], v[176:179]
v_mfma_f32_16x16x32_bf16 v[176:179], a[36:39], a[100:103], v[176:179]
ds_read_b128 a[64:67], v15 offset:0
v_mfma_f32_16x16x32_bf16 v[180:183], a[36:39], a[108:111], v[180:183]
v_mfma_f32_16x16x32_bf16 v[180:183], a[32:35], a[104:107], v[180:183]
ds_read_b128 a[68:71], v14 offset:0
v_mfma_f32_16x16x32_bf16 v[184:187], a[32:35], a[112:115], v[184:187]
v_mfma_f32_16x16x32_bf16 v[184:187], a[36:39], a[116:119], v[184:187]
ds_read_b128 a[72:75], v15 offset:2048
v_mfma_f32_16x16x32_bf16 v[188:191], a[36:39], a[124:127], v[188:191]
v_mfma_f32_16x16x32_bf16 v[188:191], a[32:35], a[120:123], v[188:191]
ds_read_b128 a[76:79], v14 offset:2048
v_mfma_f32_16x16x32_bf16 v[208:211], a[40:43], a[96:99], v[208:211]
v_mfma_f32_16x16x32_bf16 v[208:211], a[44:47], a[100:103], v[208:211]
ds_read_b128 a[80:83], v15 offset:4096
v_mfma_f32_16x16x32_bf16 v[212:215], a[44:47], a[108:111], v[212:215]
v_mfma_f32_16x16x32_bf16 v[212:215], a[40:43], a[104:107], v[212:215]
ds_read_b128 a[84:87], v14 offset:4096
v_mfma_f32_16x16x32_bf16 v[216:219], a[40:43], a[112:115], v[216:219]
v_mfma_f32_16x16x32_bf16 v[216:219], a[44:47], a[116:119], v[216:219]
ds_read_b128 a[88:91], v15 offset:6144
v_mfma_f32_16x16x32_bf16 v[220:223], a[44:47], a[124:127], v[220:223]
v_mfma_f32_16x16x32_bf16 v[220:223], a[40:43], a[120:123], v[220:223]
ds_read_b128 a[92:95], v14 offset:6144
v_mfma_f32_16x16x32_bf16 v[240:243], a[48:51], a[96:99], v[240:243]
v_mfma_f32_16x16x32_bf16 v[240:243], a[52:55], a[100:103], v[240:243]
v_mfma_f32_16x16x32_bf16 v[244:247], a[52:55], a[108:111], v[244:247]
v_mfma_f32_16x16x32_bf16 v[244:247], a[48:51], a[104:107], v[244:247]
v_mfma_f32_16x16x32_bf16 v[248:251], a[48:51], a[112:115], v[248:251]
v_mfma_f32_16x16x32_bf16 v[248:251], a[52:55], a[116:119], v[248:251]
v_mfma_f32_16x16x32_bf16 v[252:255], a[52:55], a[124:127], v[252:255]
v_mfma_f32_16x16x32_bf16 v[252:255], a[48:51], a[120:123], v[252:255]
v_mfma_f32_16x16x32_bf16 a[144:147], a[56:59], a[96:99], a[144:147]
v_mfma_f32_16x16x32_bf16 a[144:147], a[60:63], a[100:103], a[144:147]
v_mfma_f32_16x16x32_bf16 a[148:151], a[60:63], a[108:111], a[148:151]
v_mfma_f32_16x16x32_bf16 a[148:151], a[56:59], a[104:107], a[148:151]
v_mfma_f32_16x16x32_bf16 a[152:155], a[56:59], a[112:115], a[152:155]
s_mov_b32 s26, 2
v_mfma_f32_16x16x32_bf16 a[152:155], a[60:63], a[116:119], a[152:155]
v_mfma_f32_16x16x32_bf16 a[156:159], a[60:63], a[124:127], a[156:159]
s_waitcnt vmcnt(12) lgkmcnt(0)
v_mfma_f32_16x16x32_bf16 a[156:159], a[56:59], a[120:123], a[156:159]
s_barrier
s_cmp_eq_u32 s16, 0
s_cbranch_scc0 L_sig6
s_lshl_b32 s31, s2, 8
s_add_u32 s31, s31, 82903040
v_mov_b32 v23, 1
v_mov_b32 v24, 0
s_mov_b64 exec, 1
buffer_store_dword v23, v24, s[12:15], s31 offen sc0 sc1
s_mov_b64 exec, -1
L_sig6:
v_mfma_f32_16x16x32_bf16 v[32:35], a[0:3], a[64:67], v[32:35]
ds_read_b64_tr_b16 a[32:33], v9 offset:49152
v_add_u32 v15, 32768, v13
v_mfma_f32_16x16x32_bf16 v[32:35], a[4:7], a[68:71], v[32:35]
ds_read_b64_tr_b16 a[34:35], v9 offset:50176
v_xor_b32 v14, 64, v15
v_mfma_f32_16x16x32_bf16 v[36:39], a[4:7], a[76:79], v[36:39]
ds_read_b64_tr_b16 a[36:37], v9 offset:57344
v_mfma_f32_16x16x32_bf16 v[36:39], a[0:3], a[72:75], v[36:39]
ds_read_b64_tr_b16 a[38:39], v9 offset:58368
v_mfma_f32_16x16x32_bf16 v[40:43], a[0:3], a[80:83], v[40:43]
ds_read_b64_tr_b16 a[40:41], v10 offset:49152
v_mfma_f32_16x16x32_bf16 v[40:43], a[4:7], a[84:87], v[40:43]
ds_read_b64_tr_b16 a[42:43], v10 offset:50176
v_mfma_f32_16x16x32_bf16 v[44:47], a[4:7], a[92:95], v[44:47]
ds_read_b64_tr_b16 a[44:45], v10 offset:57344
v_mfma_f32_16x16x32_bf16 v[44:47], a[0:3], a[88:91], v[44:47]
ds_read_b64_tr_b16 a[46:47], v10 offset:58368
v_mfma_f32_16x16x32_bf16 v[64:67], a[8:11], a[64:67], v[64:67]
ds_read_b64_tr_b16 a[48:49], v11 offset:49152
v_mfma_f32_16x16x32_bf16 v[64:67], a[12:15], a[68:71], v[64:67]
ds_read_b64_tr_b16 a[50:51], v11 offset:50176
v_mfma_f32_16x16x32_bf16 v[68:71], a[12:15], a[76:79], v[68:71]
ds_read_b64_tr_b16 a[52:53], v11 offset:57344
v_mfma_f32_16x16x32_bf16 v[68:71], a[8:11], a[72:75], v[68:71]
ds_read_b64_tr_b16 a[54:55], v11 offset:58368
v_mfma_f32_16x16x32_bf16 v[72:75], a[8:11], a[80:83], v[72:75]
ds_read_b64_tr_b16 a[56:57], v12 offset:49152
v_mfma_f32_16x16x32_bf16 v[72:75], a[12:15], a[84:87], v[72:75]
ds_read_b64_tr_b16 a[58:59], v12 offset:50176
v_mfma_f32_16x16x32_bf16 v[76:79], a[12:15], a[92:95], v[76:79]
ds_read_b64_tr_b16 a[60:61], v12 offset:57344
v_mfma_f32_16x16x32_bf16 v[76:79], a[8:11], a[88:91], v[76:79]
ds_read_b64_tr_b16 a[62:63], v12 offset:58368
v_mfma_f32_16x16x32_bf16 v[96:99], a[16:19], a[64:67], v[96:99]
ds_read_b128 a[96:99], v15 offset:0
v_mfma_f32_16x16x32_bf16 v[96:99], a[20:23], a[68:71], v[96:99]
ds_read_b128 a[100:103], v14 offset:0
s_bfe_u32 s34, s2, 0x10002
s_lshl_b32 s34, s34, 1
v_mfma_f32_16x16x32_bf16 v[100:103], a[20:23], a[76:79], v[100:103]
ds_read_b128 a[104:107], v15 offset:2048
s_and_b32 s41, s2, 1
s_add_u32 s34, s34, s41
s_and_b32 s41, s2, 2
v_mfma_f32_16x16x32_bf16 v[100:103], a[16:19], a[72:75], v[100:103]
ds_read_b128 a[108:111], v14 offset:2048
s_lshl_b32 s32, s41, 1
s_and_b32 s44, s2, 5
s_bfe_u32 s42, s2, 0x20005
v_mfma_f32_16x16x32_bf16 v[104:107], a[16:19], a[80:83], v[104:107]
s_add_u32 s32, s32, s42
s_lshr_b32 s42, s2, 7
s_xor_b32 s42, s42, 1
v_mfma_f32_16x16x32_bf16 v[104:107], a[20:23], a[84:87], v[104:107]
s_lshl_b32 s42, s42, 3
s_add_u32 s32, s32, s42
s_bfe_u32 s33, s2, 0x20003
v_mfma_f32_16x16x32_bf16 v[108:111], a[20:23], a[92:95], v[108:111]
v_mov_b32 v26, v16
v_add_u32 v27, 188416, v16
v_mfma_f32_16x16x32_bf16 v[108:111], a[16:19], a[88:91], v[108:111]
s_lshl_b32 s41, s32, 2
s_add_u32 s41, s41, s16
s_mul_i32 s41, s41, 376832
v_mfma_f32_16x16x32_bf16 v[128:131], a[24:27], a[64:67], v[128:131]
s_add_u32 s41, s41, 50331648
s_mul_i32 s42, s34, 14336
s_add_u32 s35, s41, s42
v_mfma_f32_16x16x32_bf16 v[128:131], a[28:31], a[68:71], v[128:131]
s_add_u32 s35, s35, 131072
s_lshl_b32 s42, s44, 14
s_add_u32 s36, s41, s42
v_mfma_f32_16x16x32_bf16 v[132:135], a[28:31], a[76:79], v[132:135]
s_mul_i32 s41, s33, 1318912
s_lshl_b32 s42, s16, 12
s_add_u32 s41, s41, s42
v_mfma_f32_16x16x32_bf16 v[132:135], a[24:27], a[72:75], v[132:135]
s_cmp_eq_u32 s16, 3
s_cselect_b32 s42, 1024, 0
s_sub_u32 s41, s41, s42
v_mfma_f32_16x16x32_bf16 v[136:139], a[24:27], a[80:83], v[136:139]
v_mfma_f32_16x16x32_bf16 v[136:139], a[28:31], a[84:87], v[136:139]
v_mfma_f32_16x16x32_bf16 v[140:143], a[28:31], a[92:95], v[140:143]
s_waitcnt vmcnt(4) lgkmcnt(0)
v_mfma_f32_16x16x32_bf16 v[140:143], a[24:27], a[88:91], v[140:143]
s_barrier
v_mfma_f32_16x16x32_bf16 v[160:163], a[32:35], a[64:67], v[160:163]
ds_read_b64_tr_b16 a[0:1], v9 offset:0
v_mfma_f32_16x16x32_bf16 v[160:163], a[36:39], a[68:71], v[160:163]
ds_read_b64_tr_b16 a[2:3], v9 offset:1024
v_mfma_f32_16x16x32_bf16 v[164:167], a[36:39], a[76:79], v[164:167]
ds_read_b64_tr_b16 a[4:5], v9 offset:8192
v_mfma_f32_16x16x32_bf16 v[164:167], a[32:35], a[72:75], v[164:167]
ds_read_b64_tr_b16 a[6:7], v9 offset:9216
v_mfma_f32_16x16x32_bf16 v[168:171], a[32:35], a[80:83], v[168:171]
ds_read_b64_tr_b16 a[8:9], v10 offset:0
v_mfma_f32_16x16x32_bf16 v[168:171], a[36:39], a[84:87], v[168:171]
ds_read_b64_tr_b16 a[10:11], v10 offset:1024
v_mfma_f32_16x16x32_bf16 v[172:175], a[36:39], a[92:95], v[172:175]
ds_read_b64_tr_b16 a[12:13], v10 offset:8192
v_mfma_f32_16x16x32_bf16 v[172:175], a[32:35], a[88:91], v[172:175]
ds_read_b64_tr_b16 a[14:15], v10 offset:9216
v_mfma_f32_16x16x32_bf16 v[192:195], a[40:43], a[64:67], v[192:195]
ds_read_b64_tr_b16 a[16:17], v11 offset:0
v_mfma_f32_16x16x32_bf16 v[192:195], a[44:47], a[68:71], v[192:195]
ds_read_b64_tr_b16 a[18:19], v11 offset:1024
v_mfma_f32_16x16x32_bf16 v[196:199], a[44:47], a[76:79], v[196:199]
ds_read_b64_tr_b16 a[20:21], v11 offset:8192
v_mfma_f32_16x16x32_bf16 v[196:199], a[40:43], a[72:75], v[196:199]
ds_read_b64_tr_b16 a[22:23], v11 offset:9216
v_mfma_f32_16x16x32_bf16 v[200:203], a[40:43], a[80:83], v[200:203]
ds_read_b64_tr_b16 a[24:25], v12 offset:0
v_mfma_f32_16x16x32_bf16 v[200:203], a[44:47], a[84:87], v[200:203]
ds_read_b64_tr_b16 a[26:27], v12 offset:1024
v_mfma_f32_16x16x32_bf16 v[204:207], a[44:47], a[92:95], v[204:207]
ds_read_b64_tr_b16 a[28:29], v12 offset:8192
v_mfma_f32_16x16x32_bf16 v[204:207], a[40:43], a[88:91], v[204:207]
ds_read_b64_tr_b16 a[30:31], v12 offset:9216
v_mfma_f32_16x16x32_bf16 v[224:227], a[48:51], a[64:67], v[224:227]
ds_read_b128 a[112:115], v15 offset:4096
v_mfma_f32_16x16x32_bf16 v[224:227], a[52:55], a[68:71], v[224:227]
ds_read_b128 a[116:119], v14 offset:4096
s_add_u32 s41, s41, 75497472
s_mul_i32 s42, s34, 100352
v_mfma_f32_16x16x32_bf16 v[228:231], a[52:55], a[76:79], v[228:231]
ds_read_b128 a[120:123], v15 offset:6144
s_add_u32 s37, s41, s42
s_add_u32 s37, s37, 917504
s_mul_i32 s42, s44, 114688
v_mfma_f32_16x16x32_bf16 v[228:231], a[48:51], a[72:75], v[228:231]
ds_read_b128 a[124:127], v14 offset:6144
s_add_u32 s38, s41, s42
s_cmp_ge_u32 s16, 2
s_cselect_b32 s39, 0x40000000, 0
v_mfma_f32_16x16x32_bf16 v[232:235], a[48:51], a[80:83], v[232:235]
s_lshl_b32 s40, s16, 12
s_lshl_b32 s41, s44, 4
s_mul_i32 s42, s34, 14
v_mfma_f32_16x16x32_bf16 v[232:235], a[52:55], a[84:87], v[232:235]
s_add_u32 s43, s42, 416
v_and_b32 v28, 16, v0
v_add3_u32 v29, v28, v0, s41
v_mfma_f32_16x16x32_bf16 v[236:239], a[52:55], a[92:95], v[236:239]
v_min_u32 v28, 45, v0
v_add_u32 v28, s43, v28
v_cmp_gt_u32 vcc, 32, v0
v_mfma_f32_16x16x32_bf16 v[236:239], a[48:51], a[88:91], v[236:239]
v_lshrrev_b32 v28, 2, v28
s_and_b32 s41, s41, 64
v_cndmask_b32 v29, v28, v29, vcc
v_mfma_f32_16x16x32_bf16 a[128:131], a[56:59], a[64:67], a[128:131]
v_cmp_gt_u32 vcc, 56, v0
v_add_u32 v28, s41, v0
s_nop 0
v_mfma_f32_16x16x32_bf16 a[128:131], a[60:63], a[68:71], a[128:131]
v_cndmask_b32 v29, v28, v29, vcc
s_lshr_b32 s42, s42, 2
s_add_u32 s41, s42, 0
v_mfma_f32_16x16x32_bf16 a[132:135], a[60:63], a[76:79], a[132:135]
s_min_u32 s41, s41, 13
s_lshl_b32 s41, s41, 3
s_lshr_b32 s43, s32, 1
v_mfma_f32_16x16x32_bf16 a[132:135], a[56:59], a[72:75], a[132:135]
s_add_u32 s41, s41, s43
s_mul_i32 s43, s41, 4682
s_lshr_b32 s43, s43, 16
v_mfma_f32_16x16x32_bf16 a[136:139], a[56:59], a[80:83], a[136:139]
v_mfma_f32_16x16x32_bf16 a[136:139], a[60:63], a[84:87], a[136:139]
v_mfma_f32_16x16x32_bf16 a[140:143], a[60:63], a[92:95], a[140:143]
s_waitcnt vmcnt(0) lgkmcnt(0)
v_mfma_f32_16x16x32_bf16 a[140:143], a[56:59], a[88:91], a[140:143]
s_barrier
v_mfma_f32_16x16x32_bf16 v[32:35], a[0:3], a[96:99], v[32:35]
ds_read_b64_tr_b16 a[32:33], v9 offset:16384
v_add_u32 v15, 0, v13
v_mfma_f32_16x16x32_bf16 v[32:35], a[4:7], a[100:103], v[32:35]
ds_read_b64_tr_b16 a[34:35], v9 offset:17408
v_xor_b32 v14, 64, v15
v_mfma_f32_16x16x32_bf16 v[36:39], a[4:7], a[108:111], v[36:39]
ds_read_b64_tr_b16 a[36:37], v9 offset:24576
v_mfma_f32_16x16x32_bf16 v[36:39], a[0:3], a[104:107], v[36:39]
ds_read_b64_tr_b16 a[38:39], v9 offset:25600
v_mfma_f32_16x16x32_bf16 v[40:43], a[0:3], a[112:115], v[40:43]
ds_read_b64_tr_b16 a[40:41], v10 offset:16384
v_mfma_f32_16x16x32_bf16 v[40:43], a[4:7], a[116:119], v[40:43]
ds_read_b64_tr_b16 a[42:43], v10 offset:17408
v_mfma_f32_16x16x32_bf16 v[44:47], a[4:7], a[124:127], v[44:47]
ds_read_b64_tr_b16 a[44:45], v10 offset:24576
v_mfma_f32_16x16x32_bf16 v[44:47], a[0:3], a[120:123], v[44:47]
ds_read_b64_tr_b16 a[46:47], v10 offset:25600
v_mfma_f32_16x16x32_bf16 v[64:67], a[8:11], a[96:99], v[64:67]
ds_read_b64_tr_b16 a[48:49], v11 offset:16384
v_mfma_f32_16x16x32_bf16 v[64:67], a[12:15], a[100:103], v[64:67]
ds_read_b64_tr_b16 a[50:51], v11 offset:17408
v_mfma_f32_16x16x32_bf16 v[68:71], a[12:15], a[108:111], v[68:71]
ds_read_b64_tr_b16 a[52:53], v11 offset:24576
v_mfma_f32_16x16x32_bf16 v[68:71], a[8:11], a[104:107], v[68:71]
ds_read_b64_tr_b16 a[54:55], v11 offset:25600
v_mfma_f32_16x16x32_bf16 v[72:75], a[8:11], a[112:115], v[72:75]
ds_read_b64_tr_b16 a[56:57], v12 offset:16384
v_mfma_f32_16x16x32_bf16 v[72:75], a[12:15], a[116:119], v[72:75]
ds_read_b64_tr_b16 a[58:59], v12 offset:17408
v_mfma_f32_16x16x32_bf16 v[76:79], a[12:15], a[124:127], v[76:79]
ds_read_b64_tr_b16 a[60:61], v12 offset:24576
v_mfma_f32_16x16x32_bf16 v[76:79], a[8:11], a[120:123], v[76:79]
ds_read_b64_tr_b16 a[62:63], v12 offset:25600
v_mfma_f32_16x16x32_bf16 v[96:99], a[16:19], a[96:99], v[96:99]
ds_read_b128 a[64:67], v15 offset:8192
v_mfma_f32_16x16x32_bf16 v[96:99], a[20:23], a[100:103], v[96:99]
ds_read_b128 a[68:71], v14 offset:8192
s_lshl_b32 s41, s41, 3
s_mul_i32 s43, s43, 111
v_mfma_f32_16x16x32_bf16 v[100:103], a[20:23], a[108:111], v[100:103]
ds_read_b128 a[72:75], v15 offset:10240
s_sub_u32 s41, s41, s43
v_writelane_b32 v29, s41, 46
s_add_u32 s41, s42, 1
v_mfma_f32_16x16x32_bf16 v[100:103], a[16:19], a[104:107], v[100:103]
ds_read_b128 a[76:79], v14 offset:10240
s_min_u32 s41, s41, 13
s_lshl_b32 s41, s41, 3
s_lshr_b32 s43, s32, 1
v_mfma_f32_16x16x32_bf16 v[104:107], a[16:19], a[112:115], v[104:107]
s_add_u32 s41, s41, s43
s_mul_i32 s43, s41, 4682
s_lshr_b32 s43, s43, 16
v_mfma_f32_16x16x32_bf16 v[104:107], a[20:23], a[116:119], v[104:107]
s_lshl_b32 s41, s41, 3
s_mul_i32 s43, s43, 111
s_sub_u32 s41, s41, s43
v_mfma_f32_16x16x32_bf16 v[108:111], a[20:23], a[124:127], v[108:111]
v_writelane_b32 v29, s41, 47
s_add_u32 s41, s42, 2
v_mfma_f32_16x16x32_bf16 v[108:111], a[16:19], a[120:123], v[108:111]
s_min_u32 s41, s41, 13
s_lshl_b32 s41, s41, 3
s_lshr_b32 s43, s32, 1
v_mfma_f32_16x16x32_bf16 v[128:131], a[24:27], a[96:99], v[128:131]
s_add_u32 s41, s41, s43
s_mul_i32 s43, s41, 4682
s_lshr_b32 s43, s43, 16
v_mfma_f32_16x16x32_bf16 v[128:131], a[28:31], a[100:103], v[128:131]
s_lshl_b32 s41, s41, 3
s_mul_i32 s43, s43, 111
s_sub_u32 s41, s41, s43
v_mfma_f32_16x16x32_bf16 v[132:135], a[28:31], a[108:111], v[132:135]
v_writelane_b32 v29, s41, 48
s_add_u32 s41, s42, 3
s_min_u32 s41, s41, 13
v_mfma_f32_16x16x32_bf16 v[132:135], a[24:27], a[104:107], v[132:135]
s_lshl_b32 s41, s41, 3
s_lshr_b32 s43, s32, 1
s_add_u32 s41, s41, s43
v_mfma_f32_16x16x32_bf16 v[136:139], a[24:27], a[112:115], v[136:139]
v_mfma_f32_16x16x32_bf16 v[136:139], a[28:31], a[116:119], v[136:139]
v_mfma_f32_16x16x32_bf16 v[140:143], a[28:31], a[124:127], v[140:143]
v_mfma_f32_16x16x32_bf16 v[140:143], a[24:27], a[120:123], v[140:143]
s_waitcnt lgkmcnt(0)
v_mfma_f32_16x16x32_bf16 v[160:163], a[32:35], a[96:99], v[160:163]
ds_read_b64_tr_b16 a[0:1], v9 offset:32768
v_mfma_f32_16x16x32_bf16 v[160:163], a[36:39], a[100:103], v[160:163]
ds_read_b64_tr_b16 a[2:3], v9 offset:33792
v_mfma_f32_16x16x32_bf16 v[164:167], a[36:39], a[108:111], v[164:167]
ds_read_b64_tr_b16 a[4:5], v9 offset:40960
v_mfma_f32_16x16x32_bf16 v[164:167], a[32:35], a[104:107], v[164:167]
ds_read_b64_tr_b16 a[6:7], v9 offset:41984
v_mfma_f32_16x16x32_bf16 v[168:171], a[32:35], a[112:115], v[168:171]
ds_read_b64_tr_b16 a[8:9], v10 offset:32768
v_mfma_f32_16x16x32_bf16 v[168:171], a[36:39], a[116:119], v[168:171]
ds_read_b64_tr_b16 a[10:11], v10 offset:33792
v_mfma_f32_16x16x32_bf16 v[172:175], a[36:39], a[124:127], v[172:175]
ds_read_b64_tr_b16 a[12:13], v10 offset:40960
v_mfma_f32_16x16x32_bf16 v[172:175], a[32:35], a[120:123], v[172:175]
ds_read_b64_tr_b16 a[14:15], v10 offset:41984
v_mfma_f32_16x16x32_bf16 v[192:195], a[40:43], a[96:99], v[192:195]
ds_read_b64_tr_b16 a[16:17], v11 offset:32768
v_mfma_f32_16x16x32_bf16 v[192:195], a[44:47], a[100:103], v[192:195]
ds_read_b64_tr_b16 a[18:19], v11 offset:33792
v_mfma_f32_16x16x32_bf16 v[196:199], a[44:47], a[108:111], v[196:199]
ds_read_b64_tr_b16 a[20:21], v11 offset:40960
v_mfma_f32_16x16x32_bf16 v[196:199], a[40:43], a[104:107], v[196:199]
ds_read_b64_tr_b16 a[22:23], v11 offset:41984
v_mfma_f32_16x16x32_bf16 v[200:203], a[40:43], a[112:115], v[200:203]
ds_read_b64_tr_b16 a[24:25], v12 offset:32768
v_mfma_f32_16x16x32_bf16 v[200:203], a[44:47], a[116:119], v[200:203]
ds_read_b64_tr_b16 a[26:27], v12 offset:33792
v_mfma_f32_16x16x32_bf16 v[204:207], a[44:47], a[124:127], v[204:207]
ds_read_b64_tr_b16 a[28:29], v12 offset:40960
v_mfma_f32_16x16x32_bf16 v[204:207], a[40:43], a[120:123], v[204:207]
ds_read_b64_tr_b16 a[30:31], v12 offset:41984
v_mfma_f32_16x16x32_bf16 v[224:227], a[48:51], a[96:99], v[224:227]
ds_read_b128 a[80:83], v15 offset:12288
v_mfma_f32_16x16x32_bf16 v[224:227], a[52:55], a[100:103], v[224:227]
ds_read_b128 a[84:87], v14 offset:12288
s_mul_i32 s43, s41, 4682
s_lshr_b32 s43, s43, 16
v_mfma_f32_16x16x32_bf16 v[228:231], a[52:55], a[108:111], v[228:231]
ds_read_b128 a[88:91], v15 offset:14336
s_lshl_b32 s41, s41, 3
s_mul_i32 s43, s43, 111
s_sub_u32 s41, s41, s43
v_mfma_f32_16x16x32_bf16 v[228:231], a[48:51], a[104:107], v[228:231]
ds_read_b128 a[92:95], v14 offset:14336
v_writelane_b32 v29, s41, 49
s_add_u32 s41, s42, 4
s_min_u32 s41, s41, 13
v_mfma_f32_16x16x32_bf16 v[232:235], a[48:51], a[112:115], v[232:235]
s_lshl_b32 s41, s41, 3
s_lshr_b32 s43, s32, 1
s_add_u32 s41, s41, s43
v_mfma_f32_16x16x32_bf16 v[232:235], a[52:55], a[116:119], v[232:235]
s_mul_i32 s43, s41, 4682
s_lshr_b32 s43, s43, 16
s_lshl_b32 s41, s41, 3
v_mfma_f32_16x16x32_bf16 v[236:239], a[52:55], a[124:127], v[236:239]
s_mul_i32 s43, s43, 111
s_sub_u32 s41, s41, s43
v_writelane_b32 v29, s41, 50
v_mfma_f32_16x16x32_bf16 v[236:239], a[48:51], a[120:123], v[236:239]
s_add_u32 s41, s32, 112
v_writelane_b32 v29, s41, 51
v_lshlrev_b32 v29, 8, v29
v_mfma_f32_16x16x32_bf16 a[128:131], a[56:59], a[96:99], a[128:131]
s_mov_b32 s45, 82903056
v_and_b32 v21, 7, v0
v_lshlrev_b32 v21, 11, v21
v_mfma_f32_16x16x32_bf16 a[128:131], a[60:63], a[100:103], a[128:131]
v_bfe_u32 v22, v0, 3, 1
v_lshl_add_u32 v21, v22, 15, v21
s_and_b32 s47, s2, 0x47
v_mfma_f32_16x16x32_bf16 a[132:135], a[60:63], a[108:111], a[132:135]
s_lshl_b32 s47, s47, 8
s_add_u32 s47, s47, 82903040
s_mov_b32 s4, s29
v_mfma_f32_16x16x32_bf16 a[132:135], a[56:59], a[104:107], a[132:135]
s_mov_b32 s5, s20
s_mov_b32 s8, s18
s_mov_b32 s9, s17
v_mfma_f32_16x16x32_bf16 a[136:139], a[56:59], a[112:115], a[136:139]
buffer_load_dword v22, v21, s[12:15], s47 offen sc0 sc1
v_mfma_f32_16x16x32_bf16 a[136:139], a[60:63], a[116:119], a[136:139]
v_mfma_f32_16x16x32_bf16 a[140:143], a[60:63], a[124:127], a[140:143]
v_mfma_f32_16x16x32_bf16 a[140:143], a[56:59], a[120:123], a[140:143]
s_waitcnt lgkmcnt(0)
v_mfma_f32_16x16x32_bf16 v[48:51], a[0:3], a[64:67], v[48:51]
ds_read_b64_tr_b16 a[32:33], v9 offset:49152
v_add_u32 v15, 32768, v13
v_mfma_f32_16x16x32_bf16 v[48:51], a[4:7], a[68:71], v[48:51]
ds_read_b64_tr_b16 a[34:35], v9 offset:50176
v_xor_b32 v14, 64, v15
v_mfma_f32_16x16x32_bf16 v[52:55], a[4:7], a[76:79], v[52:55]
ds_read_b64_tr_b16 a[36:37], v9 offset:57344
v_mfma_f32_16x16x32_bf16 v[52:55], a[0:3], a[72:75], v[52:55]
ds_read_b64_tr_b16 a[38:39], v9 offset:58368
v_mfma_f32_16x16x32_bf16 v[56:59], a[0:3], a[80:83], v[56:59]
ds_read_b64_tr_b16 a[40:41], v10 offset:49152
v_cvt_pk_bf16_f32 v32, v32, v33
v_mfma_f32_16x16x32_bf16 v[56:59], a[4:7], a[84:87], v[56:59]
ds_read_b64_tr_b16 a[42:43], v10 offset:50176
v_cvt_pk_bf16_f32 v33, v34, v35
v_mfma_f32_16x16x32_bf16 v[60:63], a[4:7], a[92:95], v[60:63]
ds_read_b64_tr_b16 a[44:45], v10 offset:57344
v_cvt_pk_bf16_f32 v34, v64, v65
v_mfma_f32_16x16x32_bf16 v[60:63], a[0:3], a[88:91], v[60:63]
ds_read_b64_tr_b16 a[46:47], v10 offset:58368
v_cvt_pk_bf16_f32 v35, v66, v67
v_mfma_f32_16x16x32_bf16 v[80:83], a[8:11], a[64:67], v[80:83]
ds_read_b64_tr_b16 a[48:49], v11 offset:49152
v_cvt_pk_bf16_f32 v96, v96, v97
s_add_u32 s30, s29, 0
buffer_store_dwordx4 v[32:35], v16, s[12:15], s30 offen offset:0 sc0 sc1
v_mfma_f32_16x16x32_bf16 v[80:83], a[12:15], a[68:71], v[80:83]
ds_read_b64_tr_b16 a[50:51], v11 offset:50176
v_cvt_pk_bf16_f32 v97, v98, v99
v_mfma_f32_16x16x32_bf16 v[84:87], a[12:15], a[76:79], v[84:87]
ds_read_b64_tr_b16 a[52:53], v11 offset:57344
v_cvt_pk_bf16_f32 v98, v128, v129
v_mfma_f32_16x16x32_bf16 v[84:87], a[8:11], a[72:75], v[84:87]
ds_read_b64_tr_b16 a[54:55], v11 offset:58368
v_cvt_pk_bf16_f32 v99, v130, v131
v_mfma_f32_16x16x32_bf16 v[88:91], a[8:11], a[80:83], v[88:91]
ds_read_b64_tr_b16 a[56:57], v12 offset:49152
v_cvt_pk_bf16_f32 v160, v160, v161
s_add_u32 s30, s29, 0
buffer_store_dwordx4 v[96:99], v16, s[12:15], s30 offen offset:1024 sc0 sc1
v_mfma_f32_16x16x32_bf16 v[88:91], a[12:15], a[84:87], v[88:91]
ds_read_b64_tr_b16 a[58:59], v12 offset:50176
v_cvt_pk_bf16_f32 v161, v162, v163
v_mfma_f32_16x16x32_bf16 v[92:95], a[12:15], a[92:95], v[92:95]
ds_read_b64_tr_b16 a[60:61], v12 offset:57344
v_cvt_pk_bf16_f32 v162, v192, v193
v_mfma_f32_16x16x32_bf16 v[92:95], a[8:11], a[88:91], v[92:95]
ds_read_b64_tr_b16 a[62:63], v12 offset:58368
v_cvt_pk_bf16_f32 v163, v194, v195
v_mfma_f32_16x16x32_bf16 v[112:115], a[16:19], a[64:67], v[112:115]
ds_read_b128 a[96:99], v15 offset:8192
v_accvgpr_read_b32 v64, a128
s_add_u32 s30, s29, 4096
buffer_store_dwordx4 v[160:163], v16, s[12:15], s30 offen offset:0 sc0 sc1
v_mfma_f32_16x16x32_bf16 v[112:115], a[20:23], a[68:71], v[112:115]
ds_read_b128 a[100:103], v14 offset:8192
v_accvgpr_read_b32 v65, a129
v_mfma_f32_16x16x32_bf16 v[116:119], a[20:23], a[76:79], v[116:119]
ds_read_b128 a[104:107], v15 offset:10240
v_accvgpr_read_b32 v66, a130
v_mfma_f32_16x16x32_bf16 v[116:119], a[16:19], a[72:75], v[116:119]
ds_read_b128 a[108:111], v14 offset:10240
v_accvgpr_read_b32 v67, a131
v_mfma_f32_16x16x32_bf16 v[120:123], a[16:19], a[80:83], v[120:123]
v_cvt_pk_bf16_f32 v224, v224, v225
v_cvt_pk_bf16_f32 v225, v226, v227
v_mfma_f32_16x16x32_bf16 v[120:123], a[20:23], a[84:87], v[120:123]
v_cvt_pk_bf16_f32 v226, v64, v65
v_cvt_pk_bf16_f32 v227, v66, v67
v_mfma_f32_16x16x32_bf16 v[124:127], a[20:23], a[92:95], v[124:127]
v_cvt_pk_bf16_f32 v36, v36, v37
v_cvt_pk_bf16_f32 v37, v38, v39
s_add_u32 s30, s29, 4096
buffer_store_dwordx4 v[224:227], v16, s[12:15], s30 offen offset:1024 sc0 sc1
v_mfma_f32_16x16x32_bf16 v[124:127], a[16:19], a[88:91], v[124:127]
v_cvt_pk_bf16_f32 v38, v68, v69
v_cvt_pk_bf16_f32 v39, v70, v71
v_mfma_f32_16x16x32_bf16 v[144:147], a[24:27], a[64:67], v[144:147]
s_add_u32 s30, s29, 8192
buffer_store_dwordx4 v[36:39], v16, s[12:15], s30 offen offset:0 sc0 sc1
v_mfma_f32_16x16x32_bf16 v[144:147], a[28:31], a[68:71], v[144:147]
v_mfma_f32_16x16x32_bf16 v[148:151], a[28:31], a[76:79], v[148:151]
v_mfma_f32_16x16x32_bf16 v[148:151], a[24:27], a[72:75], v[148:151]
v_mfma_f32_16x16x32_bf16 v[152:155], a[24:27], a[80:83], v[152:155]
v_mfma_f32_16x16x32_bf16 v[152:155], a[28:31], a[84:87], v[152:155]
v_mfma_f32_16x16x32_bf16 v[156:159], a[28:31], a[92:95], v[156:159]
v_mfma_f32_16x16x32_bf16 v[156:159], a[24:27], a[88:91], v[156:159]
s_waitcnt lgkmcnt(0)
v_mfma_f32_16x16x32_bf16 v[176:179], a[32:35], a[64:67], v[176:179]
ds_read_b64_tr_b16 a[0:1], v9 offset:0
v_mfma_f32_16x16x32_bf16 v[176:179], a[36:39], a[68:71], v[176:179]
ds_read_b64_tr_b16 a[2:3], v9 offset:1024
v_mfma_f32_16x16x32_bf16 v[180:183], a[36:39], a[76:79], v[180:183]
ds_read_b64_tr_b16 a[4:5], v9 offset:8192
v_cvt_pk_bf16_f32 v100, v100, v101
v_mfma_f32_16x16x32_bf16 v[180:183], a[32:35], a[72:75], v[180:183]
ds_read_b64_tr_b16 a[6:7], v9 offset:9216
v_cvt_pk_bf16_f32 v101, v102, v103
v_mfma_f32_16x16x32_bf16 v[184:187], a[32:35], a[80:83], v[184:187]
ds_read_b64_tr_b16 a[8:9], v10 offset:0
v_cvt_pk_bf16_f32 v102, v132, v133
v_mfma_f32_16x16x32_bf16 v[184:187], a[36:39], a[84:87], v[184:187]
ds_read_b64_tr_b16 a[10:11], v10 offset:1024
v_cvt_pk_bf16_f32 v103, v134, v135
v_mfma_f32_16x16x32_bf16 v[188:191], a[36:39], a[92:95], v[188:191]
ds_read_b64_tr_b16 a[12:13], v10 offset:8192
v_cvt_pk_bf16_f32 v164, v164, v165
s_add_u32 s30, s29, 8192
buffer_store_dwordx4 v[100:103], v16, s[12:15], s30 offen offset:1024 sc0 sc1
v_mfma_f32_16x16x32_bf16 v[188:191], a[32:35], a[88:91], v[188:191]
ds_read_b64_tr_b16 a[14:15], v10 offset:9216
v_cvt_pk_bf16_f32 v165, v166, v167
v_mfma_f32_16x16x32_bf16 v[208:211], a[40:43], a[64:67], v[208:211]
ds_read_b64_tr_b16 a[16:17], v11 offset:0
v_cvt_pk_bf16_f32 v166, v196, v197
v_mfma_f32_16x16x32_bf16 v[208:211], a[44:47], a[68:71], v[208:211]
ds_read_b64_tr_b16 a[18:19], v11 offset:1024
v_cvt_pk_bf16_f32 v167, v198, v199
v_mfma_f32_16x16x32_bf16 v[212:215], a[44:47], a[76:79], v[212:215]
ds_read_b64_tr_b16 a[20:21], v11 offset:8192
v_accvgpr_read_b32 v68, a132
s_add_u32 s30, s29, 12288
buffer_store_dwordx4 v[164:167], v16, s[12:15], s30 offen offset:0 sc0 sc1
v_mfma_f32_16x16x32_bf16 v[212:215], a[40:43], a[72:75], v[212:215]
ds_read_b64_tr_b16 a[22:23], v11 offset:9216
v_accvgpr_read_b32 v69, a133
v_mfma_f32_16x16x32_bf16 v[216:219], a[40:43], a[80:83], v[216:219]
ds_read_b64_tr_b16 a[24:25], v12 offset:0
v_accvgpr_read_b32 v70, a134
v_mfma_f32_16x16x32_bf16 v[216:219], a[44:47], a[84:87], v[216:219]
ds_read_b64_tr_b16 a[26:27], v12 offset:1024
v_accvgpr_read_b32 v71, a135
v_mfma_f32_16x16x32_bf16 v[220:223], a[44:47], a[92:95], v[220:223]
ds_read_b64_tr_b16 a[28:29], v12 offset:8192
v_cvt_pk_bf16_f32 v228, v228, v229
v_mfma_f32_16x16x32_bf16 v[220:223], a[40:43], a[88:91], v[220:223]
ds_read_b64_tr_b16 a[30:31], v12 offset:9216
v_cvt_pk_bf16_f32 v229, v230, v231
v_mfma_f32_16x16x32_bf16 v[240:243], a[48:51], a[64:67], v[240:243]
ds_read_b128 a[112:115], v15 offset:12288
v_cvt_pk_bf16_f32 v230, v68, v69
v_mfma_f32_16x16x32_bf16 v[240:243], a[52:55], a[68:71], v[240:243]
ds_read_b128 a[116:119], v14 offset:12288
v_cvt_pk_bf16_f32 v231, v70, v71
v_mfma_f32_16x16x32_bf16 v[244:247], a[52:55], a[76:79], v[244:247]
ds_read_b128 a[120:123], v15 offset:14336
v_cvt_pk_bf16_f32 v40, v40, v41
s_add_u32 s30, s29, 12288
buffer_store_dwordx4 v[228:231], v16, s[12:15], s30 offen offset:1024 sc0 sc1
v_mfma_f32_16x16x32_bf16 v[244:247], a[48:51], a[72:75], v[244:247]
ds_read_b128 a[124:127], v14 offset:14336
v_cvt_pk_bf16_f32 v41, v42, v43
v_mfma_f32_16x16x32_bf16 v[248:251], a[48:51], a[80:83], v[248:251]
v_cvt_pk_bf16_f32 v42, v72, v73
v_cvt_pk_bf16_f32 v43, v74, v75
v_mfma_f32_16x16x32_bf16 v[248:251], a[52:55], a[84:87], v[248:251]
v_cvt_pk_bf16_f32 v104, v104, v105
v_cvt_pk_bf16_f32 v105, v106, v107
s_add_u32 s30, s29, 16384
buffer_store_dwordx4 v[40:43], v16, s[12:15], s30 offen offset:0 sc0 sc1
v_mfma_f32_16x16x32_bf16 v[252:255], a[52:55], a[92:95], v[252:255]
v_cvt_pk_bf16_f32 v106, v136, v137
v_cvt_pk_bf16_f32 v107, v138, v139
v_mfma_f32_16x16x32_bf16 v[252:255], a[48:51], a[88:91], v[252:255]
v_cvt_pk_bf16_f32 v168, v168, v169
v_cvt_pk_bf16_f32 v169, v170, v171
s_add_u32 s30, s29, 16384
buffer_store_dwordx4 v[104:107], v16, s[12:15], s30 offen offset:1024 sc0 sc1
v_mfma_f32_16x16x32_bf16 a[144:147], a[56:59], a[64:67], a[144:147]
v_cvt_pk_bf16_f32 v170, v200, v201
v_cvt_pk_bf16_f32 v171, v202, v203
v_mfma_f32_16x16x32_bf16 a[144:147], a[60:63], a[68:71], a[144:147]
s_add_u32 s30, s29, 20480
buffer_store_dwordx4 v[168:171], v16, s[12:15], s30 offen offset:0 sc0 sc1
v_mfma_f32_16x16x32_bf16 a[148:151], a[60:63], a[76:79], a[148:151]
v_mfma_f32_16x16x32_bf16 a[148:151], a[56:59], a[72:75], a[148:151]
v_mfma_f32_16x16x32_bf16 a[152:155], a[56:59], a[80:83], a[152:155]
v_mfma_f32_16x16x32_bf16 a[152:155], a[60:63], a[84:87], a[152:155]
v_mfma_f32_16x16x32_bf16 a[156:159], a[60:63], a[92:95], a[156:159]
v_mfma_f32_16x16x32_bf16 a[156:159], a[56:59], a[88:91], a[156:159]
s_waitcnt lgkmcnt(0)
v_mfma_f32_16x16x32_bf16 v[48:51], a[0:3], a[96:99], v[48:51]
ds_read_b64_tr_b16 a[32:33], v9 offset:16384
v_mfma_f32_16x16x32_bf16 v[48:51], a[4:7], a[100:103], v[48:51]
ds_read_b64_tr_b16 a[34:35], v9 offset:17408
v_mfma_f32_16x16x32_bf16 v[52:55], a[4:7], a[108:111], v[52:55]
ds_read_b64_tr_b16 a[36:37], v9 offset:24576
v_accvgpr_read_b32 v72, a136
v_mfma_f32_16x16x32_bf16 v[52:55], a[0:3], a[104:107], v[52:55]
ds_read_b64_tr_b16 a[38:39], v9 offset:25600
v_accvgpr_read_b32 v73, a137
v_mfma_f32_16x16x32_bf16 v[56:59], a[0:3], a[112:115], v[56:59]
ds_read_b64_tr_b16 a[40:41], v10 offset:16384
v_accvgpr_read_b32 v74, a138
v_mfma_f32_16x16x32_bf16 v[56:59], a[4:7], a[116:119], v[56:59]
ds_read_b64_tr_b16 a[42:43], v10 offset:17408
v_accvgpr_read_b32 v75, a139
v_mfma_f32_16x16x32_bf16 v[60:63], a[4:7], a[124:127], v[60:63]
ds_read_b64_tr_b16 a[44:45], v10 offset:24576
v_cvt_pk_bf16_f32 v232, v232, v233
v_mfma_f32_16x16x32_bf16 v[60:63], a[0:3], a[120:123], v[60:63]
ds_read_b64_tr_b16 a[46:47], v10 offset:25600
v_cvt_pk_bf16_f32 v233, v234, v235
v_mfma_f32_16x16x32_bf16 v[80:83], a[8:11], a[96:99], v[80:83]
ds_read_b64_tr_b16 a[48:49], v11 offset:16384
v_cvt_pk_bf16_f32 v234, v72, v73
v_mfma_f32_16x16x32_bf16 v[80:83], a[12:15], a[100:103], v[80:83]
ds_read_b64_tr_b16 a[50:51], v11 offset:17408
v_cvt_pk_bf16_f32 v235, v74, v75
v_mfma_f32_16x16x32_bf16 v[84:87], a[12:15], a[108:111], v[84:87]
ds_read_b64_tr_b16 a[52:53], v11 offset:24576
v_cvt_pk_bf16_f32 v44, v44, v45
s_add_u32 s30, s29, 20480
buffer_store_dwordx4 v[232:235], v16, s[12:15], s30 offen offset:1024 sc0 sc1
v_mfma_f32_16x16x32_bf16 v[84:87], a[8:11], a[104:107], v[84:87]
ds_read_b64_tr_b16 a[54:55], v11 offset:25600
v_cvt_pk_bf16_f32 v45, v46, v47
v_mfma_f32_16x16x32_bf16 v[88:91], a[8:11], a[112:115], v[88:91]
ds_read_b64_tr_b16 a[56:57], v12 offset:16384
v_cvt_pk_bf16_f32 v46, v76, v77
v_mfma_f32_16x16x32_bf16 v[88:91], a[12:15], a[116:119], v[88:91]
ds_read_b64_tr_b16 a[58:59], v12 offset:17408
v_cvt_pk_bf16_f32 v47, v78, v79
v_mfma_f32_16x16x32_bf16 v[92:95], a[12:15], a[124:127], v[92:95]
ds_read_b64_tr_b16 a[60:61], v12 offset:24576
v_cvt_pk_bf16_f32 v108, v108, v109
s_add_u32 s30, s29, 24576
buffer_store_dwordx4 v[44:47], v16, s[12:15], s30 offen offset:0 sc0 sc1
v_mfma_f32_16x16x32_bf16 v[92:95], a[8:11], a[120:123], v[92:95]
ds_read_b64_tr_b16 a[62:63], v12 offset:25600
v_cvt_pk_bf16_f32 v109, v110, v111
v_mfma_f32_16x16x32_bf16 v[112:115], a[16:19], a[96:99], v[112:115]
v_cvt_pk_bf16_f32 v110, v140, v141
v_mfma_f32_16x16x32_bf16 v[112:115], a[20:23], a[100:103], v[112:115]
v_cvt_pk_bf16_f32 v111, v142, v143
v_mfma_f32_16x16x32_bf16 v[116:119], a[20:23], a[108:111], v[116:119]
v_cvt_pk_bf16_f32 v172, v172, v173
s_add_u32 s30, s29, 24576
buffer_store_dwordx4 v[108:111], v16, s[12:15], s30 offen offset:1024 sc0 sc1
v_mfma_f32_16x16x32_bf16 v[116:119], a[16:19], a[104:107], v[116:119]
v_cvt_pk_bf16_f32 v173, v174, v175
v_mfma_f32_16x16x32_bf16 v[120:123], a[16:19], a[112:115], v[120:123]
v_cvt_pk_bf16_f32 v174, v204, v205
v_cvt_pk_bf16_f32 v175, v206, v207
v_mfma_f32_16x16x32_bf16 v[120:123], a[20:23], a[116:119], v[120:123]
v_accvgpr_read_b32 v76, a140
v_accvgpr_read_b32 v77, a141
s_add_u32 s30, s29, 28672
buffer_store_dwordx4 v[172:175], v16, s[12:15], s30 offen offset:0 sc0 sc1
v_mfma_f32_16x16x32_bf16 v[124:127], a[20:23], a[124:127], v[124:127]
v_accvgpr_read_b32 v78, a142
v_accvgpr_read_b32 v79, a143
v_mfma_f32_16x16x32_bf16 v[124:127], a[16:19], a[120:123], v[124:127]
v_cvt_pk_bf16_f32 v236, v236, v237
v_cvt_pk_bf16_f32 v237, v238, v239
v_mfma_f32_16x16x32_bf16 v[144:147], a[24:27], a[96:99], v[144:147]
v_cvt_pk_bf16_f32 v238, v76, v77
v_cvt_pk_bf16_f32 v239, v78, v79
v_mfma_f32_16x16x32_bf16 v[144:147], a[28:31], a[100:103], v[144:147]
s_add_u32 s30, s29, 28672
buffer_store_dwordx4 v[236:239], v16, s[12:15], s30 offen offset:1024 sc0 sc1
v_mfma_f32_16x16x32_bf16 v[148:151], a[28:31], a[108:111], v[148:151]
v_mfma_f32_16x16x32_bf16 v[148:151], a[24:27], a[104:107], v[148:151]
v_mfma_f32_16x16x32_bf16 v[152:155], a[24:27], a[112:115], v[152:155]
v_mfma_f32_16x16x32_bf16 v[152:155], a[28:31], a[116:119], v[152:155]
v_mfma_f32_16x16x32_bf16 v[156:159], a[28:31], a[124:127], v[156:159]
s_waitcnt lgkmcnt(0)
v_mfma_f32_16x16x32_bf16 v[156:159], a[24:27], a[120:123], v[156:159]
s_barrier
v_mfma_f32_16x16x32_bf16 v[176:179], a[32:35], a[96:99], v[176:179]
v_lshlrev_b32 v1, 4, v0
s_lshl_b32 s17, s16, 13
v_mfma_f32_16x16x32_bf16 v[176:179], a[36:39], a[100:103], v[176:179]
s_and_b32 s29, s2, 7
s_lshr_b32 s30, s2, 3
v_mfma_f32_16x16x32_bf16 v[180:183], a[36:39], a[108:111], v[180:183]
s_lshl_b32 s65, s29, 1
s_bfe_u32 s29, s30, 0x10003
v_mfma_f32_16x16x32_bf16 v[180:183], a[32:35], a[104:107], v[180:183]
s_add_u32 s65, s65, s29
s_lshr_b32 s25, s30, 4
v_mfma_f32_16x16x32_bf16 v[184:187], a[32:35], a[112:115], v[184:187]
s_and_b32 s66, s30, 7
s_sub_u32 s67, 15, s66
v_mfma_f32_16x16x32_bf16 v[184:187], a[36:39], a[116:119], v[184:187]
s_lshl_b32 s31, s66, 1
s_sub_u32 s31, 15, s31
v_mfma_f32_16x16x32_bf16 v[188:191], a[36:39], a[124:127], v[188:191]
s_lshl_b32 s29, s65, 20
s_lshl_b32 s30, s67, 16
v_mfma_f32_16x16x32_bf16 v[188:191], a[32:35], a[120:123], v[188:191]
s_add_u32 s26, s29, s30
s_add_u32 s29, s29, s17
v_mfma_f32_16x16x32_bf16 v[208:211], a[40:43], a[96:99], v[208:211]
s_sub_u32 s69, 16, s31
s_mov_b32 s10, 28672
v_mfma_f32_16x16x32_bf16 v[208:211], a[44:47], a[100:103], v[208:211]
s_cmp_eq_u32 s25, 0
s_cselect_b32 s30, 32768, 0
v_mfma_f32_16x16x32_bf16 v[212:215], a[44:47], a[108:111], v[212:215]
s_cselect_b32 s23, 0x7fff, s31
s_cselect_b32 s69, s69, s31
v_mfma_f32_16x16x32_bf16 v[212:215], a[40:43], a[104:107], v[212:215]
s_cselect_b32 s10, 4294930432, s10
s_mov_b32 s11, s10
v_mfma_f32_16x16x32_bf16 v[216:219], a[40:43], a[112:115], v[216:219]
s_lshl_b32 s31, s30, 4
s_add_u32 s29, s29, s31
v_mfma_f32_16x16x32_bf16 v[216:219], a[44:47], a[116:119], v[216:219]
s_add_u32 s72, s29, 16777216
s_add_u32 s73, s29, 33554432
v_mfma_f32_16x16x32_bf16 v[220:223], a[44:47], a[124:127], v[220:223]
s_sub_u32 s20, s72, s30
s_sub_u32 s21, s73, s30
v_mfma_f32_16x16x32_bf16 v[220:223], a[40:43], a[120:123], v[220:223]
s_mov_b32 s60, s56
s_mov_b32 s61, s57
v_mfma_f32_16x16x32_bf16 v[240:243], a[48:51], a[96:99], v[240:243]
s_mov_b32 s62, 256
s_mov_b32 s63, 0x20000
v_mfma_f32_16x16x32_bf16 v[240:243], a[52:55], a[100:103], v[240:243]
s_or_b32 s71, s2, 128
s_lshl_b32 s71, s71, 8
v_mfma_f32_16x16x32_bf16 v[244:247], a[52:55], a[108:111], v[244:247]
s_add_u32 s71, s71, 82903040
v_and_b32 v4, 15, v0
v_mfma_f32_16x16x32_bf16 v[244:247], a[48:51], a[104:107], v[244:247]
v_lshrrev_b32 v14, 4, v0
v_lshlrev_b32 v14, 2, v14
v_mfma_f32_16x16x32_bf16 v[248:251], a[48:51], a[112:115], v[248:251]
v_sub_u32 v4, v4, v14
s_mov_b32 s27, 0x3db8aa3b
v_mfma_f32_16x16x32_bf16 v[248:251], a[52:55], a[116:119], v[248:251]
s_mov_b32 s28, 1149239296
s_lshl_b32 s29, s65, 3
v_mfma_f32_16x16x32_bf16 v[252:255], a[52:55], a[124:127], v[252:255]
s_add_u32 s29, s29, s66
s_mul_i32 s70, s29, 69632
v_mfma_f32_16x16x32_bf16 v[252:255], a[48:51], a[120:123], v[252:255]
s_mul_i32 s30, s16, 17408
s_add_u32 s70, s70, s30
v_mfma_f32_16x16x32_bf16 a[144:147], a[56:59], a[96:99], a[144:147]
s_add_u32 s70, s70, 83886080
s_sub_u32 s83, s23, 1
v_mfma_f32_16x16x32_bf16 a[144:147], a[60:63], a[100:103], a[144:147]
s_lshl_b32 s24, 3, s83
s_cmp_eq_u32 s25, 0
v_mfma_f32_16x16x32_bf16 a[148:151], a[60:63], a[108:111], a[148:151]
s_cselect_b32 s24, 0, s24
s_cselect_b32 s68, 340, s24
v_mfma_f32_16x16x32_bf16 a[148:151], a[56:59], a[104:107], a[148:151]
s_or_b32 s68, s68, 20480
v_mov_b32 v8, 0
v_mfma_f32_16x16x32_bf16 a[152:155], a[56:59], a[112:115], a[152:155]
v_mov_b32 v9, 0
s_mov_b32 s22, 0
v_mfma_f32_16x16x32_bf16 a[152:155], a[60:63], a[116:119], a[152:155]
v_add_u32 v3, 131072, v1
v_add_u32 v2, 0, v1
v_mfma_f32_16x16x32_bf16 a[156:159], a[60:63], a[124:127], a[156:159]
s_waitcnt vmcnt(16)
v_mfma_f32_16x16x32_bf16 a[156:159], a[56:59], a[120:123], a[156:159]
s_mov_b32 s31, 256
v_cmp_gt_u32 vcc, s31, v30
v_mov_b32 v5, 0
s_nop 3
s_cbranch_vccnz L_kv7_s
v_cmp_ne_u32 vcc, 1, v22
s_nop 4
s_cbranch_vccz L_kv7_ok
s_branch L_kv7_p
L_kv7_s:
s_mov_b32 s30, 0
L_poll8:
buffer_load_dword v14, v5, s[60:63], 0 offen sc0 sc1
s_waitcnt vmcnt(0)
v_cmp_gt_u32 vcc, s31, v14
s_nop 4
s_cbranch_vccnz L_poll8_r
s_branch L_poll8_ok
L_poll8_r:
s_add_u32 s30, s30, 1
s_cmp_lt_u32 s30, 32768
s_sleep 32
s_cbranch_scc1 L_poll8
L_poll8_ok:
L_kv7_p:
s_mov_b32 s30, 0
L_poll9:
buffer_load_dword v22, v21, s[12:15], s47 offen sc0 sc1
s_waitcnt vmcnt(0)
v_cmp_ne_u32 vcc, 1, v22
s_nop 4
s_cbranch_vccnz L_poll9_r
s_branch L_poll9_ok
L_poll9_r:
s_add_u32 s30, s30, 1
s_cmp_lt_u32 s30, 32768
s_sleep 4
s_cbranch_scc1 L_poll9
L_poll9_ok:
L_kv7_ok:
s_lshl_b32 s6, s8, 15
s_lshl_b32 s7, s9, 11
s_add_u32 s6, s6, s7
s_add_u32 s6, s6, 65536
v_add_u32 v23, s6, v1
s_mov_b32 s4, 0x40000000
s_mov_b32 s5, 0x40000000
v_add_u32 v24, s17, v1
v_subrev_u32 v25, s17, v1
v_add_u32 v24, 65536, v24
v_add_u32 v25, 122880, v25
s_add_u32 m0, s17, 131072
s_nop 0
buffer_load_dwordx4 v1, s[12:15], s20 offen offset:0 lds
v_cvt_pk_bf16_f32 v48, v48, v49
v_cvt_pk_bf16_f32 v49, v50, v51
v_cvt_pk_bf16_f32 v50, v80, v81
v_cvt_pk_bf16_f32 v51, v82, v83
ds_write_b128 v23, v[48:51] offset:0
buffer_load_dwordx4 v1, s[12:15], s20 offen offset:1024 lds
v_cvt_pk_bf16_f32 v112, v112, v113
v_cvt_pk_bf16_f32 v113, v114, v115
v_cvt_pk_bf16_f32 v114, v144, v145
v_cvt_pk_bf16_f32 v115, v146, v147
ds_write_b128 v23, v[112:115] offset:1024
buffer_load_dwordx4 v1, s[12:15], s20 offen offset:2048 lds
v_cvt_pk_bf16_f32 v176, v176, v177
v_cvt_pk_bf16_f32 v177, v178, v179
v_cvt_pk_bf16_f32 v178, v208, v209
v_cvt_pk_bf16_f32 v179, v210, v211
ds_write_b128 v23, v[176:179] offset:4096
buffer_load_dwordx4 v1, s[12:15], s20 offen offset:3072 lds
s_add_u32 s20, s20, 4096
s_add_u32 m0, s17, 135168
s_nop 0
v_accvgpr_read_b32 v80, a144
v_accvgpr_read_b32 v81, a145
v_accvgpr_read_b32 v82, a146
v_accvgpr_read_b32 v83, a147
v_cvt_pk_bf16_f32 v240, v240, v241
v_cvt_pk_bf16_f32 v241, v242, v243
v_cvt_pk_bf16_f32 v242, v80, v81
v_cvt_pk_bf16_f32 v243, v82, v83
ds_write_b128 v23, v[240:243] offset:5120
buffer_load_dwordx4 v1, s[12:15], s20 offen offset:0 lds
v_cvt_pk_bf16_f32 v52, v52, v53
v_cvt_pk_bf16_f32 v53, v54, v55
v_cvt_pk_bf16_f32 v54, v84, v85
v_cvt_pk_bf16_f32 v55, v86, v87
ds_write_b128 v23, v[52:55] offset:8192
buffer_load_dwordx4 v1, s[12:15], s20 offen offset:1024 lds
v_cvt_pk_bf16_f32 v116, v116, v117
v_cvt_pk_bf16_f32 v117, v118, v119
v_cvt_pk_bf16_f32 v118, v148, v149
v_cvt_pk_bf16_f32 v119, v150, v151
ds_write_b128 v23, v[116:119] offset:9216
buffer_load_dwordx4 v1, s[12:15], s20 offen offset:2048 lds
v_cvt_pk_bf16_f32 v180, v180, v181
v_cvt_pk_bf16_f32 v181, v182, v183
v_cvt_pk_bf16_f32 v182, v212, v213
v_cvt_pk_bf16_f32 v183, v214, v215
ds_write_b128 v23, v[180:183] offset:12288
buffer_load_dwordx4 v1, s[12:15], s20 offen offset:3072 lds
s_add_u32 s20, s20, s10
s_cmp_eq_u32 s69, 1
s_cselect_b32 s20, s72, s20
s_cselect_b32 s10, 28672, s10
s_add_u32 m0, s17, 0
s_nop 0
v_accvgpr_read_b32 v84, a148
v_accvgpr_read_b32 v85, a149
v_accvgpr_read_b32 v86, a150
v_accvgpr_read_b32 v87, a151
v_cvt_pk_bf16_f32 v244, v244, v245
v_cvt_pk_bf16_f32 v245, v246, v247
v_cvt_pk_bf16_f32 v246, v84, v85
v_cvt_pk_bf16_f32 v247, v86, v87
ds_write_b128 v23, v[244:247] offset:13312
buffer_load_dwordx4 v1, s[12:15], s20 offen offset:0 lds
v_cvt_pk_bf16_f32 v56, v56, v57
v_cvt_pk_bf16_f32 v57, v58, v59
v_cvt_pk_bf16_f32 v58, v88, v89
v_cvt_pk_bf16_f32 v59, v90, v91
ds_write_b128 v23, v[56:59] offset:16384
buffer_load_dwordx4 v1, s[12:15], s20 offen offset:1024 lds
v_cvt_pk_bf16_f32 v120, v120, v121
v_cvt_pk_bf16_f32 v121, v122, v123
v_cvt_pk_bf16_f32 v122, v152, v153
v_cvt_pk_bf16_f32 v123, v154, v155
ds_write_b128 v23, v[120:123] offset:17408
buffer_load_dwordx4 v1, s[12:15], s20 offen offset:2048 lds
v_cvt_pk_bf16_f32 v184, v184, v185
v_cvt_pk_bf16_f32 v185, v186, v187
v_cvt_pk_bf16_f32 v186, v216, v217
v_cvt_pk_bf16_f32 v187, v218, v219
ds_write_b128 v23, v[184:187] offset:20480
buffer_load_dwordx4 v1, s[12:15], s20 offen offset:3072 lds
s_add_u32 s20, s20, 4096
s_add_u32 m0, s17, 4096
s_nop 0
v_accvgpr_read_b32 v88, a152
v_accvgpr_read_b32 v89, a153
v_accvgpr_read_b32 v90, a154
v_accvgpr_read_b32 v91, a155
v_cvt_pk_bf16_f32 v248, v248, v249
v_cvt_pk_bf16_f32 v249, v250, v251
v_cvt_pk_bf16_f32 v250, v88, v89
v_cvt_pk_bf16_f32 v251, v90, v91
ds_write_b128 v23, v[248:251] offset:21504
buffer_load_dwordx4 v1, s[12:15], s20 offen offset:0 lds
v_cvt_pk_bf16_f32 v60, v60, v61
v_cvt_pk_bf16_f32 v61, v62, v63
v_cvt_pk_bf16_f32 v62, v92, v93
v_cvt_pk_bf16_f32 v63, v94, v95
ds_write_b128 v23, v[60:63] offset:24576
buffer_load_dwordx4 v1, s[12:15], s20 offen offset:1024 lds
v_cvt_pk_bf16_f32 v124, v124, v125
v_cvt_pk_bf16_f32 v125, v126, v127
v_cvt_pk_bf16_f32 v126, v156, v157
v_cvt_pk_bf16_f32 v127, v158, v159
ds_write_b128 v23, v[124:127] offset:25600
buffer_load_dwordx4 v1, s[12:15], s20 offen offset:2048 lds
v_cvt_pk_bf16_f32 v188, v188, v189
v_cvt_pk_bf16_f32 v189, v190, v191
v_cvt_pk_bf16_f32 v190, v220, v221
v_cvt_pk_bf16_f32 v191, v222, v223
ds_write_b128 v23, v[188:191] offset:28672
buffer_load_dwordx4 v1, s[12:15], s20 offen offset:3072 lds
s_add_u32 s20, s20, s10
s_add_u32 m0, s17, 32768
s_nop 0
v_accvgpr_read_b32 v92, a156
v_accvgpr_read_b32 v93, a157
v_accvgpr_read_b32 v94, a158
v_accvgpr_read_b32 v95, a159
v_cvt_pk_bf16_f32 v252, v252, v253
v_cvt_pk_bf16_f32 v253, v254, v255
v_cvt_pk_bf16_f32 v254, v92, v93
v_cvt_pk_bf16_f32 v255, v94, v95
ds_write_b128 v23, v[252:255] offset:29696
s_waitcnt vmcnt(16) lgkmcnt(0)
s_barrier
s_cmp_eq_u32 s16, 0
s_cbranch_scc0 L_sig10
s_lshl_b32 s29, s2, 8
s_add_u32 s29, s29, 82903044
v_mov_b32 v14, 1
v_mov_b32 v15, 0
s_mov_b64 exec, 1
buffer_store_dword v14, v15, s[12:15], s29 offen sc0 sc1
s_mov_b64 exec, -1
L_sig10:
ds_read_b128 a[128:131], v24 offset:0
ds_read_b128 a[132:135], v24 offset:1024
ds_read_b128 a[136:139], v24 offset:2048
ds_read_b128 a[140:143], v24 offset:3072
ds_read_b128 a[144:147], v24 offset:4096
ds_read_b128 a[148:151], v24 offset:5120
ds_read_b128 a[152:155], v24 offset:6144
ds_read_b128 a[156:159], v24 offset:7168
ds_read_b128 a[160:163], v25 offset:0
ds_read_b128 a[164:167], v25 offset:1024
ds_read_b128 a[168:171], v25 offset:2048
ds_read_b128 a[172:175], v25 offset:3072
ds_read_b128 a[176:179], v25 offset:4096
ds_read_b128 a[180:183], v25 offset:5120
ds_read_b128 a[184:187], v25 offset:6144
ds_read_b128 a[188:191], v25 offset:7168
buffer_load_dwordx4 v1, s[12:15], s21 offen offset:0 lds
buffer_load_dwordx4 v1, s[12:15], s21 offen offset:1024 lds
buffer_load_dwordx4 v1, s[12:15], s21 offen offset:2048 lds
buffer_load_dwordx4 v1, s[12:15], s21 offen offset:3072 lds
s_add_u32 s21, s21, 4096
s_add_u32 m0, s17, 36864
s_nop 0
buffer_load_dwordx4 v1, s[12:15], s21 offen offset:0 lds
buffer_load_dwordx4 v1, s[12:15], s21 offen offset:1024 lds
buffer_load_dwordx4 v1, s[12:15], s21 offen offset:2048 lds
buffer_load_dwordx4 v1, s[12:15], s21 offen offset:3072 lds
s_add_u32 s21, s21, s11
s_add_u32 s30, s26, s17
s_sub_u32 s29, s26, s17
s_add_u32 s29, s29, 57344
buffer_load_dwordx4 a[0:3], v1, s[12:15], s30 offen offset:0
buffer_load_dwordx4 a[32:35], v1, s[12:15], s29 offen offset:0
buffer_load_dwordx4 a[4:7], v1, s[12:15], s30 offen offset:1024
buffer_load_dwordx4 a[36:39], v1, s[12:15], s29 offen offset:1024
buffer_load_dwordx4 a[8:11], v1, s[12:15], s30 offen offset:2048
buffer_load_dwordx4 a[40:43], v1, s[12:15], s29 offen offset:2048
buffer_load_dwordx4 a[12:15], v1, s[12:15], s30 offen offset:3072
buffer_load_dwordx4 a[44:47], v1, s[12:15], s29 offen offset:3072
s_add_u32 s30, s30, 4096
s_add_u32 s29, s29, 4096
buffer_load_dwordx4 a[16:19], v1, s[12:15], s30 offen offset:0
buffer_load_dwordx4 a[48:51], v1, s[12:15], s29 offen offset:0
buffer_load_dwordx4 a[20:23], v1, s[12:15], s30 offen offset:1024
buffer_load_dwordx4 a[52:55], v1, s[12:15], s29 offen offset:1024
buffer_load_dwordx4 a[24:27], v1, s[12:15], s30 offen offset:2048
buffer_load_dwordx4 a[56:59], v1, s[12:15], s29 offen offset:2048
buffer_load_dwordx4 a[28:31], v1, s[12:15], s30 offen offset:3072
buffer_load_dwordx4 a[60:63], v1, s[12:15], s29 offen offset:3072
L_f_p0:
s_waitcnt vmcnt(16) lgkmcnt(0)
s_barrier
ds_read_b128 a[64:67], v3 offset:0
ds_read_b128 a[68:71], v3 offset:8192
ds_read_b128 a[72:75], v3 offset:16384
ds_read_b128 a[76:79], v3 offset:24576
ds_read_b128 a[80:83], v3 offset:1024
ds_read_b128 a[84:87], v3 offset:9216
ds_read_b128 a[88:91], v3 offset:17408
ds_read_b128 a[92:95], v3 offset:25600
s_waitcnt lgkmcnt(4)
s_waitcnt vmcnt(14)
v_mfma_f32_16x16x32_bf16 v[32:35], a[64:67], a[0:3], 0
ds_read_b128 a[96:99], v3 offset:2048
v_mov_b64 v[128:129], 0
v_mfma_f32_16x16x32_bf16 v[36:39], a[64:67], a[32:35], 0
s_add_u32 m0, s17, 65536
s_nop 0
buffer_load_dwordx4 v1, s[12:15], s20 offen offset:0 lds
v_mov_b64 v[130:131], 0
v_mfma_f32_16x16x32_bf16 v[40:43], a[68:71], a[0:3], 0
ds_read_b128 a[100:103], v3 offset:10240
v_mov_b64 v[132:133], 0
v_mfma_f32_16x16x32_bf16 v[44:47], a[68:71], a[32:35], 0
buffer_load_dwordx4 v1, s[12:15], s20 offen offset:1024 lds
v_mov_b64 v[134:135], 0
v_mfma_f32_16x16x32_bf16 v[48:51], a[72:75], a[0:3], 0
ds_read_b128 a[104:107], v3 offset:18432
v_mov_b64 v[136:137], 0
v_mfma_f32_16x16x32_bf16 v[52:55], a[72:75], a[32:35], 0
buffer_load_dwordx4 v1, s[12:15], s20 offen offset:2048 lds
v_mov_b64 v[138:139], 0
v_mfma_f32_16x16x32_bf16 v[56:59], a[76:79], a[0:3], 0
ds_read_b128 a[108:111], v3 offset:26624
v_mov_b64 v[140:141], 0
v_mfma_f32_16x16x32_bf16 v[60:63], a[76:79], a[32:35], 0
buffer_load_dwordx4 v1, s[12:15], s20 offen offset:3072 lds
s_add_u32 s20, s20, 4096
s_add_u32 m0, s17, 69632
v_mov_b64 v[142:143], 0
s_waitcnt lgkmcnt(4)
s_waitcnt vmcnt(16)
v_mfma_f32_16x16x32_bf16 v[32:35], a[80:83], a[4:7], v[32:35]
ds_read_b128 a[112:115], v3 offset:3072
v_mov_b64 v[144:145], 0
v_mfma_f32_16x16x32_bf16 v[36:39], a[80:83], a[36:39], v[36:39]
buffer_load_dwordx4 v1, s[12:15], s20 offen offset:0 lds
v_mov_b64 v[146:147], 0
v_mfma_f32_16x16x32_bf16 v[40:43], a[84:87], a[4:7], v[40:43]
ds_read_b128 a[116:119], v3 offset:11264
v_mov_b64 v[148:149], 0
v_mfma_f32_16x16x32_bf16 v[44:47], a[84:87], a[36:39], v[44:47]
buffer_load_dwordx4 v1, s[12:15], s20 offen offset:1024 lds
v_mov_b64 v[150:151], 0
v_mfma_f32_16x16x32_bf16 v[48:51], a[88:91], a[4:7], v[48:51]
ds_read_b128 a[120:123], v3 offset:19456
v_mov_b64 v[152:153], 0
v_mfma_f32_16x16x32_bf16 v[52:55], a[88:91], a[36:39], v[52:55]
buffer_load_dwordx4 v1, s[12:15], s20 offen offset:2048 lds
v_mov_b64 v[154:155], 0
v_mfma_f32_16x16x32_bf16 v[56:59], a[92:95], a[4:7], v[56:59]
ds_read_b128 a[124:127], v3 offset:27648
v_mov_b64 v[156:157], 0
v_mfma_f32_16x16x32_bf16 v[60:63], a[92:95], a[36:39], v[60:63]
buffer_load_dwordx4 v1, s[12:15], s20 offen offset:3072 lds
s_add_u32 s20, s20, s10
s_cmp_eq_u32 s69, 1
s_cselect_b32 s21, s73, s21
s_cselect_b32 s11, 28672, s11
s_add_u32 m0, s17, 98304
v_mov_b64 v[158:159], 0
s_waitcnt lgkmcnt(4)
s_waitcnt vmcnt(18)
v_mfma_f32_16x16x32_bf16 v[32:35], a[96:99], a[8:11], v[32:35]
ds_read_b128 a[64:67], v3 offset:4096
v_mov_b64 v[160:161], 0
v_mfma_f32_16x16x32_bf16 v[36:39], a[96:99], a[40:43], v[36:39]
buffer_load_dwordx4 v1, s[12:15], s21 offen offset:0 lds
v_mov_b64 v[162:163], 0
v_mfma_f32_16x16x32_bf16 v[40:43], a[100:103], a[8:11], v[40:43]
ds_read_b128 a[68:71], v3 offset:12288
v_mov_b64 v[164:165], 0
v_mfma_f32_16x16x32_bf16 v[44:47], a[100:103], a[40:43], v[44:47]
buffer_load_dwordx4 v1, s[12:15], s21 offen offset:1024 lds
v_mov_b64 v[166:167], 0
v_mfma_f32_16x16x32_bf16 v[48:51], a[104:107], a[8:11], v[48:51]
ds_read_b128 a[72:75], v3 offset:20480
v_mov_b64 v[168:169], 0
v_mfma_f32_16x16x32_bf16 v[52:55], a[104:107], a[40:43], v[52:55]
buffer_load_dwordx4 v1, s[12:15], s21 offen offset:2048 lds
v_mov_b64 v[170:171], 0
v_mfma_f32_16x16x32_bf16 v[56:59], a[108:111], a[8:11], v[56:59]
ds_read_b128 a[76:79], v3 offset:28672
v_mov_b64 v[172:173], 0
v_mfma_f32_16x16x32_bf16 v[60:63], a[108:111], a[40:43], v[60:63]
buffer_load_dwordx4 v1, s[12:15], s21 offen offset:3072 lds
s_add_u32 s21, s21, 4096
s_add_u32 m0, s17, 102400
v_mov_b64 v[174:175], 0
s_waitcnt lgkmcnt(4)
s_waitcnt vmcnt(20)
v_mfma_f32_16x16x32_bf16 v[32:35], a[112:115], a[12:15], v[32:35]
ds_read_b128 a[80:83], v3 offset:5120
v_mov_b64 v[176:177], 0
v_mfma_f32_16x16x32_bf16 v[36:39], a[112:115], a[44:47], v[36:39]
buffer_load_dwordx4 v1, s[12:15], s21 offen offset:0 lds
v_mov_b64 v[178:179], 0
v_mfma_f32_16x16x32_bf16 v[40:43], a[116:119], a[12:15], v[40:43]
ds_read_b128 a[84:87], v3 offset:13312
v_mov_b64 v[180:181], 0
v_mfma_f32_16x16x32_bf16 v[44:47], a[116:119], a[44:47], v[44:47]
buffer_load_dwordx4 v1, s[12:15], s21 offen offset:1024 lds
v_mov_b64 v[182:183], 0
v_mfma_f32_16x16x32_bf16 v[48:51], a[120:123], a[12:15], v[48:51]
ds_read_b128 a[88:91], v3 offset:21504
v_mov_b64 v[184:185], 0
v_mfma_f32_16x16x32_bf16 v[52:55], a[120:123], a[44:47], v[52:55]
buffer_load_dwordx4 v1, s[12:15], s21 offen offset:2048 lds
v_mov_b64 v[186:187], 0
v_mfma_f32_16x16x32_bf16 v[56:59], a[124:127], a[12:15], v[56:59]
ds_read_b128 a[92:95], v3 offset:29696
v_mov_b64 v[188:189], 0
v_mfma_f32_16x16x32_bf16 v[60:63], a[124:127], a[44:47], v[60:63]
buffer_load_dwordx4 v1, s[12:15], s21 offen offset:3072 lds
s_add_u32 s21, s21, s11
s_cmp_eq_u32 s69, 3
s_cselect_b32 s20, s72, s20
s_cselect_b32 s10, 28672, s10
v_mov_b64 v[190:191], 0
s_waitcnt lgkmcnt(4)
s_waitcnt vmcnt(22)
v_mfma_f32_16x16x32_bf16 v[32:35], a[64:67], a[16:19], v[32:35]
ds_read_b128 a[96:99], v3 offset:6144
v_mov_b64 v[192:193], 0
v_mfma_f32_16x16x32_bf16 v[36:39], a[64:67], a[48:51], v[36:39]
v_mov_b64 v[194:195], 0
v_mfma_f32_16x16x32_bf16 v[40:43], a[68:71], a[16:19], v[40:43]
ds_read_b128 a[100:103], v3 offset:14336
v_mov_b64 v[196:197], 0
v_mfma_f32_16x16x32_bf16 v[44:47], a[68:71], a[48:51], v[44:47]
v_mov_b64 v[198:199], 0
v_mfma_f32_16x16x32_bf16 v[48:51], a[72:75], a[16:19], v[48:51]
ds_read_b128 a[104:107], v3 offset:22528
v_mov_b64 v[200:201], 0
v_mfma_f32_16x16x32_bf16 v[52:55], a[72:75], a[48:51], v[52:55]
v_mov_b64 v[202:203], 0
v_mfma_f32_16x16x32_bf16 v[56:59], a[76:79], a[16:19], v[56:59]
ds_read_b128 a[108:111], v3 offset:30720
v_mov_b64 v[204:205], 0
v_mfma_f32_16x16x32_bf16 v[60:63], a[76:79], a[48:51], v[60:63]
v_mov_b64 v[206:207], 0
s_waitcnt lgkmcnt(4)
s_waitcnt vmcnt(20)
v_mfma_f32_16x16x32_bf16 v[32:35], a[80:83], a[20:23], v[32:35]
ds_read_b128 a[112:115], v3 offset:7168
v_mov_b64 v[208:209], 0
v_mfma_f32_16x16x32_bf16 v[36:39], a[80:83], a[52:55], v[36:39]
v_mov_b64 v[210:211], 0
v_mfma_f32_16x16x32_bf16 v[40:43], a[84:87], a[20:23], v[40:43]
ds_read_b128 a[116:119], v3 offset:15360
v_mov_b64 v[212:213], 0
v_mfma_f32_16x16x32_bf16 v[44:47], a[84:87], a[52:55], v[44:47]
v_mov_b64 v[214:215], 0
v_mfma_f32_16x16x32_bf16 v[48:51], a[88:91], a[20:23], v[48:51]
ds_read_b128 a[120:123], v3 offset:23552
v_mov_b64 v[216:217], 0
v_mfma_f32_16x16x32_bf16 v[52:55], a[88:91], a[52:55], v[52:55]
v_mov_b64 v[218:219], 0
v_mfma_f32_16x16x32_bf16 v[56:59], a[92:95], a[20:23], v[56:59]
ds_read_b128 a[124:127], v3 offset:31744
v_mov_b64 v[220:221], 0
v_mfma_f32_16x16x32_bf16 v[60:63], a[92:95], a[52:55], v[60:63]
v_mov_b64 v[222:223], 0
s_waitcnt lgkmcnt(4)
s_waitcnt vmcnt(18)
v_mfma_f32_16x16x32_bf16 v[32:35], a[96:99], a[24:27], v[32:35]
v_mov_b64 v[224:225], 0
v_mfma_f32_16x16x32_bf16 v[36:39], a[96:99], a[56:59], v[36:39]
v_mov_b64 v[226:227], 0
v_mfma_f32_16x16x32_bf16 v[40:43], a[100:103], a[24:27], v[40:43]
v_mov_b64 v[228:229], 0
v_mfma_f32_16x16x32_bf16 v[44:47], a[100:103], a[56:59], v[44:47]
v_mov_b64 v[230:231], 0
v_mfma_f32_16x16x32_bf16 v[48:51], a[104:107], a[24:27], v[48:51]
v_mov_b64 v[232:233], 0
v_mfma_f32_16x16x32_bf16 v[52:55], a[104:107], a[56:59], v[52:55]
v_mov_b64 v[234:235], 0
v_mfma_f32_16x16x32_bf16 v[56:59], a[108:111], a[24:27], v[56:59]
v_mov_b64 v[236:237], 0
v_mfma_f32_16x16x32_bf16 v[60:63], a[108:111], a[56:59], v[60:63]
v_mov_b64 v[238:239], 0
s_waitcnt lgkmcnt(0)
s_waitcnt vmcnt(16)
v_mfma_f32_16x16x32_bf16 v[32:35], a[112:115], a[28:31], v[32:35]
v_mov_b64 v[240:241], 0
v_mfma_f32_16x16x32_bf16 v[36:39], a[112:115], a[60:63], v[36:39]
v_mov_b64 v[242:243], 0
v_mfma_f32_16x16x32_bf16 v[40:43], a[116:119], a[28:31], v[40:43]
v_mov_b64 v[244:245], 0
v_mfma_f32_16x16x32_bf16 v[44:47], a[116:119], a[60:63], v[44:47]
v_mov_b64 v[246:247], 0
v_mfma_f32_16x16x32_bf16 v[48:51], a[120:123], a[28:31], v[48:51]
v_mov_b64 v[248:249], 0
v_mfma_f32_16x16x32_bf16 v[52:55], a[120:123], a[60:63], v[52:55]
v_mov_b64 v[250:251], 0
v_mfma_f32_16x16x32_bf16 v[56:59], a[124:127], a[28:31], v[56:59]
v_mov_b64 v[252:253], 0
v_mfma_f32_16x16x32_bf16 v[60:63], a[124:127], a[60:63], v[60:63]
v_mov_b64 v[254:255], 0
s_nop 7
v_max3_f32 v6, v32, v33, v34
v_max3_f32 v6, v6, v35, v40
v_max3_f32 v6, v6, v41, v42
v_max3_f32 v6, v6, v43, v48
v_max3_f32 v6, v6, v49, v50
v_max3_f32 v6, v6, v51, v56
v_max3_f32 v6, v6, v57, v58
v_max_f32 v6, v6, v59
v_mov_b32 v14, v6
s_nop 1
v_permlane16_swap_b32 v6, v14
s_nop 1
v_max_f32 v6, v6, v14
v_mov_b32 v14, v6
s_nop 1
v_permlane32_swap_b32 v6, v14
s_nop 1
v_max_f32 v6, v6, v14
v_mul_f32 v6, s27, v6
v_max3_f32 v7, v36, v37, v38
v_max3_f32 v7, v7, v39, v44
v_max3_f32 v7, v7, v45, v46
v_max3_f32 v7, v7, v47, v52
v_max3_f32 v7, v7, v53, v54
v_max3_f32 v7, v7, v55, v60
v_max3_f32 v7, v7, v61, v62
v_max_f32 v7, v7, v63
v_mov_b32 v14, v7
s_nop 1
v_permlane16_swap_b32 v7, v14
s_nop 1
v_max_f32 v7, v7, v14
v_mov_b32 v14, v7
s_nop 1
v_permlane32_swap_b32 v7, v14
s_nop 1
v_max_f32 v7, v7, v14
v_mul_f32 v7, s27, v7
s_waitcnt vmcnt(16)
s_barrier
ds_read_b128 a[64:67], v2 offset:0
ds_read_b128 a[68:71], v2 offset:1024
ds_read_b128 a[72:75], v2 offset:2048
ds_read_b128 a[76:79], v2 offset:3072
ds_read_b128 a[80:83], v2 offset:4096
ds_read_b128 a[84:87], v2 offset:5120
ds_read_b128 a[88:91], v2 offset:6144
ds_read_b128 a[92:95], v2 offset:7168
v_fma_f32 v16, v32, s27, -v6
v_fma_f32 v17, v33, s27, -v6
v_fma_f32 v18, v34, s27, -v6
v_fma_f32 v19, v35, s27, -v6
v_exp_f32 v16, v16
v_exp_f32 v17, v17
v_exp_f32 v18, v18
v_exp_f32 v19, v19
v_mov_b32 v10, v16
v_add_f32 v10, v10, v17
v_cvt_pk_bf16_f32 v96, v16, v17
v_add_f32 v10, v10, v18
v_add_f32 v10, v10, v19
v_cvt_pk_bf16_f32 v97, v18, v19
v_fma_f32 v16, v36, s27, -v7
v_fma_f32 v17, v37, s27, -v7
v_fma_f32 v18, v38, s27, -v7
v_fma_f32 v19, v39, s27, -v7
v_exp_f32 v16, v16
v_exp_f32 v17, v17
v_exp_f32 v18, v18
v_exp_f32 v19, v19
v_mov_b32 v11, v16
v_add_f32 v11, v11, v17
v_cvt_pk_bf16_f32 v100, v16, v17
v_add_f32 v11, v11, v18
v_add_f32 v11, v11, v19
v_cvt_pk_bf16_f32 v101, v18, v19
v_fma_f32 v16, v40, s27, -v6
v_fma_f32 v17, v41, s27, -v6
v_fma_f32 v18, v42, s27, -v6
v_fma_f32 v19, v43, s27, -v6
v_exp_f32 v16, v16
v_exp_f32 v17, v17
v_exp_f32 v18, v18
v_exp_f32 v19, v19
v_add_f32 v10, v10, v16
v_add_f32 v10, v10, v17
v_cvt_pk_bf16_f32 v98, v16, v17
v_add_f32 v10, v10, v18
v_add_f32 v10, v10, v19
v_cvt_pk_bf16_f32 v99, v18, v19
v_fma_f32 v16, v44, s27, -v7
v_fma_f32 v17, v45, s27, -v7
v_fma_f32 v18, v46, s27, -v7
v_fma_f32 v19, v47, s27, -v7
v_exp_f32 v16, v16
v_exp_f32 v17, v17
v_exp_f32 v18, v18
v_exp_f32 v19, v19
v_add_f32 v11, v11, v16
v_add_f32 v11, v11, v17
v_cvt_pk_bf16_f32 v102, v16, v17
v_add_f32 v11, v11, v18
v_add_f32 v11, v11, v19
v_cvt_pk_bf16_f32 v103, v18, v19
v_fma_f32 v24, v48, s27, -v6
v_fma_f32 v25, v49, s27, -v6
v_exp_f32 v24, v24
v_exp_f32 v25, v25
v_add_f32 v10, v10, v24
s_mov_b32 s18, 0
s_add_u32 m0, s17, 131072
s_waitcnt lgkmcnt(4)
s_bitcmp1_b32 s68, 0
s_cbranch_scc1 L_k2_evb0
.p2align 6
L_k2_a0:
v_mfma_f32_16x16x32_bf16 v[64:67], a[64:67], a[0:3], 0
ds_read_b128 a[96:99], v2 offset:8192
v_fma_f32 v18, v50, s27, -v6
v_mfma_f32_16x16x32_bf16 v[64:67], a[68:71], a[4:7], v[64:67]
buffer_load_dwordx4 v1, s[12:15], s20 offen offset:0 lds
v_mfma_f32_16x16x32_bf16 v[64:67], a[72:75], a[8:11], v[64:67]
ds_read_b128 a[100:103], v2 offset:9216
v_fma_f32 v19, v51, s27, -v6
v_mfma_f32_16x16x32_bf16 v[64:67], a[76:79], a[12:15], v[64:67]
s_add_u32 s19, s18, 32768
v_exp_f32 v18, v18
v_mfma_f32_16x16x32_bf16 v[68:71], a[64:67], a[32:35], 0
ds_read_b128 a[104:107], v2 offset:10240
v_add_f32 v10, v10, v25
v_mfma_f32_16x16x32_bf16 v[68:71], a[68:71], a[36:39], v[68:71]
s_cmp_eq_u32 s19, 163840
v_exp_f32 v19, v19
v_mfma_f32_16x16x32_bf16 v[68:71], a[72:75], a[40:43], v[68:71]
ds_read_b128 a[108:111], v2 offset:11264
v_add_f32 v10, v10, v18
v_mfma_f32_16x16x32_bf16 v[68:71], a[76:79], a[44:47], v[68:71]
s_waitcnt lgkmcnt(4)
v_add_f32 v10, v10, v19
v_cvt_pk_bf16_f32 v105, v18, v19
v_mfma_f32_16x16x32_bf16 v[68:71], a[80:83], a[48:51], v[68:71]
ds_read_b128 a[112:115], v2 offset:12288
v_fma_f32 v16, v52, s27, -v7
v_mfma_f32_16x16x32_bf16 v[68:71], a[84:87], a[52:55], v[68:71]
buffer_load_dwordx4 v1, s[12:15], s20 offen offset:1024 lds
v_mfma_f32_16x16x32_bf16 v[68:71], a[88:91], a[56:59], v[68:71]
ds_read_b128 a[116:119], v2 offset:13312
v_fma_f32 v17, v53, s27, -v7
v_mfma_f32_16x16x32_bf16 v[68:71], a[92:95], a[60:63], v[68:71]
s_cselect_b32 s19, 0, s19
v_exp_f32 v16, v16
v_mfma_f32_16x16x32_bf16 v[64:67], a[80:83], a[16:19], v[64:67]
ds_read_b128 a[120:123], v2 offset:14336
v_cvt_pk_bf16_f32 v104, v24, v25
v_mfma_f32_16x16x32_bf16 v[64:67], a[84:87], a[20:23], v[64:67]
s_add_u32 s29, s22, 2
v_exp_f32 v17, v17
v_mfma_f32_16x16x32_bf16 v[64:67], a[88:91], a[24:27], v[64:67]
ds_read_b128 a[124:127], v2 offset:15360
v_add_f32 v11, v11, v16
v_mfma_f32_16x16x32_bf16 v[64:67], a[92:95], a[28:31], v[64:67]
s_waitcnt lgkmcnt(4)
v_add_f32 v11, v11, v17
v_cvt_pk_bf16_f32 v108, v16, v17
v_mfma_f32_16x16x32_bf16 v[72:75], a[96:99], a[0:3], 0
ds_read_b128 a[64:67], v2 offset:16384
v_fma_f32 v18, v54, s27, -v7
v_mfma_f32_16x16x32_bf16 v[72:75], a[100:103], a[4:7], v[72:75]
buffer_load_dwordx4 v1, s[12:15], s20 offen offset:2048 lds
v_mfma_f32_16x16x32_bf16 v[72:75], a[104:107], a[8:11], v[72:75]
ds_read_b128 a[68:71], v2 offset:17408
v_fma_f32 v19, v55, s27, -v7
v_mfma_f32_16x16x32_bf16 v[72:75], a[108:111], a[12:15], v[72:75]
s_cmp_eq_u32 s29, s69
v_exp_f32 v18, v18
v_mfma_f32_16x16x32_bf16 v[76:79], a[96:99], a[32:35], 0
ds_read_b128 a[72:75], v2 offset:18432
v_mfma_f32_16x16x32_bf16 v[76:79], a[100:103], a[36:39], v[76:79]
s_cselect_b32 s21, s73, s21
v_exp_f32 v19, v19
v_mfma_f32_16x16x32_bf16 v[76:79], a[104:107], a[40:43], v[76:79]
ds_read_b128 a[76:79], v2 offset:19456
v_add_f32 v11, v11, v18
v_mfma_f32_16x16x32_bf16 v[76:79], a[108:111], a[44:47], v[76:79]
s_waitcnt lgkmcnt(4)
v_add_f32 v11, v11, v19
v_cvt_pk_bf16_f32 v109, v18, v19
v_mfma_f32_16x16x32_bf16 v[76:79], a[112:115], a[48:51], v[76:79]
ds_read_b128 a[80:83], v2 offset:20480
v_fma_f32 v16, v56, s27, -v6
v_mfma_f32_16x16x32_bf16 v[76:79], a[116:119], a[52:55], v[76:79]
buffer_load_dwordx4 v1, s[12:15], s20 offen offset:3072 lds
s_cselect_b32 s11, 28672, s11
v_mfma_f32_16x16x32_bf16 v[76:79], a[120:123], a[56:59], v[76:79]
ds_read_b128 a[84:87], v2 offset:21504
v_fma_f32 v17, v57, s27, -v6
v_mfma_f32_16x16x32_bf16 v[76:79], a[124:127], a[60:63], v[76:79]
s_add_u32 m0, m0, 4096
v_exp_f32 v16, v16
v_mfma_f32_16x16x32_bf16 v[72:75], a[112:115], a[16:19], v[72:75]
ds_read_b128 a[88:91], v2 offset:22528
v_mfma_f32_16x16x32_bf16 v[72:75], a[116:119], a[20:23], v[72:75]
s_add_u32 s20, s20, 4096
v_exp_f32 v17, v17
v_mfma_f32_16x16x32_bf16 v[72:75], a[120:123], a[24:27], v[72:75]
ds_read_b128 a[92:95], v2 offset:23552
v_add_f32 v10, v10, v16
v_mfma_f32_16x16x32_bf16 v[72:75], a[124:127], a[28:31], v[72:75]
s_waitcnt lgkmcnt(4)
v_add_f32 v10, v10, v17
v_cvt_pk_bf16_f32 v106, v16, v17
v_mfma_f32_16x16x32_bf16 v[80:83], a[64:67], a[0:3], 0
ds_read_b128 a[96:99], v2 offset:24576
v_fma_f32 v18, v58, s27, -v6
v_mfma_f32_16x16x32_bf16 v[80:83], a[68:71], a[4:7], v[80:83]
buffer_load_dwordx4 v1, s[12:15], s20 offen offset:0 lds
v_mfma_f32_16x16x32_bf16 v[80:83], a[72:75], a[8:11], v[80:83]
ds_read_b128 a[100:103], v2 offset:25600
v_fma_f32 v19, v59, s27, -v6
v_mfma_f32_16x16x32_bf16 v[80:83], a[76:79], a[12:15], v[80:83]
v_exp_f32 v18, v18
v_mfma_f32_16x16x32_bf16 v[84:87], a[64:67], a[32:35], 0
ds_read_b128 a[104:107], v2 offset:26624
v_mfma_f32_16x16x32_bf16 v[84:87], a[68:71], a[36:39], v[84:87]
s_add_u32 s30, s18, s17
v_exp_f32 v19, v19
v_mfma_f32_16x16x32_bf16 v[84:87], a[72:75], a[40:43], v[84:87]
ds_read_b128 a[108:111], v2 offset:27648
v_add_f32 v10, v10, v18
v_mfma_f32_16x16x32_bf16 v[84:87], a[76:79], a[44:47], v[84:87]
s_waitcnt lgkmcnt(4)
v_add_f32 v10, v10, v19
v_cvt_pk_bf16_f32 v107, v18, v19
v_mfma_f32_16x16x32_bf16 v[84:87], a[80:83], a[48:51], v[84:87]
ds_read_b128 a[112:115], v2 offset:28672
v_fma_f32 v16, v60, s27, -v7
v_mfma_f32_16x16x32_bf16 v[84:87], a[84:87], a[52:55], v[84:87]
buffer_load_dwordx4 v1, s[12:15], s20 offen offset:1024 lds
v_mfma_f32_16x16x32_bf16 v[84:87], a[88:91], a[56:59], v[84:87]
ds_read_b128 a[116:119], v2 offset:29696
v_fma_f32 v17, v61, s27, -v7
v_mfma_f32_16x16x32_bf16 v[84:87], a[92:95], a[60:63], v[84:87]
s_mov_b32 s18, s19
v_exp_f32 v16, v16
v_mfma_f32_16x16x32_bf16 v[80:83], a[80:83], a[16:19], v[80:83]
ds_read_b128 a[120:123], v2 offset:30720
v_add_u32 v3, s19, v1
v_mfma_f32_16x16x32_bf16 v[80:83], a[84:87], a[20:23], v[80:83]
s_add_u32 s31, s20, s10
v_exp_f32 v17, v17
v_mfma_f32_16x16x32_bf16 v[80:83], a[88:91], a[24:27], v[80:83]
ds_read_b128 a[124:127], v2 offset:31744
v_add_f32 v11, v11, v16
v_mfma_f32_16x16x32_bf16 v[80:83], a[92:95], a[28:31], v[80:83]
s_waitcnt lgkmcnt(4)
v_add_f32 v11, v11, v17
v_cvt_pk_bf16_f32 v110, v16, v17
v_mfma_f32_16x16x32_bf16 v[88:91], a[96:99], a[0:3], 0
ds_read_b128 a[64:67], v3 offset:0
v_fma_f32 v18, v62, s27, -v7
v_mfma_f32_16x16x32_bf16 v[88:91], a[100:103], a[4:7], v[88:91]
buffer_load_dwordx4 v1, s[12:15], s20 offen offset:2048 lds
v_mfma_f32_16x16x32_bf16 v[88:91], a[104:107], a[8:11], v[88:91]
ds_read_b128 a[68:71], v3 offset:16384
v_fma_f32 v19, v63, s27, -v7
v_mfma_f32_16x16x32_bf16 v[88:91], a[108:111], a[12:15], v[88:91]
s_bitcmp1_b32 s24, s22
v_exp_f32 v18, v18
v_mfma_f32_16x16x32_bf16 v[92:95], a[96:99], a[32:35], 0
ds_read_b128 a[72:75], v3 offset:1024
v_mfma_f32_16x16x32_bf16 v[92:95], a[100:103], a[36:39], v[92:95]
s_waitcnt vmcnt(15)
v_exp_f32 v19, v19
v_mfma_f32_16x16x32_bf16 v[92:95], a[104:107], a[40:43], v[92:95]
ds_read_b128 a[76:79], v3 offset:17408
v_add_f32 v11, v11, v18
v_mfma_f32_16x16x32_bf16 v[92:95], a[108:111], a[44:47], v[92:95]
s_waitcnt lgkmcnt(4)
v_add_f32 v11, v11, v19
v_cvt_pk_bf16_f32 v111, v18, v19
v_mfma_f32_16x16x32_bf16 v[92:95], a[112:115], a[48:51], v[92:95]
ds_read_b128 a[80:83], v3 offset:2048
v_add_f32 v14, v10, v11
v_mfma_f32_16x16x32_bf16 v[92:95], a[116:119], a[52:55], v[92:95]
buffer_load_dwordx4 v1, s[12:15], s20 offen offset:3072 lds
v_mfma_f32_16x16x32_bf16 v[92:95], a[120:123], a[56:59], v[92:95]
ds_read_b128 a[84:87], v3 offset:18432
v_cmp_nge_f32 vcc, s28, v14
v_mfma_f32_16x16x32_bf16 v[92:95], a[124:127], a[60:63], v[92:95]
s_mov_b32 m0, s30
v_mfma_f32_16x16x32_bf16 v[88:91], a[112:115], a[16:19], v[88:91]
ds_read_b128 a[88:91], v3 offset:3072
v_mfma_f32_16x16x32_bf16 v[88:91], a[116:119], a[20:23], v[88:91]
s_barrier
v_mfma_f32_16x16x32_bf16 v[88:91], a[120:123], a[24:27], v[88:91]
ds_read_b128 a[92:95], v3 offset:19456
s_mov_b32 s20, s31
v_mfma_f32_16x16x32_bf16 v[88:91], a[124:127], a[28:31], v[88:91]
s_waitcnt lgkmcnt(4)
s_cbranch_scc1 L_k2_eva0
s_cbranch_vccnz L_k2_eva0
L_k2_b0:
v_mfma_f32_16x16x32_bf16 v[128:131], a[64:67], v[96:99], v[128:131]
ds_read_b128 a[96:99], v3 offset:4096
v_fma_f32 v16, v64, s27, -v6
v_mfma_f32_16x16x32_bf16 v[128:131], a[68:71], v[104:107], v[128:131]
buffer_load_dwordx4 v1, s[12:15], s21 offen offset:0 lds
v_mfma_f32_16x16x32_bf16 v[132:135], a[68:71], v[108:111], v[132:135]
ds_read_b128 a[100:103], v3 offset:20480
v_fma_f32 v17, v65, s27, -v6
v_mfma_f32_16x16x32_bf16 v[132:135], a[64:67], v[100:103], v[132:135]
s_add_u32 s19, s18, 32768
v_exp_f32 v16, v16
v_mfma_f32_16x16x32_bf16 v[136:139], a[72:75], v[96:99], v[136:139]
ds_read_b128 a[104:107], v3 offset:5120
v_add_f32 v8, v8, v10
v_mfma_f32_16x16x32_bf16 v[136:139], a[76:79], v[104:107], v[136:139]
s_cmp_eq_u32 s19, 163840
v_exp_f32 v17, v17
v_mfma_f32_16x16x32_bf16 v[140:143], a[76:79], v[108:111], v[140:143]
ds_read_b128 a[108:111], v3 offset:21504
v_mov_b32 v12, v16
v_mfma_f32_16x16x32_bf16 v[140:143], a[72:75], v[100:103], v[140:143]
s_waitcnt lgkmcnt(4)
v_add_f32 v12, v12, v17
v_cvt_pk_bf16_f32 v112, v16, v17
v_mfma_f32_16x16x32_bf16 v[144:147], a[80:83], v[96:99], v[144:147]
ds_read_b128 a[112:115], v3 offset:6144
v_fma_f32 v18, v66, s27, -v6
v_mfma_f32_16x16x32_bf16 v[144:147], a[84:87], v[104:107], v[144:147]
buffer_load_dwordx4 v1, s[12:15], s21 offen offset:1024 lds
v_mfma_f32_16x16x32_bf16 v[148:151], a[84:87], v[108:111], v[148:151]
ds_read_b128 a[116:119], v3 offset:22528
v_fma_f32 v19, v67, s27, -v6
v_mfma_f32_16x16x32_bf16 v[148:151], a[80:83], v[100:103], v[148:151]
s_cselect_b32 s19, 0, s19
v_exp_f32 v18, v18
v_mfma_f32_16x16x32_bf16 v[152:155], a[88:91], v[96:99], v[152:155]
ds_read_b128 a[120:123], v3 offset:7168
v_add_f32 v9, v9, v11
v_mfma_f32_16x16x32_bf16 v[152:155], a[92:95], v[104:107], v[152:155]
s_add_u32 s29, s22, 4
v_exp_f32 v19, v19
v_mfma_f32_16x16x32_bf16 v[156:159], a[92:95], v[108:111], v[156:159]
ds_read_b128 a[124:127], v3 offset:23552
v_add_f32 v12, v12, v18
v_mfma_f32_16x16x32_bf16 v[156:159], a[88:91], v[100:103], v[156:159]
s_waitcnt lgkmcnt(4)
v_add_f32 v12, v12, v19
v_cvt_pk_bf16_f32 v113, v18, v19
v_mfma_f32_16x16x32_bf16 v[160:163], a[96:99], v[96:99], v[160:163]
ds_read_b128 a[64:67], v3 offset:8192
v_fma_f32 v16, v68, s27, -v7
v_mfma_f32_16x16x32_bf16 v[160:163], a[100:103], v[104:107], v[160:163]
buffer_load_dwordx4 v1, s[12:15], s21 offen offset:2048 lds
v_mfma_f32_16x16x32_bf16 v[164:167], a[100:103], v[108:111], v[164:167]
ds_read_b128 a[68:71], v3 offset:24576
v_fma_f32 v17, v69, s27, -v7
v_mfma_f32_16x16x32_bf16 v[164:167], a[96:99], v[100:103], v[164:167]
s_cmp_eq_u32 s29, s69
v_exp_f32 v16, v16
v_mfma_f32_16x16x32_bf16 v[168:171], a[104:107], v[96:99], v[168:171]
ds_read_b128 a[72:75], v3 offset:9216
v_fma_f32 v24, v80, s27, -v6
v_mfma_f32_16x16x32_bf16 v[168:171], a[108:111], v[104:107], v[168:171]
s_cselect_b32 s20, s72, s20
v_exp_f32 v17, v17
v_mfma_f32_16x16x32_bf16 v[172:175], a[108:111], v[108:111], v[172:175]
ds_read_b128 a[76:79], v3 offset:25600
v_mov_b32 v13, v16
v_mfma_f32_16x16x32_bf16 v[172:175], a[104:107], v[100:103], v[172:175]
s_waitcnt lgkmcnt(4)
v_add_f32 v13, v13, v17
v_cvt_pk_bf16_f32 v116, v16, v17
v_mfma_f32_16x16x32_bf16 v[176:179], a[112:115], v[96:99], v[176:179]
ds_read_b128 a[80:83], v3 offset:10240
v_fma_f32 v18, v70, s27, -v7
v_mfma_f32_16x16x32_bf16 v[176:179], a[116:119], v[104:107], v[176:179]
buffer_load_dwordx4 v1, s[12:15], s21 offen offset:3072 lds
s_cselect_b32 s10, 28672, s10
v_mfma_f32_16x16x32_bf16 v[180:183], a[116:119], v[108:111], v[180:183]
ds_read_b128 a[84:87], v3 offset:26624
v_fma_f32 v19, v71, s27, -v7
v_mfma_f32_16x16x32_bf16 v[180:183], a[112:115], v[100:103], v[180:183]
s_add_u32 m0, m0, 4096
v_exp_f32 v18, v18
v_mfma_f32_16x16x32_bf16 v[184:187], a[120:123], v[96:99], v[184:187]
ds_read_b128 a[88:91], v3 offset:11264
v_fma_f32 v25, v81, s27, -v6
v_mfma_f32_16x16x32_bf16 v[184:187], a[124:127], v[104:107], v[184:187]
s_add_u32 s21, s21, 4096
v_exp_f32 v19, v19
v_mfma_f32_16x16x32_bf16 v[188:191], a[124:127], v[108:111], v[188:191]
ds_read_b128 a[92:95], v3 offset:27648
v_add_f32 v13, v13, v18
v_mfma_f32_16x16x32_bf16 v[188:191], a[120:123], v[100:103], v[188:191]
s_waitcnt lgkmcnt(4)
v_add_f32 v13, v13, v19
v_cvt_pk_bf16_f32 v117, v18, v19
v_mfma_f32_16x16x32_bf16 v[192:195], a[64:67], v[96:99], v[192:195]
ds_read_b128 a[96:99], v3 offset:12288
v_fma_f32 v16, v72, s27, -v6
v_mfma_f32_16x16x32_bf16 v[192:195], a[68:71], v[104:107], v[192:195]
buffer_load_dwordx4 v1, s[12:15], s21 offen offset:0 lds
v_mfma_f32_16x16x32_bf16 v[196:199], a[68:71], v[108:111], v[196:199]
ds_read_b128 a[100:103], v3 offset:28672
v_fma_f32 v17, v73, s27, -v6
v_mfma_f32_16x16x32_bf16 v[196:199], a[64:67], v[100:103], v[196:199]
s_add_u32 s22, s22, 1
v_exp_f32 v16, v16
v_mfma_f32_16x16x32_bf16 v[200:203], a[72:75], v[96:99], v[200:203]
ds_read_b128 a[104:107], v3 offset:13312
v_exp_f32 v24, v24
v_mfma_f32_16x16x32_bf16 v[200:203], a[76:79], v[104:107], v[200:203]
s_add_u32 s30, s18, s17
v_exp_f32 v17, v17
v_mfma_f32_16x16x32_bf16 v[204:207], a[76:79], v[108:111], v[204:207]
ds_read_b128 a[108:111], v3 offset:29696
v_add_f32 v12, v12, v16
v_mfma_f32_16x16x32_bf16 v[204:207], a[72:75], v[100:103], v[204:207]
s_waitcnt lgkmcnt(4)
v_add_f32 v12, v12, v17
v_cvt_pk_bf16_f32 v114, v16, v17
v_mfma_f32_16x16x32_bf16 v[208:211], a[80:83], v[96:99], v[208:211]
ds_read_b128 a[112:115], v3 offset:14336
v_fma_f32 v18, v74, s27, -v6
v_mfma_f32_16x16x32_bf16 v[208:211], a[84:87], v[104:107], v[208:211]
buffer_load_dwordx4 v1, s[12:15], s21 offen offset:1024 lds
v_mfma_f32_16x16x32_bf16 v[212:215], a[84:87], v[108:111], v[212:215]
ds_read_b128 a[116:119], v3 offset:30720
v_fma_f32 v19, v75, s27, -v6
v_mfma_f32_16x16x32_bf16 v[212:215], a[80:83], v[100:103], v[212:215]
s_mov_b32 s18, s19
v_exp_f32 v18, v18
v_mfma_f32_16x16x32_bf16 v[216:219], a[88:91], v[96:99], v[216:219]
ds_read_b128 a[120:123], v3 offset:15360
v_add_u32 v2, s19, v1
v_mfma_f32_16x16x32_bf16 v[216:219], a[92:95], v[104:107], v[216:219]
s_add_u32 s31, s21, s11
v_exp_f32 v19, v19
v_mfma_f32_16x16x32_bf16 v[220:223], a[92:95], v[108:111], v[220:223]
ds_read_b128 a[124:127], v3 offset:31744
v_add_f32 v12, v12, v18
v_mfma_f32_16x16x32_bf16 v[220:223], a[88:91], v[100:103], v[220:223]
s_waitcnt lgkmcnt(4)
v_add_f32 v12, v12, v19
v_cvt_pk_bf16_f32 v115, v18, v19
v_mfma_f32_16x16x32_bf16 v[224:227], a[96:99], v[96:99], v[224:227]
ds_read_b128 a[64:67], v2 offset:0
v_fma_f32 v16, v76, s27, -v7
v_mfma_f32_16x16x32_bf16 v[224:227], a[100:103], v[104:107], v[224:227]
buffer_load_dwordx4 v1, s[12:15], s21 offen offset:2048 lds
v_mfma_f32_16x16x32_bf16 v[228:231], a[100:103], v[108:111], v[228:231]
ds_read_b128 a[68:71], v2 offset:1024
v_fma_f32 v17, v77, s27, -v7
v_mfma_f32_16x16x32_bf16 v[228:231], a[96:99], v[100:103], v[228:231]
s_bitcmp1_b32 s68, s22
v_exp_f32 v16, v16
v_mfma_f32_16x16x32_bf16 v[232:235], a[104:107], v[96:99], v[232:235]
ds_read_b128 a[72:75], v2 offset:2048
v_exp_f32 v25, v25
v_mfma_f32_16x16x32_bf16 v[232:235], a[108:111], v[104:107], v[232:235]
s_waitcnt vmcnt(15)
v_exp_f32 v17, v17
v_mfma_f32_16x16x32_bf16 v[236:239], a[108:111], v[108:111], v[236:239]
ds_read_b128 a[76:79], v2 offset:3072
v_add_f32 v13, v13, v16
v_mfma_f32_16x16x32_bf16 v[236:239], a[104:107], v[100:103], v[236:239]
s_waitcnt lgkmcnt(4)
v_add_f32 v13, v13, v17
v_cvt_pk_bf16_f32 v118, v16, v17
v_mfma_f32_16x16x32_bf16 v[240:243], a[112:115], v[96:99], v[240:243]
ds_read_b128 a[80:83], v2 offset:4096
v_fma_f32 v18, v78, s27, -v7
v_mfma_f32_16x16x32_bf16 v[240:243], a[116:119], v[104:107], v[240:243]
buffer_load_dwordx4 v1, s[12:15], s21 offen offset:3072 lds
s_mov_b32 s21, s31
v_mfma_f32_16x16x32_bf16 v[244:247], a[116:119], v[108:111], v[244:247]
ds_read_b128 a[84:87], v2 offset:5120
v_fma_f32 v19, v79, s27, -v7
v_mfma_f32_16x16x32_bf16 v[244:247], a[112:115], v[100:103], v[244:247]
s_mov_b32 m0, s30
v_exp_f32 v18, v18
v_mfma_f32_16x16x32_bf16 v[248:251], a[120:123], v[96:99], v[248:251]
ds_read_b128 a[88:91], v2 offset:6144
v_add_f32 v12, v12, v24
v_mfma_f32_16x16x32_bf16 v[248:251], a[124:127], v[104:107], v[248:251]
s_barrier
v_exp_f32 v19, v19
v_mfma_f32_16x16x32_bf16 v[252:255], a[124:127], v[108:111], v[252:255]
ds_read_b128 a[92:95], v2 offset:7168
v_add_f32 v13, v13, v18
v_mfma_f32_16x16x32_bf16 v[252:255], a[120:123], v[100:103], v[252:255]
s_waitcnt lgkmcnt(4)
v_add_f32 v13, v13, v19
v_cvt_pk_bf16_f32 v119, v18, v19
s_cbranch_scc1 L_k2_evb1
L_k2_a1:
v_mfma_f32_16x16x32_bf16 v[32:35], a[64:67], a[0:3], 0
ds_read_b128 a[96:99], v2 offset:8192
v_fma_f32 v18, v82, s27, -v6
v_mfma_f32_16x16x32_bf16 v[32:35], a[68:71], a[4:7], v[32:35]
buffer_load_dwordx4 v1, s[12:15], s20 offen offset:0 lds
v_mfma_f32_16x16x32_bf16 v[32:35], a[72:75], a[8:11], v[32:35]
ds_read_b128 a[100:103], v2 offset:9216
v_fma_f32 v19, v83, s27, -v6
v_mfma_f32_16x16x32_bf16 v[32:35], a[76:79], a[12:15], v[32:35]
s_add_u32 s19, s18, 32768
v_exp_f32 v18, v18
v_mfma_f32_16x16x32_bf16 v[36:39], a[64:67], a[32:35], 0
ds_read_b128 a[104:107], v2 offset:10240
v_add_f32 v12, v12, v25
v_mfma_f32_16x16x32_bf16 v[36:39], a[68:71], a[36:39], v[36:39]
s_cmp_eq_u32 s19, 163840
v_exp_f32 v19, v19
v_mfma_f32_16x16x32_bf16 v[36:39], a[72:75], a[40:43], v[36:39]
ds_read_b128 a[108:111], v2 offset:11264
v_add_f32 v12, v12, v18
v_mfma_f32_16x16x32_bf16 v[36:39], a[76:79], a[44:47], v[36:39]
s_waitcnt lgkmcnt(4)
v_add_f32 v12, v12, v19
v_cvt_pk_bf16_f32 v121, v18, v19
v_mfma_f32_16x16x32_bf16 v[36:39], a[80:83], a[48:51], v[36:39]
ds_read_b128 a[112:115], v2 offset:12288
v_fma_f32 v16, v84, s27, -v7
v_mfma_f32_16x16x32_bf16 v[36:39], a[84:87], a[52:55], v[36:39]
buffer_load_dwordx4 v1, s[12:15], s20 offen offset:1024 lds
v_mfma_f32_16x16x32_bf16 v[36:39], a[88:91], a[56:59], v[36:39]
ds_read_b128 a[116:119], v2 offset:13312
v_fma_f32 v17, v85, s27, -v7
v_mfma_f32_16x16x32_bf16 v[36:39], a[92:95], a[60:63], v[36:39]
s_cselect_b32 s19, 0, s19
v_exp_f32 v16, v16
v_mfma_f32_16x16x32_bf16 v[32:35], a[80:83], a[16:19], v[32:35]
ds_read_b128 a[120:123], v2 offset:14336
v_cvt_pk_bf16_f32 v120, v24, v25
v_mfma_f32_16x16x32_bf16 v[32:35], a[84:87], a[20:23], v[32:35]
s_add_u32 s29, s22, 2
v_exp_f32 v17, v17
v_mfma_f32_16x16x32_bf16 v[32:35], a[88:91], a[24:27], v[32:35]
ds_read_b128 a[124:127], v2 offset:15360
v_add_f32 v13, v13, v16
v_mfma_f32_16x16x32_bf16 v[32:35], a[92:95], a[28:31], v[32:35]
s_waitcnt lgkmcnt(4)
v_add_f32 v13, v13, v17
v_cvt_pk_bf16_f32 v124, v16, v17
v_mfma_f32_16x16x32_bf16 v[40:43], a[96:99], a[0:3], 0
ds_read_b128 a[64:67], v2 offset:16384
v_fma_f32 v18, v86, s27, -v7
v_mfma_f32_16x16x32_bf16 v[40:43], a[100:103], a[4:7], v[40:43]
buffer_load_dwordx4 v1, s[12:15], s20 offen offset:2048 lds
v_mfma_f32_16x16x32_bf16 v[40:43], a[104:107], a[8:11], v[40:43]
ds_read_b128 a[68:71], v2 offset:17408
v_fma_f32 v19, v87, s27, -v7
v_mfma_f32_16x16x32_bf16 v[40:43], a[108:111], a[12:15], v[40:43]
s_cmp_eq_u32 s29, s69
v_exp_f32 v18, v18
v_mfma_f32_16x16x32_bf16 v[44:47], a[96:99], a[32:35], 0
ds_read_b128 a[72:75], v2 offset:18432
v_mfma_f32_16x16x32_bf16 v[44:47], a[100:103], a[36:39], v[44:47]
s_cselect_b32 s21, s73, s21
v_exp_f32 v19, v19
v_mfma_f32_16x16x32_bf16 v[44:47], a[104:107], a[40:43], v[44:47]
ds_read_b128 a[76:79], v2 offset:19456
v_add_f32 v13, v13, v18
v_mfma_f32_16x16x32_bf16 v[44:47], a[108:111], a[44:47], v[44:47]
s_waitcnt lgkmcnt(4)
v_add_f32 v13, v13, v19
v_cvt_pk_bf16_f32 v125, v18, v19
v_mfma_f32_16x16x32_bf16 v[44:47], a[112:115], a[48:51], v[44:47]
ds_read_b128 a[80:83], v2 offset:20480
v_fma_f32 v16, v88, s27, -v6
v_mfma_f32_16x16x32_bf16 v[44:47], a[116:119], a[52:55], v[44:47]
buffer_load_dwordx4 v1, s[12:15], s20 offen offset:3072 lds
s_cselect_b32 s11, 28672, s11
v_mfma_f32_16x16x32_bf16 v[44:47], a[120:123], a[56:59], v[44:47]
ds_read_b128 a[84:87], v2 offset:21504
v_fma_f32 v17, v89, s27, -v6
v_mfma_f32_16x16x32_bf16 v[44:47], a[124:127], a[60:63], v[44:47]
s_add_u32 m0, m0, 4096
v_exp_f32 v16, v16
v_mfma_f32_16x16x32_bf16 v[40:43], a[112:115], a[16:19], v[40:43]
ds_read_b128 a[88:91], v2 offset:22528
v_mfma_f32_16x16x32_bf16 v[40:43], a[116:119], a[20:23], v[40:43]
s_add_u32 s20, s20, 4096
v_exp_f32 v17, v17
v_mfma_f32_16x16x32_bf16 v[40:43], a[120:123], a[24:27], v[40:43]
ds_read_b128 a[92:95], v2 offset:23552
v_add_f32 v12, v12, v16
v_mfma_f32_16x16x32_bf16 v[40:43], a[124:127], a[28:31], v[40:43]
s_waitcnt lgkmcnt(4)
v_add_f32 v12, v12, v17
v_cvt_pk_bf16_f32 v122, v16, v17
v_mfma_f32_16x16x32_bf16 v[48:51], a[64:67], a[0:3], 0
ds_read_b128 a[96:99], v2 offset:24576
v_fma_f32 v18, v90, s27, -v6
v_mfma_f32_16x16x32_bf16 v[48:51], a[68:71], a[4:7], v[48:51]
buffer_load_dwordx4 v1, s[12:15], s20 offen offset:0 lds
v_mfma_f32_16x16x32_bf16 v[48:51], a[72:75], a[8:11], v[48:51]
ds_read_b128 a[100:103], v2 offset:25600
v_fma_f32 v19, v91, s27, -v6
v_mfma_f32_16x16x32_bf16 v[48:51], a[76:79], a[12:15], v[48:51]
v_exp_f32 v18, v18
v_mfma_f32_16x16x32_bf16 v[52:55], a[64:67], a[32:35], 0
ds_read_b128 a[104:107], v2 offset:26624
v_mfma_f32_16x16x32_bf16 v[52:55], a[68:71], a[36:39], v[52:55]
s_add_u32 s30, s18, s17
v_exp_f32 v19, v19
v_mfma_f32_16x16x32_bf16 v[52:55], a[72:75], a[40:43], v[52:55]
ds_read_b128 a[108:111], v2 offset:27648
v_add_f32 v12, v12, v18
v_mfma_f32_16x16x32_bf16 v[52:55], a[76:79], a[44:47], v[52:55]
s_waitcnt lgkmcnt(4)
v_add_f32 v12, v12, v19
v_cvt_pk_bf16_f32 v123, v18, v19
v_mfma_f32_16x16x32_bf16 v[52:55], a[80:83], a[48:51], v[52:55]
ds_read_b128 a[112:115], v2 offset:28672
v_fma_f32 v16, v92, s27, -v7
v_mfma_f32_16x16x32_bf16 v[52:55], a[84:87], a[52:55], v[52:55]
buffer_load_dwordx4 v1, s[12:15], s20 offen offset:1024 lds
v_mfma_f32_16x16x32_bf16 v[52:55], a[88:91], a[56:59], v[52:55]
ds_read_b128 a[116:119], v2 offset:29696
v_fma_f32 v17, v93, s27, -v7
v_mfma_f32_16x16x32_bf16 v[52:55], a[92:95], a[60:63], v[52:55]
s_mov_b32 s18, s19
v_exp_f32 v16, v16
v_mfma_f32_16x16x32_bf16 v[48:51], a[80:83], a[16:19], v[48:51]
ds_read_b128 a[120:123], v2 offset:30720
v_add_u32 v3, s19, v1
v_mfma_f32_16x16x32_bf16 v[48:51], a[84:87], a[20:23], v[48:51]
s_add_u32 s31, s20, s10
v_exp_f32 v17, v17
v_mfma_f32_16x16x32_bf16 v[48:51], a[88:91], a[24:27], v[48:51]
ds_read_b128 a[124:127], v2 offset:31744
v_add_f32 v13, v13, v16
v_mfma_f32_16x16x32_bf16 v[48:51], a[92:95], a[28:31], v[48:51]
s_waitcnt lgkmcnt(4)
v_add_f32 v13, v13, v17
v_cvt_pk_bf16_f32 v126, v16, v17
v_mfma_f32_16x16x32_bf16 v[56:59], a[96:99], a[0:3], 0
ds_read_b128 a[64:67], v3 offset:0
v_fma_f32 v18, v94, s27, -v7
v_mfma_f32_16x16x32_bf16 v[56:59], a[100:103], a[4:7], v[56:59]
buffer_load_dwordx4 v1, s[12:15], s20 offen offset:2048 lds
v_mfma_f32_16x16x32_bf16 v[56:59], a[104:107], a[8:11], v[56:59]
ds_read_b128 a[68:71], v3 offset:16384
v_fma_f32 v19, v95, s27, -v7
v_mfma_f32_16x16x32_bf16 v[56:59], a[108:111], a[12:15], v[56:59]
s_bitcmp1_b32 s24, s22
v_exp_f32 v18, v18
v_mfma_f32_16x16x32_bf16 v[60:63], a[96:99], a[32:35], 0
ds_read_b128 a[72:75], v3 offset:1024
v_mfma_f32_16x16x32_bf16 v[60:63], a[100:103], a[36:39], v[60:63]
s_waitcnt vmcnt(15)
v_exp_f32 v19, v19
v_mfma_f32_16x16x32_bf16 v[60:63], a[104:107], a[40:43], v[60:63]
ds_read_b128 a[76:79], v3 offset:17408
v_add_f32 v13, v13, v18
v_mfma_f32_16x16x32_bf16 v[60:63], a[108:111], a[44:47], v[60:63]
s_waitcnt lgkmcnt(4)
v_add_f32 v13, v13, v19
v_cvt_pk_bf16_f32 v127, v18, v19
v_mfma_f32_16x16x32_bf16 v[60:63], a[112:115], a[48:51], v[60:63]
ds_read_b128 a[80:83], v3 offset:2048
v_add_f32 v14, v12, v13
v_mfma_f32_16x16x32_bf16 v[60:63], a[116:119], a[52:55], v[60:63]
buffer_load_dwordx4 v1, s[12:15], s20 offen offset:3072 lds
v_mfma_f32_16x16x32_bf16 v[60:63], a[120:123], a[56:59], v[60:63]
ds_read_b128 a[84:87], v3 offset:18432
v_cmp_nge_f32 vcc, s28, v14
v_mfma_f32_16x16x32_bf16 v[60:63], a[124:127], a[60:63], v[60:63]
s_mov_b32 m0, s30
v_mfma_f32_16x16x32_bf16 v[56:59], a[112:115], a[16:19], v[56:59]
ds_read_b128 a[88:91], v3 offset:3072
v_mfma_f32_16x16x32_bf16 v[56:59], a[116:119], a[20:23], v[56:59]
s_barrier
v_mfma_f32_16x16x32_bf16 v[56:59], a[120:123], a[24:27], v[56:59]
ds_read_b128 a[92:95], v3 offset:19456
s_mov_b32 s20, s31
v_mfma_f32_16x16x32_bf16 v[56:59], a[124:127], a[28:31], v[56:59]
s_waitcnt lgkmcnt(4)
s_cbranch_scc1 L_k2_eva1
s_cbranch_vccnz L_k2_eva1
L_k2_b1:
v_mfma_f32_16x16x32_bf16 v[128:131], a[64:67], v[112:115], v[128:131]
ds_read_b128 a[96:99], v3 offset:4096
v_fma_f32 v16, v32, s27, -v6
v_mfma_f32_16x16x32_bf16 v[128:131], a[68:71], v[120:123], v[128:131]
buffer_load_dwordx4 v1, s[12:15], s21 offen offset:0 lds
v_mfma_f32_16x16x32_bf16 v[132:135], a[68:71], v[124:127], v[132:135]
ds_read_b128 a[100:103], v3 offset:20480
v_fma_f32 v17, v33, s27, -v6
v_mfma_f32_16x16x32_bf16 v[132:135], a[64:67], v[116:119], v[132:135]
s_add_u32 s19, s18, 32768
v_exp_f32 v16, v16
v_mfma_f32_16x16x32_bf16 v[136:139], a[72:75], v[112:115], v[136:139]
ds_read_b128 a[104:107], v3 offset:5120
v_add_f32 v8, v8, v12
v_mfma_f32_16x16x32_bf16 v[136:139], a[76:79], v[120:123], v[136:139]
s_cmp_eq_u32 s19, 163840
v_exp_f32 v17, v17
v_mfma_f32_16x16x32_bf16 v[140:143], a[76:79], v[124:127], v[140:143]
ds_read_b128 a[108:111], v3 offset:21504
v_mov_b32 v10, v16
v_mfma_f32_16x16x32_bf16 v[140:143], a[72:75], v[116:119], v[140:143]
s_waitcnt lgkmcnt(4)
v_add_f32 v10, v10, v17
v_cvt_pk_bf16_f32 v96, v16, v17
v_mfma_f32_16x16x32_bf16 v[144:147], a[80:83], v[112:115], v[144:147]
ds_read_b128 a[112:115], v3 offset:6144
v_fma_f32 v18, v34, s27, -v6
v_mfma_f32_16x16x32_bf16 v[144:147], a[84:87], v[120:123], v[144:147]
buffer_load_dwordx4 v1, s[12:15], s21 offen offset:1024 lds
v_mfma_f32_16x16x32_bf16 v[148:151], a[84:87], v[124:127], v[148:151]
ds_read_b128 a[116:119], v3 offset:22528
v_fma_f32 v19, v35, s27, -v6
v_mfma_f32_16x16x32_bf16 v[148:151], a[80:83], v[116:119], v[148:151]
s_cselect_b32 s19, 0, s19
v_exp_f32 v18, v18
v_mfma_f32_16x16x32_bf16 v[152:155], a[88:91], v[112:115], v[152:155]
ds_read_b128 a[120:123], v3 offset:7168
v_add_f32 v9, v9, v13
v_mfma_f32_16x16x32_bf16 v[152:155], a[92:95], v[120:123], v[152:155]
s_add_u32 s29, s22, 4
v_exp_f32 v19, v19
v_mfma_f32_16x16x32_bf16 v[156:159], a[92:95], v[124:127], v[156:159]
ds_read_b128 a[124:127], v3 offset:23552
v_add_f32 v10, v10, v18
v_mfma_f32_16x16x32_bf16 v[156:159], a[88:91], v[116:119], v[156:159]
s_waitcnt lgkmcnt(4)
v_add_f32 v10, v10, v19
v_cvt_pk_bf16_f32 v97, v18, v19
v_mfma_f32_16x16x32_bf16 v[160:163], a[96:99], v[112:115], v[160:163]
ds_read_b128 a[64:67], v3 offset:8192
v_fma_f32 v16, v36, s27, -v7
v_mfma_f32_16x16x32_bf16 v[160:163], a[100:103], v[120:123], v[160:163]
buffer_load_dwordx4 v1, s[12:15], s21 offen offset:2048 lds
v_mfma_f32_16x16x32_bf16 v[164:167], a[100:103], v[124:127], v[164:167]
ds_read_b128 a[68:71], v3 offset:24576
v_fma_f32 v17, v37, s27, -v7
v_mfma_f32_16x16x32_bf16 v[164:167], a[96:99], v[116:119], v[164:167]
s_cmp_eq_u32 s29, s69
v_exp_f32 v16, v16
v_mfma_f32_16x16x32_bf16 v[168:171], a[104:107], v[112:115], v[168:171]
ds_read_b128 a[72:75], v3 offset:9216
v_fma_f32 v24, v48, s27, -v6
v_mfma_f32_16x16x32_bf16 v[168:171], a[108:111], v[120:123], v[168:171]
s_cselect_b32 s20, s72, s20
v_exp_f32 v17, v17
v_mfma_f32_16x16x32_bf16 v[172:175], a[108:111], v[124:127], v[172:175]
ds_read_b128 a[76:79], v3 offset:25600
v_mov_b32 v11, v16
v_mfma_f32_16x16x32_bf16 v[172:175], a[104:107], v[116:119], v[172:175]
s_waitcnt lgkmcnt(4)
v_add_f32 v11, v11, v17
v_cvt_pk_bf16_f32 v100, v16, v17
v_mfma_f32_16x16x32_bf16 v[176:179], a[112:115], v[112:115], v[176:179]
ds_read_b128 a[80:83], v3 offset:10240
v_fma_f32 v18, v38, s27, -v7
v_mfma_f32_16x16x32_bf16 v[176:179], a[116:119], v[120:123], v[176:179]
buffer_load_dwordx4 v1, s[12:15], s21 offen offset:3072 lds
s_cselect_b32 s10, 28672, s10
v_mfma_f32_16x16x32_bf16 v[180:183], a[116:119], v[124:127], v[180:183]
ds_read_b128 a[84:87], v3 offset:26624
v_fma_f32 v19, v39, s27, -v7
v_mfma_f32_16x16x32_bf16 v[180:183], a[112:115], v[116:119], v[180:183]
s_add_u32 m0, m0, 4096
v_exp_f32 v18, v18
v_mfma_f32_16x16x32_bf16 v[184:187], a[120:123], v[112:115], v[184:187]
ds_read_b128 a[88:91], v3 offset:11264
v_fma_f32 v25, v49, s27, -v6
v_mfma_f32_16x16x32_bf16 v[184:187], a[124:127], v[120:123], v[184:187]
s_add_u32 s21, s21, 4096
v_exp_f32 v19, v19
v_mfma_f32_16x16x32_bf16 v[188:191], a[124:127], v[124:127], v[188:191]
ds_read_b128 a[92:95], v3 offset:27648
v_add_f32 v11, v11, v18
v_mfma_f32_16x16x32_bf16 v[188:191], a[120:123], v[116:119], v[188:191]
s_waitcnt lgkmcnt(4)
v_add_f32 v11, v11, v19
v_cvt_pk_bf16_f32 v101, v18, v19
v_mfma_f32_16x16x32_bf16 v[192:195], a[64:67], v[112:115], v[192:195]
ds_read_b128 a[96:99], v3 offset:12288
v_fma_f32 v16, v40, s27, -v6
v_mfma_f32_16x16x32_bf16 v[192:195], a[68:71], v[120:123], v[192:195]
buffer_load_dwordx4 v1, s[12:15], s21 offen offset:0 lds
v_mfma_f32_16x16x32_bf16 v[196:199], a[68:71], v[124:127], v[196:199]
ds_read_b128 a[100:103], v3 offset:28672
v_fma_f32 v17, v41, s27, -v6
v_mfma_f32_16x16x32_bf16 v[196:199], a[64:67], v[116:119], v[196:199]
s_add_u32 s22, s22, 1
v_exp_f32 v16, v16
v_mfma_f32_16x16x32_bf16 v[200:203], a[72:75], v[112:115], v[200:203]
ds_read_b128 a[104:107], v3 offset:13312
v_exp_f32 v24, v24
v_mfma_f32_16x16x32_bf16 v[200:203], a[76:79], v[120:123], v[200:203]
s_add_u32 s30, s18, s17
v_exp_f32 v17, v17
v_mfma_f32_16x16x32_bf16 v[204:207], a[76:79], v[124:127], v[204:207]
ds_read_b128 a[108:111], v3 offset:29696
v_add_f32 v10, v10, v16
v_mfma_f32_16x16x32_bf16 v[204:207], a[72:75], v[116:119], v[204:207]
s_waitcnt lgkmcnt(4)
v_add_f32 v10, v10, v17
v_cvt_pk_bf16_f32 v98, v16, v17
v_mfma_f32_16x16x32_bf16 v[208:211], a[80:83], v[112:115], v[208:211]
ds_read_b128 a[112:115], v3 offset:14336
v_fma_f32 v18, v42, s27, -v6
v_mfma_f32_16x16x32_bf16 v[208:211], a[84:87], v[120:123], v[208:211]
buffer_load_dwordx4 v1, s[12:15], s21 offen offset:1024 lds
v_mfma_f32_16x16x32_bf16 v[212:215], a[84:87], v[124:127], v[212:215]
ds_read_b128 a[116:119], v3 offset:30720
v_fma_f32 v19, v43, s27, -v6
v_mfma_f32_16x16x32_bf16 v[212:215], a[80:83], v[116:119], v[212:215]
s_mov_b32 s18, s19
v_exp_f32 v18, v18
v_mfma_f32_16x16x32_bf16 v[216:219], a[88:91], v[112:115], v[216:219]
ds_read_b128 a[120:123], v3 offset:15360
v_add_u32 v2, s19, v1
v_mfma_f32_16x16x32_bf16 v[216:219], a[92:95], v[120:123], v[216:219]
s_add_u32 s31, s21, s11
v_exp_f32 v19, v19
v_mfma_f32_16x16x32_bf16 v[220:223], a[92:95], v[124:127], v[220:223]
ds_read_b128 a[124:127], v3 offset:31744
v_add_f32 v10, v10, v18
v_mfma_f32_16x16x32_bf16 v[220:223], a[88:91], v[116:119], v[220:223]
s_waitcnt lgkmcnt(4)
v_add_f32 v10, v10, v19
v_cvt_pk_bf16_f32 v99, v18, v19
v_mfma_f32_16x16x32_bf16 v[224:227], a[96:99], v[112:115], v[224:227]
ds_read_b128 a[64:67], v2 offset:0
v_fma_f32 v16, v44, s27, -v7
v_mfma_f32_16x16x32_bf16 v[224:227], a[100:103], v[120:123], v[224:227]
buffer_load_dwordx4 v1, s[12:15], s21 offen offset:2048 lds
v_mfma_f32_16x16x32_bf16 v[228:231], a[100:103], v[124:127], v[228:231]
ds_read_b128 a[68:71], v2 offset:1024
v_fma_f32 v17, v45, s27, -v7
v_mfma_f32_16x16x32_bf16 v[228:231], a[96:99], v[116:119], v[228:231]
s_bitcmp1_b32 s68, s22
v_exp_f32 v16, v16
v_mfma_f32_16x16x32_bf16 v[232:235], a[104:107], v[112:115], v[232:235]
ds_read_b128 a[72:75], v2 offset:2048
v_exp_f32 v25, v25
v_mfma_f32_16x16x32_bf16 v[232:235], a[108:111], v[120:123], v[232:235]
s_waitcnt vmcnt(15)
v_exp_f32 v17, v17
v_mfma_f32_16x16x32_bf16 v[236:239], a[108:111], v[124:127], v[236:239]
ds_read_b128 a[76:79], v2 offset:3072
v_add_f32 v11, v11, v16
v_mfma_f32_16x16x32_bf16 v[236:239], a[104:107], v[116:119], v[236:239]
s_waitcnt lgkmcnt(4)
v_add_f32 v11, v11, v17
v_cvt_pk_bf16_f32 v102, v16, v17
v_mfma_f32_16x16x32_bf16 v[240:243], a[112:115], v[112:115], v[240:243]
ds_read_b128 a[80:83], v2 offset:4096
v_fma_f32 v18, v46, s27, -v7
v_mfma_f32_16x16x32_bf16 v[240:243], a[116:119], v[120:123], v[240:243]
buffer_load_dwordx4 v1, s[12:15], s21 offen offset:3072 lds
s_mov_b32 s21, s31
v_mfma_f32_16x16x32_bf16 v[244:247], a[116:119], v[124:127], v[244:247]
ds_read_b128 a[84:87], v2 offset:5120
v_fma_f32 v19, v47, s27, -v7
v_mfma_f32_16x16x32_bf16 v[244:247], a[112:115], v[116:119], v[244:247]
s_mov_b32 m0, s30
v_exp_f32 v18, v18
v_mfma_f32_16x16x32_bf16 v[248:251], a[120:123], v[112:115], v[248:251]
ds_read_b128 a[88:91], v2 offset:6144
v_add_f32 v10, v10, v24
v_mfma_f32_16x16x32_bf16 v[248:251], a[124:127], v[120:123], v[248:251]
s_barrier
v_exp_f32 v19, v19
v_mfma_f32_16x16x32_bf16 v[252:255], a[124:127], v[124:127], v[252:255]
ds_read_b128 a[92:95], v2 offset:7168
v_add_f32 v11, v11, v18
v_mfma_f32_16x16x32_bf16 v[252:255], a[120:123], v[116:119], v[252:255]
s_waitcnt lgkmcnt(4)
v_add_f32 v11, v11, v19
v_cvt_pk_bf16_f32 v103, v18, v19
s_cbranch_scc0 L_k2_a0
L_k2_evb0:
s_cmp_eq_u32 s22, s83
s_cbranch_scc0 L_k2_noq
v_accvgpr_mov_b32 a0, a128
v_accvgpr_mov_b32 a1, a129
v_accvgpr_mov_b32 a2, a130
v_accvgpr_mov_b32 a3, a131
v_accvgpr_mov_b32 a4, a132
v_accvgpr_mov_b32 a5, a133
v_accvgpr_mov_b32 a6, a134
v_accvgpr_mov_b32 a7, a135
v_accvgpr_mov_b32 a8, a136
v_accvgpr_mov_b32 a9, a137
v_accvgpr_mov_b32 a10, a138
v_accvgpr_mov_b32 a11, a139
v_accvgpr_mov_b32 a12, a140
v_accvgpr_mov_b32 a13, a141
v_accvgpr_mov_b32 a14, a142
v_accvgpr_mov_b32 a15, a143
v_accvgpr_mov_b32 a16, a144
v_accvgpr_mov_b32 a17, a145
v_accvgpr_mov_b32 a18, a146
v_accvgpr_mov_b32 a19, a147
v_accvgpr_mov_b32 a20, a148
v_accvgpr_mov_b32 a21, a149
v_accvgpr_mov_b32 a22, a150
v_accvgpr_mov_b32 a23, a151
v_accvgpr_mov_b32 a24, a152
v_accvgpr_mov_b32 a25, a153
v_accvgpr_mov_b32 a26, a154
v_accvgpr_mov_b32 a27, a155
v_accvgpr_mov_b32 a28, a156
v_accvgpr_mov_b32 a29, a157
v_accvgpr_mov_b32 a30, a158
v_accvgpr_mov_b32 a31, a159
v_accvgpr_mov_b32 a32, a160
v_accvgpr_mov_b32 a33, a161
v_accvgpr_mov_b32 a34, a162
v_accvgpr_mov_b32 a35, a163
v_accvgpr_mov_b32 a36, a164
v_accvgpr_mov_b32 a37, a165
v_accvgpr_mov_b32 a38, a166
v_accvgpr_mov_b32 a39, a167
v_accvgpr_mov_b32 a40, a168
v_accvgpr_mov_b32 a41, a169
v_accvgpr_mov_b32 a42, a170
v_accvgpr_mov_b32 a43, a171
v_accvgpr_mov_b32 a44, a172
v_accvgpr_mov_b32 a45, a173
v_accvgpr_mov_b32 a46, a174
v_accvgpr_mov_b32 a47, a175
v_accvgpr_mov_b32 a48, a176
v_accvgpr_mov_b32 a49, a177
v_accvgpr_mov_b32 a50, a178
v_accvgpr_mov_b32 a51, a179
v_accvgpr_mov_b32 a52, a180
v_accvgpr_mov_b32 a53, a181
v_accvgpr_mov_b32 a54, a182
v_accvgpr_mov_b32 a55, a183
v_accvgpr_mov_b32 a56, a184
v_accvgpr_mov_b32 a57, a185
v_accvgpr_mov_b32 a58, a186
v_accvgpr_mov_b32 a59, a187
v_accvgpr_mov_b32 a60, a188
v_accvgpr_mov_b32 a61, a189
v_accvgpr_mov_b32 a62, a190
v_accvgpr_mov_b32 a63, a191
L_k2_noq:
s_cmp_eq_u32 s22, 14
s_cbranch_scc1 L_k2_eg
s_cmp_eq_u32 s22, 2
s_cbranch_scc1 L_k2_sp2
s_cmp_eq_u32 s22, 4
s_cbranch_scc1 L_k2_sp4
s_cmp_eq_u32 s22, 6
s_cbranch_scc1 L_k2_sp6
s_cmp_eq_u32 s22, 8
s_cbranch_scc0 L_k2_nd8
s_cmp_eq_u32 s16, 0
s_cbranch_scc0 L_sig11
s_lshl_b32 s29, s2, 8
s_add_u32 s29, s29, 82903056
v_mov_b32 v14, 1
v_mov_b32 v15, 0
s_mov_b64 exec, 1
buffer_store_dword v14, v15, s[12:15], s29 offen sc0 sc1
s_mov_b64 exec, -1
L_sig11:
L_k2_nd8:
s_cmp_eq_u32 s22, 12
s_cbranch_scc0 L_k2_nd12
v_mov_b32 v28, 1
s_cmp_eq_u32 s16, 0
s_cbranch_scc0 L_aux12
buffer_load_dword v28, v29, s[12:15], s45 offen sc0 sc1
L_aux12:
s_mov_b32 s76, s0
s_mov_b32 s77, s1
s_mov_b32 s78, L_f_end-L_f_pc
s_mov_b32 s79, 0x20000
s_lshr_b32 s29, s2, 3
s_lshl_b32 s29, s29, 2
s_add_u32 s29, s29, s16
s_lshl_b32 s29, s29, 10
v_and_b32 v14, 7, v0
v_lshlrev_b32 v14, 7, v14
buffer_load_dword v31, v14, s[76:79], s29 offen
L_k2_nd12:
s_branch L_k2_a0
L_k2_sp2:
s_add_u32 s74, s5, 4096
v_mfma_f32_16x16x32_bf16 v[64:67], a[64:67], a[0:3], 0
ds_read_b128 a[96:99], v2 offset:8192
v_fma_f32 v18, v50, s27, -v6
v_mfma_f32_16x16x32_bf16 v[64:67], a[68:71], a[4:7], v[64:67]
buffer_load_dwordx4 v1, s[12:15], s20 offen offset:0 lds
v_mfma_f32_16x16x32_bf16 v[64:67], a[72:75], a[8:11], v[64:67]
ds_read_b128 a[100:103], v2 offset:9216
v_fma_f32 v19, v51, s27, -v6
v_mfma_f32_16x16x32_bf16 v[64:67], a[76:79], a[12:15], v[64:67]
s_add_u32 s19, s18, 32768
v_exp_f32 v18, v18
v_mfma_f32_16x16x32_bf16 v[68:71], a[64:67], a[32:35], 0
ds_read_b128 a[104:107], v2 offset:10240
v_add_f32 v10, v10, v25
v_mfma_f32_16x16x32_bf16 v[68:71], a[68:71], a[36:39], v[68:71]
s_cmp_eq_u32 s19, 163840
v_exp_f32 v19, v19
v_mfma_f32_16x16x32_bf16 v[68:71], a[72:75], a[40:43], v[68:71]
ds_read_b128 a[108:111], v2 offset:11264
v_add_f32 v10, v10, v18
v_mfma_f32_16x16x32_bf16 v[68:71], a[76:79], a[44:47], v[68:71]
s_waitcnt lgkmcnt(4)
v_add_f32 v10, v10, v19
v_cvt_pk_bf16_f32 v105, v18, v19
v_mfma_f32_16x16x32_bf16 v[68:71], a[80:83], a[48:51], v[68:71]
ds_read_b128 a[112:115], v2 offset:12288
v_fma_f32 v16, v52, s27, -v7
v_mfma_f32_16x16x32_bf16 v[68:71], a[84:87], a[52:55], v[68:71]
buffer_load_dwordx4 v1, s[12:15], s20 offen offset:1024 lds
v_mfma_f32_16x16x32_bf16 v[68:71], a[88:91], a[56:59], v[68:71]
ds_read_b128 a[116:119], v2 offset:13312
v_fma_f32 v17, v53, s27, -v7
v_mfma_f32_16x16x32_bf16 v[68:71], a[92:95], a[60:63], v[68:71]
s_cselect_b32 s19, 0, s19
v_exp_f32 v16, v16
v_mfma_f32_16x16x32_bf16 v[64:67], a[80:83], a[16:19], v[64:67]
ds_read_b128 a[120:123], v2 offset:14336
v_cvt_pk_bf16_f32 v104, v24, v25
v_mfma_f32_16x16x32_bf16 v[64:67], a[84:87], a[20:23], v[64:67]
s_add_u32 s29, s22, 2
v_exp_f32 v17, v17
v_mfma_f32_16x16x32_bf16 v[64:67], a[88:91], a[24:27], v[64:67]
ds_read_b128 a[124:127], v2 offset:15360
v_add_f32 v11, v11, v16
v_mfma_f32_16x16x32_bf16 v[64:67], a[92:95], a[28:31], v[64:67]
s_waitcnt lgkmcnt(4)
v_add_f32 v11, v11, v17
v_cvt_pk_bf16_f32 v108, v16, v17
v_mfma_f32_16x16x32_bf16 v[72:75], a[96:99], a[0:3], 0
ds_read_b128 a[64:67], v2 offset:16384
v_fma_f32 v18, v54, s27, -v7
v_mfma_f32_16x16x32_bf16 v[72:75], a[100:103], a[4:7], v[72:75]
buffer_load_dwordx4 v1, s[12:15], s20 offen offset:2048 lds
v_mfma_f32_16x16x32_bf16 v[72:75], a[104:107], a[8:11], v[72:75]
ds_read_b128 a[68:71], v2 offset:17408
v_fma_f32 v19, v55, s27, -v7
v_mfma_f32_16x16x32_bf16 v[72:75], a[108:111], a[12:15], v[72:75]
s_cmp_eq_u32 s29, s69
v_exp_f32 v18, v18
v_mfma_f32_16x16x32_bf16 v[76:79], a[96:99], a[32:35], 0
ds_read_b128 a[72:75], v2 offset:18432
buffer_store_dwordx4 a[224:227], v1, s[12:15], s5 offen offset:0 sc0 sc1
v_mfma_f32_16x16x32_bf16 v[76:79], a[100:103], a[36:39], v[76:79]
s_cselect_b32 s21, s73, s21
v_exp_f32 v19, v19
v_mfma_f32_16x16x32_bf16 v[76:79], a[104:107], a[40:43], v[76:79]
ds_read_b128 a[76:79], v2 offset:19456
v_add_f32 v11, v11, v18
v_mfma_f32_16x16x32_bf16 v[76:79], a[108:111], a[44:47], v[76:79]
s_waitcnt lgkmcnt(4)
v_add_f32 v11, v11, v19
v_cvt_pk_bf16_f32 v109, v18, v19
v_mfma_f32_16x16x32_bf16 v[76:79], a[112:115], a[48:51], v[76:79]
ds_read_b128 a[80:83], v2 offset:20480
v_fma_f32 v16, v56, s27, -v6
v_mfma_f32_16x16x32_bf16 v[76:79], a[116:119], a[52:55], v[76:79]
buffer_load_dwordx4 v1, s[12:15], s20 offen offset:3072 lds
s_cselect_b32 s11, 28672, s11
v_mfma_f32_16x16x32_bf16 v[76:79], a[120:123], a[56:59], v[76:79]
ds_read_b128 a[84:87], v2 offset:21504
v_fma_f32 v17, v57, s27, -v6
v_mfma_f32_16x16x32_bf16 v[76:79], a[124:127], a[60:63], v[76:79]
s_add_u32 m0, m0, 4096
v_exp_f32 v16, v16
v_mfma_f32_16x16x32_bf16 v[72:75], a[112:115], a[16:19], v[72:75]
ds_read_b128 a[88:91], v2 offset:22528
buffer_store_dwordx4 a[228:231], v1, s[12:15], s5 offen offset:1024 sc0 sc1
v_mfma_f32_16x16x32_bf16 v[72:75], a[116:119], a[20:23], v[72:75]
s_add_u32 s20, s20, 4096
v_exp_f32 v17, v17
v_mfma_f32_16x16x32_bf16 v[72:75], a[120:123], a[24:27], v[72:75]
ds_read_b128 a[92:95], v2 offset:23552
v_add_f32 v10, v10, v16
v_mfma_f32_16x16x32_bf16 v[72:75], a[124:127], a[28:31], v[72:75]
s_waitcnt lgkmcnt(4)
v_add_f32 v10, v10, v17
v_cvt_pk_bf16_f32 v106, v16, v17
v_mfma_f32_16x16x32_bf16 v[80:83], a[64:67], a[0:3], 0
ds_read_b128 a[96:99], v2 offset:24576
v_fma_f32 v18, v58, s27, -v6
v_mfma_f32_16x16x32_bf16 v[80:83], a[68:71], a[4:7], v[80:83]
buffer_load_dwordx4 v1, s[12:15], s20 offen offset:0 lds
v_mfma_f32_16x16x32_bf16 v[80:83], a[72:75], a[8:11], v[80:83]
ds_read_b128 a[100:103], v2 offset:25600
v_fma_f32 v19, v59, s27, -v6
v_mfma_f32_16x16x32_bf16 v[80:83], a[76:79], a[12:15], v[80:83]
v_exp_f32 v18, v18
v_mfma_f32_16x16x32_bf16 v[84:87], a[64:67], a[32:35], 0
ds_read_b128 a[104:107], v2 offset:26624
buffer_store_dwordx4 a[232:235], v1, s[12:15], s5 offen offset:2048 sc0 sc1
v_mfma_f32_16x16x32_bf16 v[84:87], a[68:71], a[36:39], v[84:87]
s_add_u32 s30, s18, s17
v_exp_f32 v19, v19
v_mfma_f32_16x16x32_bf16 v[84:87], a[72:75], a[40:43], v[84:87]
ds_read_b128 a[108:111], v2 offset:27648
v_add_f32 v10, v10, v18
v_mfma_f32_16x16x32_bf16 v[84:87], a[76:79], a[44:47], v[84:87]
s_waitcnt lgkmcnt(4)
v_add_f32 v10, v10, v19
v_cvt_pk_bf16_f32 v107, v18, v19
v_mfma_f32_16x16x32_bf16 v[84:87], a[80:83], a[48:51], v[84:87]
ds_read_b128 a[112:115], v2 offset:28672
v_fma_f32 v16, v60, s27, -v7
v_mfma_f32_16x16x32_bf16 v[84:87], a[84:87], a[52:55], v[84:87]
buffer_load_dwordx4 v1, s[12:15], s20 offen offset:1024 lds
v_mfma_f32_16x16x32_bf16 v[84:87], a[88:91], a[56:59], v[84:87]
ds_read_b128 a[116:119], v2 offset:29696
v_fma_f32 v17, v61, s27, -v7
v_mfma_f32_16x16x32_bf16 v[84:87], a[92:95], a[60:63], v[84:87]
s_mov_b32 s18, s19
v_exp_f32 v16, v16
v_mfma_f32_16x16x32_bf16 v[80:83], a[80:83], a[16:19], v[80:83]
ds_read_b128 a[120:123], v2 offset:30720
v_add_u32 v3, s19, v1
v_mfma_f32_16x16x32_bf16 v[80:83], a[84:87], a[20:23], v[80:83]
s_add_u32 s31, s20, s10
v_exp_f32 v17, v17
v_mfma_f32_16x16x32_bf16 v[80:83], a[88:91], a[24:27], v[80:83]
ds_read_b128 a[124:127], v2 offset:31744
v_add_f32 v11, v11, v16
v_mfma_f32_16x16x32_bf16 v[80:83], a[92:95], a[28:31], v[80:83]
s_waitcnt lgkmcnt(4)
v_add_f32 v11, v11, v17
v_cvt_pk_bf16_f32 v110, v16, v17
v_mfma_f32_16x16x32_bf16 v[88:91], a[96:99], a[0:3], 0
ds_read_b128 a[64:67], v3 offset:0
v_fma_f32 v18, v62, s27, -v7
v_mfma_f32_16x16x32_bf16 v[88:91], a[100:103], a[4:7], v[88:91]
buffer_load_dwordx4 v1, s[12:15], s20 offen offset:2048 lds
v_mfma_f32_16x16x32_bf16 v[88:91], a[104:107], a[8:11], v[88:91]
ds_read_b128 a[68:71], v3 offset:16384
v_fma_f32 v19, v63, s27, -v7
v_mfma_f32_16x16x32_bf16 v[88:91], a[108:111], a[12:15], v[88:91]
s_bitcmp1_b32 s24, s22
v_exp_f32 v18, v18
v_mfma_f32_16x16x32_bf16 v[92:95], a[96:99], a[32:35], 0
ds_read_b128 a[72:75], v3 offset:1024
buffer_store_dwordx4 a[236:239], v1, s[12:15], s5 offen offset:3072 sc0 sc1
v_mfma_f32_16x16x32_bf16 v[92:95], a[100:103], a[36:39], v[92:95]
s_waitcnt vmcnt(15)
v_exp_f32 v19, v19
v_mfma_f32_16x16x32_bf16 v[92:95], a[104:107], a[40:43], v[92:95]
ds_read_b128 a[76:79], v3 offset:17408
v_add_f32 v11, v11, v18
v_mfma_f32_16x16x32_bf16 v[92:95], a[108:111], a[44:47], v[92:95]
s_waitcnt lgkmcnt(4)
v_add_f32 v11, v11, v19
v_cvt_pk_bf16_f32 v111, v18, v19
v_mfma_f32_16x16x32_bf16 v[92:95], a[112:115], a[48:51], v[92:95]
ds_read_b128 a[80:83], v3 offset:2048
v_add_f32 v14, v10, v11
v_mfma_f32_16x16x32_bf16 v[92:95], a[116:119], a[52:55], v[92:95]
buffer_load_dwordx4 v1, s[12:15], s20 offen offset:3072 lds
v_mfma_f32_16x16x32_bf16 v[92:95], a[120:123], a[56:59], v[92:95]
ds_read_b128 a[84:87], v3 offset:18432
v_cmp_nge_f32 vcc, s28, v14
v_mfma_f32_16x16x32_bf16 v[92:95], a[124:127], a[60:63], v[92:95]
s_mov_b32 m0, s30
buffer_store_dwordx4 a[240:243], v1, s[12:15], s74 offen offset:0 sc0 sc1
v_mfma_f32_16x16x32_bf16 v[88:91], a[112:115], a[16:19], v[88:91]
ds_read_b128 a[88:91], v3 offset:3072
v_mfma_f32_16x16x32_bf16 v[88:91], a[116:119], a[20:23], v[88:91]
s_barrier
buffer_store_dwordx4 a[244:247], v1, s[12:15], s74 offen offset:1024 sc0 sc1
v_mfma_f32_16x16x32_bf16 v[88:91], a[120:123], a[24:27], v[88:91]
ds_read_b128 a[92:95], v3 offset:19456
s_mov_b32 s20, s31
v_mfma_f32_16x16x32_bf16 v[88:91], a[124:127], a[28:31], v[88:91]
s_waitcnt lgkmcnt(4)
buffer_store_dwordx4 a[248:251], v1, s[12:15], s74 offen offset:2048 sc0 sc1
s_cbranch_scc1 L_k2_eva0
s_cbranch_vccnz L_k2_eva0
s_branch L_k2_b0
L_k2_sp4:
s_add_u32 s74, s4, 0
s_add_u32 s75, s4, 188416
s_add_u32 s76, s4, 376832
s_add_u32 s77, s4, 565248
v_mfma_f32_16x16x32_bf16 v[64:67], a[64:67], a[0:3], 0
ds_read_b128 a[96:99], v2 offset:8192
v_fma_f32 v18, v50, s27, -v6
v_mfma_f32_16x16x32_bf16 v[64:67], a[68:71], a[4:7], v[64:67]
buffer_load_dwordx4 v1, s[12:15], s20 offen offset:0 lds
v_mfma_f32_16x16x32_bf16 v[64:67], a[72:75], a[8:11], v[64:67]
ds_read_b128 a[100:103], v2 offset:9216
v_fma_f32 v19, v51, s27, -v6
v_mfma_f32_16x16x32_bf16 v[64:67], a[76:79], a[12:15], v[64:67]
s_add_u32 s19, s18, 32768
v_exp_f32 v18, v18
v_mfma_f32_16x16x32_bf16 v[68:71], a[64:67], a[32:35], 0
ds_read_b128 a[104:107], v2 offset:10240
v_add_f32 v10, v10, v25
v_mfma_f32_16x16x32_bf16 v[68:71], a[68:71], a[36:39], v[68:71]
s_cmp_eq_u32 s19, 163840
v_exp_f32 v19, v19
v_mfma_f32_16x16x32_bf16 v[68:71], a[72:75], a[40:43], v[68:71]
ds_read_b128 a[108:111], v2 offset:11264
v_add_f32 v10, v10, v18
v_mfma_f32_16x16x32_bf16 v[68:71], a[76:79], a[44:47], v[68:71]
s_waitcnt lgkmcnt(4)
v_add_f32 v10, v10, v19
v_cvt_pk_bf16_f32 v105, v18, v19
v_mfma_f32_16x16x32_bf16 v[68:71], a[80:83], a[48:51], v[68:71]
ds_read_b128 a[112:115], v2 offset:12288
v_fma_f32 v16, v52, s27, -v7
v_mfma_f32_16x16x32_bf16 v[68:71], a[84:87], a[52:55], v[68:71]
buffer_load_dwordx4 v1, s[12:15], s20 offen offset:1024 lds
v_mfma_f32_16x16x32_bf16 v[68:71], a[88:91], a[56:59], v[68:71]
ds_read_b128 a[116:119], v2 offset:13312
v_fma_f32 v17, v53, s27, -v7
v_mfma_f32_16x16x32_bf16 v[68:71], a[92:95], a[60:63], v[68:71]
s_cselect_b32 s19, 0, s19
v_exp_f32 v16, v16
v_mfma_f32_16x16x32_bf16 v[64:67], a[80:83], a[16:19], v[64:67]
ds_read_b128 a[120:123], v2 offset:14336
v_cvt_pk_bf16_f32 v104, v24, v25
v_mfma_f32_16x16x32_bf16 v[64:67], a[84:87], a[20:23], v[64:67]
s_add_u32 s29, s22, 2
v_exp_f32 v17, v17
v_mfma_f32_16x16x32_bf16 v[64:67], a[88:91], a[24:27], v[64:67]
ds_read_b128 a[124:127], v2 offset:15360
v_add_f32 v11, v11, v16
v_mfma_f32_16x16x32_bf16 v[64:67], a[92:95], a[28:31], v[64:67]
s_waitcnt lgkmcnt(4)
v_add_f32 v11, v11, v17
v_cvt_pk_bf16_f32 v108, v16, v17
v_mfma_f32_16x16x32_bf16 v[72:75], a[96:99], a[0:3], 0
ds_read_b128 a[64:67], v2 offset:16384
v_fma_f32 v18, v54, s27, -v7
v_mfma_f32_16x16x32_bf16 v[72:75], a[100:103], a[4:7], v[72:75]
buffer_load_dwordx4 v1, s[12:15], s20 offen offset:2048 lds
v_mfma_f32_16x16x32_bf16 v[72:75], a[104:107], a[8:11], v[72:75]
ds_read_b128 a[68:71], v2 offset:17408
v_fma_f32 v19, v55, s27, -v7
v_mfma_f32_16x16x32_bf16 v[72:75], a[108:111], a[12:15], v[72:75]
s_cmp_eq_u32 s29, s69
v_exp_f32 v18, v18
v_mfma_f32_16x16x32_bf16 v[76:79], a[96:99], a[32:35], 0
ds_read_b128 a[72:75], v2 offset:18432
buffer_store_dwordx4 a[160:163], v1, s[12:15], s74 offen offset:0 sc0 sc1
v_mfma_f32_16x16x32_bf16 v[76:79], a[100:103], a[36:39], v[76:79]
s_cselect_b32 s21, s73, s21
v_exp_f32 v19, v19
v_mfma_f32_16x16x32_bf16 v[76:79], a[104:107], a[40:43], v[76:79]
ds_read_b128 a[76:79], v2 offset:19456
v_add_f32 v11, v11, v18
v_mfma_f32_16x16x32_bf16 v[76:79], a[108:111], a[44:47], v[76:79]
s_waitcnt lgkmcnt(4)
v_add_f32 v11, v11, v19
v_cvt_pk_bf16_f32 v109, v18, v19
v_mfma_f32_16x16x32_bf16 v[76:79], a[112:115], a[48:51], v[76:79]
ds_read_b128 a[80:83], v2 offset:20480
v_fma_f32 v16, v56, s27, -v6
v_mfma_f32_16x16x32_bf16 v[76:79], a[116:119], a[52:55], v[76:79]
buffer_load_dwordx4 v1, s[12:15], s20 offen offset:3072 lds
s_cselect_b32 s11, 28672, s11
v_mfma_f32_16x16x32_bf16 v[76:79], a[120:123], a[56:59], v[76:79]
ds_read_b128 a[84:87], v2 offset:21504
v_fma_f32 v17, v57, s27, -v6
v_mfma_f32_16x16x32_bf16 v[76:79], a[124:127], a[60:63], v[76:79]
s_add_u32 m0, m0, 4096
v_exp_f32 v16, v16
v_mfma_f32_16x16x32_bf16 v[72:75], a[112:115], a[16:19], v[72:75]
ds_read_b128 a[88:91], v2 offset:22528
buffer_store_dwordx4 a[164:167], v1, s[12:15], s74 offen offset:1024 sc0 sc1
v_mfma_f32_16x16x32_bf16 v[72:75], a[116:119], a[20:23], v[72:75]
s_add_u32 s20, s20, 4096
v_exp_f32 v17, v17
v_mfma_f32_16x16x32_bf16 v[72:75], a[120:123], a[24:27], v[72:75]
ds_read_b128 a[92:95], v2 offset:23552
v_add_f32 v10, v10, v16
v_mfma_f32_16x16x32_bf16 v[72:75], a[124:127], a[28:31], v[72:75]
s_waitcnt lgkmcnt(4)
v_add_f32 v10, v10, v17
v_cvt_pk_bf16_f32 v106, v16, v17
v_mfma_f32_16x16x32_bf16 v[80:83], a[64:67], a[0:3], 0
ds_read_b128 a[96:99], v2 offset:24576
v_fma_f32 v18, v58, s27, -v6
v_mfma_f32_16x16x32_bf16 v[80:83], a[68:71], a[4:7], v[80:83]
buffer_load_dwordx4 v1, s[12:15], s20 offen offset:0 lds
v_mfma_f32_16x16x32_bf16 v[80:83], a[72:75], a[8:11], v[80:83]
ds_read_b128 a[100:103], v2 offset:25600
v_fma_f32 v19, v59, s27, -v6
v_mfma_f32_16x16x32_bf16 v[80:83], a[76:79], a[12:15], v[80:83]
v_exp_f32 v18, v18
v_mfma_f32_16x16x32_bf16 v[84:87], a[64:67], a[32:35], 0
ds_read_b128 a[104:107], v2 offset:26624
buffer_store_dwordx4 a[168:171], v1, s[12:15], s75 offen offset:0 sc0 sc1
v_mfma_f32_16x16x32_bf16 v[84:87], a[68:71], a[36:39], v[84:87]
s_add_u32 s30, s18, s17
v_exp_f32 v19, v19
v_mfma_f32_16x16x32_bf16 v[84:87], a[72:75], a[40:43], v[84:87]
ds_read_b128 a[108:111], v2 offset:27648
v_add_f32 v10, v10, v18
v_mfma_f32_16x16x32_bf16 v[84:87], a[76:79], a[44:47], v[84:87]
s_waitcnt lgkmcnt(4)
v_add_f32 v10, v10, v19
v_cvt_pk_bf16_f32 v107, v18, v19
v_mfma_f32_16x16x32_bf16 v[84:87], a[80:83], a[48:51], v[84:87]
ds_read_b128 a[112:115], v2 offset:28672
v_fma_f32 v16, v60, s27, -v7
v_mfma_f32_16x16x32_bf16 v[84:87], a[84:87], a[52:55], v[84:87]
buffer_load_dwordx4 v1, s[12:15], s20 offen offset:1024 lds
v_mfma_f32_16x16x32_bf16 v[84:87], a[88:91], a[56:59], v[84:87]
ds_read_b128 a[116:119], v2 offset:29696
v_fma_f32 v17, v61, s27, -v7
v_mfma_f32_16x16x32_bf16 v[84:87], a[92:95], a[60:63], v[84:87]
s_mov_b32 s18, s19
v_exp_f32 v16, v16
v_mfma_f32_16x16x32_bf16 v[80:83], a[80:83], a[16:19], v[80:83]
ds_read_b128 a[120:123], v2 offset:30720
v_add_u32 v3, s19, v1
v_mfma_f32_16x16x32_bf16 v[80:83], a[84:87], a[20:23], v[80:83]
s_add_u32 s31, s20, s10
v_exp_f32 v17, v17
v_mfma_f32_16x16x32_bf16 v[80:83], a[88:91], a[24:27], v[80:83]
ds_read_b128 a[124:127], v2 offset:31744
v_add_f32 v11, v11, v16
v_mfma_f32_16x16x32_bf16 v[80:83], a[92:95], a[28:31], v[80:83]
s_waitcnt lgkmcnt(4)
v_add_f32 v11, v11, v17
v_cvt_pk_bf16_f32 v110, v16, v17
v_mfma_f32_16x16x32_bf16 v[88:91], a[96:99], a[0:3], 0
ds_read_b128 a[64:67], v3 offset:0
v_fma_f32 v18, v62, s27, -v7
v_mfma_f32_16x16x32_bf16 v[88:91], a[100:103], a[4:7], v[88:91]
buffer_load_dwordx4 v1, s[12:15], s20 offen offset:2048 lds
v_mfma_f32_16x16x32_bf16 v[88:91], a[104:107], a[8:11], v[88:91]
ds_read_b128 a[68:71], v3 offset:16384
v_fma_f32 v19, v63, s27, -v7
v_mfma_f32_16x16x32_bf16 v[88:91], a[108:111], a[12:15], v[88:91]
s_bitcmp1_b32 s24, s22
v_exp_f32 v18, v18
v_mfma_f32_16x16x32_bf16 v[92:95], a[96:99], a[32:35], 0
ds_read_b128 a[72:75], v3 offset:1024
buffer_store_dwordx4 a[172:175], v1, s[12:15], s75 offen offset:1024 sc0 sc1
v_mfma_f32_16x16x32_bf16 v[92:95], a[100:103], a[36:39], v[92:95]
s_waitcnt vmcnt(15)
v_exp_f32 v19, v19
v_mfma_f32_16x16x32_bf16 v[92:95], a[104:107], a[40:43], v[92:95]
ds_read_b128 a[76:79], v3 offset:17408
v_add_f32 v11, v11, v18
v_mfma_f32_16x16x32_bf16 v[92:95], a[108:111], a[44:47], v[92:95]
s_waitcnt lgkmcnt(4)
v_add_f32 v11, v11, v19
v_cvt_pk_bf16_f32 v111, v18, v19
v_mfma_f32_16x16x32_bf16 v[92:95], a[112:115], a[48:51], v[92:95]
ds_read_b128 a[80:83], v3 offset:2048
v_add_f32 v14, v10, v11
v_mfma_f32_16x16x32_bf16 v[92:95], a[116:119], a[52:55], v[92:95]
buffer_load_dwordx4 v1, s[12:15], s20 offen offset:3072 lds
v_mfma_f32_16x16x32_bf16 v[92:95], a[120:123], a[56:59], v[92:95]
ds_read_b128 a[84:87], v3 offset:18432
v_cmp_nge_f32 vcc, s28, v14
v_mfma_f32_16x16x32_bf16 v[92:95], a[124:127], a[60:63], v[92:95]
s_mov_b32 m0, s30
buffer_store_dwordx4 a[176:179], v1, s[12:15], s76 offen offset:0 sc0 sc1
v_mfma_f32_16x16x32_bf16 v[88:91], a[112:115], a[16:19], v[88:91]
ds_read_b128 a[88:91], v3 offset:3072
buffer_store_dwordx4 a[188:191], v1, s[12:15], s77 offen offset:1024 sc0 sc1
v_mfma_f32_16x16x32_bf16 v[88:91], a[116:119], a[20:23], v[88:91]
s_barrier
buffer_store_dwordx4 a[180:183], v1, s[12:15], s76 offen offset:1024 sc0 sc1
v_mfma_f32_16x16x32_bf16 v[88:91], a[120:123], a[24:27], v[88:91]
ds_read_b128 a[92:95], v3 offset:19456
s_mov_b32 s20, s31
v_mfma_f32_16x16x32_bf16 v[88:91], a[124:127], a[28:31], v[88:91]
s_waitcnt lgkmcnt(4)
buffer_store_dwordx4 a[184:187], v1, s[12:15], s77 offen offset:0 sc0 sc1
s_cbranch_scc1 L_k2_eva0
s_cbranch_vccnz L_k2_eva0
s_branch L_k2_b0
L_k2_sp6:
s_add_u32 s74, s4, 753664
s_add_u32 s75, s4, 942080
s_add_u32 s76, s4, 1130496
s_add_u32 s77, s4, 1318912
v_mfma_f32_16x16x32_bf16 v[64:67], a[64:67], a[0:3], 0
ds_read_b128 a[96:99], v2 offset:8192
v_fma_f32 v18, v50, s27, -v6
v_mfma_f32_16x16x32_bf16 v[64:67], a[68:71], a[4:7], v[64:67]
buffer_load_dwordx4 v1, s[12:15], s20 offen offset:0 lds
v_mfma_f32_16x16x32_bf16 v[64:67], a[72:75], a[8:11], v[64:67]
ds_read_b128 a[100:103], v2 offset:9216
v_fma_f32 v19, v51, s27, -v6
v_mfma_f32_16x16x32_bf16 v[64:67], a[76:79], a[12:15], v[64:67]
s_add_u32 s19, s18, 32768
v_exp_f32 v18, v18
v_mfma_f32_16x16x32_bf16 v[68:71], a[64:67], a[32:35], 0
ds_read_b128 a[104:107], v2 offset:10240
v_add_f32 v10, v10, v25
v_mfma_f32_16x16x32_bf16 v[68:71], a[68:71], a[36:39], v[68:71]
s_cmp_eq_u32 s19, 163840
v_exp_f32 v19, v19
v_mfma_f32_16x16x32_bf16 v[68:71], a[72:75], a[40:43], v[68:71]
ds_read_b128 a[108:111], v2 offset:11264
v_add_f32 v10, v10, v18
v_mfma_f32_16x16x32_bf16 v[68:71], a[76:79], a[44:47], v[68:71]
s_waitcnt lgkmcnt(4)
v_add_f32 v10, v10, v19
v_cvt_pk_bf16_f32 v105, v18, v19
v_mfma_f32_16x16x32_bf16 v[68:71], a[80:83], a[48:51], v[68:71]
ds_read_b128 a[112:115], v2 offset:12288
v_fma_f32 v16, v52, s27, -v7
v_mfma_f32_16x16x32_bf16 v[68:71], a[84:87], a[52:55], v[68:71]
buffer_load_dwordx4 v1, s[12:15], s20 offen offset:1024 lds
v_mfma_f32_16x16x32_bf16 v[68:71], a[88:91], a[56:59], v[68:71]
ds_read_b128 a[116:119], v2 offset:13312
v_fma_f32 v17, v53, s27, -v7
v_mfma_f32_16x16x32_bf16 v[68:71], a[92:95], a[60:63], v[68:71]
s_cselect_b32 s19, 0, s19
v_exp_f32 v16, v16
v_mfma_f32_16x16x32_bf16 v[64:67], a[80:83], a[16:19], v[64:67]
ds_read_b128 a[120:123], v2 offset:14336
v_cvt_pk_bf16_f32 v104, v24, v25
v_mfma_f32_16x16x32_bf16 v[64:67], a[84:87], a[20:23], v[64:67]
s_add_u32 s29, s22, 2
v_exp_f32 v17, v17
v_mfma_f32_16x16x32_bf16 v[64:67], a[88:91], a[24:27], v[64:67]
ds_read_b128 a[124:127], v2 offset:15360
v_add_f32 v11, v11, v16
v_mfma_f32_16x16x32_bf16 v[64:67], a[92:95], a[28:31], v[64:67]
s_waitcnt lgkmcnt(4)
v_add_f32 v11, v11, v17
v_cvt_pk_bf16_f32 v108, v16, v17
v_mfma_f32_16x16x32_bf16 v[72:75], a[96:99], a[0:3], 0
ds_read_b128 a[64:67], v2 offset:16384
v_fma_f32 v18, v54, s27, -v7
v_mfma_f32_16x16x32_bf16 v[72:75], a[100:103], a[4:7], v[72:75]
buffer_load_dwordx4 v1, s[12:15], s20 offen offset:2048 lds
v_mfma_f32_16x16x32_bf16 v[72:75], a[104:107], a[8:11], v[72:75]
ds_read_b128 a[68:71], v2 offset:17408
v_fma_f32 v19, v55, s27, -v7
v_mfma_f32_16x16x32_bf16 v[72:75], a[108:111], a[12:15], v[72:75]
s_cmp_eq_u32 s29, s69
v_exp_f32 v18, v18
v_mfma_f32_16x16x32_bf16 v[76:79], a[96:99], a[32:35], 0
ds_read_b128 a[72:75], v2 offset:18432
buffer_store_dwordx4 a[192:195], v1, s[12:15], s74 offen offset:0 sc0 sc1
v_mfma_f32_16x16x32_bf16 v[76:79], a[100:103], a[36:39], v[76:79]
s_cselect_b32 s21, s73, s21
v_exp_f32 v19, v19
v_mfma_f32_16x16x32_bf16 v[76:79], a[104:107], a[40:43], v[76:79]
ds_read_b128 a[76:79], v2 offset:19456
v_add_f32 v11, v11, v18
v_mfma_f32_16x16x32_bf16 v[76:79], a[108:111], a[44:47], v[76:79]
s_waitcnt lgkmcnt(4)
v_add_f32 v11, v11, v19
v_cvt_pk_bf16_f32 v109, v18, v19
v_mfma_f32_16x16x32_bf16 v[76:79], a[112:115], a[48:51], v[76:79]
ds_read_b128 a[80:83], v2 offset:20480
v_fma_f32 v16, v56, s27, -v6
v_mfma_f32_16x16x32_bf16 v[76:79], a[116:119], a[52:55], v[76:79]
buffer_load_dwordx4 v1, s[12:15], s20 offen offset:3072 lds
s_cselect_b32 s11, 28672, s11
v_mfma_f32_16x16x32_bf16 v[76:79], a[120:123], a[56:59], v[76:79]
ds_read_b128 a[84:87], v2 offset:21504
v_fma_f32 v17, v57, s27, -v6
v_mfma_f32_16x16x32_bf16 v[76:79], a[124:127], a[60:63], v[76:79]
s_add_u32 m0, m0, 4096
v_exp_f32 v16, v16
v_mfma_f32_16x16x32_bf16 v[72:75], a[112:115], a[16:19], v[72:75]
ds_read_b128 a[88:91], v2 offset:22528
buffer_store_dwordx4 a[196:199], v1, s[12:15], s74 offen offset:1024 sc0 sc1
v_mfma_f32_16x16x32_bf16 v[72:75], a[116:119], a[20:23], v[72:75]
s_add_u32 s20, s20, 4096
v_exp_f32 v17, v17
v_mfma_f32_16x16x32_bf16 v[72:75], a[120:123], a[24:27], v[72:75]
ds_read_b128 a[92:95], v2 offset:23552
v_add_f32 v10, v10, v16
v_mfma_f32_16x16x32_bf16 v[72:75], a[124:127], a[28:31], v[72:75]
s_waitcnt lgkmcnt(4)
v_add_f32 v10, v10, v17
v_cvt_pk_bf16_f32 v106, v16, v17
v_mfma_f32_16x16x32_bf16 v[80:83], a[64:67], a[0:3], 0
ds_read_b128 a[96:99], v2 offset:24576
v_fma_f32 v18, v58, s27, -v6
v_mfma_f32_16x16x32_bf16 v[80:83], a[68:71], a[4:7], v[80:83]
buffer_load_dwordx4 v1, s[12:15], s20 offen offset:0 lds
v_mfma_f32_16x16x32_bf16 v[80:83], a[72:75], a[8:11], v[80:83]
ds_read_b128 a[100:103], v2 offset:25600
v_fma_f32 v19, v59, s27, -v6
v_mfma_f32_16x16x32_bf16 v[80:83], a[76:79], a[12:15], v[80:83]
v_exp_f32 v18, v18
v_mfma_f32_16x16x32_bf16 v[84:87], a[64:67], a[32:35], 0
ds_read_b128 a[104:107], v2 offset:26624
buffer_store_dwordx4 a[200:203], v1, s[12:15], s75 offen offset:0 sc0 sc1
v_mfma_f32_16x16x32_bf16 v[84:87], a[68:71], a[36:39], v[84:87]
s_add_u32 s30, s18, s17
v_exp_f32 v19, v19
v_mfma_f32_16x16x32_bf16 v[84:87], a[72:75], a[40:43], v[84:87]
ds_read_b128 a[108:111], v2 offset:27648
v_add_f32 v10, v10, v18
v_mfma_f32_16x16x32_bf16 v[84:87], a[76:79], a[44:47], v[84:87]
s_waitcnt lgkmcnt(4)
v_add_f32 v10, v10, v19
v_cvt_pk_bf16_f32 v107, v18, v19
v_mfma_f32_16x16x32_bf16 v[84:87], a[80:83], a[48:51], v[84:87]
ds_read_b128 a[112:115], v2 offset:28672
v_fma_f32 v16, v60, s27, -v7
v_mfma_f32_16x16x32_bf16 v[84:87], a[84:87], a[52:55], v[84:87]
buffer_load_dwordx4 v1, s[12:15], s20 offen offset:1024 lds
v_mfma_f32_16x16x32_bf16 v[84:87], a[88:91], a[56:59], v[84:87]
ds_read_b128 a[116:119], v2 offset:29696
v_fma_f32 v17, v61, s27, -v7
v_mfma_f32_16x16x32_bf16 v[84:87], a[92:95], a[60:63], v[84:87]
s_mov_b32 s18, s19
v_exp_f32 v16, v16
v_mfma_f32_16x16x32_bf16 v[80:83], a[80:83], a[16:19], v[80:83]
ds_read_b128 a[120:123], v2 offset:30720
v_add_u32 v3, s19, v1
v_mfma_f32_16x16x32_bf16 v[80:83], a[84:87], a[20:23], v[80:83]
s_add_u32 s31, s20, s10
v_exp_f32 v17, v17
v_mfma_f32_16x16x32_bf16 v[80:83], a[88:91], a[24:27], v[80:83]
ds_read_b128 a[124:127], v2 offset:31744
v_add_f32 v11, v11, v16
v_mfma_f32_16x16x32_bf16 v[80:83], a[92:95], a[28:31], v[80:83]
s_waitcnt lgkmcnt(4)
v_add_f32 v11, v11, v17
v_cvt_pk_bf16_f32 v110, v16, v17
v_mfma_f32_16x16x32_bf16 v[88:91], a[96:99], a[0:3], 0
ds_read_b128 a[64:67], v3 offset:0
v_fma_f32 v18, v62, s27, -v7
v_mfma_f32_16x16x32_bf16 v[88:91], a[100:103], a[4:7], v[88:91]
buffer_load_dwordx4 v1, s[12:15], s20 offen offset:2048 lds
v_mfma_f32_16x16x32_bf16 v[88:91], a[104:107], a[8:11], v[88:91]
ds_read_b128 a[68:71], v3 offset:16384
v_fma_f32 v19, v63, s27, -v7
v_mfma_f32_16x16x32_bf16 v[88:91], a[108:111], a[12:15], v[88:91]
s_bitcmp1_b32 s24, s22
v_exp_f32 v18, v18
v_mfma_f32_16x16x32_bf16 v[92:95], a[96:99], a[32:35], 0
ds_read_b128 a[72:75], v3 offset:1024
buffer_store_dwordx4 a[204:207], v1, s[12:15], s75 offen offset:1024 sc0 sc1
v_mfma_f32_16x16x32_bf16 v[92:95], a[100:103], a[36:39], v[92:95]
s_waitcnt vmcnt(15)
v_exp_f32 v19, v19
v_mfma_f32_16x16x32_bf16 v[92:95], a[104:107], a[40:43], v[92:95]
ds_read_b128 a[76:79], v3 offset:17408
v_add_f32 v11, v11, v18
v_mfma_f32_16x16x32_bf16 v[92:95], a[108:111], a[44:47], v[92:95]
s_waitcnt lgkmcnt(4)
v_add_f32 v11, v11, v19
v_cvt_pk_bf16_f32 v111, v18, v19
v_mfma_f32_16x16x32_bf16 v[92:95], a[112:115], a[48:51], v[92:95]
ds_read_b128 a[80:83], v3 offset:2048
v_add_f32 v14, v10, v11
v_mfma_f32_16x16x32_bf16 v[92:95], a[116:119], a[52:55], v[92:95]
buffer_load_dwordx4 v1, s[12:15], s20 offen offset:3072 lds
v_mfma_f32_16x16x32_bf16 v[92:95], a[120:123], a[56:59], v[92:95]
ds_read_b128 a[84:87], v3 offset:18432
v_cmp_nge_f32 vcc, s28, v14
v_mfma_f32_16x16x32_bf16 v[92:95], a[124:127], a[60:63], v[92:95]
s_mov_b32 m0, s30
buffer_store_dwordx4 a[208:211], v1, s[12:15], s76 offen offset:0 sc0 sc1
v_mfma_f32_16x16x32_bf16 v[88:91], a[112:115], a[16:19], v[88:91]
ds_read_b128 a[88:91], v3 offset:3072
buffer_store_dwordx4 a[220:223], v1, s[12:15], s77 offen offset:1024 sc0 sc1
v_mfma_f32_16x16x32_bf16 v[88:91], a[116:119], a[20:23], v[88:91]
s_barrier
buffer_store_dwordx4 a[212:215], v1, s[12:15], s76 offen offset:1024 sc0 sc1
v_mfma_f32_16x16x32_bf16 v[88:91], a[120:123], a[24:27], v[88:91]
ds_read_b128 a[92:95], v3 offset:19456
s_mov_b32 s20, s31
v_mfma_f32_16x16x32_bf16 v[88:91], a[124:127], a[28:31], v[88:91]
s_waitcnt lgkmcnt(4)
buffer_store_dwordx4 a[216:219], v1, s[12:15], s77 offen offset:0 sc0 sc1
s_cbranch_scc1 L_k2_eva0
s_cbranch_vccnz L_k2_eva0
s_branch L_k2_b0
L_k2_evb1:
s_call_b64 s[46:47], L_k2_ostore
s_branch L_k2_a1
L_k2_eva0:
s_cbranch_vccz L_k2_cs0
s_call_b64 s[46:47], L_k2_slow0
L_k2_cs0:
s_cmp_eq_u32 s22, s83
s_cbranch_scc0 L_k2_cc0
s_call_b64 s[46:47], L_k2_x
L_k2_cc0:
s_branch L_k2_b0
L_k2_eva1:
s_cbranch_vccz L_k2_cs1
s_call_b64 s[46:47], L_k2_slow1
L_k2_cs1:
s_cmp_eq_u32 s22, s23
s_cbranch_scc0 L_k2_b1
s_waitcnt vmcnt(8)
s_call_b64 s[46:47], L_k2_pub
s_branch L_k2_b1
L_k2_eg:
v_cmp_ne_u32 vcc, 1, v28
s_nop 4
s_cbranch_vccz L_auxc13
s_mov_b32 s42, 0
L_poll14:
buffer_load_dword v28, v29, s[12:15], s45 offen sc0 sc1
s_waitcnt vmcnt(0)
v_cmp_ne_u32 vcc, 1, v28
s_nop 4
s_cbranch_vccnz L_poll14_r
s_branch L_poll14_ok
L_poll14_r:
s_add_u32 s42, s42, 1
s_cmp_lt_u32 s42, 32768
s_sleep 4
s_cbranch_scc1 L_poll14
L_poll14_ok:
L_auxc13:
s_barrier
s_add_u32 m0, s40, 65536
s_add_u32 s41, s37, 0
s_add_u32 s42, s41, s39
v_mfma_f32_16x16x32_bf16 v[64:67], a[64:67], a[0:3], 0
ds_read_b128 a[96:99], v2 offset:8192
v_fma_f32 v18, v50, s27, -v6
v_mfma_f32_16x16x32_bf16 v[64:67], a[68:71], a[4:7], v[64:67]
buffer_load_dwordx4 v1, s[12:15], s41 offen offset:0 lds
v_mfma_f32_16x16x32_bf16 v[64:67], a[72:75], a[8:11], v[64:67]
ds_read_b128 a[100:103], v2 offset:9216
v_fma_f32 v19, v51, s27, -v6
v_mfma_f32_16x16x32_bf16 v[64:67], a[76:79], a[12:15], v[64:67]
v_exp_f32 v18, v18
v_mfma_f32_16x16x32_bf16 v[68:71], a[64:67], a[32:35], 0
ds_read_b128 a[104:107], v2 offset:10240
v_add_f32 v10, v10, v25
v_mfma_f32_16x16x32_bf16 v[68:71], a[68:71], a[36:39], v[68:71]
v_exp_f32 v19, v19
v_mfma_f32_16x16x32_bf16 v[68:71], a[72:75], a[40:43], v[68:71]
ds_read_b128 a[108:111], v2 offset:11264
v_add_f32 v10, v10, v18
v_mfma_f32_16x16x32_bf16 v[68:71], a[76:79], a[44:47], v[68:71]
s_waitcnt lgkmcnt(4)
v_add_f32 v10, v10, v19
v_cvt_pk_bf16_f32 v105, v18, v19
v_mfma_f32_16x16x32_bf16 v[68:71], a[80:83], a[48:51], v[68:71]
ds_read_b128 a[112:115], v2 offset:12288
v_fma_f32 v16, v52, s27, -v7
v_mfma_f32_16x16x32_bf16 v[68:71], a[84:87], a[52:55], v[68:71]
buffer_load_dwordx4 v1, s[12:15], s41 offen offset:1024 lds
v_mfma_f32_16x16x32_bf16 v[68:71], a[88:91], a[56:59], v[68:71]
ds_read_b128 a[116:119], v2 offset:13312
v_fma_f32 v17, v53, s27, -v7
v_mfma_f32_16x16x32_bf16 v[68:71], a[92:95], a[60:63], v[68:71]
v_exp_f32 v16, v16
v_mfma_f32_16x16x32_bf16 v[64:67], a[80:83], a[16:19], v[64:67]
ds_read_b128 a[120:123], v2 offset:14336
v_cvt_pk_bf16_f32 v104, v24, v25
v_mfma_f32_16x16x32_bf16 v[64:67], a[84:87], a[20:23], v[64:67]
v_exp_f32 v17, v17
v_mfma_f32_16x16x32_bf16 v[64:67], a[88:91], a[24:27], v[64:67]
ds_read_b128 a[124:127], v2 offset:15360
v_add_f32 v11, v11, v16
v_mfma_f32_16x16x32_bf16 v[64:67], a[92:95], a[28:31], v[64:67]
s_waitcnt lgkmcnt(4)
v_add_f32 v11, v11, v17
v_cvt_pk_bf16_f32 v108, v16, v17
v_mfma_f32_16x16x32_bf16 v[72:75], a[96:99], a[0:3], 0
ds_read_b128 a[64:67], v2 offset:16384
v_fma_f32 v18, v54, s27, -v7
v_mfma_f32_16x16x32_bf16 v[72:75], a[100:103], a[4:7], v[72:75]
buffer_load_dwordx4 v1, s[12:15], s41 offen offset:2048 lds
v_mfma_f32_16x16x32_bf16 v[72:75], a[104:107], a[8:11], v[72:75]
ds_read_b128 a[68:71], v2 offset:17408
v_fma_f32 v19, v55, s27, -v7
v_mfma_f32_16x16x32_bf16 v[72:75], a[108:111], a[12:15], v[72:75]
v_exp_f32 v18, v18
v_mfma_f32_16x16x32_bf16 v[76:79], a[96:99], a[32:35], 0
ds_read_b128 a[72:75], v2 offset:18432
s_add_u32 s43, s35, 0
buffer_load_dwordx4 a[192:195], v26, s[12:15], s43 offen offset:0
v_mfma_f32_16x16x32_bf16 v[76:79], a[100:103], a[36:39], v[76:79]
v_exp_f32 v19, v19
v_mfma_f32_16x16x32_bf16 v[76:79], a[104:107], a[40:43], v[76:79]
ds_read_b128 a[76:79], v2 offset:19456
v_add_f32 v11, v11, v18
v_mfma_f32_16x16x32_bf16 v[76:79], a[108:111], a[44:47], v[76:79]
s_waitcnt lgkmcnt(4)
v_add_f32 v11, v11, v19
v_cvt_pk_bf16_f32 v109, v18, v19
v_mfma_f32_16x16x32_bf16 v[76:79], a[112:115], a[48:51], v[76:79]
ds_read_b128 a[80:83], v2 offset:20480
v_fma_f32 v16, v56, s27, -v6
v_mfma_f32_16x16x32_bf16 v[76:79], a[116:119], a[52:55], v[76:79]
buffer_load_dwordx4 v1, s[12:15], s42 offen offset:3072 lds
v_mfma_f32_16x16x32_bf16 v[76:79], a[120:123], a[56:59], v[76:79]
ds_read_b128 a[84:87], v2 offset:21504
v_fma_f32 v17, v57, s27, -v6
v_mfma_f32_16x16x32_bf16 v[76:79], a[124:127], a[60:63], v[76:79]
s_add_u32 m0, s40, 81920
v_exp_f32 v16, v16
v_mfma_f32_16x16x32_bf16 v[72:75], a[112:115], a[16:19], v[72:75]
ds_read_b128 a[88:91], v2 offset:22528
buffer_load_dwordx4 a[196:199], v27, s[12:15], s43 offen offset:0
v_mfma_f32_16x16x32_bf16 v[72:75], a[116:119], a[20:23], v[72:75]
s_add_u32 s41, s37, 14336
v_exp_f32 v17, v17
v_mfma_f32_16x16x32_bf16 v[72:75], a[120:123], a[24:27], v[72:75]
ds_read_b128 a[92:95], v2 offset:23552
v_add_f32 v10, v10, v16
v_mfma_f32_16x16x32_bf16 v[72:75], a[124:127], a[28:31], v[72:75]
s_waitcnt lgkmcnt(4)
v_add_f32 v10, v10, v17
v_cvt_pk_bf16_f32 v106, v16, v17
v_mfma_f32_16x16x32_bf16 v[80:83], a[64:67], a[0:3], 0
ds_read_b128 a[96:99], v2 offset:24576
v_fma_f32 v18, v58, s27, -v6
v_mfma_f32_16x16x32_bf16 v[80:83], a[68:71], a[4:7], v[80:83]
buffer_load_dwordx4 v1, s[12:15], s41 offen offset:0 lds
v_mfma_f32_16x16x32_bf16 v[80:83], a[72:75], a[8:11], v[80:83]
ds_read_b128 a[100:103], v2 offset:25600
v_fma_f32 v19, v59, s27, -v6
v_mfma_f32_16x16x32_bf16 v[80:83], a[76:79], a[12:15], v[80:83]
s_add_u32 s42, s41, s39
v_exp_f32 v18, v18
v_mfma_f32_16x16x32_bf16 v[84:87], a[64:67], a[32:35], 0
ds_read_b128 a[104:107], v2 offset:26624
buffer_load_dwordx4 a[200:203], v26, s[12:15], s43 offen offset:1024
v_mfma_f32_16x16x32_bf16 v[84:87], a[68:71], a[36:39], v[84:87]
v_exp_f32 v19, v19
v_mfma_f32_16x16x32_bf16 v[84:87], a[72:75], a[40:43], v[84:87]
ds_read_b128 a[108:111], v2 offset:27648
v_add_f32 v10, v10, v18
v_mfma_f32_16x16x32_bf16 v[84:87], a[76:79], a[44:47], v[84:87]
s_waitcnt lgkmcnt(4)
v_add_f32 v10, v10, v19
v_cvt_pk_bf16_f32 v107, v18, v19
v_mfma_f32_16x16x32_bf16 v[84:87], a[80:83], a[48:51], v[84:87]
ds_read_b128 a[112:115], v2 offset:28672
v_fma_f32 v16, v60, s27, -v7
v_mfma_f32_16x16x32_bf16 v[84:87], a[84:87], a[52:55], v[84:87]
buffer_load_dwordx4 v1, s[12:15], s41 offen offset:1024 lds
v_mfma_f32_16x16x32_bf16 v[84:87], a[88:91], a[56:59], v[84:87]
ds_read_b128 a[116:119], v2 offset:29696
v_fma_f32 v17, v61, s27, -v7
v_mfma_f32_16x16x32_bf16 v[84:87], a[92:95], a[60:63], v[84:87]
v_exp_f32 v16, v16
v_mfma_f32_16x16x32_bf16 v[80:83], a[80:83], a[16:19], v[80:83]
ds_read_b128 a[120:123], v2 offset:30720
v_add_u32 v3, 131072, v1
v_mfma_f32_16x16x32_bf16 v[80:83], a[84:87], a[20:23], v[80:83]
v_exp_f32 v17, v17
v_mfma_f32_16x16x32_bf16 v[80:83], a[88:91], a[24:27], v[80:83]
ds_read_b128 a[124:127], v2 offset:31744
v_add_f32 v11, v11, v16
v_mfma_f32_16x16x32_bf16 v[80:83], a[92:95], a[28:31], v[80:83]
s_waitcnt lgkmcnt(4)
v_add_f32 v11, v11, v17
v_cvt_pk_bf16_f32 v110, v16, v17
v_mfma_f32_16x16x32_bf16 v[88:91], a[96:99], a[0:3], 0
ds_read_b128 a[64:67], v3 offset:0
v_fma_f32 v18, v62, s27, -v7
v_mfma_f32_16x16x32_bf16 v[88:91], a[100:103], a[4:7], v[88:91]
buffer_load_dwordx4 v1, s[12:15], s41 offen offset:2048 lds
v_mfma_f32_16x16x32_bf16 v[88:91], a[104:107], a[8:11], v[88:91]
ds_read_b128 a[68:71], v3 offset:16384
v_fma_f32 v19, v63, s27, -v7
v_mfma_f32_16x16x32_bf16 v[88:91], a[108:111], a[12:15], v[88:91]
v_exp_f32 v18, v18
v_mfma_f32_16x16x32_bf16 v[92:95], a[96:99], a[32:35], 0
ds_read_b128 a[72:75], v3 offset:1024
buffer_load_dwordx4 a[204:207], v27, s[12:15], s43 offen offset:1024
v_mfma_f32_16x16x32_bf16 v[92:95], a[100:103], a[36:39], v[92:95]
s_waitcnt vmcnt(19)
v_exp_f32 v19, v19
v_mfma_f32_16x16x32_bf16 v[92:95], a[104:107], a[40:43], v[92:95]
ds_read_b128 a[76:79], v3 offset:17408
v_add_f32 v11, v11, v18
v_mfma_f32_16x16x32_bf16 v[92:95], a[108:111], a[44:47], v[92:95]
s_waitcnt lgkmcnt(4)
v_add_f32 v11, v11, v19
v_cvt_pk_bf16_f32 v111, v18, v19
v_mfma_f32_16x16x32_bf16 v[92:95], a[112:115], a[48:51], v[92:95]
ds_read_b128 a[80:83], v3 offset:2048
v_add_f32 v14, v10, v11
v_mfma_f32_16x16x32_bf16 v[92:95], a[116:119], a[52:55], v[92:95]
buffer_load_dwordx4 v1, s[12:15], s42 offen offset:3072 lds
v_mfma_f32_16x16x32_bf16 v[92:95], a[120:123], a[56:59], v[92:95]
ds_read_b128 a[84:87], v3 offset:18432
v_cmp_nge_f32 vcc, s28, v14
v_mfma_f32_16x16x32_bf16 v[92:95], a[124:127], a[60:63], v[92:95]
s_add_u32 m0, s17, 98304
s_add_u32 s43, s35, 2048
buffer_load_dwordx4 a[208:211], v26, s[12:15], s43 offen offset:0
v_mfma_f32_16x16x32_bf16 v[88:91], a[112:115], a[16:19], v[88:91]
ds_read_b128 a[88:91], v3 offset:3072
buffer_load_dwordx4 a[212:215], v27, s[12:15], s43 offen offset:0
v_mfma_f32_16x16x32_bf16 v[88:91], a[116:119], a[20:23], v[88:91]
s_barrier
buffer_load_dwordx4 a[216:219], v26, s[12:15], s43 offen offset:1024
v_mfma_f32_16x16x32_bf16 v[88:91], a[120:123], a[24:27], v[88:91]
ds_read_b128 a[92:95], v3 offset:19456
v_mfma_f32_16x16x32_bf16 v[88:91], a[124:127], a[28:31], v[88:91]
s_waitcnt lgkmcnt(4)
buffer_load_dwordx4 a[220:223], v27, s[12:15], s43 offen offset:1024
v_mov_b32 v5, 0
buffer_load_dword v30, v5, s[12:15], s71 offen offset:8 sc0 sc1
s_cbranch_vccz L_k2_cs2
s_call_b64 s[46:47], L_k2_slow0
L_k2_cs2:
s_lshl_b32 s29, s16, 4
v_add_u32 v5, s29, v4
v_mov_b32 v14, 0xff800000
s_nop 4
v_cmp_le_i32 s[74:75], 0, v5
v_cmp_le_i32 s[76:77], 1, v5
v_cmp_le_i32 s[78:79], 2, v5
v_cmp_le_i32 s[80:81], 3, v5
v_cndmask_b32 v64, v14, v64, s[74:75]
v_cndmask_b32 v65, v14, v65, s[76:77]
v_cndmask_b32 v66, v14, v66, s[78:79]
v_cndmask_b32 v67, v14, v67, s[80:81]
v_cmp_le_i32 s[74:75], 16, v5
v_cmp_le_i32 s[76:77], 17, v5
v_cmp_le_i32 s[78:79], 18, v5
v_cmp_le_i32 s[80:81], 19, v5
v_cndmask_b32 v72, v14, v72, s[74:75]
v_cndmask_b32 v73, v14, v73, s[76:77]
v_cndmask_b32 v74, v14, v74, s[78:79]
v_cndmask_b32 v75, v14, v75, s[80:81]
v_cmp_le_i32 s[74:75], 32, v5
v_cmp_le_i32 s[76:77], 33, v5
v_cmp_le_i32 s[78:79], 34, v5
v_cmp_le_i32 s[80:81], 35, v5
v_cndmask_b32 v80, v14, v80, s[74:75]
v_cndmask_b32 v81, v14, v81, s[76:77]
v_cndmask_b32 v82, v14, v82, s[78:79]
v_cndmask_b32 v83, v14, v83, s[80:81]
v_cmp_le_i32 s[74:75], 48, v5
v_cmp_le_i32 s[76:77], 49, v5
v_cmp_le_i32 s[78:79], 50, v5
v_cmp_le_i32 s[80:81], 51, v5
v_cndmask_b32 v88, v14, v88, s[74:75]
v_cndmask_b32 v89, v14, v89, s[76:77]
v_cndmask_b32 v90, v14, v90, s[78:79]
v_cndmask_b32 v91, v14, v91, s[80:81]
s_cmp_eq_u32 s22, s83
s_cbranch_scc0 L_k2_cc2
s_call_b64 s[46:47], L_k2_x
L_k2_cc2:
v_mfma_f32_16x16x32_bf16 v[128:131], a[64:67], v[96:99], v[128:131]
ds_read_b128 a[96:99], v3 offset:4096
v_fma_f32 v16, v64, s27, -v6
v_mfma_f32_16x16x32_bf16 v[128:131], a[68:71], v[104:107], v[128:131]
buffer_load_dwordx4 v1, s[12:15], s21 offen offset:0 lds
v_mfma_f32_16x16x32_bf16 v[132:135], a[68:71], v[108:111], v[132:135]
ds_read_b128 a[100:103], v3 offset:20480
v_fma_f32 v17, v65, s27, -v6
v_mfma_f32_16x16x32_bf16 v[132:135], a[64:67], v[100:103], v[132:135]
v_exp_f32 v16, v16
s_add_u32 s43, s35, 4096
buffer_load_dwordx4 a[224:227], v26, s[12:15], s43 offen offset:0
v_mfma_f32_16x16x32_bf16 v[136:139], a[72:75], v[96:99], v[136:139]
ds_read_b128 a[104:107], v3 offset:5120
v_add_f32 v8, v8, v10
v_mfma_f32_16x16x32_bf16 v[136:139], a[76:79], v[104:107], v[136:139]
v_exp_f32 v17, v17
v_mfma_f32_16x16x32_bf16 v[140:143], a[76:79], v[108:111], v[140:143]
ds_read_b128 a[108:111], v3 offset:21504
v_mov_b32 v12, v16
v_mfma_f32_16x16x32_bf16 v[140:143], a[72:75], v[100:103], v[140:143]
s_waitcnt lgkmcnt(4)
v_add_f32 v12, v12, v17
v_cvt_pk_bf16_f32 v112, v16, v17
v_mfma_f32_16x16x32_bf16 v[144:147], a[80:83], v[96:99], v[144:147]
ds_read_b128 a[112:115], v3 offset:6144
v_fma_f32 v18, v66, s27, -v6
v_mfma_f32_16x16x32_bf16 v[144:147], a[84:87], v[104:107], v[144:147]
buffer_load_dwordx4 v1, s[12:15], s21 offen offset:1024 lds
v_mfma_f32_16x16x32_bf16 v[148:151], a[84:87], v[108:111], v[148:151]
ds_read_b128 a[116:119], v3 offset:22528
v_fma_f32 v19, v67, s27, -v6
v_mfma_f32_16x16x32_bf16 v[148:151], a[80:83], v[100:103], v[148:151]
v_exp_f32 v18, v18
buffer_load_dwordx4 a[228:231], v27, s[12:15], s43 offen offset:0
v_mfma_f32_16x16x32_bf16 v[152:155], a[88:91], v[96:99], v[152:155]
ds_read_b128 a[120:123], v3 offset:7168
v_add_f32 v9, v9, v11
v_mfma_f32_16x16x32_bf16 v[152:155], a[92:95], v[104:107], v[152:155]
v_exp_f32 v19, v19
v_mfma_f32_16x16x32_bf16 v[156:159], a[92:95], v[108:111], v[156:159]
ds_read_b128 a[124:127], v3 offset:23552
v_add_f32 v12, v12, v18
v_mfma_f32_16x16x32_bf16 v[156:159], a[88:91], v[100:103], v[156:159]
s_waitcnt lgkmcnt(4)
v_add_f32 v12, v12, v19
v_cvt_pk_bf16_f32 v113, v18, v19
v_mfma_f32_16x16x32_bf16 v[160:163], a[96:99], v[96:99], v[160:163]
ds_read_b128 a[64:67], v3 offset:8192
v_fma_f32 v16, v68, s27, -v7
v_mfma_f32_16x16x32_bf16 v[160:163], a[100:103], v[104:107], v[160:163]
buffer_load_dwordx4 v1, s[12:15], s21 offen offset:2048 lds
v_mfma_f32_16x16x32_bf16 v[164:167], a[100:103], v[108:111], v[164:167]
ds_read_b128 a[68:71], v3 offset:24576
v_fma_f32 v17, v69, s27, -v7
v_mfma_f32_16x16x32_bf16 v[164:167], a[96:99], v[100:103], v[164:167]
v_exp_f32 v16, v16
buffer_load_dwordx4 a[232:235], v26, s[12:15], s43 offen offset:1024
v_mfma_f32_16x16x32_bf16 v[168:171], a[104:107], v[96:99], v[168:171]
ds_read_b128 a[72:75], v3 offset:9216
v_fma_f32 v24, v80, s27, -v6
v_mfma_f32_16x16x32_bf16 v[168:171], a[108:111], v[104:107], v[168:171]
v_exp_f32 v17, v17
v_mfma_f32_16x16x32_bf16 v[172:175], a[108:111], v[108:111], v[172:175]
ds_read_b128 a[76:79], v3 offset:25600
v_mov_b32 v13, v16
v_mfma_f32_16x16x32_bf16 v[172:175], a[104:107], v[100:103], v[172:175]
s_waitcnt lgkmcnt(4)
v_add_f32 v13, v13, v17
v_cvt_pk_bf16_f32 v116, v16, v17
v_mfma_f32_16x16x32_bf16 v[176:179], a[112:115], v[96:99], v[176:179]
ds_read_b128 a[80:83], v3 offset:10240
v_fma_f32 v18, v70, s27, -v7
v_mfma_f32_16x16x32_bf16 v[176:179], a[116:119], v[104:107], v[176:179]
buffer_load_dwordx4 v1, s[12:15], s21 offen offset:3072 lds
v_mfma_f32_16x16x32_bf16 v[180:183], a[116:119], v[108:111], v[180:183]
ds_read_b128 a[84:87], v3 offset:26624
v_fma_f32 v19, v71, s27, -v7
v_mfma_f32_16x16x32_bf16 v[180:183], a[112:115], v[100:103], v[180:183]
s_add_u32 m0, m0, 4096
v_exp_f32 v18, v18
buffer_load_dwordx4 a[236:239], v27, s[12:15], s43 offen offset:1024
v_mfma_f32_16x16x32_bf16 v[184:187], a[120:123], v[96:99], v[184:187]
ds_read_b128 a[88:91], v3 offset:11264
v_fma_f32 v25, v81, s27, -v6
v_mfma_f32_16x16x32_bf16 v[184:187], a[124:127], v[104:107], v[184:187]
s_add_u32 s21, s21, 4096
v_exp_f32 v19, v19
v_mfma_f32_16x16x32_bf16 v[188:191], a[124:127], v[108:111], v[188:191]
ds_read_b128 a[92:95], v3 offset:27648
v_add_f32 v13, v13, v18
v_mfma_f32_16x16x32_bf16 v[188:191], a[120:123], v[100:103], v[188:191]
s_waitcnt lgkmcnt(4)
v_add_f32 v13, v13, v19
v_cvt_pk_bf16_f32 v117, v18, v19
v_mfma_f32_16x16x32_bf16 v[192:195], a[64:67], v[96:99], v[192:195]
ds_read_b128 a[96:99], v3 offset:12288
v_fma_f32 v16, v72, s27, -v6
v_mfma_f32_16x16x32_bf16 v[192:195], a[68:71], v[104:107], v[192:195]
buffer_load_dwordx4 v1, s[12:15], s21 offen offset:0 lds
v_mfma_f32_16x16x32_bf16 v[196:199], a[68:71], v[108:111], v[196:199]
ds_read_b128 a[100:103], v3 offset:28672
v_fma_f32 v17, v73, s27, -v6
v_mfma_f32_16x16x32_bf16 v[196:199], a[64:67], v[100:103], v[196:199]
s_add_u32 s22, s22, 1
v_exp_f32 v16, v16
s_add_u32 s43, s35, 6144
buffer_load_dwordx4 a[240:243], v26, s[12:15], s43 offen offset:0
v_mfma_f32_16x16x32_bf16 v[200:203], a[72:75], v[96:99], v[200:203]
ds_read_b128 a[104:107], v3 offset:13312
v_exp_f32 v24, v24
v_mfma_f32_16x16x32_bf16 v[200:203], a[76:79], v[104:107], v[200:203]
v_exp_f32 v17, v17
v_mfma_f32_16x16x32_bf16 v[204:207], a[76:79], v[108:111], v[204:207]
ds_read_b128 a[108:111], v3 offset:29696
v_add_f32 v12, v12, v16
v_mfma_f32_16x16x32_bf16 v[204:207], a[72:75], v[100:103], v[204:207]
s_waitcnt lgkmcnt(4)
v_add_f32 v12, v12, v17
v_cvt_pk_bf16_f32 v114, v16, v17
v_mfma_f32_16x16x32_bf16 v[208:211], a[80:83], v[96:99], v[208:211]
ds_read_b128 a[112:115], v3 offset:14336
v_fma_f32 v18, v74, s27, -v6
v_mfma_f32_16x16x32_bf16 v[208:211], a[84:87], v[104:107], v[208:211]
buffer_load_dwordx4 v1, s[12:15], s21 offen offset:1024 lds
v_mfma_f32_16x16x32_bf16 v[212:215], a[84:87], v[108:111], v[212:215]
ds_read_b128 a[116:119], v3 offset:30720
v_fma_f32 v19, v75, s27, -v6
v_mfma_f32_16x16x32_bf16 v[212:215], a[80:83], v[100:103], v[212:215]
v_exp_f32 v18, v18
buffer_load_dwordx4 a[244:247], v27, s[12:15], s43 offen offset:0
v_mfma_f32_16x16x32_bf16 v[216:219], a[88:91], v[96:99], v[216:219]
ds_read_b128 a[120:123], v3 offset:15360
v_add_u32 v2, 0, v1
v_mfma_f32_16x16x32_bf16 v[216:219], a[92:95], v[104:107], v[216:219]
v_exp_f32 v19, v19
v_mfma_f32_16x16x32_bf16 v[220:223], a[92:95], v[108:111], v[220:223]
ds_read_b128 a[124:127], v3 offset:31744
v_add_f32 v12, v12, v18
v_mfma_f32_16x16x32_bf16 v[220:223], a[88:91], v[100:103], v[220:223]
s_waitcnt lgkmcnt(4)
v_add_f32 v12, v12, v19
v_cvt_pk_bf16_f32 v115, v18, v19
v_mfma_f32_16x16x32_bf16 v[224:227], a[96:99], v[96:99], v[224:227]
ds_read_b128 a[64:67], v2 offset:0
v_fma_f32 v16, v76, s27, -v7
v_mfma_f32_16x16x32_bf16 v[224:227], a[100:103], v[104:107], v[224:227]
buffer_load_dwordx4 v1, s[12:15], s21 offen offset:2048 lds
v_mfma_f32_16x16x32_bf16 v[228:231], a[100:103], v[108:111], v[228:231]
ds_read_b128 a[68:71], v2 offset:1024
v_fma_f32 v17, v77, s27, -v7
v_mfma_f32_16x16x32_bf16 v[228:231], a[96:99], v[100:103], v[228:231]
v_exp_f32 v16, v16
buffer_load_dwordx4 a[248:251], v26, s[12:15], s43 offen offset:1024
v_mfma_f32_16x16x32_bf16 v[232:235], a[104:107], v[96:99], v[232:235]
ds_read_b128 a[72:75], v2 offset:2048
v_exp_f32 v25, v25
v_mfma_f32_16x16x32_bf16 v[232:235], a[108:111], v[104:107], v[232:235]
s_waitcnt vmcnt(14)
v_exp_f32 v17, v17
v_mfma_f32_16x16x32_bf16 v[236:239], a[108:111], v[108:111], v[236:239]
ds_read_b128 a[76:79], v2 offset:3072
v_add_f32 v13, v13, v16
v_mfma_f32_16x16x32_bf16 v[236:239], a[104:107], v[100:103], v[236:239]
s_waitcnt lgkmcnt(4)
v_add_f32 v13, v13, v17
v_cvt_pk_bf16_f32 v118, v16, v17
v_mfma_f32_16x16x32_bf16 v[240:243], a[112:115], v[96:99], v[240:243]
ds_read_b128 a[80:83], v2 offset:4096
v_fma_f32 v18, v78, s27, -v7
v_mfma_f32_16x16x32_bf16 v[240:243], a[116:119], v[104:107], v[240:243]
buffer_load_dwordx4 v1, s[12:15], s21 offen offset:3072 lds
v_mfma_f32_16x16x32_bf16 v[244:247], a[116:119], v[108:111], v[244:247]
ds_read_b128 a[84:87], v2 offset:5120
v_fma_f32 v19, v79, s27, -v7
v_mfma_f32_16x16x32_bf16 v[244:247], a[112:115], v[100:103], v[244:247]
v_exp_f32 v18, v18
buffer_load_dwordx4 a[252:255], v27, s[12:15], s43 offen offset:1024
v_mfma_f32_16x16x32_bf16 v[248:251], a[120:123], v[96:99], v[248:251]
ds_read_b128 a[88:91], v2 offset:6144
v_add_f32 v12, v12, v24
v_mfma_f32_16x16x32_bf16 v[248:251], a[124:127], v[104:107], v[248:251]
s_barrier
v_exp_f32 v19, v19
v_mfma_f32_16x16x32_bf16 v[252:255], a[124:127], v[108:111], v[252:255]
ds_read_b128 a[92:95], v2 offset:7168
v_add_f32 v13, v13, v18
v_mfma_f32_16x16x32_bf16 v[252:255], a[120:123], v[100:103], v[252:255]
s_waitcnt lgkmcnt(4)
v_add_f32 v13, v13, v19
v_cvt_pk_bf16_f32 v119, v18, v19
s_cmp_eq_u32 s22, s23
s_cbranch_scc0 L_k2_cc3
s_call_b64 s[46:47], L_k2_ostore
L_k2_cc3:
v_readfirstlane_b32 s29, v30
s_mov_b32 s82, 0x40000000
s_nop 2
s_sub_u32 s29, s29, s25
s_sub_u32 s29, s29, s25
s_cmp_eq_u32 s29, 1
s_cselect_b32 s82, s70, s82
s_add_u32 m0, s40, 131072
s_add_u32 s41, s37, 28672
s_add_u32 s42, s41, s39
v_mfma_f32_16x16x32_bf16 v[36:39], a[64:67], a[32:35], 0
ds_read_b128 a[96:99], v2 offset:8192
v_fma_f32 v18, v82, s27, -v6
v_fma_f32 v19, v83, s27, -v6
v_mfma_f32_16x16x32_bf16 v[36:39], a[68:71], a[36:39], v[36:39]
ds_read_b128 a[100:103], v2 offset:9216
v_add_f32 v12, v12, v25
v_exp_f32 v18, v18
buffer_load_dwordx4 v1, s[12:15], s41 offen offset:0 lds
v_mfma_f32_16x16x32_bf16 v[36:39], a[72:75], a[40:43], v[36:39]
ds_read_b128 a[104:107], v2 offset:10240
v_exp_f32 v19, v19
v_cvt_pk_bf16_f32 v120, v24, v25
v_mfma_f32_16x16x32_bf16 v[36:39], a[76:79], a[44:47], v[36:39]
ds_read_b128 a[108:111], v2 offset:11264
v_add_f32 v12, v12, v18
v_add_f32 v12, v12, v19
s_waitcnt lgkmcnt(4)
v_mfma_f32_16x16x32_bf16 v[36:39], a[80:83], a[48:51], v[36:39]
ds_read_b128 a[112:115], v2 offset:12288
v_cvt_pk_bf16_f32 v121, v18, v19
v_fma_f32 v16, v84, s27, -v7
buffer_load_dwordx4 v1, s[12:15], s41 offen offset:1024 lds
v_mfma_f32_16x16x32_bf16 v[36:39], a[84:87], a[52:55], v[36:39]
ds_read_b128 a[116:119], v2 offset:13312
v_fma_f32 v17, v85, s27, -v7
v_mfma_f32_16x16x32_bf16 v[36:39], a[88:91], a[56:59], v[36:39]
ds_read_b128 a[120:123], v2 offset:14336
v_fma_f32 v18, v86, s27, -v7
v_fma_f32 v19, v87, s27, -v7
v_mfma_f32_16x16x32_bf16 v[36:39], a[92:95], a[60:63], v[36:39]
ds_read_b128 a[124:127], v2 offset:15360
v_exp_f32 v16, v16
v_exp_f32 v17, v17
buffer_load_dwordx4 v1, s[12:15], s41 offen offset:2048 lds
s_waitcnt lgkmcnt(4)
v_mfma_f32_16x16x32_bf16 v[44:47], a[96:99], a[32:35], 0
ds_read_b128 a[64:67], v2 offset:16384
v_exp_f32 v18, v18
v_exp_f32 v19, v19
v_mfma_f32_16x16x32_bf16 v[44:47], a[100:103], a[36:39], v[44:47]
ds_read_b128 a[68:71], v2 offset:17408
v_add_f32 v13, v13, v16
v_add_f32 v13, v13, v17
v_mfma_f32_16x16x32_bf16 v[44:47], a[104:107], a[40:43], v[44:47]
ds_read_b128 a[72:75], v2 offset:18432
v_cvt_pk_bf16_f32 v124, v16, v17
v_add_f32 v13, v13, v18
buffer_load_dwordx4 v1, s[12:15], s42 offen offset:3072 lds
v_mfma_f32_16x16x32_bf16 v[44:47], a[108:111], a[44:47], v[44:47]
ds_read_b128 a[76:79], v2 offset:19456
v_add_f32 v13, v13, v19
s_add_u32 m0, s40, 147456
s_add_u32 s41, s37, 43008
s_add_u32 s42, s41, s39
s_waitcnt lgkmcnt(4)
v_mfma_f32_16x16x32_bf16 v[44:47], a[112:115], a[48:51], v[44:47]
ds_read_b128 a[80:83], v2 offset:20480
v_cvt_pk_bf16_f32 v125, v18, v19
v_fma_f32 v16, v88, s27, -v6
v_mfma_f32_16x16x32_bf16 v[44:47], a[116:119], a[52:55], v[44:47]
ds_read_b128 a[84:87], v2 offset:21504
v_fma_f32 v17, v89, s27, -v6
v_fma_f32 v18, v90, s27, -v6
buffer_load_dwordx4 v1, s[12:15], s41 offen offset:0 lds
v_mfma_f32_16x16x32_bf16 v[44:47], a[120:123], a[56:59], v[44:47]
ds_read_b128 a[88:91], v2 offset:22528
v_fma_f32 v19, v91, s27, -v6
v_exp_f32 v16, v16
v_mfma_f32_16x16x32_bf16 v[44:47], a[124:127], a[60:63], v[44:47]
ds_read_b128 a[92:95], v2 offset:23552
v_exp_f32 v17, v17
v_exp_f32 v18, v18
s_waitcnt lgkmcnt(4)
v_mfma_f32_16x16x32_bf16 v[52:55], a[64:67], a[32:35], 0
ds_read_b128 a[96:99], v2 offset:24576
v_exp_f32 v19, v19
v_add_f32 v12, v12, v16
buffer_load_dwordx4 v1, s[12:15], s41 offen offset:1024 lds
v_mfma_f32_16x16x32_bf16 v[52:55], a[68:71], a[36:39], v[52:55]
ds_read_b128 a[100:103], v2 offset:25600
v_add_f32 v12, v12, v17
v_mfma_f32_16x16x32_bf16 v[52:55], a[72:75], a[40:43], v[52:55]
ds_read_b128 a[104:107], v2 offset:26624
v_cvt_pk_bf16_f32 v122, v16, v17
v_add_f32 v12, v12, v18
v_mfma_f32_16x16x32_bf16 v[52:55], a[76:79], a[44:47], v[52:55]
ds_read_b128 a[108:111], v2 offset:27648
v_add_f32 v12, v12, v19
v_cvt_pk_bf16_f32 v123, v18, v19
buffer_load_dwordx4 v1, s[12:15], s41 offen offset:2048 lds
s_waitcnt lgkmcnt(4)
v_mfma_f32_16x16x32_bf16 v[52:55], a[80:83], a[48:51], v[52:55]
ds_read_b128 a[112:115], v2 offset:28672
v_fma_f32 v16, v92, s27, -v7
v_fma_f32 v17, v93, s27, -v7
v_add_u32 v3, 32768, v1
v_mfma_f32_16x16x32_bf16 v[52:55], a[84:87], a[52:55], v[52:55]
ds_read_b128 a[116:119], v2 offset:29696
v_fma_f32 v18, v94, s27, -v7
v_fma_f32 v19, v95, s27, -v7
v_mfma_f32_16x16x32_bf16 v[52:55], a[88:91], a[56:59], v[52:55]
ds_read_b128 a[120:123], v2 offset:30720
v_exp_f32 v16, v16
v_exp_f32 v17, v17
buffer_load_dwordx4 v1, s[12:15], s42 offen offset:3072 lds
v_mfma_f32_16x16x32_bf16 v[52:55], a[92:95], a[60:63], v[52:55]
ds_read_b128 a[124:127], v2 offset:31744
v_exp_f32 v18, v18
s_waitcnt lgkmcnt(4)
v_mfma_f32_16x16x32_bf16 v[60:63], a[96:99], a[32:35], 0
ds_read_b128 a[64:67], v3 offset:0
v_exp_f32 v19, v19
v_add_f32 v13, v13, v16
v_mfma_f32_16x16x32_bf16 v[60:63], a[100:103], a[36:39], v[60:63]
ds_read_b128 a[68:71], v3 offset:16384
v_add_f32 v13, v13, v17
v_cvt_pk_bf16_f32 v126, v16, v17
v_mfma_f32_16x16x32_bf16 v[60:63], a[104:107], a[40:43], v[60:63]
ds_read_b128 a[72:75], v3 offset:1024
v_add_f32 v13, v13, v18
v_add_f32 v13, v13, v19
v_mfma_f32_16x16x32_bf16 v[60:63], a[108:111], a[44:47], v[60:63]
ds_read_b128 a[76:79], v3 offset:17408
v_cvt_pk_bf16_f32 v127, v18, v19
v_add_f32 v14, v12, v13
s_waitcnt lgkmcnt(4)
v_mfma_f32_16x16x32_bf16 v[60:63], a[112:115], a[48:51], v[60:63]
ds_read_b128 a[80:83], v3 offset:2048
v_cmp_nge_f32 vcc, s28, v14
v_mfma_f32_16x16x32_bf16 v[60:63], a[116:119], a[52:55], v[60:63]
ds_read_b128 a[84:87], v3 offset:18432
s_waitcnt vmcnt(9)
s_barrier
v_mfma_f32_16x16x32_bf16 v[60:63], a[120:123], a[56:59], v[60:63]
ds_read_b128 a[88:91], v3 offset:3072
v_mfma_f32_16x16x32_bf16 v[60:63], a[124:127], a[60:63], v[60:63]
ds_read_b128 a[92:95], v3 offset:19456
s_waitcnt lgkmcnt(4)
s_cbranch_vccz L_k2_cs4
s_call_b64 s[46:47], L_k2_slow1
L_k2_cs4:
s_lshl_b32 s29, s16, 4
s_sub_u32 s29, 48, s29
v_add_u32 v5, s29, v4
v_mov_b32 v14, 0xff800000
s_nop 4
v_cmp_le_i32 s[74:75], 0, v5
v_cmp_le_i32 s[76:77], 1, v5
v_cmp_le_i32 s[78:79], 2, v5
v_cmp_le_i32 s[80:81], 3, v5
v_cndmask_b32 v36, v14, v36, s[74:75]
v_cndmask_b32 v37, v14, v37, s[76:77]
v_cndmask_b32 v38, v14, v38, s[78:79]
v_cndmask_b32 v39, v14, v39, s[80:81]
v_cmp_le_i32 s[74:75], 16, v5
v_cmp_le_i32 s[76:77], 17, v5
v_cmp_le_i32 s[78:79], 18, v5
v_cmp_le_i32 s[80:81], 19, v5
v_cndmask_b32 v44, v14, v44, s[74:75]
v_cndmask_b32 v45, v14, v45, s[76:77]
v_cndmask_b32 v46, v14, v46, s[78:79]
v_cndmask_b32 v47, v14, v47, s[80:81]
v_cmp_le_i32 s[74:75], 32, v5
v_cmp_le_i32 s[76:77], 33, v5
v_cmp_le_i32 s[78:79], 34, v5
v_cmp_le_i32 s[80:81], 35, v5
v_cndmask_b32 v52, v14, v52, s[74:75]
v_cndmask_b32 v53, v14, v53, s[76:77]
v_cndmask_b32 v54, v14, v54, s[78:79]
v_cndmask_b32 v55, v14, v55, s[80:81]
v_cmp_le_i32 s[74:75], 48, v5
v_cmp_le_i32 s[76:77], 49, v5
v_cmp_le_i32 s[78:79], 50, v5
v_cmp_le_i32 s[80:81], 51, v5
v_cndmask_b32 v60, v14, v60, s[74:75]
v_cndmask_b32 v61, v14, v61, s[76:77]
v_cndmask_b32 v62, v14, v62, s[78:79]
v_cndmask_b32 v63, v14, v63, s[80:81]
s_cmp_eq_u32 s22, s23
s_cbranch_scc0 L_k2_cc5
s_waitcnt vmcnt(8)
s_call_b64 s[46:47], L_k2_pub
L_k2_cc5:
v_mfma_f32_16x16x32_bf16 v[128:131], a[64:67], v[112:115], v[128:131]
ds_read_b128 a[96:99], v3 offset:4096
v_fma_f32 v16, v36, s27, -v7
v_mfma_f32_16x16x32_bf16 v[128:131], a[68:71], v[120:123], v[128:131]
s_add_u32 s64, s82, 0
buffer_load_dwordx4 a[128:131], v1, s[12:15], s64 offen offset:0 sc0 sc1
v_mfma_f32_16x16x32_bf16 v[132:135], a[68:71], v[124:127], v[132:135]
ds_read_b128 a[100:103], v3 offset:20480
v_fma_f32 v17, v37, s27, -v7
v_mfma_f32_16x16x32_bf16 v[132:135], a[64:67], v[116:119], v[132:135]
v_exp_f32 v16, v16
v_mfma_f32_16x16x32_bf16 v[136:139], a[72:75], v[112:115], v[136:139]
ds_read_b128 a[104:107], v3 offset:5120
v_add_f32 v8, v8, v12
v_mfma_f32_16x16x32_bf16 v[136:139], a[76:79], v[120:123], v[136:139]
v_exp_f32 v17, v17
buffer_load_dwordx4 a[132:135], v1, s[12:15], s64 offen offset:1024 sc0 sc1
v_mfma_f32_16x16x32_bf16 v[140:143], a[76:79], v[124:127], v[140:143]
ds_read_b128 a[108:111], v3 offset:21504
v_mov_b32 v11, v16
v_mfma_f32_16x16x32_bf16 v[140:143], a[72:75], v[116:119], v[140:143]
s_waitcnt lgkmcnt(4)
v_add_f32 v11, v11, v17
v_cvt_pk_bf16_f32 v100, v16, v17
v_mfma_f32_16x16x32_bf16 v[144:147], a[80:83], v[112:115], v[144:147]
ds_read_b128 a[112:115], v3 offset:6144
v_fma_f32 v18, v38, s27, -v7
v_mfma_f32_16x16x32_bf16 v[144:147], a[84:87], v[120:123], v[144:147]
buffer_load_dwordx4 a[136:139], v1, s[12:15], s64 offen offset:2048 sc0 sc1
v_mfma_f32_16x16x32_bf16 v[148:151], a[84:87], v[124:127], v[148:151]
ds_read_b128 a[116:119], v3 offset:22528
v_fma_f32 v19, v39, s27, -v7
v_mfma_f32_16x16x32_bf16 v[148:151], a[80:83], v[116:119], v[148:151]
v_exp_f32 v18, v18
v_mfma_f32_16x16x32_bf16 v[152:155], a[88:91], v[112:115], v[152:155]
ds_read_b128 a[120:123], v3 offset:7168
v_add_f32 v9, v9, v13
v_mfma_f32_16x16x32_bf16 v[152:155], a[92:95], v[120:123], v[152:155]
v_exp_f32 v19, v19
buffer_load_dwordx4 a[140:143], v1, s[12:15], s64 offen offset:3072 sc0 sc1
v_mfma_f32_16x16x32_bf16 v[156:159], a[92:95], v[124:127], v[156:159]
ds_read_b128 a[124:127], v3 offset:23552
v_add_f32 v11, v11, v18
v_mfma_f32_16x16x32_bf16 v[156:159], a[88:91], v[116:119], v[156:159]
s_waitcnt lgkmcnt(4)
v_add_f32 v11, v11, v19
v_cvt_pk_bf16_f32 v101, v18, v19
v_mfma_f32_16x16x32_bf16 v[160:163], a[96:99], v[112:115], v[160:163]
ds_read_b128 a[64:67], v3 offset:8192
v_fma_f32 v16, v44, s27, -v7
v_mfma_f32_16x16x32_bf16 v[160:163], a[100:103], v[120:123], v[160:163]
s_add_u32 s64, s82, 4096
buffer_load_dwordx4 a[144:147], v1, s[12:15], s64 offen offset:0 sc0 sc1
v_mfma_f32_16x16x32_bf16 v[164:167], a[100:103], v[124:127], v[164:167]
ds_read_b128 a[68:71], v3 offset:24576
v_fma_f32 v17, v45, s27, -v7
v_mfma_f32_16x16x32_bf16 v[164:167], a[96:99], v[116:119], v[164:167]
v_exp_f32 v16, v16
v_mfma_f32_16x16x32_bf16 v[168:171], a[104:107], v[112:115], v[168:171]
ds_read_b128 a[72:75], v3 offset:9216
buffer_load_dwordx4 a[148:151], v1, s[12:15], s64 offen offset:1024 sc0 sc1
v_mfma_f32_16x16x32_bf16 v[168:171], a[108:111], v[120:123], v[168:171]
v_exp_f32 v17, v17
v_mfma_f32_16x16x32_bf16 v[172:175], a[108:111], v[124:127], v[172:175]
ds_read_b128 a[76:79], v3 offset:25600
v_add_f32 v11, v11, v16
v_mfma_f32_16x16x32_bf16 v[172:175], a[104:107], v[116:119], v[172:175]
s_waitcnt lgkmcnt(4)
v_add_f32 v11, v11, v17
v_cvt_pk_bf16_f32 v102, v16, v17
v_mfma_f32_16x16x32_bf16 v[176:179], a[112:115], v[112:115], v[176:179]
ds_read_b128 a[80:83], v3 offset:10240
v_fma_f32 v18, v46, s27, -v7
v_mfma_f32_16x16x32_bf16 v[176:179], a[116:119], v[120:123], v[176:179]
buffer_load_dwordx4 a[152:155], v1, s[12:15], s64 offen offset:2048 sc0 sc1
v_mfma_f32_16x16x32_bf16 v[180:183], a[116:119], v[124:127], v[180:183]
ds_read_b128 a[84:87], v3 offset:26624
v_fma_f32 v19, v47, s27, -v7
v_mfma_f32_16x16x32_bf16 v[180:183], a[112:115], v[116:119], v[180:183]
v_exp_f32 v18, v18
v_mfma_f32_16x16x32_bf16 v[184:187], a[120:123], v[112:115], v[184:187]
ds_read_b128 a[88:91], v3 offset:11264
buffer_load_dwordx4 a[156:159], v1, s[12:15], s64 offen offset:3072 sc0 sc1
v_mfma_f32_16x16x32_bf16 v[184:187], a[124:127], v[120:123], v[184:187]
v_exp_f32 v19, v19
v_mfma_f32_16x16x32_bf16 v[188:191], a[124:127], v[124:127], v[188:191]
ds_read_b128 a[92:95], v3 offset:27648
v_add_f32 v11, v11, v18
v_mfma_f32_16x16x32_bf16 v[188:191], a[120:123], v[116:119], v[188:191]
s_waitcnt lgkmcnt(4)
v_add_f32 v11, v11, v19
v_cvt_pk_bf16_f32 v103, v18, v19
v_mfma_f32_16x16x32_bf16 v[192:195], a[64:67], v[112:115], v[192:195]
ds_read_b128 a[96:99], v3 offset:12288
v_fma_f32 v16, v52, s27, -v7
v_mfma_f32_16x16x32_bf16 v[192:195], a[68:71], v[120:123], v[192:195]
s_add_u32 s64, s82, 8192
buffer_load_dwordx4 a[160:163], v1, s[12:15], s64 offen offset:0 sc0 sc1
v_mfma_f32_16x16x32_bf16 v[196:199], a[68:71], v[124:127], v[196:199]
ds_read_b128 a[100:103], v3 offset:28672
v_fma_f32 v17, v53, s27, -v7
v_mfma_f32_16x16x32_bf16 v[196:199], a[64:67], v[116:119], v[196:199]
v_exp_f32 v16, v16
v_mfma_f32_16x16x32_bf16 v[200:203], a[72:75], v[112:115], v[200:203]
ds_read_b128 a[104:107], v3 offset:13312
buffer_load_dwordx4 a[164:167], v1, s[12:15], s64 offen offset:1024 sc0 sc1
v_mfma_f32_16x16x32_bf16 v[200:203], a[76:79], v[120:123], v[200:203]
v_exp_f32 v17, v17
v_mfma_f32_16x16x32_bf16 v[204:207], a[76:79], v[124:127], v[204:207]
ds_read_b128 a[108:111], v3 offset:29696
v_add_f32 v11, v11, v16
v_mfma_f32_16x16x32_bf16 v[204:207], a[72:75], v[116:119], v[204:207]
s_waitcnt lgkmcnt(4)
v_add_f32 v11, v11, v17
v_cvt_pk_bf16_f32 v108, v16, v17
v_mfma_f32_16x16x32_bf16 v[208:211], a[80:83], v[112:115], v[208:211]
ds_read_b128 a[112:115], v3 offset:14336
v_fma_f32 v18, v54, s27, -v7
v_mfma_f32_16x16x32_bf16 v[208:211], a[84:87], v[120:123], v[208:211]
buffer_load_dwordx4 a[168:171], v1, s[12:15], s64 offen offset:2048 sc0 sc1
v_mfma_f32_16x16x32_bf16 v[212:215], a[84:87], v[124:127], v[212:215]
ds_read_b128 a[116:119], v3 offset:30720
v_fma_f32 v19, v55, s27, -v7
v_mfma_f32_16x16x32_bf16 v[212:215], a[80:83], v[116:119], v[212:215]
v_exp_f32 v18, v18
v_mfma_f32_16x16x32_bf16 v[216:219], a[88:91], v[112:115], v[216:219]
ds_read_b128 a[120:123], v3 offset:15360
v_add_u32 v2, 98304, v1
v_mfma_f32_16x16x32_bf16 v[216:219], a[92:95], v[120:123], v[216:219]
v_exp_f32 v19, v19
buffer_load_dwordx4 a[172:175], v1, s[12:15], s64 offen offset:3072 sc0 sc1
v_mfma_f32_16x16x32_bf16 v[220:223], a[92:95], v[124:127], v[220:223]
ds_read_b128 a[124:127], v3 offset:31744
v_add_f32 v11, v11, v18
v_mfma_f32_16x16x32_bf16 v[220:223], a[88:91], v[116:119], v[220:223]
s_waitcnt lgkmcnt(4)
v_add_f32 v11, v11, v19
v_cvt_pk_bf16_f32 v109, v18, v19
v_mfma_f32_16x16x32_bf16 v[224:227], a[96:99], v[112:115], v[224:227]
ds_read_b128 a[64:67], v2 offset:0
v_fma_f32 v16, v60, s27, -v7
v_mfma_f32_16x16x32_bf16 v[224:227], a[100:103], v[120:123], v[224:227]
s_add_u32 s64, s82, 12288
buffer_load_dwordx4 a[176:179], v1, s[12:15], s64 offen offset:0 sc0 sc1
v_mfma_f32_16x16x32_bf16 v[228:231], a[100:103], v[124:127], v[228:231]
ds_read_b128 a[68:71], v2 offset:16384
v_fma_f32 v17, v61, s27, -v7
v_mfma_f32_16x16x32_bf16 v[228:231], a[96:99], v[116:119], v[228:231]
v_exp_f32 v16, v16
v_mfma_f32_16x16x32_bf16 v[232:235], a[104:107], v[112:115], v[232:235]
ds_read_b128 a[72:75], v2 offset:1024
buffer_load_dwordx4 a[180:183], v1, s[12:15], s64 offen offset:1024 sc0 sc1
v_mfma_f32_16x16x32_bf16 v[232:235], a[108:111], v[120:123], v[232:235]
s_waitcnt vmcnt(63)
v_exp_f32 v17, v17
v_mfma_f32_16x16x32_bf16 v[236:239], a[108:111], v[124:127], v[236:239]
ds_read_b128 a[76:79], v2 offset:17408
v_add_f32 v11, v11, v16
v_mfma_f32_16x16x32_bf16 v[236:239], a[104:107], v[116:119], v[236:239]
s_waitcnt lgkmcnt(4)
v_add_f32 v11, v11, v17
v_cvt_pk_bf16_f32 v110, v16, v17
v_mfma_f32_16x16x32_bf16 v[240:243], a[112:115], v[112:115], v[240:243]
ds_read_b128 a[80:83], v2 offset:2048
v_fma_f32 v18, v62, s27, -v7
v_mfma_f32_16x16x32_bf16 v[240:243], a[116:119], v[120:123], v[240:243]
buffer_load_dwordx4 a[184:187], v1, s[12:15], s64 offen offset:2048 sc0 sc1
v_mfma_f32_16x16x32_bf16 v[244:247], a[116:119], v[124:127], v[244:247]
ds_read_b128 a[84:87], v2 offset:18432
v_fma_f32 v19, v63, s27, -v7
v_mfma_f32_16x16x32_bf16 v[244:247], a[112:115], v[116:119], v[244:247]
v_exp_f32 v18, v18
v_mfma_f32_16x16x32_bf16 v[248:251], a[120:123], v[112:115], v[248:251]
ds_read_b128 a[88:91], v2 offset:3072
buffer_load_dwordx4 a[188:191], v1, s[12:15], s64 offen offset:3072 sc0 sc1
v_mfma_f32_16x16x32_bf16 v[248:251], a[124:127], v[120:123], v[248:251]
s_barrier
v_exp_f32 v19, v19
s_add_u32 s64, s82, 16384
buffer_load_dwordx4 v[20:23], v1, s[12:15], s64 offen sc0 sc1
v_mfma_f32_16x16x32_bf16 v[252:255], a[124:127], v[124:127], v[252:255]
ds_read_b128 a[92:95], v2 offset:19456
v_add_f32 v11, v11, v18
v_mfma_f32_16x16x32_bf16 v[252:255], a[120:123], v[116:119], v[252:255]
s_waitcnt lgkmcnt(4)
v_add_f32 v11, v11, v19
v_cvt_pk_bf16_f32 v111, v18, v19
v_cmp_nge_f32 vcc, s28, v11
s_add_u32 m0, s40, 0
s_add_u32 s41, s37, 57344
s_add_u32 s42, s41, s39
s_add_u32 s29, s82, s25
s_cmp_eq_u32 s29, 0x40000000
s_cbranch_vccz L_k2_cs6
s_call_b64 s[46:47], L_k2_slowl
L_k2_cs6:
s_cbranch_scc1 L_k2_late
L_k2_lateback:
v_mfma_f32_16x16x32_bf16 v[132:135], a[64:67], v[100:103], v[132:135]
ds_read_b128 a[96:99], v2 offset:4096
v_add_f32 v9, v9, v11
v_mfma_f32_16x16x32_bf16 v[132:135], a[68:71], v[108:111], v[132:135]
ds_read_b128 a[100:103], v2 offset:20480
buffer_load_dwordx4 v1, s[12:15], s41 offen offset:0 lds
v_mfma_f32_16x16x32_bf16 v[140:143], a[72:75], v[100:103], v[140:143]
ds_read_b128 a[104:107], v2 offset:5120
v_mfma_f32_16x16x32_bf16 v[140:143], a[76:79], v[108:111], v[140:143]
ds_read_b128 a[108:111], v2 offset:21504
s_waitcnt lgkmcnt(4)
v_mfma_f32_16x16x32_bf16 v[148:151], a[80:83], v[100:103], v[148:151]
ds_read_b128 a[112:115], v2 offset:6144
v_mfma_f32_16x16x32_bf16 v[148:151], a[84:87], v[108:111], v[148:151]
ds_read_b128 a[116:119], v2 offset:22528
buffer_load_dwordx4 v1, s[12:15], s41 offen offset:1024 lds
v_mfma_f32_16x16x32_bf16 v[156:159], a[88:91], v[100:103], v[156:159]
ds_read_b128 a[120:123], v2 offset:7168
v_mfma_f32_16x16x32_bf16 v[156:159], a[92:95], v[108:111], v[156:159]
ds_read_b128 a[124:127], v2 offset:23552
s_waitcnt lgkmcnt(4)
v_mfma_f32_16x16x32_bf16 v[164:167], a[96:99], v[100:103], v[164:167]
ds_read_b128 a[64:67], v2 offset:8192
v_mfma_f32_16x16x32_bf16 v[164:167], a[100:103], v[108:111], v[164:167]
ds_read_b128 a[68:71], v2 offset:24576
buffer_load_dwordx4 v1, s[12:15], s41 offen offset:2048 lds
v_mfma_f32_16x16x32_bf16 v[172:175], a[104:107], v[100:103], v[172:175]
ds_read_b128 a[72:75], v2 offset:9216
v_mfma_f32_16x16x32_bf16 v[172:175], a[108:111], v[108:111], v[172:175]
ds_read_b128 a[76:79], v2 offset:25600
s_waitcnt lgkmcnt(4)
v_mfma_f32_16x16x32_bf16 v[180:183], a[112:115], v[100:103], v[180:183]
ds_read_b128 a[80:83], v2 offset:10240
v_mfma_f32_16x16x32_bf16 v[180:183], a[116:119], v[108:111], v[180:183]
ds_read_b128 a[84:87], v2 offset:26624
buffer_load_dwordx4 v1, s[12:15], s42 offen offset:3072 lds
v_mfma_f32_16x16x32_bf16 v[188:191], a[120:123], v[100:103], v[188:191]
ds_read_b128 a[88:91], v2 offset:11264
s_add_u32 m0, s40, 16384
s_add_u32 s41, s37, 71680
s_add_u32 s42, s41, s39
v_mfma_f32_16x16x32_bf16 v[188:191], a[124:127], v[108:111], v[188:191]
ds_read_b128 a[92:95], v2 offset:27648
s_waitcnt lgkmcnt(4)
v_mfma_f32_16x16x32_bf16 v[196:199], a[64:67], v[100:103], v[196:199]
ds_read_b128 a[96:99], v2 offset:12288
v_mfma_f32_16x16x32_bf16 v[196:199], a[68:71], v[108:111], v[196:199]
ds_read_b128 a[100:103], v2 offset:28672
buffer_load_dwordx4 v1, s[12:15], s41 offen offset:0 lds
v_mfma_f32_16x16x32_bf16 v[204:207], a[72:75], v[100:103], v[204:207]
ds_read_b128 a[104:107], v2 offset:13312
v_mfma_f32_16x16x32_bf16 v[204:207], a[76:79], v[108:111], v[204:207]
ds_read_b128 a[108:111], v2 offset:29696
s_waitcnt lgkmcnt(4)
v_mfma_f32_16x16x32_bf16 v[212:215], a[80:83], v[100:103], v[212:215]
ds_read_b128 a[112:115], v2 offset:14336
v_mfma_f32_16x16x32_bf16 v[212:215], a[84:87], v[108:111], v[212:215]
ds_read_b128 a[116:119], v2 offset:30720
buffer_load_dwordx4 v1, s[12:15], s41 offen offset:1024 lds
v_mfma_f32_16x16x32_bf16 v[220:223], a[88:91], v[100:103], v[220:223]
ds_read_b128 a[120:123], v2 offset:15360
v_mfma_f32_16x16x32_bf16 v[220:223], a[92:95], v[108:111], v[220:223]
ds_read_b128 a[124:127], v2 offset:31744
s_waitcnt lgkmcnt(4)
v_mfma_f32_16x16x32_bf16 v[228:231], a[96:99], v[100:103], v[228:231]
v_mfma_f32_16x16x32_bf16 v[228:231], a[100:103], v[108:111], v[228:231]
buffer_load_dwordx4 v1, s[12:15], s41 offen offset:2048 lds
v_mfma_f32_16x16x32_bf16 v[236:239], a[104:107], v[100:103], v[236:239]
v_mfma_f32_16x16x32_bf16 v[236:239], a[108:111], v[108:111], v[236:239]
s_waitcnt lgkmcnt(0)
v_mfma_f32_16x16x32_bf16 v[244:247], a[112:115], v[100:103], v[244:247]
v_mfma_f32_16x16x32_bf16 v[244:247], a[116:119], v[108:111], v[244:247]
buffer_load_dwordx4 v1, s[12:15], s42 offen offset:3072 lds
v_mfma_f32_16x16x32_bf16 v[252:255], a[120:123], v[100:103], v[252:255]
v_mfma_f32_16x16x32_bf16 v[252:255], a[124:127], v[108:111], v[252:255]
s_mul_i32 s29, s67, 1507328
s_lshl_b32 s30, s65, 13
s_add_u32 s29, s29, s30
s_mul_i32 s30, s16, 188416
s_add_u32 s29, s29, 50331648
s_sub_u32 s64, s29, s30
s_add_u32 s64, s64, 1318912
s_add_u32 s29, s29, s30
s_add_u32 s30, s29, 4096
s_add_u32 s82, s64, 4096
s_cmp_eq_u32 s25, 0
s_cbranch_scc1 L_k2_epi_comb
v_mov_b32 v14, v8
s_nop 1
v_permlane16_swap_b32 v8, v14
s_nop 1
v_add_f32 v8, v8, v14
v_mov_b32 v14, v8
s_nop 1
v_permlane32_swap_b32 v8, v14
s_nop 1
v_add_f32 v8, v8, v14
v_rcp_f32 v8, v8
v_mov_b32 v14, v9
s_nop 1
v_permlane16_swap_b32 v9, v14
s_nop 1
v_add_f32 v9, v9, v14
v_mov_b32 v14, v9
s_nop 1
v_permlane32_swap_b32 v9, v14
s_nop 1
v_add_f32 v9, v9, v14
v_rcp_f32 v9, v9
s_nop 0
v_pk_mul_f32 v[128:129], v[128:129], v[8:9] op_sel:[0,0] op_sel_hi:[1,0]
v_pk_mul_f32 v[130:131], v[130:131], v[8:9] op_sel:[0,0] op_sel_hi:[1,0]
v_pk_mul_f32 v[136:137], v[136:137], v[8:9] op_sel:[0,0] op_sel_hi:[1,0]
v_pk_mul_f32 v[138:139], v[138:139], v[8:9] op_sel:[0,0] op_sel_hi:[1,0]
v_cvt_pk_bf16_f32 v128, v128, v129
v_cvt_pk_bf16_f32 v129, v130, v131
v_cvt_pk_bf16_f32 v130, v136, v137
v_cvt_pk_bf16_f32 v131, v138, v139
v_pk_mul_f32 v[144:145], v[144:145], v[8:9] op_sel:[0,0] op_sel_hi:[1,0]
v_pk_mul_f32 v[146:147], v[146:147], v[8:9] op_sel:[0,0] op_sel_hi:[1,0]
v_pk_mul_f32 v[152:153], v[152:153], v[8:9] op_sel:[0,0] op_sel_hi:[1,0]
v_pk_mul_f32 v[154:155], v[154:155], v[8:9] op_sel:[0,0] op_sel_hi:[1,0]
v_cvt_pk_bf16_f32 v144, v144, v145
v_cvt_pk_bf16_f32 v145, v146, v147
v_cvt_pk_bf16_f32 v146, v152, v153
v_cvt_pk_bf16_f32 v147, v154, v155
v_pk_mul_f32 v[160:161], v[160:161], v[8:9] op_sel:[0,0] op_sel_hi:[1,0]
v_pk_mul_f32 v[162:163], v[162:163], v[8:9] op_sel:[0,0] op_sel_hi:[1,0]
v_pk_mul_f32 v[168:169], v[168:169], v[8:9] op_sel:[0,0] op_sel_hi:[1,0]
v_pk_mul_f32 v[170:171], v[170:171], v[8:9] op_sel:[0,0] op_sel_hi:[1,0]
v_cvt_pk_bf16_f32 v160, v160, v161
v_cvt_pk_bf16_f32 v161, v162, v163
v_cvt_pk_bf16_f32 v162, v168, v169
v_cvt_pk_bf16_f32 v163, v170, v171
buffer_store_dwordx4 v[128:131], v1, s[12:15], s29 offen offset:0 sc0 sc1
v_pk_mul_f32 v[176:177], v[176:177], v[8:9] op_sel:[0,0] op_sel_hi:[1,0]
v_pk_mul_f32 v[178:179], v[178:179], v[8:9] op_sel:[0,0] op_sel_hi:[1,0]
v_pk_mul_f32 v[184:185], v[184:185], v[8:9] op_sel:[0,0] op_sel_hi:[1,0]
v_pk_mul_f32 v[186:187], v[186:187], v[8:9] op_sel:[0,0] op_sel_hi:[1,0]
v_cvt_pk_bf16_f32 v176, v176, v177
v_cvt_pk_bf16_f32 v177, v178, v179
v_cvt_pk_bf16_f32 v178, v184, v185
v_cvt_pk_bf16_f32 v179, v186, v187
v_pk_mul_f32 v[192:193], v[192:193], v[8:9] op_sel:[0,0] op_sel_hi:[1,0]
v_pk_mul_f32 v[194:195], v[194:195], v[8:9] op_sel:[0,0] op_sel_hi:[1,0]
v_pk_mul_f32 v[200:201], v[200:201], v[8:9] op_sel:[0,0] op_sel_hi:[1,0]
v_pk_mul_f32 v[202:203], v[202:203], v[8:9] op_sel:[0,0] op_sel_hi:[1,0]
v_cvt_pk_bf16_f32 v192, v192, v193
v_cvt_pk_bf16_f32 v193, v194, v195
v_cvt_pk_bf16_f32 v194, v200, v201
v_cvt_pk_bf16_f32 v195, v202, v203
v_pk_mul_f32 v[208:209], v[208:209], v[8:9] op_sel:[0,0] op_sel_hi:[1,0]
v_pk_mul_f32 v[210:211], v[210:211], v[8:9] op_sel:[0,0] op_sel_hi:[1,0]
v_pk_mul_f32 v[216:217], v[216:217], v[8:9] op_sel:[0,0] op_sel_hi:[1,0]
v_pk_mul_f32 v[218:219], v[218:219], v[8:9] op_sel:[0,0] op_sel_hi:[1,0]
v_cvt_pk_bf16_f32 v208, v208, v209
v_cvt_pk_bf16_f32 v209, v210, v211
v_cvt_pk_bf16_f32 v210, v216, v217
v_cvt_pk_bf16_f32 v211, v218, v219
buffer_store_dwordx4 v[144:147], v1, s[12:15], s29 offen offset:1024 sc0 sc1
v_pk_mul_f32 v[224:225], v[224:225], v[8:9] op_sel:[0,0] op_sel_hi:[1,0]
v_pk_mul_f32 v[226:227], v[226:227], v[8:9] op_sel:[0,0] op_sel_hi:[1,0]
v_pk_mul_f32 v[232:233], v[232:233], v[8:9] op_sel:[0,0] op_sel_hi:[1,0]
v_pk_mul_f32 v[234:235], v[234:235], v[8:9] op_sel:[0,0] op_sel_hi:[1,0]
v_cvt_pk_bf16_f32 v224, v224, v225
v_cvt_pk_bf16_f32 v225, v226, v227
v_cvt_pk_bf16_f32 v226, v232, v233
v_cvt_pk_bf16_f32 v227, v234, v235
v_pk_mul_f32 v[240:241], v[240:241], v[8:9] op_sel:[0,0] op_sel_hi:[1,0]
v_pk_mul_f32 v[242:243], v[242:243], v[8:9] op_sel:[0,0] op_sel_hi:[1,0]
v_pk_mul_f32 v[248:249], v[248:249], v[8:9] op_sel:[0,0] op_sel_hi:[1,0]
v_pk_mul_f32 v[250:251], v[250:251], v[8:9] op_sel:[0,0] op_sel_hi:[1,0]
v_cvt_pk_bf16_f32 v240, v240, v241
v_cvt_pk_bf16_f32 v241, v242, v243
v_cvt_pk_bf16_f32 v242, v248, v249
v_cvt_pk_bf16_f32 v243, v250, v251
buffer_store_dwordx4 v[160:163], v1, s[12:15], s29 offen offset:2048 sc0 sc1
v_pk_mul_f32 v[132:133], v[132:133], v[8:9] op_sel:[0,1] op_sel_hi:[1,1]
v_pk_mul_f32 v[134:135], v[134:135], v[8:9] op_sel:[0,1] op_sel_hi:[1,1]
v_pk_mul_f32 v[140:141], v[140:141], v[8:9] op_sel:[0,1] op_sel_hi:[1,1]
v_pk_mul_f32 v[142:143], v[142:143], v[8:9] op_sel:[0,1] op_sel_hi:[1,1]
v_cvt_pk_bf16_f32 v132, v132, v133
v_cvt_pk_bf16_f32 v133, v134, v135
v_cvt_pk_bf16_f32 v134, v140, v141
v_cvt_pk_bf16_f32 v135, v142, v143
v_pk_mul_f32 v[148:149], v[148:149], v[8:9] op_sel:[0,1] op_sel_hi:[1,1]
v_pk_mul_f32 v[150:151], v[150:151], v[8:9] op_sel:[0,1] op_sel_hi:[1,1]
v_pk_mul_f32 v[156:157], v[156:157], v[8:9] op_sel:[0,1] op_sel_hi:[1,1]
v_pk_mul_f32 v[158:159], v[158:159], v[8:9] op_sel:[0,1] op_sel_hi:[1,1]
v_cvt_pk_bf16_f32 v148, v148, v149
v_cvt_pk_bf16_f32 v149, v150, v151
v_cvt_pk_bf16_f32 v150, v156, v157
v_cvt_pk_bf16_f32 v151, v158, v159
v_pk_mul_f32 v[164:165], v[164:165], v[8:9] op_sel:[0,1] op_sel_hi:[1,1]
v_pk_mul_f32 v[166:167], v[166:167], v[8:9] op_sel:[0,1] op_sel_hi:[1,1]
v_pk_mul_f32 v[172:173], v[172:173], v[8:9] op_sel:[0,1] op_sel_hi:[1,1]
v_pk_mul_f32 v[174:175], v[174:175], v[8:9] op_sel:[0,1] op_sel_hi:[1,1]
v_cvt_pk_bf16_f32 v164, v164, v165
v_cvt_pk_bf16_f32 v165, v166, v167
v_cvt_pk_bf16_f32 v166, v172, v173
v_cvt_pk_bf16_f32 v167, v174, v175
buffer_store_dwordx4 v[176:179], v1, s[12:15], s29 offen offset:3072 sc0 sc1
v_pk_mul_f32 v[180:181], v[180:181], v[8:9] op_sel:[0,1] op_sel_hi:[1,1]
v_pk_mul_f32 v[182:183], v[182:183], v[8:9] op_sel:[0,1] op_sel_hi:[1,1]
v_pk_mul_f32 v[188:189], v[188:189], v[8:9] op_sel:[0,1] op_sel_hi:[1,1]
v_pk_mul_f32 v[190:191], v[190:191], v[8:9] op_sel:[0,1] op_sel_hi:[1,1]
v_cvt_pk_bf16_f32 v180, v180, v181
v_cvt_pk_bf16_f32 v181, v182, v183
v_cvt_pk_bf16_f32 v182, v188, v189
v_cvt_pk_bf16_f32 v183, v190, v191
v_pk_mul_f32 v[196:197], v[196:197], v[8:9] op_sel:[0,1] op_sel_hi:[1,1]
v_pk_mul_f32 v[198:199], v[198:199], v[8:9] op_sel:[0,1] op_sel_hi:[1,1]
v_pk_mul_f32 v[204:205], v[204:205], v[8:9] op_sel:[0,1] op_sel_hi:[1,1]
v_pk_mul_f32 v[206:207], v[206:207], v[8:9] op_sel:[0,1] op_sel_hi:[1,1]
v_cvt_pk_bf16_f32 v196, v196, v197
v_cvt_pk_bf16_f32 v197, v198, v199
v_cvt_pk_bf16_f32 v198, v204, v205
v_cvt_pk_bf16_f32 v199, v206, v207
v_pk_mul_f32 v[212:213], v[212:213], v[8:9] op_sel:[0,1] op_sel_hi:[1,1]
v_pk_mul_f32 v[214:215], v[214:215], v[8:9] op_sel:[0,1] op_sel_hi:[1,1]
v_pk_mul_f32 v[220:221], v[220:221], v[8:9] op_sel:[0,1] op_sel_hi:[1,1]
v_pk_mul_f32 v[222:223], v[222:223], v[8:9] op_sel:[0,1] op_sel_hi:[1,1]
v_cvt_pk_bf16_f32 v212, v212, v213
v_cvt_pk_bf16_f32 v213, v214, v215
v_cvt_pk_bf16_f32 v214, v220, v221
v_cvt_pk_bf16_f32 v215, v222, v223
buffer_store_dwordx4 v[192:195], v1, s[12:15], s30 offen offset:0 sc0 sc1
v_pk_mul_f32 v[228:229], v[228:229], v[8:9] op_sel:[0,1] op_sel_hi:[1,1]
v_pk_mul_f32 v[230:231], v[230:231], v[8:9] op_sel:[0,1] op_sel_hi:[1,1]
v_pk_mul_f32 v[236:237], v[236:237], v[8:9] op_sel:[0,1] op_sel_hi:[1,1]
v_pk_mul_f32 v[238:239], v[238:239], v[8:9] op_sel:[0,1] op_sel_hi:[1,1]
v_cvt_pk_bf16_f32 v228, v228, v229
v_cvt_pk_bf16_f32 v229, v230, v231
v_cvt_pk_bf16_f32 v230, v236, v237
v_cvt_pk_bf16_f32 v231, v238, v239
v_pk_mul_f32 v[244:245], v[244:245], v[8:9] op_sel:[0,1] op_sel_hi:[1,1]
v_pk_mul_f32 v[246:247], v[246:247], v[8:9] op_sel:[0,1] op_sel_hi:[1,1]
v_pk_mul_f32 v[252:253], v[252:253], v[8:9] op_sel:[0,1] op_sel_hi:[1,1]
v_pk_mul_f32 v[254:255], v[254:255], v[8:9] op_sel:[0,1] op_sel_hi:[1,1]
v_cvt_pk_bf16_f32 v244, v244, v245
v_cvt_pk_bf16_f32 v245, v246, v247
v_cvt_pk_bf16_f32 v246, v252, v253
v_cvt_pk_bf16_f32 v247, v254, v255
buffer_store_dwordx4 v[208:211], v1, s[12:15], s30 offen offset:1024 sc0 sc1
s_branch L_f_k3
L_k2_epi_comb:
s_waitcnt vmcnt(8)
v_max_f32 v14, v6, v20
v_sub_f32 v16, v6, v14
v_sub_f32 v18, v20, v14
v_exp_f32 v16, v16
v_exp_f32 v18, v18
s_nop 0
v_mul_f32 v8, v8, v16
v_fma_f32 v8, v22, v18, v8
v_mov_b32 v14, v8
s_nop 1
v_permlane16_swap_b32 v8, v14
s_nop 1
v_add_f32 v8, v8, v14
v_mov_b32 v14, v8
s_nop 1
v_permlane32_swap_b32 v8, v14
s_nop 1
v_add_f32 v8, v8, v14
v_rcp_f32 v8, v8
s_nop 0
v_mul_f32 v16, v16, v8
v_mul_f32 v18, v18, v8
v_max_f32 v14, v7, v21
v_sub_f32 v17, v7, v14
v_sub_f32 v19, v21, v14
v_exp_f32 v17, v17
v_exp_f32 v19, v19
s_nop 0
v_mul_f32 v9, v9, v17
v_fma_f32 v9, v23, v19, v9
v_mov_b32 v14, v9
s_nop 1
v_permlane16_swap_b32 v9, v14
s_nop 1
v_add_f32 v9, v9, v14
v_mov_b32 v14, v9
s_nop 1
v_permlane32_swap_b32 v9, v14
s_nop 1
v_add_f32 v9, v9, v14
v_rcp_f32 v9, v9
s_nop 0
v_mul_f32 v17, v17, v9
v_mul_f32 v19, v19, v9
s_mov_b32 s31, 0xffff0000
v_accvgpr_read_b32 v33, a128
v_accvgpr_read_b32 v35, a129
v_accvgpr_read_b32 v37, a130
v_accvgpr_read_b32 v39, a131
v_pk_mul_f32 v[128:129], v[128:129], v[16:17] op_sel:[0,0] op_sel_hi:[1,0]
v_pk_mul_f32 v[130:131], v[130:131], v[16:17] op_sel:[0,0] op_sel_hi:[1,0]
v_pk_mul_f32 v[136:137], v[136:137], v[16:17] op_sel:[0,0] op_sel_hi:[1,0]
v_pk_mul_f32 v[138:139], v[138:139], v[16:17] op_sel:[0,0] op_sel_hi:[1,0]
v_lshlrev_b32 v32, 16, v33
v_and_b32 v33, s31, v33
v_lshlrev_b32 v34, 16, v35
v_and_b32 v35, s31, v35
v_lshlrev_b32 v36, 16, v37
v_and_b32 v37, s31, v37
v_lshlrev_b32 v38, 16, v39
v_and_b32 v39, s31, v39
v_pk_fma_f32 v[128:129], v[32:33], v[18:19], v[128:129] op_sel:[0,0,0] op_sel_hi:[1,0,1]
v_pk_fma_f32 v[130:131], v[34:35], v[18:19], v[130:131] op_sel:[0,0,0] op_sel_hi:[1,0,1]
v_pk_fma_f32 v[136:137], v[36:37], v[18:19], v[136:137] op_sel:[0,0,0] op_sel_hi:[1,0,1]
v_pk_fma_f32 v[138:139], v[38:39], v[18:19], v[138:139] op_sel:[0,0,0] op_sel_hi:[1,0,1]
v_cvt_pk_bf16_f32 v128, v128, v129
v_cvt_pk_bf16_f32 v129, v130, v131
v_cvt_pk_bf16_f32 v130, v136, v137
v_cvt_pk_bf16_f32 v131, v138, v139
v_accvgpr_read_b32 v41, a132
v_accvgpr_read_b32 v43, a133
v_accvgpr_read_b32 v45, a134
v_accvgpr_read_b32 v47, a135
v_pk_mul_f32 v[144:145], v[144:145], v[16:17] op_sel:[0,0] op_sel_hi:[1,0]
v_pk_mul_f32 v[146:147], v[146:147], v[16:17] op_sel:[0,0] op_sel_hi:[1,0]
v_pk_mul_f32 v[152:153], v[152:153], v[16:17] op_sel:[0,0] op_sel_hi:[1,0]
v_pk_mul_f32 v[154:155], v[154:155], v[16:17] op_sel:[0,0] op_sel_hi:[1,0]
v_lshlrev_b32 v40, 16, v41
v_and_b32 v41, s31, v41
v_lshlrev_b32 v42, 16, v43
v_and_b32 v43, s31, v43
v_lshlrev_b32 v44, 16, v45
v_and_b32 v45, s31, v45
v_lshlrev_b32 v46, 16, v47
v_and_b32 v47, s31, v47
v_pk_fma_f32 v[144:145], v[40:41], v[18:19], v[144:145] op_sel:[0,0,0] op_sel_hi:[1,0,1]
v_pk_fma_f32 v[146:147], v[42:43], v[18:19], v[146:147] op_sel:[0,0,0] op_sel_hi:[1,0,1]
v_pk_fma_f32 v[152:153], v[44:45], v[18:19], v[152:153] op_sel:[0,0,0] op_sel_hi:[1,0,1]
v_pk_fma_f32 v[154:155], v[46:47], v[18:19], v[154:155] op_sel:[0,0,0] op_sel_hi:[1,0,1]
v_cvt_pk_bf16_f32 v144, v144, v145
v_cvt_pk_bf16_f32 v145, v146, v147
v_cvt_pk_bf16_f32 v146, v152, v153
v_cvt_pk_bf16_f32 v147, v154, v155
v_accvgpr_read_b32 v33, a136
v_accvgpr_read_b32 v35, a137
v_accvgpr_read_b32 v37, a138
v_accvgpr_read_b32 v39, a139
v_pk_mul_f32 v[160:161], v[160:161], v[16:17] op_sel:[0,0] op_sel_hi:[1,0]
v_pk_mul_f32 v[162:163], v[162:163], v[16:17] op_sel:[0,0] op_sel_hi:[1,0]
v_pk_mul_f32 v[168:169], v[168:169], v[16:17] op_sel:[0,0] op_sel_hi:[1,0]
v_pk_mul_f32 v[170:171], v[170:171], v[16:17] op_sel:[0,0] op_sel_hi:[1,0]
v_lshlrev_b32 v32, 16, v33
v_and_b32 v33, s31, v33
v_lshlrev_b32 v34, 16, v35
v_and_b32 v35, s31, v35
v_lshlrev_b32 v36, 16, v37
v_and_b32 v37, s31, v37
v_lshlrev_b32 v38, 16, v39
v_and_b32 v39, s31, v39
v_pk_fma_f32 v[160:161], v[32:33], v[18:19], v[160:161] op_sel:[0,0,0] op_sel_hi:[1,0,1]
v_pk_fma_f32 v[162:163], v[34:35], v[18:19], v[162:163] op_sel:[0,0,0] op_sel_hi:[1,0,1]
v_pk_fma_f32 v[168:169], v[36:37], v[18:19], v[168:169] op_sel:[0,0,0] op_sel_hi:[1,0,1]
v_pk_fma_f32 v[170:171], v[38:39], v[18:19], v[170:171] op_sel:[0,0,0] op_sel_hi:[1,0,1]
v_cvt_pk_bf16_f32 v160, v160, v161
v_cvt_pk_bf16_f32 v161, v162, v163
v_cvt_pk_bf16_f32 v162, v168, v169
v_cvt_pk_bf16_f32 v163, v170, v171
buffer_store_dwordx4 v[128:131], v1, s[12:15], s29 offen offset:0 sc0 sc1
v_accvgpr_read_b32 v41, a140
v_accvgpr_read_b32 v43, a141
v_accvgpr_read_b32 v45, a142
v_accvgpr_read_b32 v47, a143
v_pk_mul_f32 v[176:177], v[176:177], v[16:17] op_sel:[0,0] op_sel_hi:[1,0]
v_pk_mul_f32 v[178:179], v[178:179], v[16:17] op_sel:[0,0] op_sel_hi:[1,0]
v_pk_mul_f32 v[184:185], v[184:185], v[16:17] op_sel:[0,0] op_sel_hi:[1,0]
v_pk_mul_f32 v[186:187], v[186:187], v[16:17] op_sel:[0,0] op_sel_hi:[1,0]
v_lshlrev_b32 v40, 16, v41
v_and_b32 v41, s31, v41
v_lshlrev_b32 v42, 16, v43
v_and_b32 v43, s31, v43
v_lshlrev_b32 v44, 16, v45
v_and_b32 v45, s31, v45
v_lshlrev_b32 v46, 16, v47
v_and_b32 v47, s31, v47
v_pk_fma_f32 v[176:177], v[40:41], v[18:19], v[176:177] op_sel:[0,0,0] op_sel_hi:[1,0,1]
v_pk_fma_f32 v[178:179], v[42:43], v[18:19], v[178:179] op_sel:[0,0,0] op_sel_hi:[1,0,1]
v_pk_fma_f32 v[184:185], v[44:45], v[18:19], v[184:185] op_sel:[0,0,0] op_sel_hi:[1,0,1]
v_pk_fma_f32 v[186:187], v[46:47], v[18:19], v[186:187] op_sel:[0,0,0] op_sel_hi:[1,0,1]
v_cvt_pk_bf16_f32 v176, v176, v177
v_cvt_pk_bf16_f32 v177, v178, v179
v_cvt_pk_bf16_f32 v178, v184, v185
v_cvt_pk_bf16_f32 v179, v186, v187
v_accvgpr_read_b32 v33, a144
v_accvgpr_read_b32 v35, a145
v_accvgpr_read_b32 v37, a146
v_accvgpr_read_b32 v39, a147
v_pk_mul_f32 v[192:193], v[192:193], v[16:17] op_sel:[0,0] op_sel_hi:[1,0]
v_pk_mul_f32 v[194:195], v[194:195], v[16:17] op_sel:[0,0] op_sel_hi:[1,0]
v_pk_mul_f32 v[200:201], v[200:201], v[16:17] op_sel:[0,0] op_sel_hi:[1,0]
v_pk_mul_f32 v[202:203], v[202:203], v[16:17] op_sel:[0,0] op_sel_hi:[1,0]
v_lshlrev_b32 v32, 16, v33
v_and_b32 v33, s31, v33
v_lshlrev_b32 v34, 16, v35
v_and_b32 v35, s31, v35
v_lshlrev_b32 v36, 16, v37
v_and_b32 v37, s31, v37
v_lshlrev_b32 v38, 16, v39
v_and_b32 v39, s31, v39
v_pk_fma_f32 v[192:193], v[32:33], v[18:19], v[192:193] op_sel:[0,0,0] op_sel_hi:[1,0,1]
v_pk_fma_f32 v[194:195], v[34:35], v[18:19], v[194:195] op_sel:[0,0,0] op_sel_hi:[1,0,1]
v_pk_fma_f32 v[200:201], v[36:37], v[18:19], v[200:201] op_sel:[0,0,0] op_sel_hi:[1,0,1]
v_pk_fma_f32 v[202:203], v[38:39], v[18:19], v[202:203] op_sel:[0,0,0] op_sel_hi:[1,0,1]
v_cvt_pk_bf16_f32 v192, v192, v193
v_cvt_pk_bf16_f32 v193, v194, v195
v_cvt_pk_bf16_f32 v194, v200, v201
v_cvt_pk_bf16_f32 v195, v202, v203
v_accvgpr_read_b32 v41, a148
v_accvgpr_read_b32 v43, a149
v_accvgpr_read_b32 v45, a150
v_accvgpr_read_b32 v47, a151
v_pk_mul_f32 v[208:209], v[208:209], v[16:17] op_sel:[0,0] op_sel_hi:[1,0]
v_pk_mul_f32 v[210:211], v[210:211], v[16:17] op_sel:[0,0] op_sel_hi:[1,0]
v_pk_mul_f32 v[216:217], v[216:217], v[16:17] op_sel:[0,0] op_sel_hi:[1,0]
v_pk_mul_f32 v[218:219], v[218:219], v[16:17] op_sel:[0,0] op_sel_hi:[1,0]
v_lshlrev_b32 v40, 16, v41
v_and_b32 v41, s31, v41
v_lshlrev_b32 v42, 16, v43
v_and_b32 v43, s31, v43
v_lshlrev_b32 v44, 16, v45
v_and_b32 v45, s31, v45
v_lshlrev_b32 v46, 16, v47
v_and_b32 v47, s31, v47
v_pk_fma_f32 v[208:209], v[40:41], v[18:19], v[208:209] op_sel:[0,0,0] op_sel_hi:[1,0,1]
v_pk_fma_f32 v[210:211], v[42:43], v[18:19], v[210:211] op_sel:[0,0,0] op_sel_hi:[1,0,1]
v_pk_fma_f32 v[216:217], v[44:45], v[18:19], v[216:217] op_sel:[0,0,0] op_sel_hi:[1,0,1]
v_pk_fma_f32 v[218:219], v[46:47], v[18:19], v[218:219] op_sel:[0,0,0] op_sel_hi:[1,0,1]
v_cvt_pk_bf16_f32 v208, v208, v209
v_cvt_pk_bf16_f32 v209, v210, v211
v_cvt_pk_bf16_f32 v210, v216, v217
v_cvt_pk_bf16_f32 v211, v218, v219
buffer_store_dwordx4 v[144:147], v1, s[12:15], s29 offen offset:1024 sc0 sc1
v_accvgpr_read_b32 v33, a152
v_accvgpr_read_b32 v35, a153
v_accvgpr_read_b32 v37, a154
v_accvgpr_read_b32 v39, a155
v_pk_mul_f32 v[224:225], v[224:225], v[16:17] op_sel:[0,0] op_sel_hi:[1,0]
v_pk_mul_f32 v[226:227], v[226:227], v[16:17] op_sel:[0,0] op_sel_hi:[1,0]
v_pk_mul_f32 v[232:233], v[232:233], v[16:17] op_sel:[0,0] op_sel_hi:[1,0]
v_pk_mul_f32 v[234:235], v[234:235], v[16:17] op_sel:[0,0] op_sel_hi:[1,0]
v_lshlrev_b32 v32, 16, v33
v_and_b32 v33, s31, v33
v_lshlrev_b32 v34, 16, v35
v_and_b32 v35, s31, v35
v_lshlrev_b32 v36, 16, v37
v_and_b32 v37, s31, v37
v_lshlrev_b32 v38, 16, v39
v_and_b32 v39, s31, v39
v_pk_fma_f32 v[224:225], v[32:33], v[18:19], v[224:225] op_sel:[0,0,0] op_sel_hi:[1,0,1]
v_pk_fma_f32 v[226:227], v[34:35], v[18:19], v[226:227] op_sel:[0,0,0] op_sel_hi:[1,0,1]
v_pk_fma_f32 v[232:233], v[36:37], v[18:19], v[232:233] op_sel:[0,0,0] op_sel_hi:[1,0,1]
v_pk_fma_f32 v[234:235], v[38:39], v[18:19], v[234:235] op_sel:[0,0,0] op_sel_hi:[1,0,1]
v_cvt_pk_bf16_f32 v224, v224, v225
v_cvt_pk_bf16_f32 v225, v226, v227
v_cvt_pk_bf16_f32 v226, v232, v233
v_cvt_pk_bf16_f32 v227, v234, v235
v_accvgpr_read_b32 v41, a156
v_accvgpr_read_b32 v43, a157
v_accvgpr_read_b32 v45, a158
v_accvgpr_read_b32 v47, a159
v_pk_mul_f32 v[240:241], v[240:241], v[16:17] op_sel:[0,0] op_sel_hi:[1,0]
v_pk_mul_f32 v[242:243], v[242:243], v[16:17] op_sel:[0,0] op_sel_hi:[1,0]
v_pk_mul_f32 v[248:249], v[248:249], v[16:17] op_sel:[0,0] op_sel_hi:[1,0]
v_pk_mul_f32 v[250:251], v[250:251], v[16:17] op_sel:[0,0] op_sel_hi:[1,0]
v_lshlrev_b32 v40, 16, v41
v_and_b32 v41, s31, v41
v_lshlrev_b32 v42, 16, v43
v_and_b32 v43, s31, v43
v_lshlrev_b32 v44, 16, v45
v_and_b32 v45, s31, v45
v_lshlrev_b32 v46, 16, v47
v_and_b32 v47, s31, v47
v_pk_fma_f32 v[240:241], v[40:41], v[18:19], v[240:241] op_sel:[0,0,0] op_sel_hi:[1,0,1]
v_pk_fma_f32 v[242:243], v[42:43], v[18:19], v[242:243] op_sel:[0,0,0] op_sel_hi:[1,0,1]
v_pk_fma_f32 v[248:249], v[44:45], v[18:19], v[248:249] op_sel:[0,0,0] op_sel_hi:[1,0,1]
v_pk_fma_f32 v[250:251], v[46:47], v[18:19], v[250:251] op_sel:[0,0,0] op_sel_hi:[1,0,1]
v_cvt_pk_bf16_f32 v240, v240, v241
v_cvt_pk_bf16_f32 v241, v242, v243
v_cvt_pk_bf16_f32 v242, v248, v249
v_cvt_pk_bf16_f32 v243, v250, v251
buffer_store_dwordx4 v[160:163], v1, s[12:15], s29 offen offset:2048 sc0 sc1
v_accvgpr_read_b32 v33, a160
v_accvgpr_read_b32 v35, a161
v_accvgpr_read_b32 v37, a162
v_accvgpr_read_b32 v39, a163
v_pk_mul_f32 v[132:133], v[132:133], v[16:17] op_sel:[0,1] op_sel_hi:[1,1]
v_pk_mul_f32 v[134:135], v[134:135], v[16:17] op_sel:[0,1] op_sel_hi:[1,1]
v_pk_mul_f32 v[140:141], v[140:141], v[16:17] op_sel:[0,1] op_sel_hi:[1,1]
v_pk_mul_f32 v[142:143], v[142:143], v[16:17] op_sel:[0,1] op_sel_hi:[1,1]
v_lshlrev_b32 v32, 16, v33
v_and_b32 v33, s31, v33
v_lshlrev_b32 v34, 16, v35
v_and_b32 v35, s31, v35
v_lshlrev_b32 v36, 16, v37
v_and_b32 v37, s31, v37
v_lshlrev_b32 v38, 16, v39
v_and_b32 v39, s31, v39
v_pk_fma_f32 v[132:133], v[32:33], v[18:19], v[132:133] op_sel:[0,1,0] op_sel_hi:[1,1,1]
v_pk_fma_f32 v[134:135], v[34:35], v[18:19], v[134:135] op_sel:[0,1,0] op_sel_hi:[1,1,1]
v_pk_fma_f32 v[140:141], v[36:37], v[18:19], v[140:141] op_sel:[0,1,0] op_sel_hi:[1,1,1]
v_pk_fma_f32 v[142:143], v[38:39], v[18:19], v[142:143] op_sel:[0,1,0] op_sel_hi:[1,1,1]
v_cvt_pk_bf16_f32 v132, v132, v133
v_cvt_pk_bf16_f32 v133, v134, v135
v_cvt_pk_bf16_f32 v134, v140, v141
v_cvt_pk_bf16_f32 v135, v142, v143
v_accvgpr_read_b32 v41, a164
v_accvgpr_read_b32 v43, a165
v_accvgpr_read_b32 v45, a166
v_accvgpr_read_b32 v47, a167
v_pk_mul_f32 v[148:149], v[148:149], v[16:17] op_sel:[0,1] op_sel_hi:[1,1]
v_pk_mul_f32 v[150:151], v[150:151], v[16:17] op_sel:[0,1] op_sel_hi:[1,1]
v_pk_mul_f32 v[156:157], v[156:157], v[16:17] op_sel:[0,1] op_sel_hi:[1,1]
v_pk_mul_f32 v[158:159], v[158:159], v[16:17] op_sel:[0,1] op_sel_hi:[1,1]
v_lshlrev_b32 v40, 16, v41
v_and_b32 v41, s31, v41
v_lshlrev_b32 v42, 16, v43
v_and_b32 v43, s31, v43
v_lshlrev_b32 v44, 16, v45
v_and_b32 v45, s31, v45
v_lshlrev_b32 v46, 16, v47
v_and_b32 v47, s31, v47
v_pk_fma_f32 v[148:149], v[40:41], v[18:19], v[148:149] op_sel:[0,1,0] op_sel_hi:[1,1,1]
v_pk_fma_f32 v[150:151], v[42:43], v[18:19], v[150:151] op_sel:[0,1,0] op_sel_hi:[1,1,1]
v_pk_fma_f32 v[156:157], v[44:45], v[18:19], v[156:157] op_sel:[0,1,0] op_sel_hi:[1,1,1]
v_pk_fma_f32 v[158:159], v[46:47], v[18:19], v[158:159] op_sel:[0,1,0] op_sel_hi:[1,1,1]
v_cvt_pk_bf16_f32 v148, v148, v149
v_cvt_pk_bf16_f32 v149, v150, v151
v_cvt_pk_bf16_f32 v150, v156, v157
v_cvt_pk_bf16_f32 v151, v158, v159
v_accvgpr_read_b32 v33, a168
v_accvgpr_read_b32 v35, a169
v_accvgpr_read_b32 v37, a170
v_accvgpr_read_b32 v39, a171
v_pk_mul_f32 v[164:165], v[164:165], v[16:17] op_sel:[0,1] op_sel_hi:[1,1]
v_pk_mul_f32 v[166:167], v[166:167], v[16:17] op_sel:[0,1] op_sel_hi:[1,1]
v_pk_mul_f32 v[172:173], v[172:173], v[16:17] op_sel:[0,1] op_sel_hi:[1,1]
v_pk_mul_f32 v[174:175], v[174:175], v[16:17] op_sel:[0,1] op_sel_hi:[1,1]
v_lshlrev_b32 v32, 16, v33
v_and_b32 v33, s31, v33
v_lshlrev_b32 v34, 16, v35
v_and_b32 v35, s31, v35
v_lshlrev_b32 v36, 16, v37
v_and_b32 v37, s31, v37
v_lshlrev_b32 v38, 16, v39
v_and_b32 v39, s31, v39
v_pk_fma_f32 v[164:165], v[32:33], v[18:19], v[164:165] op_sel:[0,1,0] op_sel_hi:[1,1,1]
v_pk_fma_f32 v[166:167], v[34:35], v[18:19], v[166:167] op_sel:[0,1,0] op_sel_hi:[1,1,1]
v_pk_fma_f32 v[172:173], v[36:37], v[18:19], v[172:173] op_sel:[0,1,0] op_sel_hi:[1,1,1]
v_pk_fma_f32 v[174:175], v[38:39], v[18:19], v[174:175] op_sel:[0,1,0] op_sel_hi:[1,1,1]
v_cvt_pk_bf16_f32 v164, v164, v165
v_cvt_pk_bf16_f32 v165, v166, v167
v_cvt_pk_bf16_f32 v166, v172, v173
v_cvt_pk_bf16_f32 v167, v174, v175
buffer_store_dwordx4 v[176:179], v1, s[12:15], s29 offen offset:3072 sc0 sc1
v_accvgpr_read_b32 v41, a172
v_accvgpr_read_b32 v43, a173
v_accvgpr_read_b32 v45, a174
v_accvgpr_read_b32 v47, a175
v_pk_mul_f32 v[180:181], v[180:181], v[16:17] op_sel:[0,1] op_sel_hi:[1,1]
v_pk_mul_f32 v[182:183], v[182:183], v[16:17] op_sel:[0,1] op_sel_hi:[1,1]
v_pk_mul_f32 v[188:189], v[188:189], v[16:17] op_sel:[0,1] op_sel_hi:[1,1]
v_pk_mul_f32 v[190:191], v[190:191], v[16:17] op_sel:[0,1] op_sel_hi:[1,1]
v_lshlrev_b32 v40, 16, v41
v_and_b32 v41, s31, v41
v_lshlrev_b32 v42, 16, v43
v_and_b32 v43, s31, v43
v_lshlrev_b32 v44, 16, v45
v_and_b32 v45, s31, v45
v_lshlrev_b32 v46, 16, v47
v_and_b32 v47, s31, v47
v_pk_fma_f32 v[180:181], v[40:41], v[18:19], v[180:181] op_sel:[0,1,0] op_sel_hi:[1,1,1]
v_pk_fma_f32 v[182:183], v[42:43], v[18:19], v[182:183] op_sel:[0,1,0] op_sel_hi:[1,1,1]
v_pk_fma_f32 v[188:189], v[44:45], v[18:19], v[188:189] op_sel:[0,1,0] op_sel_hi:[1,1,1]
v_pk_fma_f32 v[190:191], v[46:47], v[18:19], v[190:191] op_sel:[0,1,0] op_sel_hi:[1,1,1]
v_cvt_pk_bf16_f32 v180, v180, v181
v_cvt_pk_bf16_f32 v181, v182, v183
v_cvt_pk_bf16_f32 v182, v188, v189
v_cvt_pk_bf16_f32 v183, v190, v191
v_accvgpr_read_b32 v33, a176
v_accvgpr_read_b32 v35, a177
v_accvgpr_read_b32 v37, a178
v_accvgpr_read_b32 v39, a179
v_pk_mul_f32 v[196:197], v[196:197], v[16:17] op_sel:[0,1] op_sel_hi:[1,1]
v_pk_mul_f32 v[198:199], v[198:199], v[16:17] op_sel:[0,1] op_sel_hi:[1,1]
v_pk_mul_f32 v[204:205], v[204:205], v[16:17] op_sel:[0,1] op_sel_hi:[1,1]
v_pk_mul_f32 v[206:207], v[206:207], v[16:17] op_sel:[0,1] op_sel_hi:[1,1]
v_lshlrev_b32 v32, 16, v33
v_and_b32 v33, s31, v33
v_lshlrev_b32 v34, 16, v35
v_and_b32 v35, s31, v35
v_lshlrev_b32 v36, 16, v37
v_and_b32 v37, s31, v37
v_lshlrev_b32 v38, 16, v39
v_and_b32 v39, s31, v39
v_pk_fma_f32 v[196:197], v[32:33], v[18:19], v[196:197] op_sel:[0,1,0] op_sel_hi:[1,1,1]
v_pk_fma_f32 v[198:199], v[34:35], v[18:19], v[198:199] op_sel:[0,1,0] op_sel_hi:[1,1,1]
v_pk_fma_f32 v[204:205], v[36:37], v[18:19], v[204:205] op_sel:[0,1,0] op_sel_hi:[1,1,1]
v_pk_fma_f32 v[206:207], v[38:39], v[18:19], v[206:207] op_sel:[0,1,0] op_sel_hi:[1,1,1]
v_cvt_pk_bf16_f32 v196, v196, v197
v_cvt_pk_bf16_f32 v197, v198, v199
v_cvt_pk_bf16_f32 v198, v204, v205
v_cvt_pk_bf16_f32 v199, v206, v207
v_accvgpr_read_b32 v41, a180
v_accvgpr_read_b32 v43, a181
v_accvgpr_read_b32 v45, a182
v_accvgpr_read_b32 v47, a183
v_pk_mul_f32 v[212:213], v[212:213], v[16:17] op_sel:[0,1] op_sel_hi:[1,1]
v_pk_mul_f32 v[214:215], v[214:215], v[16:17] op_sel:[0,1] op_sel_hi:[1,1]
v_pk_mul_f32 v[220:221], v[220:221], v[16:17] op_sel:[0,1] op_sel_hi:[1,1]
v_pk_mul_f32 v[222:223], v[222:223], v[16:17] op_sel:[0,1] op_sel_hi:[1,1]
v_lshlrev_b32 v40, 16, v41
v_and_b32 v41, s31, v41
v_lshlrev_b32 v42, 16, v43
v_and_b32 v43, s31, v43
v_lshlrev_b32 v44, 16, v45
v_and_b32 v45, s31, v45
v_lshlrev_b32 v46, 16, v47
v_and_b32 v47, s31, v47
v_pk_fma_f32 v[212:213], v[40:41], v[18:19], v[212:213] op_sel:[0,1,0] op_sel_hi:[1,1,1]
v_pk_fma_f32 v[214:215], v[42:43], v[18:19], v[214:215] op_sel:[0,1,0] op_sel_hi:[1,1,1]
v_pk_fma_f32 v[220:221], v[44:45], v[18:19], v[220:221] op_sel:[0,1,0] op_sel_hi:[1,1,1]
v_pk_fma_f32 v[222:223], v[46:47], v[18:19], v[222:223] op_sel:[0,1,0] op_sel_hi:[1,1,1]
v_cvt_pk_bf16_f32 v212, v212, v213
v_cvt_pk_bf16_f32 v213, v214, v215
v_cvt_pk_bf16_f32 v214, v220, v221
v_cvt_pk_bf16_f32 v215, v222, v223
buffer_store_dwordx4 v[192:195], v1, s[12:15], s30 offen offset:0 sc0 sc1
v_accvgpr_read_b32 v33, a184
v_accvgpr_read_b32 v35, a185
v_accvgpr_read_b32 v37, a186
v_accvgpr_read_b32 v39, a187
v_pk_mul_f32 v[228:229], v[228:229], v[16:17] op_sel:[0,1] op_sel_hi:[1,1]
v_pk_mul_f32 v[230:231], v[230:231], v[16:17] op_sel:[0,1] op_sel_hi:[1,1]
v_pk_mul_f32 v[236:237], v[236:237], v[16:17] op_sel:[0,1] op_sel_hi:[1,1]
v_pk_mul_f32 v[238:239], v[238:239], v[16:17] op_sel:[0,1] op_sel_hi:[1,1]
v_lshlrev_b32 v32, 16, v33
v_and_b32 v33, s31, v33
v_lshlrev_b32 v34, 16, v35
v_and_b32 v35, s31, v35
v_lshlrev_b32 v36, 16, v37
v_and_b32 v37, s31, v37
v_lshlrev_b32 v38, 16, v39
v_and_b32 v39, s31, v39
v_pk_fma_f32 v[228:229], v[32:33], v[18:19], v[228:229] op_sel:[0,1,0] op_sel_hi:[1,1,1]
v_pk_fma_f32 v[230:231], v[34:35], v[18:19], v[230:231] op_sel:[0,1,0] op_sel_hi:[1,1,1]
v_pk_fma_f32 v[236:237], v[36:37], v[18:19], v[236:237] op_sel:[0,1,0] op_sel_hi:[1,1,1]
v_pk_fma_f32 v[238:239], v[38:39], v[18:19], v[238:239] op_sel:[0,1,0] op_sel_hi:[1,1,1]
v_cvt_pk_bf16_f32 v228, v228, v229
v_cvt_pk_bf16_f32 v229, v230, v231
v_cvt_pk_bf16_f32 v230, v236, v237
v_cvt_pk_bf16_f32 v231, v238, v239
v_accvgpr_read_b32 v41, a188
v_accvgpr_read_b32 v43, a189
v_accvgpr_read_b32 v45, a190
v_accvgpr_read_b32 v47, a191
v_pk_mul_f32 v[244:245], v[244:245], v[16:17] op_sel:[0,1] op_sel_hi:[1,1]
v_pk_mul_f32 v[246:247], v[246:247], v[16:17] op_sel:[0,1] op_sel_hi:[1,1]
v_pk_mul_f32 v[252:253], v[252:253], v[16:17] op_sel:[0,1] op_sel_hi:[1,1]
v_pk_mul_f32 v[254:255], v[254:255], v[16:17] op_sel:[0,1] op_sel_hi:[1,1]
v_lshlrev_b32 v40, 16, v41
v_and_b32 v41, s31, v41
v_lshlrev_b32 v42, 16, v43
v_and_b32 v43, s31, v43
v_lshlrev_b32 v44, 16, v45
v_and_b32 v45, s31, v45
v_lshlrev_b32 v46, 16, v47
v_and_b32 v47, s31, v47
v_pk_fma_f32 v[244:245], v[40:41], v[18:19], v[244:245] op_sel:[0,1,0] op_sel_hi:[1,1,1]
v_pk_fma_f32 v[246:247], v[42:43], v[18:19], v[246:247] op_sel:[0,1,0] op_sel_hi:[1,1,1]
v_pk_fma_f32 v[252:253], v[44:45], v[18:19], v[252:253] op_sel:[0,1,0] op_sel_hi:[1,1,1]
v_pk_fma_f32 v[254:255], v[46:47], v[18:19], v[254:255] op_sel:[0,1,0] op_sel_hi:[1,1,1]
v_cvt_pk_bf16_f32 v244, v244, v245
v_cvt_pk_bf16_f32 v245, v246, v247
v_cvt_pk_bf16_f32 v246, v252, v253
v_cvt_pk_bf16_f32 v247, v254, v255
buffer_store_dwordx4 v[208:211], v1, s[12:15], s30 offen offset:1024 sc0 sc1
L_f_k3:
v_mov_b32 v10, v1
v_add_u32 v11, 65536, v1
v_add_u32 v12, 131072, v1
v_and_b32 v4, 15, v0
v_lshlrev_b32 v4, 2, v4
s_lshl_b32 s41, s32, 2
s_add_u32 s41, s41, s16
s_lshl_b32 s41, s41, 7
s_add_u32 s41, s41, 82837504
buffer_load_dword v8, v4, s[12:15], s41 offen offset:0
buffer_load_dword v9, v4, s[12:15], s41 offen offset:64
s_sub_u32 s41, 15, s32
s_add_u32 s42, s32, 16
s_cmp_ge_u32 s32, 8
s_cselect_b32 s41, s41, s42
s_lshl_b32 s41, s41, 3
s_add_u32 s41, s41, s44
s_lshl_b32 s45, s41, 8
s_add_u32 s45, s45, 82903052
v_and_b32 v29, 1, v0
v_lshlrev_b32 v29, 14, v29
v_bfe_u32 v28, v0, 1, 1
v_lshl_add_u32 v29, v28, 9, v29
s_bitcmp1_b32 s2, 0
s_cselect_b32 s52, 0x40000000, s36
s_cselect_b32 s53, 0x40000000, s38
s_cselect_b32 s41, 0, 256
s_add_u32 s41, s41, 16896
v_mov_b32 v6, s41
s_waitcnt vmcnt(62)
s_barrier
ds_read_b128 a[48:51], v11 offset:0
ds_read_b128 a[52:55], v11 offset:1024
ds_read_b128 a[56:59], v11 offset:2048
ds_read_b128 a[60:63], v11 offset:3072
ds_read_b128 a[64:67], v11 offset:4096
ds_read_b128 a[68:71], v11 offset:5120
ds_read_b128 a[72:75], v11 offset:6144
ds_read_b128 a[76:79], v11 offset:7168
ds_read_b128 a[80:83], v11 offset:8192
ds_read_b128 a[84:87], v11 offset:9216
ds_read_b128 a[88:91], v11 offset:10240
ds_read_b128 a[92:95], v11 offset:12288
ds_read_b128 a[96:99], v11 offset:13312
ds_read_b128 a[100:103], v11 offset:14336
s_waitcnt vmcnt(63) lgkmcnt(0)
v_mfma_f32_16x16x32_bf16 v[32:35], a[48:51], a[192:195], 0
ds_read_b128 a[104:107], v11 offset:16384
v_mfma_f32_16x16x32_bf16 v[32:35], a[76:79], a[200:203], v[32:35]
buffer_store_dwordx4 v[224:227], v1, s[12:15], s30 offen offset:2048 sc0 sc1
v_mfma_f32_16x16x32_bf16 v[60:63], a[76:79], a[204:207], 0
ds_read_b128 a[108:111], v11 offset:17408
v_mfma_f32_16x16x32_bf16 v[60:63], a[48:51], a[196:199], v[60:63]
ds_read_b128 a[112:115], v11 offset:18432
v_mfma_f32_16x16x32_bf16 v[36:39], a[52:55], a[192:195], 0
buffer_store_dwordx4 v[240:243], v1, s[12:15], s30 offen offset:3072 sc0 sc1
v_mfma_f32_16x16x32_bf16 v[36:39], a[80:83], a[200:203], v[36:39]
ds_read_b128 a[116:119], v11 offset:19456
v_mfma_f32_16x16x32_bf16 v[64:67], a[80:83], a[204:207], 0
ds_read_b128 a[120:123], v11 offset:20480
v_mfma_f32_16x16x32_bf16 v[64:67], a[52:55], a[196:199], v[64:67]
ds_read_b128 a[124:127], v11 offset:21504
v_mfma_f32_16x16x32_bf16 v[40:43], a[56:59], a[192:195], 0
buffer_store_dwordx4 v[132:135], v1, s[12:15], s64 offen offset:0 sc0 sc1
v_mfma_f32_16x16x32_bf16 v[40:43], a[84:87], a[200:203], v[40:43]
ds_read_b128 a[128:131], v11 offset:22528
v_mfma_f32_16x16x32_bf16 v[68:71], a[84:87], a[204:207], 0
ds_read_b128 a[132:135], v11 offset:23552
v_mfma_f32_16x16x32_bf16 v[68:71], a[56:59], a[196:199], v[68:71]
buffer_store_dwordx4 v[148:151], v1, s[12:15], s64 offen offset:1024 sc0 sc1
v_mfma_f32_16x16x32_bf16 v[44:47], a[60:63], a[192:195], 0
ds_read_b128 a[136:139], v11 offset:24576
v_mfma_f32_16x16x32_bf16 v[44:47], a[88:91], a[200:203], v[44:47]
ds_read_b128 a[140:143], v11 offset:25600
v_mfma_f32_16x16x32_bf16 v[72:75], a[88:91], a[204:207], 0
ds_read_b128 a[144:147], v11 offset:26624
v_mfma_f32_16x16x32_bf16 v[72:75], a[60:63], a[196:199], v[72:75]
buffer_store_dwordx4 v[164:167], v1, s[12:15], s64 offen offset:2048 sc0 sc1
v_mfma_f32_16x16x32_bf16 v[48:51], a[64:67], a[192:195], 0
ds_read_b128 a[148:151], v11 offset:28672
v_mfma_f32_16x16x32_bf16 v[48:51], a[92:95], a[200:203], v[48:51]
ds_read_b128 a[152:155], v11 offset:29696
v_mfma_f32_16x16x32_bf16 v[76:79], a[92:95], a[204:207], 0
buffer_store_dwordx4 v[180:183], v1, s[12:15], s64 offen offset:3072 sc0 sc1
v_mfma_f32_16x16x32_bf16 v[76:79], a[64:67], a[196:199], v[76:79]
ds_read_b128 a[156:159], v11 offset:30720
v_mfma_f32_16x16x32_bf16 v[52:55], a[68:71], a[192:195], 0
v_mfma_f32_16x16x32_bf16 v[52:55], a[96:99], a[200:203], v[52:55]
v_mfma_f32_16x16x32_bf16 v[80:83], a[96:99], a[204:207], 0
buffer_store_dwordx4 v[196:199], v1, s[12:15], s82 offen offset:0 sc0 sc1
v_mfma_f32_16x16x32_bf16 v[80:83], a[68:71], a[196:199], v[80:83]
v_mfma_f32_16x16x32_bf16 v[56:59], a[72:75], a[192:195], 0
v_mfma_f32_16x16x32_bf16 v[56:59], a[100:103], a[200:203], v[56:59]
buffer_store_dwordx4 v[212:215], v1, s[12:15], s82 offen offset:1024 sc0 sc1
v_mfma_f32_16x16x32_bf16 v[84:87], a[100:103], a[204:207], 0
v_mfma_f32_16x16x32_bf16 v[84:87], a[72:75], a[196:199], v[84:87]
s_waitcnt vmcnt(45)
s_barrier
s_waitcnt vmcnt(63) lgkmcnt(0)
v_mfma_f32_16x16x32_bf16 v[32:35], a[104:107], a[208:211], v[32:35]
ds_read_b128 a[48:51], v12 offset:0
v_mfma_f32_16x16x32_bf16 v[32:35], a[132:135], a[216:219], v[32:35]
buffer_store_dwordx4 v[228:231], v1, s[12:15], s82 offen offset:2048 sc0 sc1
v_mfma_f32_16x16x32_bf16 v[60:63], a[132:135], a[220:223], v[60:63]
ds_read_b128 a[52:55], v12 offset:1024
v_mfma_f32_16x16x32_bf16 v[60:63], a[104:107], a[212:215], v[60:63]
ds_read_b128 a[56:59], v12 offset:2048
v_mfma_f32_16x16x32_bf16 v[36:39], a[108:111], a[208:211], v[36:39]
buffer_store_dwordx4 v[244:247], v1, s[12:15], s82 offen offset:3072 sc0 sc1
v_mfma_f32_16x16x32_bf16 v[36:39], a[136:139], a[216:219], v[36:39]
ds_read_b128 a[60:63], v12 offset:3072
v_mfma_f32_16x16x32_bf16 v[64:67], a[136:139], a[220:223], v[64:67]
ds_read_b128 a[64:67], v12 offset:4096
v_mfma_f32_16x16x32_bf16 v[64:67], a[108:111], a[212:215], v[64:67]
ds_read_b128 a[68:71], v12 offset:5120
v_mfma_f32_16x16x32_bf16 v[40:43], a[112:115], a[208:211], v[40:43]
s_add_u32 s43, s35, 8192
buffer_load_dwordx4 a[0:3], v26, s[12:15], s43 offen offset:0
v_mfma_f32_16x16x32_bf16 v[40:43], a[140:143], a[216:219], v[40:43]
ds_read_b128 a[72:75], v12 offset:6144
v_mfma_f32_16x16x32_bf16 v[68:71], a[140:143], a[220:223], v[68:71]
ds_read_b128 a[76:79], v12 offset:7168
v_mfma_f32_16x16x32_bf16 v[68:71], a[112:115], a[212:215], v[68:71]
buffer_load_dwordx4 a[4:7], v27, s[12:15], s43 offen offset:0
v_mfma_f32_16x16x32_bf16 v[44:47], a[116:119], a[208:211], v[44:47]
ds_read_b128 a[80:83], v12 offset:8192
v_mfma_f32_16x16x32_bf16 v[44:47], a[144:147], a[216:219], v[44:47]
ds_read_b128 a[84:87], v12 offset:9216
v_mfma_f32_16x16x32_bf16 v[72:75], a[144:147], a[220:223], v[72:75]
ds_read_b128 a[88:91], v12 offset:10240
v_mfma_f32_16x16x32_bf16 v[72:75], a[116:119], a[212:215], v[72:75]
buffer_load_dwordx4 a[8:11], v26, s[12:15], s43 offen offset:1024
v_mfma_f32_16x16x32_bf16 v[48:51], a[120:123], a[208:211], v[48:51]
ds_read_b128 a[92:95], v12 offset:12288
v_mfma_f32_16x16x32_bf16 v[48:51], a[148:151], a[216:219], v[48:51]
ds_read_b128 a[96:99], v12 offset:13312
v_mfma_f32_16x16x32_bf16 v[76:79], a[148:151], a[220:223], v[76:79]
buffer_load_dwordx4 a[12:15], v27, s[12:15], s43 offen offset:1024
v_mfma_f32_16x16x32_bf16 v[76:79], a[120:123], a[212:215], v[76:79]
ds_read_b128 a[100:103], v12 offset:14336
v_mfma_f32_16x16x32_bf16 v[52:55], a[124:127], a[208:211], v[52:55]
v_mfma_f32_16x16x32_bf16 v[52:55], a[152:155], a[216:219], v[52:55]
v_mfma_f32_16x16x32_bf16 v[80:83], a[152:155], a[220:223], v[80:83]
s_add_u32 s43, s35, 10240
buffer_load_dwordx4 a[16:19], v26, s[12:15], s43 offen offset:0
v_mfma_f32_16x16x32_bf16 v[80:83], a[124:127], a[212:215], v[80:83]
v_mfma_f32_16x16x32_bf16 v[56:59], a[128:131], a[208:211], v[56:59]
v_mfma_f32_16x16x32_bf16 v[56:59], a[156:159], a[216:219], v[56:59]
buffer_load_dwordx4 a[20:23], v27, s[12:15], s43 offen offset:0
v_mfma_f32_16x16x32_bf16 v[84:87], a[156:159], a[220:223], v[84:87]
v_mfma_f32_16x16x32_bf16 v[84:87], a[128:131], a[212:215], v[84:87]
s_waitcnt vmcnt(49)
s_barrier
s_waitcnt vmcnt(63) lgkmcnt(0)
v_mfma_f32_16x16x32_bf16 v[32:35], a[48:51], a[224:227], v[32:35]
ds_read_b128 a[104:107], v12 offset:16384
v_mfma_f32_16x16x32_bf16 v[32:35], a[76:79], a[232:235], v[32:35]
buffer_load_dwordx4 a[24:27], v26, s[12:15], s43 offen offset:1024
v_mfma_f32_16x16x32_bf16 v[60:63], a[76:79], a[236:239], v[60:63]
ds_read_b128 a[108:111], v12 offset:17408
v_mfma_f32_16x16x32_bf16 v[60:63], a[48:51], a[228:231], v[60:63]
ds_read_b128 a[112:115], v12 offset:18432
v_mfma_f32_16x16x32_bf16 v[36:39], a[52:55], a[224:227], v[36:39]
buffer_load_dwordx4 a[28:31], v27, s[12:15], s43 offen offset:1024
v_mfma_f32_16x16x32_bf16 v[36:39], a[80:83], a[232:235], v[36:39]
ds_read_b128 a[116:119], v12 offset:19456
v_mfma_f32_16x16x32_bf16 v[64:67], a[80:83], a[236:239], v[64:67]
ds_read_b128 a[120:123], v12 offset:20480
v_mfma_f32_16x16x32_bf16 v[64:67], a[52:55], a[228:231], v[64:67]
ds_read_b128 a[124:127], v12 offset:21504
v_mfma_f32_16x16x32_bf16 v[40:43], a[56:59], a[224:227], v[40:43]
s_add_u32 s43, s35, 12288
buffer_load_dwordx4 a[32:35], v26, s[12:15], s43 offen offset:0
v_mfma_f32_16x16x32_bf16 v[40:43], a[84:87], a[232:235], v[40:43]
ds_read_b128 a[128:131], v12 offset:22528
v_mfma_f32_16x16x32_bf16 v[68:71], a[84:87], a[236:239], v[68:71]
ds_read_b128 a[132:135], v12 offset:23552
v_mfma_f32_16x16x32_bf16 v[68:71], a[56:59], a[228:231], v[68:71]
buffer_load_dwordx4 a[36:39], v27, s[12:15], s43 offen offset:0
v_mfma_f32_16x16x32_bf16 v[44:47], a[60:63], a[224:227], v[44:47]
ds_read_b128 a[136:139], v12 offset:24576
v_mfma_f32_16x16x32_bf16 v[44:47], a[88:91], a[232:235], v[44:47]
ds_read_b128 a[140:143], v12 offset:25600
v_mfma_f32_16x16x32_bf16 v[72:75], a[88:91], a[236:239], v[72:75]
ds_read_b128 a[144:147], v12 offset:26624
v_mfma_f32_16x16x32_bf16 v[72:75], a[60:63], a[228:231], v[72:75]
buffer_load_dwordx4 a[40:43], v26, s[12:15], s43 offen offset:1024
v_mfma_f32_16x16x32_bf16 v[48:51], a[64:67], a[224:227], v[48:51]
ds_read_b128 a[148:151], v12 offset:28672
v_mfma_f32_16x16x32_bf16 v[48:51], a[92:95], a[232:235], v[48:51]
ds_read_b128 a[152:155], v12 offset:29696
v_mfma_f32_16x16x32_bf16 v[76:79], a[92:95], a[236:239], v[76:79]
buffer_load_dwordx4 a[44:47], v27, s[12:15], s43 offen offset:1024
v_mfma_f32_16x16x32_bf16 v[76:79], a[64:67], a[228:231], v[76:79]
ds_read_b128 a[156:159], v12 offset:30720
v_mfma_f32_16x16x32_bf16 v[52:55], a[68:71], a[224:227], v[52:55]
v_mfma_f32_16x16x32_bf16 v[52:55], a[96:99], a[232:235], v[52:55]
v_mfma_f32_16x16x32_bf16 v[80:83], a[96:99], a[236:239], v[80:83]
v_mfma_f32_16x16x32_bf16 v[80:83], a[68:71], a[228:231], v[80:83]
v_mfma_f32_16x16x32_bf16 v[56:59], a[72:75], a[224:227], v[56:59]
v_mfma_f32_16x16x32_bf16 v[56:59], a[100:103], a[232:235], v[56:59]
v_mfma_f32_16x16x32_bf16 v[84:87], a[100:103], a[236:239], v[84:87]
v_mfma_f32_16x16x32_bf16 v[84:87], a[72:75], a[228:231], v[84:87]
s_waitcnt vmcnt(12)
s_barrier
s_cmp_eq_u32 s16, 0
s_cbranch_scc0 L_sig15
s_lshl_b32 s41, s2, 8
s_add_u32 s41, s41, 82903052
v_mov_b32 v4, 1
v_mov_b32 v5, 0
s_mov_b64 exec, 1
buffer_store_dword v4, v5, s[12:15], s41 offen sc0 sc1
s_mov_b64 exec, -1
L_sig15:
s_waitcnt vmcnt(63) lgkmcnt(0)
s_add_u32 m0, s40, 32768
s_add_u32 s41, s37, 86016
s_add_u32 s42, s41, s39
v_mfma_f32_16x16x32_bf16 v[32:35], a[104:107], a[240:243], v[32:35]
ds_read_b128 a[48:51], v10 offset:0
v_mfma_f32_16x16x32_bf16 v[32:35], a[132:135], a[248:251], v[32:35]
buffer_load_dwordx4 v1, s[12:15], s41 offen offset:0 lds
v_mfma_f32_16x16x32_bf16 v[60:63], a[132:135], a[252:255], v[60:63]
ds_read_b128 a[52:55], v10 offset:1024
v_mfma_f32_16x16x32_bf16 v[60:63], a[104:107], a[244:247], v[60:63]
ds_read_b128 a[56:59], v10 offset:2048
v_mfma_f32_16x16x32_bf16 v[36:39], a[108:111], a[240:243], v[36:39]
buffer_load_dwordx4 v1, s[12:15], s41 offen offset:1024 lds
v_mfma_f32_16x16x32_bf16 v[36:39], a[136:139], a[248:251], v[36:39]
ds_read_b128 a[60:63], v10 offset:3072
v_mfma_f32_16x16x32_bf16 v[64:67], a[136:139], a[252:255], v[64:67]
ds_read_b128 a[64:67], v10 offset:4096
v_mfma_f32_16x16x32_bf16 v[64:67], a[108:111], a[244:247], v[64:67]
ds_read_b128 a[68:71], v10 offset:5120
v_mfma_f32_16x16x32_bf16 v[40:43], a[112:115], a[240:243], v[40:43]
buffer_load_dwordx4 v1, s[12:15], s41 offen offset:2048 lds
v_mfma_f32_16x16x32_bf16 v[40:43], a[140:143], a[248:251], v[40:43]
ds_read_b128 a[72:75], v10 offset:6144
v_mfma_f32_16x16x32_bf16 v[68:71], a[140:143], a[252:255], v[68:71]
ds_read_b128 a[76:79], v10 offset:7168
v_mfma_f32_16x16x32_bf16 v[68:71], a[112:115], a[244:247], v[68:71]
buffer_load_dwordx4 v1, s[12:15], s42 offen offset:3072 lds
s_add_u32 m0, s40, 49152
s_add_u32 s41, s38, 0
s_add_u32 s42, s41, s39
v_mfma_f32_16x16x32_bf16 v[44:47], a[116:119], a[240:243], v[44:47]
ds_read_b128 a[80:83], v10 offset:8192
v_mfma_f32_16x16x32_bf16 v[44:47], a[144:147], a[248:251], v[44:47]
ds_read_b128 a[84:87], v10 offset:9216
v_mfma_f32_16x16x32_bf16 v[72:75], a[144:147], a[252:255], v[72:75]
ds_read_b128 a[88:91], v10 offset:10240
v_mfma_f32_16x16x32_bf16 v[72:75], a[116:119], a[244:247], v[72:75]
buffer_load_dwordx4 v1, s[12:15], s41 offen offset:0 lds
v_mfma_f32_16x16x32_bf16 v[48:51], a[120:123], a[240:243], v[48:51]
ds_read_b128 a[92:95], v10 offset:12288
v_mfma_f32_16x16x32_bf16 v[48:51], a[148:151], a[248:251], v[48:51]
ds_read_b128 a[96:99], v10 offset:13312
v_mfma_f32_16x16x32_bf16 v[76:79], a[148:151], a[252:255], v[76:79]
buffer_load_dwordx4 v1, s[12:15], s41 offen offset:1024 lds
v_mfma_f32_16x16x32_bf16 v[76:79], a[120:123], a[244:247], v[76:79]
ds_read_b128 a[100:103], v10 offset:14336
v_mfma_f32_16x16x32_bf16 v[52:55], a[124:127], a[240:243], v[52:55]
v_mfma_f32_16x16x32_bf16 v[52:55], a[152:155], a[248:251], v[52:55]
v_mfma_f32_16x16x32_bf16 v[80:83], a[152:155], a[252:255], v[80:83]
buffer_load_dwordx4 v1, s[12:15], s41 offen offset:2048 lds
v_mfma_f32_16x16x32_bf16 v[80:83], a[124:127], a[244:247], v[80:83]
v_mfma_f32_16x16x32_bf16 v[56:59], a[128:131], a[240:243], v[56:59]
v_mfma_f32_16x16x32_bf16 v[56:59], a[156:159], a[248:251], v[56:59]
buffer_load_dwordx4 v1, s[12:15], s42 offen offset:3072 lds
v_mfma_f32_16x16x32_bf16 v[84:87], a[156:159], a[252:255], v[84:87]
v_mfma_f32_16x16x32_bf16 v[84:87], a[128:131], a[244:247], v[84:87]
s_waitcnt vmcnt(38)
s_barrier
s_waitcnt vmcnt(16) lgkmcnt(0)
s_add_u32 m0, s40, 98304
s_add_u32 s41, s38, 14336
s_add_u32 s42, s41, s39
v_mfma_f32_16x16x32_bf16 v[32:35], a[48:51], a[0:3], v[32:35]
ds_read_b128 a[104:107], v10 offset:16384
v_mfma_f32_16x16x32_bf16 v[32:35], a[76:79], a[8:11], v[32:35]
buffer_load_dwordx4 v1, s[12:15], s41 offen offset:0 lds
v_mfma_f32_16x16x32_bf16 v[60:63], a[76:79], a[12:15], v[60:63]
ds_read_b128 a[108:111], v10 offset:17408
v_mfma_f32_16x16x32_bf16 v[60:63], a[48:51], a[4:7], v[60:63]
ds_read_b128 a[112:115], v10 offset:18432
v_mfma_f32_16x16x32_bf16 v[36:39], a[52:55], a[0:3], v[36:39]
buffer_load_dwordx4 v1, s[12:15], s41 offen offset:1024 lds
v_mfma_f32_16x16x32_bf16 v[36:39], a[80:83], a[8:11], v[36:39]
ds_read_b128 a[116:119], v10 offset:19456
v_mfma_f32_16x16x32_bf16 v[64:67], a[80:83], a[12:15], v[64:67]
ds_read_b128 a[120:123], v10 offset:20480
v_mfma_f32_16x16x32_bf16 v[64:67], a[52:55], a[4:7], v[64:67]
ds_read_b128 a[124:127], v10 offset:21504
v_mfma_f32_16x16x32_bf16 v[40:43], a[56:59], a[0:3], v[40:43]
buffer_load_dwordx4 v1, s[12:15], s41 offen offset:2048 lds
v_mfma_f32_16x16x32_bf16 v[40:43], a[84:87], a[8:11], v[40:43]
ds_read_b128 a[128:131], v10 offset:22528
v_mfma_f32_16x16x32_bf16 v[68:71], a[84:87], a[12:15], v[68:71]
ds_read_b128 a[132:135], v10 offset:23552
v_mfma_f32_16x16x32_bf16 v[68:71], a[56:59], a[4:7], v[68:71]
buffer_load_dwordx4 v1, s[12:15], s42 offen offset:3072 lds
s_add_u32 m0, s40, 114688
s_add_u32 s41, s38, 28672
s_add_u32 s42, s41, s39
v_mfma_f32_16x16x32_bf16 v[44:47], a[60:63], a[0:3], v[44:47]
ds_read_b128 a[136:139], v10 offset:24576
v_mfma_f32_16x16x32_bf16 v[44:47], a[88:91], a[8:11], v[44:47]
ds_read_b128 a[140:143], v10 offset:25600
v_mfma_f32_16x16x32_bf16 v[72:75], a[88:91], a[12:15], v[72:75]
ds_read_b128 a[144:147], v10 offset:26624
v_mfma_f32_16x16x32_bf16 v[72:75], a[60:63], a[4:7], v[72:75]
buffer_load_dwordx4 v1, s[12:15], s41 offen offset:0 lds
v_mfma_f32_16x16x32_bf16 v[48:51], a[64:67], a[0:3], v[48:51]
ds_read_b128 a[148:151], v10 offset:28672
v_mfma_f32_16x16x32_bf16 v[48:51], a[92:95], a[8:11], v[48:51]
ds_read_b128 a[152:155], v10 offset:29696
v_mfma_f32_16x16x32_bf16 v[76:79], a[92:95], a[12:15], v[76:79]
buffer_load_dwordx4 v1, s[12:15], s41 offen offset:1024 lds
v_mfma_f32_16x16x32_bf16 v[76:79], a[64:67], a[4:7], v[76:79]
ds_read_b128 a[156:159], v10 offset:30720
v_mfma_f32_16x16x32_bf16 v[52:55], a[68:71], a[0:3], v[52:55]
v_mfma_f32_16x16x32_bf16 v[52:55], a[96:99], a[8:11], v[52:55]
v_mfma_f32_16x16x32_bf16 v[80:83], a[96:99], a[12:15], v[80:83]
buffer_load_dwordx4 v1, s[12:15], s41 offen offset:2048 lds
v_mfma_f32_16x16x32_bf16 v[80:83], a[68:71], a[4:7], v[80:83]
v_mfma_f32_16x16x32_bf16 v[56:59], a[72:75], a[0:3], v[56:59]
v_mfma_f32_16x16x32_bf16 v[56:59], a[100:103], a[8:11], v[56:59]
buffer_load_dwordx4 v1, s[12:15], s42 offen offset:3072 lds
v_mfma_f32_16x16x32_bf16 v[84:87], a[100:103], a[12:15], v[84:87]
v_mfma_f32_16x16x32_bf16 v[84:87], a[72:75], a[4:7], v[84:87]
s_waitcnt vmcnt(12)
s_barrier
s_waitcnt vmcnt(20) lgkmcnt(0)
s_add_u32 m0, s40, 65536
s_add_u32 s41, s38, 43008
s_add_u32 s42, s41, s39
v_mfma_f32_16x16x32_bf16 v[32:35], a[104:107], a[16:19], v[32:35]
ds_read_b128 a[48:51], v10 offset:32768
v_mfma_f32_16x16x32_bf16 v[32:35], a[132:135], a[24:27], v[32:35]
buffer_load_dwordx4 v1, s[12:15], s41 offen offset:0 lds
v_mfma_f32_16x16x32_bf16 v[60:63], a[132:135], a[28:31], v[60:63]
ds_read_b128 a[52:55], v10 offset:33792
v_mfma_f32_16x16x32_bf16 v[60:63], a[104:107], a[20:23], v[60:63]
ds_read_b128 a[56:59], v10 offset:34816
v_mfma_f32_16x16x32_bf16 v[36:39], a[108:111], a[16:19], v[36:39]
buffer_load_dwordx4 v1, s[12:15], s41 offen offset:1024 lds
v_mfma_f32_16x16x32_bf16 v[36:39], a[136:139], a[24:27], v[36:39]
ds_read_b128 a[60:63], v10 offset:35840
v_mfma_f32_16x16x32_bf16 v[64:67], a[136:139], a[28:31], v[64:67]
ds_read_b128 a[64:67], v10 offset:36864
v_mfma_f32_16x16x32_bf16 v[64:67], a[108:111], a[20:23], v[64:67]
ds_read_b128 a[68:71], v10 offset:37888
v_mfma_f32_16x16x32_bf16 v[40:43], a[112:115], a[16:19], v[40:43]
buffer_load_dwordx4 v1, s[12:15], s41 offen offset:2048 lds
v_mfma_f32_16x16x32_bf16 v[40:43], a[140:143], a[24:27], v[40:43]
ds_read_b128 a[72:75], v10 offset:38912
v_mfma_f32_16x16x32_bf16 v[68:71], a[140:143], a[28:31], v[68:71]
ds_read_b128 a[76:79], v10 offset:39936
v_mfma_f32_16x16x32_bf16 v[68:71], a[112:115], a[20:23], v[68:71]
buffer_load_dwordx4 v1, s[12:15], s42 offen offset:3072 lds
s_add_u32 m0, s40, 81920
s_add_u32 s41, s38, 57344
s_add_u32 s42, s41, s39
v_mfma_f32_16x16x32_bf16 v[44:47], a[116:119], a[16:19], v[44:47]
ds_read_b128 a[80:83], v10 offset:40960
v_mfma_f32_16x16x32_bf16 v[44:47], a[144:147], a[24:27], v[44:47]
ds_read_b128 a[84:87], v10 offset:41984
v_mfma_f32_16x16x32_bf16 v[72:75], a[144:147], a[28:31], v[72:75]
ds_read_b128 a[88:91], v10 offset:43008
v_mfma_f32_16x16x32_bf16 v[72:75], a[116:119], a[20:23], v[72:75]
buffer_load_dwordx4 v1, s[12:15], s41 offen offset:0 lds
v_mfma_f32_16x16x32_bf16 v[48:51], a[120:123], a[16:19], v[48:51]
ds_read_b128 a[92:95], v10 offset:45056
v_mfma_f32_16x16x32_bf16 v[48:51], a[148:151], a[24:27], v[48:51]
ds_read_b128 a[96:99], v10 offset:46080
v_mfma_f32_16x16x32_bf16 v[76:79], a[148:151], a[28:31], v[76:79]
buffer_load_dwordx4 v1, s[12:15], s41 offen offset:1024 lds
v_mfma_f32_16x16x32_bf16 v[76:79], a[120:123], a[20:23], v[76:79]
ds_read_b128 a[100:103], v10 offset:47104
v_mfma_f32_16x16x32_bf16 v[52:55], a[124:127], a[16:19], v[52:55]
v_mfma_f32_16x16x32_bf16 v[52:55], a[152:155], a[24:27], v[52:55]
v_mfma_f32_16x16x32_bf16 v[80:83], a[152:155], a[28:31], v[80:83]
buffer_load_dwordx4 v1, s[12:15], s41 offen offset:2048 lds
v_mfma_f32_16x16x32_bf16 v[80:83], a[124:127], a[20:23], v[80:83]
v_mfma_f32_16x16x32_bf16 v[56:59], a[128:131], a[16:19], v[56:59]
v_mfma_f32_16x16x32_bf16 v[56:59], a[156:159], a[24:27], v[56:59]
buffer_load_dwordx4 v1, s[12:15], s42 offen offset:3072 lds
v_mfma_f32_16x16x32_bf16 v[84:87], a[156:159], a[28:31], v[84:87]
v_mfma_f32_16x16x32_bf16 v[84:87], a[128:131], a[20:23], v[84:87]
s_waitcnt vmcnt(16)
s_barrier
s_mov_b32 s42, 0
L_poll16:
buffer_load_dword v28, v29, s[12:15], s45 offen sc0 sc1
s_waitcnt vmcnt(0)
v_cmp_ne_u32 vcc, 1, v28
s_nop 4
s_cbranch_vccnz L_poll16_r
s_branch L_poll16_ok
L_poll16_r:
s_add_u32 s42, s42, 1
s_cmp_lt_u32 s42, 32768
s_sleep 4
s_cbranch_scc1 L_poll16
L_poll16_ok:
s_add_u32 s43, s36, 0
buffer_load_dwordx4 v[152:155], v26, s[12:15], s43 offen offset:0
buffer_load_dwordx4 v[156:159], v27, s[12:15], s43 offen offset:0
buffer_load_dwordx4 v[160:163], v26, s[12:15], s43 offen offset:1024
buffer_load_dwordx4 v[164:167], v27, s[12:15], s43 offen offset:1024
s_add_u32 s43, s36, 2048
buffer_load_dwordx4 v[168:171], v26, s[12:15], s43 offen offset:0
buffer_load_dwordx4 v[172:175], v27, s[12:15], s43 offen offset:0
buffer_load_dwordx4 v[176:179], v26, s[12:15], s43 offen offset:1024
buffer_load_dwordx4 v[180:183], v27, s[12:15], s43 offen offset:1024
s_add_u32 s43, s36, 4096
buffer_load_dwordx4 v[184:187], v26, s[12:15], s43 offen offset:0
buffer_load_dwordx4 v[188:191], v27, s[12:15], s43 offen offset:0
buffer_load_dwordx4 v[192:195], v26, s[12:15], s43 offen offset:1024
buffer_load_dwordx4 v[196:199], v27, s[12:15], s43 offen offset:1024
s_waitcnt vmcnt(63) lgkmcnt(0)
s_add_u32 s43, s36, 6144
s_add_u32 m0, s40, 131072
s_add_u32 s41, s38, 71680
s_add_u32 s42, s41, s39
v_mfma_f32_16x16x32_bf16 v[32:35], a[48:51], a[32:35], v[32:35]
ds_read_b128 a[104:107], v10 offset:49152
v_mfma_f32_16x16x32_bf16 v[32:35], a[76:79], a[40:43], v[32:35]
buffer_load_dwordx4 v[200:203], v26, s[12:15], s43 offen offset:0
v_mfma_f32_16x16x32_bf16 v[60:63], a[76:79], a[44:47], v[60:63]
ds_read_b128 a[108:111], v10 offset:50176
v_mfma_f32_16x16x32_bf16 v[60:63], a[48:51], a[36:39], v[60:63]
ds_read_b128 a[112:115], v10 offset:51200
v_mfma_f32_16x16x32_bf16 v[36:39], a[52:55], a[32:35], v[36:39]
buffer_load_dwordx4 v[204:207], v27, s[12:15], s43 offen offset:0
v_mfma_f32_16x16x32_bf16 v[36:39], a[80:83], a[40:43], v[36:39]
ds_read_b128 a[116:119], v10 offset:52224
v_mfma_f32_16x16x32_bf16 v[64:67], a[80:83], a[44:47], v[64:67]
ds_read_b128 a[120:123], v10 offset:53248
v_mfma_f32_16x16x32_bf16 v[64:67], a[52:55], a[36:39], v[64:67]
ds_read_b128 a[124:127], v10 offset:54272
v_mfma_f32_16x16x32_bf16 v[40:43], a[56:59], a[32:35], v[40:43]
buffer_load_dwordx4 v[208:211], v26, s[12:15], s43 offen offset:1024
v_mfma_f32_16x16x32_bf16 v[40:43], a[84:87], a[40:43], v[40:43]
ds_read_b128 a[128:131], v10 offset:55296
v_mfma_f32_16x16x32_bf16 v[68:71], a[84:87], a[44:47], v[68:71]
ds_read_b128 a[132:135], v10 offset:56320
v_mfma_f32_16x16x32_bf16 v[68:71], a[56:59], a[36:39], v[68:71]
buffer_load_dwordx4 v[212:215], v27, s[12:15], s43 offen offset:1024
v_mfma_f32_16x16x32_bf16 v[44:47], a[60:63], a[32:35], v[44:47]
ds_read_b128 a[136:139], v10 offset:57344
v_mfma_f32_16x16x32_bf16 v[44:47], a[88:91], a[40:43], v[44:47]
ds_read_b128 a[140:143], v10 offset:58368
v_mfma_f32_16x16x32_bf16 v[72:75], a[88:91], a[44:47], v[72:75]
ds_read_b128 a[144:147], v10 offset:59392
v_mfma_f32_16x16x32_bf16 v[72:75], a[60:63], a[36:39], v[72:75]
buffer_load_dwordx4 v1, s[12:15], s41 offen offset:0 lds
v_mfma_f32_16x16x32_bf16 v[48:51], a[64:67], a[32:35], v[48:51]
ds_read_b128 a[148:151], v10 offset:61440
v_mfma_f32_16x16x32_bf16 v[48:51], a[92:95], a[40:43], v[48:51]
ds_read_b128 a[152:155], v10 offset:62464
v_mfma_f32_16x16x32_bf16 v[76:79], a[92:95], a[44:47], v[76:79]
buffer_load_dwordx4 v1, s[12:15], s41 offen offset:1024 lds
v_mfma_f32_16x16x32_bf16 v[76:79], a[64:67], a[36:39], v[76:79]
ds_read_b128 a[156:159], v10 offset:63488
v_mfma_f32_16x16x32_bf16 v[52:55], a[68:71], a[32:35], v[52:55]
v_mfma_f32_16x16x32_bf16 v[52:55], a[96:99], a[40:43], v[52:55]
v_mfma_f32_16x16x32_bf16 v[80:83], a[96:99], a[44:47], v[80:83]
buffer_load_dwordx4 v1, s[12:15], s41 offen offset:2048 lds
v_mfma_f32_16x16x32_bf16 v[80:83], a[68:71], a[36:39], v[80:83]
v_mfma_f32_16x16x32_bf16 v[56:59], a[72:75], a[32:35], v[56:59]
v_mfma_f32_16x16x32_bf16 v[56:59], a[100:103], a[40:43], v[56:59]
buffer_load_dwordx4 v1, s[12:15], s42 offen offset:3072 lds
v_mfma_f32_16x16x32_bf16 v[84:87], a[100:103], a[44:47], v[84:87]
v_mfma_f32_16x16x32_bf16 v[84:87], a[72:75], a[36:39], v[84:87]
s_waitcnt vmcnt(63)
s_barrier
s_waitcnt vmcnt(16) lgkmcnt(0)
s_add_u32 s43, s36, 8192
s_add_u32 m0, s40, 147456
s_add_u32 s41, s38, 86016
s_add_u32 s42, s41, s39
v_mfma_f32_16x16x32_bf16 v[88:91], a[104:107], v[152:155], 0
ds_read_b128 a[48:51], v11 offset:32768
v_mfma_f32_16x16x32_bf16 v[88:91], a[132:135], v[160:163], v[88:91]
buffer_load_dwordx4 v[216:219], v26, s[12:15], s43 offen offset:0
v_mfma_f32_16x16x32_bf16 v[116:119], a[132:135], v[164:167], 0
ds_read_b128 a[52:55], v11 offset:33792
v_mfma_f32_16x16x32_bf16 v[116:119], a[104:107], v[156:159], v[116:119]
ds_read_b128 a[56:59], v11 offset:34816
v_mfma_f32_16x16x32_bf16 v[92:95], a[108:111], v[152:155], 0
buffer_load_dwordx4 v[220:223], v27, s[12:15], s43 offen offset:0
v_mfma_f32_16x16x32_bf16 v[92:95], a[136:139], v[160:163], v[92:95]
ds_read_b128 a[60:63], v11 offset:35840
v_mfma_f32_16x16x32_bf16 v[120:123], a[136:139], v[164:167], 0
ds_read_b128 a[64:67], v11 offset:36864
v_mfma_f32_16x16x32_bf16 v[120:123], a[108:111], v[156:159], v[120:123]
ds_read_b128 a[68:71], v11 offset:37888
v_mfma_f32_16x16x32_bf16 v[96:99], a[112:115], v[152:155], 0
buffer_load_dwordx4 v[224:227], v26, s[12:15], s43 offen offset:1024
v_mfma_f32_16x16x32_bf16 v[96:99], a[140:143], v[160:163], v[96:99]
ds_read_b128 a[72:75], v11 offset:38912
v_mfma_f32_16x16x32_bf16 v[124:127], a[140:143], v[164:167], 0
ds_read_b128 a[76:79], v11 offset:39936
v_mfma_f32_16x16x32_bf16 v[124:127], a[112:115], v[156:159], v[124:127]
buffer_load_dwordx4 v[228:231], v27, s[12:15], s43 offen offset:1024
v_mfma_f32_16x16x32_bf16 v[100:103], a[116:119], v[152:155], 0
ds_read_b128 a[80:83], v11 offset:40960
v_mfma_f32_16x16x32_bf16 v[100:103], a[144:147], v[160:163], v[100:103]
ds_read_b128 a[84:87], v11 offset:41984
v_mfma_f32_16x16x32_bf16 v[128:131], a[144:147], v[164:167], 0
ds_read_b128 a[88:91], v11 offset:43008
v_mfma_f32_16x16x32_bf16 v[128:131], a[116:119], v[156:159], v[128:131]
buffer_load_dwordx4 v1, s[12:15], s41 offen offset:0 lds
v_mfma_f32_16x16x32_bf16 v[104:107], a[120:123], v[152:155], 0
ds_read_b128 a[92:95], v11 offset:45056
v_mfma_f32_16x16x32_bf16 v[104:107], a[148:151], v[160:163], v[104:107]
ds_read_b128 a[96:99], v11 offset:46080
v_mfma_f32_16x16x32_bf16 v[132:135], a[148:151], v[164:167], 0
buffer_load_dwordx4 v1, s[12:15], s41 offen offset:1024 lds
v_mfma_f32_16x16x32_bf16 v[132:135], a[120:123], v[156:159], v[132:135]
ds_read_b128 a[100:103], v11 offset:47104
v_mfma_f32_16x16x32_bf16 v[108:111], a[124:127], v[152:155], 0
v_mfma_f32_16x16x32_bf16 v[108:111], a[152:155], v[160:163], v[108:111]
v_mfma_f32_16x16x32_bf16 v[136:139], a[152:155], v[164:167], 0
buffer_load_dwordx4 v1, s[12:15], s41 offen offset:2048 lds
v_mfma_f32_16x16x32_bf16 v[136:139], a[124:127], v[156:159], v[136:139]
v_mfma_f32_16x16x32_bf16 v[112:115], a[128:131], v[152:155], 0
v_mfma_f32_16x16x32_bf16 v[112:115], a[156:159], v[160:163], v[112:115]
buffer_load_dwordx4 v1, s[12:15], s42 offen offset:3072 lds
v_mfma_f32_16x16x32_bf16 v[140:143], a[156:159], v[164:167], 0
v_mfma_f32_16x16x32_bf16 v[140:143], a[128:131], v[156:159], v[140:143]
s_waitcnt vmcnt(63)
s_barrier
s_waitcnt vmcnt(20) lgkmcnt(0)
s_add_u32 s43, s36, 10240
s_add_u32 m0, s40, 0
s_add_u32 s41, s38, 100352
s_add_u32 s42, s41, s39
v_mfma_f32_16x16x32_bf16 v[88:91], a[48:51], v[168:171], v[88:91]
ds_read_b128 a[104:107], v11 offset:49152
v_mfma_f32_16x16x32_bf16 v[88:91], a[76:79], v[176:179], v[88:91]
buffer_load_dwordx4 v[232:235], v26, s[12:15], s43 offen offset:0
v_mfma_f32_16x16x32_bf16 v[116:119], a[76:79], v[180:183], v[116:119]
ds_read_b128 a[108:111], v11 offset:50176
v_mfma_f32_16x16x32_bf16 v[116:119], a[48:51], v[172:175], v[116:119]
ds_read_b128 a[112:115], v11 offset:51200
v_mfma_f32_16x16x32_bf16 v[92:95], a[52:55], v[168:171], v[92:95]
buffer_load_dwordx4 v[236:239], v27, s[12:15], s43 offen offset:0
v_mfma_f32_16x16x32_bf16 v[92:95], a[80:83], v[176:179], v[92:95]
ds_read_b128 a[116:119], v11 offset:52224
v_mfma_f32_16x16x32_bf16 v[120:123], a[80:83], v[180:183], v[120:123]
ds_read_b128 a[120:123], v11 offset:53248
v_mfma_f32_16x16x32_bf16 v[120:123], a[52:55], v[172:175], v[120:123]
ds_read_b128 a[124:127], v11 offset:54272
v_mfma_f32_16x16x32_bf16 v[96:99], a[56:59], v[168:171], v[96:99]
buffer_load_dwordx4 v[240:243], v26, s[12:15], s43 offen offset:1024
v_mfma_f32_16x16x32_bf16 v[96:99], a[84:87], v[176:179], v[96:99]
ds_read_b128 a[128:131], v11 offset:55296
v_mfma_f32_16x16x32_bf16 v[124:127], a[84:87], v[180:183], v[124:127]
ds_read_b128 a[132:135], v11 offset:56320
v_mfma_f32_16x16x32_bf16 v[124:127], a[56:59], v[172:175], v[124:127]
buffer_load_dwordx4 v[244:247], v27, s[12:15], s43 offen offset:1024
v_mfma_f32_16x16x32_bf16 v[100:103], a[60:63], v[168:171], v[100:103]
ds_read_b128 a[136:139], v11 offset:57344
v_mfma_f32_16x16x32_bf16 v[100:103], a[88:91], v[176:179], v[100:103]
ds_read_b128 a[140:143], v11 offset:58368
v_mfma_f32_16x16x32_bf16 v[128:131], a[88:91], v[180:183], v[128:131]
ds_read_b128 a[144:147], v11 offset:59392
v_mfma_f32_16x16x32_bf16 v[128:131], a[60:63], v[172:175], v[128:131]
buffer_load_dwordx4 v1, s[12:15], s41 offen offset:0 lds
v_mfma_f32_16x16x32_bf16 v[104:107], a[64:67], v[168:171], v[104:107]
ds_read_b128 a[148:151], v11 offset:61440
v_mfma_f32_16x16x32_bf16 v[104:107], a[92:95], v[176:179], v[104:107]
ds_read_b128 a[152:155], v11 offset:62464
v_mfma_f32_16x16x32_bf16 v[132:135], a[92:95], v[180:183], v[132:135]
buffer_load_dwordx4 v1, s[12:15], s41 offen offset:1024 lds
v_mfma_f32_16x16x32_bf16 v[132:135], a[64:67], v[172:175], v[132:135]
ds_read_b128 a[156:159], v11 offset:63488
v_mfma_f32_16x16x32_bf16 v[108:111], a[68:71], v[168:171], v[108:111]
v_mfma_f32_16x16x32_bf16 v[108:111], a[96:99], v[176:179], v[108:111]
v_mfma_f32_16x16x32_bf16 v[136:139], a[96:99], v[180:183], v[136:139]
buffer_load_dwordx4 v1, s[12:15], s41 offen offset:2048 lds
v_mfma_f32_16x16x32_bf16 v[136:139], a[68:71], v[172:175], v[136:139]
v_mfma_f32_16x16x32_bf16 v[112:115], a[72:75], v[168:171], v[112:115]
v_mfma_f32_16x16x32_bf16 v[112:115], a[100:103], v[176:179], v[112:115]
buffer_load_dwordx4 v1, s[12:15], s42 offen offset:3072 lds
v_mfma_f32_16x16x32_bf16 v[140:143], a[100:103], v[180:183], v[140:143]
v_mfma_f32_16x16x32_bf16 v[140:143], a[72:75], v[172:175], v[140:143]
s_waitcnt vmcnt(63)
s_barrier
s_waitcnt vmcnt(24) lgkmcnt(0)
s_add_u32 s43, s36, 12288
s_add_u32 m0, s40, 16384
s_add_u32 s41, s38, 229376
s_add_u32 s42, s41, s39
v_mfma_f32_16x16x32_bf16 v[88:91], a[104:107], v[184:187], v[88:91]
ds_read_b128 a[48:51], v11 offset:0
v_mfma_f32_16x16x32_bf16 v[88:91], a[132:135], v[192:195], v[88:91]
buffer_load_dwordx4 v[152:155], v26, s[12:15], s43 offen offset:0
v_mfma_f32_16x16x32_bf16 v[116:119], a[132:135], v[196:199], v[116:119]
ds_read_b128 a[52:55], v11 offset:1024
v_mfma_f32_16x16x32_bf16 v[116:119], a[104:107], v[188:191], v[116:119]
ds_read_b128 a[56:59], v11 offset:2048
v_mfma_f32_16x16x32_bf16 v[92:95], a[108:111], v[184:187], v[92:95]
buffer_load_dwordx4 v[156:159], v27, s[12:15], s43 offen offset:0
v_mfma_f32_16x16x32_bf16 v[92:95], a[136:139], v[192:195], v[92:95]
ds_read_b128 a[60:63], v11 offset:3072
v_mfma_f32_16x16x32_bf16 v[120:123], a[136:139], v[196:199], v[120:123]
ds_read_b128 a[64:67], v11 offset:4096
v_mfma_f32_16x16x32_bf16 v[120:123], a[108:111], v[188:191], v[120:123]
ds_read_b128 a[68:71], v11 offset:5120
v_mfma_f32_16x16x32_bf16 v[96:99], a[112:115], v[184:187], v[96:99]
buffer_load_dwordx4 v[160:163], v26, s[12:15], s43 offen offset:1024
v_mfma_f32_16x16x32_bf16 v[96:99], a[140:143], v[192:195], v[96:99]
ds_read_b128 a[72:75], v11 offset:6144
v_mfma_f32_16x16x32_bf16 v[124:127], a[140:143], v[196:199], v[124:127]
ds_read_b128 a[76:79], v11 offset:7168
v_mfma_f32_16x16x32_bf16 v[124:127], a[112:115], v[188:191], v[124:127]
buffer_load_dwordx4 v[164:167], v27, s[12:15], s43 offen offset:1024
v_mfma_f32_16x16x32_bf16 v[100:103], a[116:119], v[184:187], v[100:103]
ds_read_b128 a[80:83], v11 offset:8192
v_mfma_f32_16x16x32_bf16 v[100:103], a[144:147], v[192:195], v[100:103]
ds_read_b128 a[84:87], v11 offset:9216
v_mfma_f32_16x16x32_bf16 v[128:131], a[144:147], v[196:199], v[128:131]
ds_read_b128 a[88:91], v11 offset:10240
v_mfma_f32_16x16x32_bf16 v[128:131], a[116:119], v[188:191], v[128:131]
buffer_load_dwordx4 v1, s[12:15], s41 offen offset:0 lds
v_mfma_f32_16x16x32_bf16 v[104:107], a[120:123], v[184:187], v[104:107]
ds_read_b128 a[92:95], v11 offset:12288
v_mfma_f32_16x16x32_bf16 v[104:107], a[148:151], v[192:195], v[104:107]
ds_read_b128 a[96:99], v11 offset:13312
v_mfma_f32_16x16x32_bf16 v[132:135], a[148:151], v[196:199], v[132:135]
buffer_load_dwordx4 v1, s[12:15], s41 offen offset:1024 lds
v_mfma_f32_16x16x32_bf16 v[132:135], a[120:123], v[188:191], v[132:135]
ds_read_b128 a[100:103], v11 offset:14336
v_mfma_f32_16x16x32_bf16 v[108:111], a[124:127], v[184:187], v[108:111]
v_mfma_f32_16x16x32_bf16 v[108:111], a[152:155], v[192:195], v[108:111]
v_mfma_f32_16x16x32_bf16 v[136:139], a[152:155], v[196:199], v[136:139]
buffer_load_dwordx4 v1, s[12:15], s41 offen offset:2048 lds
v_mfma_f32_16x16x32_bf16 v[136:139], a[124:127], v[188:191], v[136:139]
v_mfma_f32_16x16x32_bf16 v[112:115], a[128:131], v[184:187], v[112:115]
v_mfma_f32_16x16x32_bf16 v[112:115], a[156:159], v[192:195], v[112:115]
buffer_load_dwordx4 v1, s[12:15], s42 offen offset:3072 lds
v_mfma_f32_16x16x32_bf16 v[140:143], a[156:159], v[196:199], v[140:143]
v_mfma_f32_16x16x32_bf16 v[140:143], a[128:131], v[188:191], v[140:143]
s_waitcnt vmcnt(63)
s_barrier
s_waitcnt vmcnt(28) lgkmcnt(0)
s_add_u32 s43, s36, 14336
s_add_u32 m0, s40, 32768
s_add_u32 s41, s38, 243712
s_add_u32 s42, s41, s39
v_mfma_f32_16x16x32_bf16 v[88:91], a[48:51], v[200:203], v[88:91]
ds_read_b128 a[104:107], v11 offset:16384
v_mfma_f32_16x16x32_bf16 v[88:91], a[76:79], v[208:211], v[88:91]
buffer_load_dwordx4 v[168:171], v26, s[12:15], s43 offen offset:0
v_mfma_f32_16x16x32_bf16 v[116:119], a[76:79], v[212:215], v[116:119]
ds_read_b128 a[108:111], v11 offset:17408
v_mfma_f32_16x16x32_bf16 v[116:119], a[48:51], v[204:207], v[116:119]
ds_read_b128 a[112:115], v11 offset:18432
v_mfma_f32_16x16x32_bf16 v[92:95], a[52:55], v[200:203], v[92:95]
buffer_load_dwordx4 v[172:175], v27, s[12:15], s43 offen offset:0
v_mfma_f32_16x16x32_bf16 v[92:95], a[80:83], v[208:211], v[92:95]
ds_read_b128 a[116:119], v11 offset:19456
v_mfma_f32_16x16x32_bf16 v[120:123], a[80:83], v[212:215], v[120:123]
ds_read_b128 a[120:123], v11 offset:20480
v_mfma_f32_16x16x32_bf16 v[120:123], a[52:55], v[204:207], v[120:123]
ds_read_b128 a[124:127], v11 offset:21504
v_mfma_f32_16x16x32_bf16 v[96:99], a[56:59], v[200:203], v[96:99]
buffer_load_dwordx4 v[176:179], v26, s[12:15], s43 offen offset:1024
v_mfma_f32_16x16x32_bf16 v[96:99], a[84:87], v[208:211], v[96:99]
ds_read_b128 a[128:131], v11 offset:22528
v_mfma_f32_16x16x32_bf16 v[124:127], a[84:87], v[212:215], v[124:127]
ds_read_b128 a[132:135], v11 offset:23552
v_mfma_f32_16x16x32_bf16 v[124:127], a[56:59], v[204:207], v[124:127]
buffer_load_dwordx4 v[180:183], v27, s[12:15], s43 offen offset:1024
v_mfma_f32_16x16x32_bf16 v[100:103], a[60:63], v[200:203], v[100:103]
ds_read_b128 a[136:139], v11 offset:24576
v_mfma_f32_16x16x32_bf16 v[100:103], a[88:91], v[208:211], v[100:103]
ds_read_b128 a[140:143], v11 offset:25600
v_mfma_f32_16x16x32_bf16 v[128:131], a[88:91], v[212:215], v[128:131]
ds_read_b128 a[144:147], v11 offset:26624
v_mfma_f32_16x16x32_bf16 v[128:131], a[60:63], v[204:207], v[128:131]
buffer_load_dwordx4 v1, s[12:15], s41 offen offset:0 lds
v_mfma_f32_16x16x32_bf16 v[104:107], a[64:67], v[200:203], v[104:107]
ds_read_b128 a[148:151], v11 offset:28672
v_mfma_f32_16x16x32_bf16 v[104:107], a[92:95], v[208:211], v[104:107]
ds_read_b128 a[152:155], v11 offset:29696
v_mfma_f32_16x16x32_bf16 v[132:135], a[92:95], v[212:215], v[132:135]
buffer_load_dwordx4 v1, s[12:15], s41 offen offset:1024 lds
v_mfma_f32_16x16x32_bf16 v[132:135], a[64:67], v[204:207], v[132:135]
ds_read_b128 a[156:159], v11 offset:30720
v_mfma_f32_16x16x32_bf16 v[108:111], a[68:71], v[200:203], v[108:111]
v_mfma_f32_16x16x32_bf16 v[108:111], a[96:99], v[208:211], v[108:111]
v_mfma_f32_16x16x32_bf16 v[136:139], a[96:99], v[212:215], v[136:139]
buffer_load_dwordx4 v1, s[12:15], s41 offen offset:2048 lds
v_mfma_f32_16x16x32_bf16 v[136:139], a[68:71], v[204:207], v[136:139]
v_mfma_f32_16x16x32_bf16 v[112:115], a[72:75], v[200:203], v[112:115]
v_mfma_f32_16x16x32_bf16 v[112:115], a[100:103], v[208:211], v[112:115]
buffer_load_dwordx4 v1, s[12:15], s42 offen offset:3072 lds
v_mfma_f32_16x16x32_bf16 v[140:143], a[100:103], v[212:215], v[140:143]
v_mfma_f32_16x16x32_bf16 v[140:143], a[72:75], v[204:207], v[140:143]
s_waitcnt vmcnt(32)
s_barrier
s_waitcnt vmcnt(28) lgkmcnt(0)
s_add_u32 s43, s36, 32768
s_add_u32 m0, s40, 49152
s_add_u32 s41, s38, 258048
s_add_u32 s42, s41, s39
v_mfma_f32_16x16x32_bf16 v[88:91], a[104:107], v[216:219], v[88:91]
ds_read_b128 a[48:51], v12 offset:0
v_mfma_f32_16x16x32_bf16 v[88:91], a[132:135], v[224:227], v[88:91]
buffer_load_dwordx4 v[184:187], v26, s[12:15], s43 offen offset:0
v_mfma_f32_16x16x32_bf16 v[116:119], a[132:135], v[228:231], v[116:119]
ds_read_b128 a[52:55], v12 offset:1024
v_mfma_f32_16x16x32_bf16 v[116:119], a[104:107], v[220:223], v[116:119]
ds_read_b128 a[56:59], v12 offset:2048
v_mfma_f32_16x16x32_bf16 v[92:95], a[108:111], v[216:219], v[92:95]
buffer_load_dwordx4 v[188:191], v27, s[12:15], s43 offen offset:0
v_mfma_f32_16x16x32_bf16 v[92:95], a[136:139], v[224:227], v[92:95]
ds_read_b128 a[60:63], v12 offset:3072
v_mfma_f32_16x16x32_bf16 v[120:123], a[136:139], v[228:231], v[120:123]
ds_read_b128 a[64:67], v12 offset:4096
v_mfma_f32_16x16x32_bf16 v[120:123], a[108:111], v[220:223], v[120:123]
ds_read_b128 a[68:71], v12 offset:5120
v_mfma_f32_16x16x32_bf16 v[96:99], a[112:115], v[216:219], v[96:99]
buffer_load_dwordx4 v[192:195], v26, s[12:15], s43 offen offset:1024
v_mfma_f32_16x16x32_bf16 v[96:99], a[140:143], v[224:227], v[96:99]
ds_read_b128 a[72:75], v12 offset:6144
v_mfma_f32_16x16x32_bf16 v[124:127], a[140:143], v[228:231], v[124:127]
ds_read_b128 a[76:79], v12 offset:7168
v_mfma_f32_16x16x32_bf16 v[124:127], a[112:115], v[220:223], v[124:127]
buffer_load_dwordx4 v[196:199], v27, s[12:15], s43 offen offset:1024
v_mfma_f32_16x16x32_bf16 v[100:103], a[116:119], v[216:219], v[100:103]
ds_read_b128 a[80:83], v12 offset:8192
v_mfma_f32_16x16x32_bf16 v[100:103], a[144:147], v[224:227], v[100:103]
ds_read_b128 a[84:87], v12 offset:9216
v_mfma_f32_16x16x32_bf16 v[128:131], a[144:147], v[228:231], v[128:131]
ds_read_b128 a[88:91], v12 offset:10240
v_mfma_f32_16x16x32_bf16 v[128:131], a[116:119], v[220:223], v[128:131]
buffer_load_dwordx4 v1, s[12:15], s41 offen offset:0 lds
v_mfma_f32_16x16x32_bf16 v[104:107], a[120:123], v[216:219], v[104:107]
ds_read_b128 a[92:95], v12 offset:12288
v_mfma_f32_16x16x32_bf16 v[104:107], a[148:151], v[224:227], v[104:107]
ds_read_b128 a[96:99], v12 offset:13312
v_mfma_f32_16x16x32_bf16 v[132:135], a[148:151], v[228:231], v[132:135]
buffer_load_dwordx4 v1, s[12:15], s41 offen offset:1024 lds
v_mfma_f32_16x16x32_bf16 v[132:135], a[120:123], v[220:223], v[132:135]
ds_read_b128 a[100:103], v12 offset:14336
v_mfma_f32_16x16x32_bf16 v[108:111], a[124:127], v[216:219], v[108:111]
v_mfma_f32_16x16x32_bf16 v[108:111], a[152:155], v[224:227], v[108:111]
v_mfma_f32_16x16x32_bf16 v[136:139], a[152:155], v[228:231], v[136:139]
buffer_load_dwordx4 v1, s[12:15], s41 offen offset:2048 lds
v_mfma_f32_16x16x32_bf16 v[136:139], a[124:127], v[220:223], v[136:139]
v_mfma_f32_16x16x32_bf16 v[112:115], a[128:131], v[216:219], v[112:115]
v_mfma_f32_16x16x32_bf16 v[112:115], a[156:159], v[224:227], v[112:115]
buffer_load_dwordx4 v1, s[12:15], s42 offen offset:3072 lds
v_mfma_f32_16x16x32_bf16 v[140:143], a[156:159], v[228:231], v[140:143]
v_mfma_f32_16x16x32_bf16 v[140:143], a[128:131], v[220:223], v[140:143]
s_waitcnt vmcnt(32)
s_barrier
s_waitcnt vmcnt(28) lgkmcnt(0)
s_add_u32 s43, s36, 34816
s_add_u32 m0, s40, 98304
s_add_u32 s41, s38, 272384
s_add_u32 s42, s41, s39
v_mfma_f32_16x16x32_bf16 v[88:91], a[48:51], v[232:235], v[88:91]
ds_read_b128 a[104:107], v12 offset:16384
v_mfma_f32_16x16x32_bf16 v[88:91], a[76:79], v[240:243], v[88:91]
buffer_load_dwordx4 v[200:203], v26, s[12:15], s43 offen offset:0
v_mfma_f32_16x16x32_bf16 v[116:119], a[76:79], v[244:247], v[116:119]
ds_read_b128 a[108:111], v12 offset:17408
v_mfma_f32_16x16x32_bf16 v[116:119], a[48:51], v[236:239], v[116:119]
ds_read_b128 a[112:115], v12 offset:18432
v_mfma_f32_16x16x32_bf16 v[92:95], a[52:55], v[232:235], v[92:95]
buffer_load_dwordx4 v[204:207], v27, s[12:15], s43 offen offset:0
v_mfma_f32_16x16x32_bf16 v[92:95], a[80:83], v[240:243], v[92:95]
ds_read_b128 a[116:119], v12 offset:19456
v_mfma_f32_16x16x32_bf16 v[120:123], a[80:83], v[244:247], v[120:123]
ds_read_b128 a[120:123], v12 offset:20480
v_mfma_f32_16x16x32_bf16 v[120:123], a[52:55], v[236:239], v[120:123]
ds_read_b128 a[124:127], v12 offset:21504
v_mfma_f32_16x16x32_bf16 v[96:99], a[56:59], v[232:235], v[96:99]
buffer_load_dwordx4 v[208:211], v26, s[12:15], s43 offen offset:1024
v_mfma_f32_16x16x32_bf16 v[96:99], a[84:87], v[240:243], v[96:99]
ds_read_b128 a[128:131], v12 offset:22528
v_mfma_f32_16x16x32_bf16 v[124:127], a[84:87], v[244:247], v[124:127]
ds_read_b128 a[132:135], v12 offset:23552
v_mfma_f32_16x16x32_bf16 v[124:127], a[56:59], v[236:239], v[124:127]
buffer_load_dwordx4 v[212:215], v27, s[12:15], s43 offen offset:1024
v_mfma_f32_16x16x32_bf16 v[100:103], a[60:63], v[232:235], v[100:103]
ds_read_b128 a[136:139], v12 offset:24576
v_mfma_f32_16x16x32_bf16 v[100:103], a[88:91], v[240:243], v[100:103]
ds_read_b128 a[140:143], v12 offset:25600
v_mfma_f32_16x16x32_bf16 v[128:131], a[88:91], v[244:247], v[128:131]
ds_read_b128 a[144:147], v12 offset:26624
v_mfma_f32_16x16x32_bf16 v[128:131], a[60:63], v[236:239], v[128:131]
buffer_load_dwordx4 v1, s[12:15], s41 offen offset:0 lds
v_mfma_f32_16x16x32_bf16 v[104:107], a[64:67], v[232:235], v[104:107]
ds_read_b128 a[148:151], v12 offset:28672
v_mfma_f32_16x16x32_bf16 v[104:107], a[92:95], v[240:243], v[104:107]
ds_read_b128 a[152:155], v12 offset:29696
v_mfma_f32_16x16x32_bf16 v[132:135], a[92:95], v[244:247], v[132:135]
buffer_load_dwordx4 v1, s[12:15], s41 offen offset:1024 lds
v_mfma_f32_16x16x32_bf16 v[132:135], a[64:67], v[236:239], v[132:135]
ds_read_b128 a[156:159], v12 offset:30720
v_mfma_f32_16x16x32_bf16 v[108:111], a[68:71], v[232:235], v[108:111]
v_mfma_f32_16x16x32_bf16 v[108:111], a[96:99], v[240:243], v[108:111]
v_mfma_f32_16x16x32_bf16 v[136:139], a[96:99], v[244:247], v[136:139]
buffer_load_dwordx4 v1, s[12:15], s41 offen offset:2048 lds
v_mfma_f32_16x16x32_bf16 v[136:139], a[68:71], v[236:239], v[136:139]
v_mfma_f32_16x16x32_bf16 v[112:115], a[72:75], v[232:235], v[112:115]
v_mfma_f32_16x16x32_bf16 v[112:115], a[100:103], v[240:243], v[112:115]
buffer_load_dwordx4 v1, s[12:15], s42 offen offset:3072 lds
v_mfma_f32_16x16x32_bf16 v[140:143], a[100:103], v[244:247], v[140:143]
v_mfma_f32_16x16x32_bf16 v[140:143], a[72:75], v[236:239], v[140:143]
s_waitcnt vmcnt(32)
s_barrier
s_waitcnt vmcnt(28) lgkmcnt(0)
s_add_u32 s43, s36, 36864
s_add_u32 m0, s40, 114688
s_add_u32 s41, s38, 286720
s_add_u32 s42, s41, s39
v_mfma_f32_16x16x32_bf16 v[88:91], a[104:107], v[152:155], v[88:91]
ds_read_b128 a[48:51], v10 offset:0
v_mfma_f32_16x16x32_bf16 v[88:91], a[132:135], v[160:163], v[88:91]
buffer_load_dwordx4 v[216:219], v26, s[12:15], s43 offen offset:0
v_mfma_f32_16x16x32_bf16 v[116:119], a[132:135], v[164:167], v[116:119]
ds_read_b128 a[52:55], v10 offset:1024
v_mfma_f32_16x16x32_bf16 v[116:119], a[104:107], v[156:159], v[116:119]
ds_read_b128 a[56:59], v10 offset:2048
v_mfma_f32_16x16x32_bf16 v[92:95], a[108:111], v[152:155], v[92:95]
buffer_load_dwordx4 v[220:223], v27, s[12:15], s43 offen offset:0
v_mfma_f32_16x16x32_bf16 v[92:95], a[136:139], v[160:163], v[92:95]
ds_read_b128 a[60:63], v10 offset:3072
v_mfma_f32_16x16x32_bf16 v[120:123], a[136:139], v[164:167], v[120:123]
ds_read_b128 a[64:67], v10 offset:4096
v_mfma_f32_16x16x32_bf16 v[120:123], a[108:111], v[156:159], v[120:123]
ds_read_b128 a[68:71], v10 offset:5120
v_mfma_f32_16x16x32_bf16 v[96:99], a[112:115], v[152:155], v[96:99]
buffer_load_dwordx4 v[224:227], v26, s[12:15], s43 offen offset:1024
v_mfma_f32_16x16x32_bf16 v[96:99], a[140:143], v[160:163], v[96:99]
ds_read_b128 a[72:75], v10 offset:6144
v_mfma_f32_16x16x32_bf16 v[124:127], a[140:143], v[164:167], v[124:127]
ds_read_b128 a[76:79], v10 offset:7168
v_mfma_f32_16x16x32_bf16 v[124:127], a[112:115], v[156:159], v[124:127]
buffer_load_dwordx4 v[228:231], v27, s[12:15], s43 offen offset:1024
v_mfma_f32_16x16x32_bf16 v[100:103], a[116:119], v[152:155], v[100:103]
ds_read_b128 a[80:83], v10 offset:8192
v_mfma_f32_16x16x32_bf16 v[100:103], a[144:147], v[160:163], v[100:103]
ds_read_b128 a[84:87], v10 offset:9216
v_mfma_f32_16x16x32_bf16 v[128:131], a[144:147], v[164:167], v[128:131]
ds_read_b128 a[88:91], v10 offset:10240
v_mfma_f32_16x16x32_bf16 v[128:131], a[116:119], v[156:159], v[128:131]
buffer_load_dwordx4 v1, s[12:15], s41 offen offset:0 lds
v_mfma_f32_16x16x32_bf16 v[104:107], a[120:123], v[152:155], v[104:107]
ds_read_b128 a[92:95], v10 offset:12288
v_mfma_f32_16x16x32_bf16 v[104:107], a[148:151], v[160:163], v[104:107]
ds_read_b128 a[96:99], v10 offset:13312
v_mfma_f32_16x16x32_bf16 v[132:135], a[148:151], v[164:167], v[132:135]
buffer_load_dwordx4 v1, s[12:15], s41 offen offset:1024 lds
v_mfma_f32_16x16x32_bf16 v[132:135], a[120:123], v[156:159], v[132:135]
ds_read_b128 a[100:103], v10 offset:14336
v_mfma_f32_16x16x32_bf16 v[108:111], a[124:127], v[152:155], v[108:111]
v_mfma_f32_16x16x32_bf16 v[108:111], a[152:155], v[160:163], v[108:111]
v_mfma_f32_16x16x32_bf16 v[136:139], a[152:155], v[164:167], v[136:139]
buffer_load_dwordx4 v1, s[12:15], s41 offen offset:2048 lds
v_mfma_f32_16x16x32_bf16 v[136:139], a[124:127], v[156:159], v[136:139]
v_mfma_f32_16x16x32_bf16 v[112:115], a[128:131], v[152:155], v[112:115]
v_mfma_f32_16x16x32_bf16 v[112:115], a[156:159], v[160:163], v[112:115]
buffer_load_dwordx4 v1, s[12:15], s42 offen offset:3072 lds
v_mfma_f32_16x16x32_bf16 v[140:143], a[156:159], v[164:167], v[140:143]
v_mfma_f32_16x16x32_bf16 v[140:143], a[128:131], v[156:159], v[140:143]
s_waitcnt vmcnt(32)
s_barrier
s_waitcnt vmcnt(28) lgkmcnt(0)
s_add_u32 s43, s36, 38912
s_add_u32 m0, s40, 65536
s_add_u32 s41, s38, 301056
s_add_u32 s42, s41, s39
v_mfma_f32_16x16x32_bf16 v[88:91], a[48:51], v[168:171], v[88:91]
ds_read_b128 a[104:107], v10 offset:16384
v_mfma_f32_16x16x32_bf16 v[88:91], a[76:79], v[176:179], v[88:91]
buffer_load_dwordx4 v[232:235], v26, s[12:15], s43 offen offset:0
v_mfma_f32_16x16x32_bf16 v[116:119], a[76:79], v[180:183], v[116:119]
ds_read_b128 a[108:111], v10 offset:17408
v_mfma_f32_16x16x32_bf16 v[116:119], a[48:51], v[172:175], v[116:119]
ds_read_b128 a[112:115], v10 offset:18432
v_mfma_f32_16x16x32_bf16 v[92:95], a[52:55], v[168:171], v[92:95]
buffer_load_dwordx4 v[236:239], v27, s[12:15], s43 offen offset:0
v_mfma_f32_16x16x32_bf16 v[92:95], a[80:83], v[176:179], v[92:95]
ds_read_b128 a[116:119], v10 offset:19456
v_mfma_f32_16x16x32_bf16 v[120:123], a[80:83], v[180:183], v[120:123]
ds_read_b128 a[120:123], v10 offset:20480
v_mfma_f32_16x16x32_bf16 v[120:123], a[52:55], v[172:175], v[120:123]
ds_read_b128 a[124:127], v10 offset:21504
v_mfma_f32_16x16x32_bf16 v[96:99], a[56:59], v[168:171], v[96:99]
buffer_load_dwordx4 v[240:243], v26, s[12:15], s43 offen offset:1024
v_mfma_f32_16x16x32_bf16 v[96:99], a[84:87], v[176:179], v[96:99]
ds_read_b128 a[128:131], v10 offset:22528
v_mfma_f32_16x16x32_bf16 v[124:127], a[84:87], v[180:183], v[124:127]
ds_read_b128 a[132:135], v10 offset:23552
v_mfma_f32_16x16x32_bf16 v[124:127], a[56:59], v[172:175], v[124:127]
buffer_load_dwordx4 v[244:247], v27, s[12:15], s43 offen offset:1024
v_mfma_f32_16x16x32_bf16 v[100:103], a[60:63], v[168:171], v[100:103]
ds_read_b128 a[136:139], v10 offset:24576
v_mfma_f32_16x16x32_bf16 v[100:103], a[88:91], v[176:179], v[100:103]
ds_read_b128 a[140:143], v10 offset:25600
v_mfma_f32_16x16x32_bf16 v[128:131], a[88:91], v[180:183], v[128:131]
ds_read_b128 a[144:147], v10 offset:26624
v_mfma_f32_16x16x32_bf16 v[128:131], a[60:63], v[172:175], v[128:131]
buffer_load_dwordx4 v1, s[12:15], s41 offen offset:0 lds
v_mfma_f32_16x16x32_bf16 v[104:107], a[64:67], v[168:171], v[104:107]
ds_read_b128 a[148:151], v10 offset:28672
v_mfma_f32_16x16x32_bf16 v[104:107], a[92:95], v[176:179], v[104:107]
ds_read_b128 a[152:155], v10 offset:29696
v_mfma_f32_16x16x32_bf16 v[132:135], a[92:95], v[180:183], v[132:135]
buffer_load_dwordx4 v1, s[12:15], s41 offen offset:1024 lds
v_mfma_f32_16x16x32_bf16 v[132:135], a[64:67], v[172:175], v[132:135]
ds_read_b128 a[156:159], v10 offset:30720
v_mfma_f32_16x16x32_bf16 v[108:111], a[68:71], v[168:171], v[108:111]
v_mfma_f32_16x16x32_bf16 v[108:111], a[96:99], v[176:179], v[108:111]
v_mfma_f32_16x16x32_bf16 v[136:139], a[96:99], v[180:183], v[136:139]
buffer_load_dwordx4 v1, s[12:15], s41 offen offset:2048 lds
v_mfma_f32_16x16x32_bf16 v[136:139], a[68:71], v[172:175], v[136:139]
v_mfma_f32_16x16x32_bf16 v[112:115], a[72:75], v[168:171], v[112:115]
v_mfma_f32_16x16x32_bf16 v[112:115], a[100:103], v[176:179], v[112:115]
buffer_load_dwordx4 v1, s[12:15], s42 offen offset:3072 lds
v_mfma_f32_16x16x32_bf16 v[140:143], a[100:103], v[180:183], v[140:143]
v_mfma_f32_16x16x32_bf16 v[140:143], a[72:75], v[172:175], v[140:143]
s_waitcnt vmcnt(32)
s_barrier
s_waitcnt vmcnt(28) lgkmcnt(0)
s_add_u32 s43, s36, 40960
s_add_u32 m0, s40, 81920
s_add_u32 s41, s53, 315392
s_add_u32 s42, s41, s39
v_mfma_f32_16x16x32_bf16 v[88:91], a[104:107], v[184:187], v[88:91]
ds_read_b128 a[48:51], v10 offset:32768
v_mfma_f32_16x16x32_bf16 v[88:91], a[132:135], v[192:195], v[88:91]
buffer_load_dwordx4 v[152:155], v26, s[12:15], s43 offen offset:0
v_mfma_f32_16x16x32_bf16 v[116:119], a[132:135], v[196:199], v[116:119]
ds_read_b128 a[52:55], v10 offset:33792
v_mfma_f32_16x16x32_bf16 v[116:119], a[104:107], v[188:191], v[116:119]
ds_read_b128 a[56:59], v10 offset:34816
v_mfma_f32_16x16x32_bf16 v[92:95], a[108:111], v[184:187], v[92:95]
buffer_load_dwordx4 v[156:159], v27, s[12:15], s43 offen offset:0
v_mfma_f32_16x16x32_bf16 v[92:95], a[136:139], v[192:195], v[92:95]
ds_read_b128 a[60:63], v10 offset:35840
v_mfma_f32_16x16x32_bf16 v[120:123], a[136:139], v[196:199], v[120:123]
ds_read_b128 a[64:67], v10 offset:36864
v_mfma_f32_16x16x32_bf16 v[120:123], a[108:111], v[188:191], v[120:123]
ds_read_b128 a[68:71], v10 offset:37888
v_mfma_f32_16x16x32_bf16 v[96:99], a[112:115], v[184:187], v[96:99]
buffer_load_dwordx4 v[160:163], v26, s[12:15], s43 offen offset:1024
v_mfma_f32_16x16x32_bf16 v[96:99], a[140:143], v[192:195], v[96:99]
ds_read_b128 a[72:75], v10 offset:38912
v_mfma_f32_16x16x32_bf16 v[124:127], a[140:143], v[196:199], v[124:127]
ds_read_b128 a[76:79], v10 offset:39936
v_mfma_f32_16x16x32_bf16 v[124:127], a[112:115], v[188:191], v[124:127]
buffer_load_dwordx4 v[164:167], v27, s[12:15], s43 offen offset:1024
v_mfma_f32_16x16x32_bf16 v[100:103], a[116:119], v[184:187], v[100:103]
ds_read_b128 a[80:83], v10 offset:40960
v_mfma_f32_16x16x32_bf16 v[100:103], a[144:147], v[192:195], v[100:103]
ds_read_b128 a[84:87], v10 offset:41984
v_mfma_f32_16x16x32_bf16 v[128:131], a[144:147], v[196:199], v[128:131]
ds_read_b128 a[88:91], v10 offset:43008
v_mfma_f32_16x16x32_bf16 v[128:131], a[116:119], v[188:191], v[128:131]
buffer_load_dwordx4 v1, s[12:15], s41 offen offset:0 lds
v_mfma_f32_16x16x32_bf16 v[104:107], a[120:123], v[184:187], v[104:107]
ds_read_b128 a[92:95], v10 offset:45056
v_mfma_f32_16x16x32_bf16 v[104:107], a[148:151], v[192:195], v[104:107]
ds_read_b128 a[96:99], v10 offset:46080
v_mfma_f32_16x16x32_bf16 v[132:135], a[148:151], v[196:199], v[132:135]
buffer_load_dwordx4 v1, s[12:15], s41 offen offset:1024 lds
v_mfma_f32_16x16x32_bf16 v[132:135], a[120:123], v[188:191], v[132:135]
ds_read_b128 a[100:103], v10 offset:47104
v_mfma_f32_16x16x32_bf16 v[108:111], a[124:127], v[184:187], v[108:111]
v_mfma_f32_16x16x32_bf16 v[108:111], a[152:155], v[192:195], v[108:111]
v_mfma_f32_16x16x32_bf16 v[136:139], a[152:155], v[196:199], v[136:139]
buffer_load_dwordx4 v1, s[12:15], s41 offen offset:2048 lds
v_mfma_f32_16x16x32_bf16 v[136:139], a[124:127], v[188:191], v[136:139]
v_mfma_f32_16x16x32_bf16 v[112:115], a[128:131], v[184:187], v[112:115]
v_mfma_f32_16x16x32_bf16 v[112:115], a[156:159], v[192:195], v[112:115]
buffer_load_dwordx4 v1, s[12:15], s42 offen offset:3072 lds
v_mfma_f32_16x16x32_bf16 v[140:143], a[156:159], v[196:199], v[140:143]
v_mfma_f32_16x16x32_bf16 v[140:143], a[128:131], v[188:191], v[140:143]
s_waitcnt vmcnt(32)
s_barrier
buffer_load_dword v7, v6, s[12:15], s45 offen sc0 sc1
s_waitcnt vmcnt(29) lgkmcnt(0)
s_add_u32 s43, s36, 43008
s_add_u32 m0, s40, 131072
s_add_u32 s41, s53, 329728
s_add_u32 s42, s41, s39
v_mfma_f32_16x16x32_bf16 v[88:91], a[48:51], v[200:203], v[88:91]
ds_read_b128 a[104:107], v10 offset:49152
v_mfma_f32_16x16x32_bf16 v[88:91], a[76:79], v[208:211], v[88:91]
buffer_load_dwordx4 v[168:171], v26, s[12:15], s43 offen offset:0
v_mfma_f32_16x16x32_bf16 v[116:119], a[76:79], v[212:215], v[116:119]
ds_read_b128 a[108:111], v10 offset:50176
v_mfma_f32_16x16x32_bf16 v[116:119], a[48:51], v[204:207], v[116:119]
ds_read_b128 a[112:115], v10 offset:51200
v_mfma_f32_16x16x32_bf16 v[92:95], a[52:55], v[200:203], v[92:95]
buffer_load_dwordx4 v[172:175], v27, s[12:15], s43 offen offset:0
v_mfma_f32_16x16x32_bf16 v[92:95], a[80:83], v[208:211], v[92:95]
ds_read_b128 a[116:119], v10 offset:52224
v_mfma_f32_16x16x32_bf16 v[120:123], a[80:83], v[212:215], v[120:123]
ds_read_b128 a[120:123], v10 offset:53248
v_mfma_f32_16x16x32_bf16 v[120:123], a[52:55], v[204:207], v[120:123]
ds_read_b128 a[124:127], v10 offset:54272
v_mfma_f32_16x16x32_bf16 v[96:99], a[56:59], v[200:203], v[96:99]
buffer_load_dwordx4 v[176:179], v26, s[12:15], s43 offen offset:1024
v_mfma_f32_16x16x32_bf16 v[96:99], a[84:87], v[208:211], v[96:99]
ds_read_b128 a[128:131], v10 offset:55296
v_mfma_f32_16x16x32_bf16 v[124:127], a[84:87], v[212:215], v[124:127]
ds_read_b128 a[132:135], v10 offset:56320
v_mfma_f32_16x16x32_bf16 v[124:127], a[56:59], v[204:207], v[124:127]
buffer_load_dwordx4 v[180:183], v27, s[12:15], s43 offen offset:1024
v_mfma_f32_16x16x32_bf16 v[100:103], a[60:63], v[200:203], v[100:103]
ds_read_b128 a[136:139], v10 offset:57344
v_mfma_f32_16x16x32_bf16 v[100:103], a[88:91], v[208:211], v[100:103]
ds_read_b128 a[140:143], v10 offset:58368
v_mfma_f32_16x16x32_bf16 v[128:131], a[88:91], v[212:215], v[128:131]
ds_read_b128 a[144:147], v10 offset:59392
v_mfma_f32_16x16x32_bf16 v[128:131], a[60:63], v[204:207], v[128:131]
buffer_load_dwordx4 v1, s[12:15], s41 offen offset:0 lds
v_mfma_f32_16x16x32_bf16 v[104:107], a[64:67], v[200:203], v[104:107]
ds_read_b128 a[148:151], v10 offset:61440
v_mfma_f32_16x16x32_bf16 v[104:107], a[92:95], v[208:211], v[104:107]
ds_read_b128 a[152:155], v10 offset:62464
v_mfma_f32_16x16x32_bf16 v[132:135], a[92:95], v[212:215], v[132:135]
buffer_load_dwordx4 v1, s[12:15], s41 offen offset:1024 lds
v_mfma_f32_16x16x32_bf16 v[132:135], a[64:67], v[204:207], v[132:135]
ds_read_b128 a[156:159], v10 offset:63488
v_mfma_f32_16x16x32_bf16 v[108:111], a[68:71], v[200:203], v[108:111]
v_mfma_f32_16x16x32_bf16 v[108:111], a[96:99], v[208:211], v[108:111]
v_mfma_f32_16x16x32_bf16 v[136:139], a[96:99], v[212:215], v[136:139]
buffer_load_dwordx4 v1, s[12:15], s41 offen offset:2048 lds
v_mfma_f32_16x16x32_bf16 v[136:139], a[68:71], v[204:207], v[136:139]
v_mfma_f32_16x16x32_bf16 v[112:115], a[72:75], v[200:203], v[112:115]
v_mfma_f32_16x16x32_bf16 v[112:115], a[100:103], v[208:211], v[112:115]
buffer_load_dwordx4 v1, s[12:15], s42 offen offset:3072 lds
v_mfma_f32_16x16x32_bf16 v[140:143], a[100:103], v[212:215], v[140:143]
v_mfma_f32_16x16x32_bf16 v[140:143], a[72:75], v[204:207], v[140:143]
s_waitcnt vmcnt(33)
s_barrier
s_waitcnt vmcnt(29) lgkmcnt(0)
s_add_u32 s43, s52, 45056
s_add_u32 m0, s40, 147456
s_add_u32 s41, s53, 430080
s_add_u32 s42, s41, s39
v_mfma_f32_16x16x32_bf16 v[88:91], a[104:107], v[216:219], v[88:91]
ds_read_b128 a[48:51], v11 offset:32768
v_mfma_f32_16x16x32_bf16 v[88:91], a[132:135], v[224:227], v[88:91]
buffer_load_dwordx4 v[184:187], v26, s[12:15], s43 offen offset:0
v_mfma_f32_16x16x32_bf16 v[116:119], a[132:135], v[228:231], v[116:119]
ds_read_b128 a[52:55], v11 offset:33792
v_mfma_f32_16x16x32_bf16 v[116:119], a[104:107], v[220:223], v[116:119]
ds_read_b128 a[56:59], v11 offset:34816
v_mfma_f32_16x16x32_bf16 v[92:95], a[108:111], v[216:219], v[92:95]
buffer_load_dwordx4 v[188:191], v27, s[12:15], s43 offen offset:0
v_mfma_f32_16x16x32_bf16 v[92:95], a[136:139], v[224:227], v[92:95]
ds_read_b128 a[60:63], v11 offset:35840
v_mfma_f32_16x16x32_bf16 v[120:123], a[136:139], v[228:231], v[120:123]
ds_read_b128 a[64:67], v11 offset:36864
v_mfma_f32_16x16x32_bf16 v[120:123], a[108:111], v[220:223], v[120:123]
ds_read_b128 a[68:71], v11 offset:37888
v_mfma_f32_16x16x32_bf16 v[96:99], a[112:115], v[216:219], v[96:99]
buffer_load_dwordx4 v[192:195], v26, s[12:15], s43 offen offset:1024
v_mfma_f32_16x16x32_bf16 v[96:99], a[140:143], v[224:227], v[96:99]
ds_read_b128 a[72:75], v11 offset:38912
v_mfma_f32_16x16x32_bf16 v[124:127], a[140:143], v[228:231], v[124:127]
ds_read_b128 a[76:79], v11 offset:39936
v_mfma_f32_16x16x32_bf16 v[124:127], a[112:115], v[220:223], v[124:127]
buffer_load_dwordx4 v[196:199], v27, s[12:15], s43 offen offset:1024
v_mfma_f32_16x16x32_bf16 v[100:103], a[116:119], v[216:219], v[100:103]
ds_read_b128 a[80:83], v11 offset:40960
v_mfma_f32_16x16x32_bf16 v[100:103], a[144:147], v[224:227], v[100:103]
ds_read_b128 a[84:87], v11 offset:41984
v_mfma_f32_16x16x32_bf16 v[128:131], a[144:147], v[228:231], v[128:131]
ds_read_b128 a[88:91], v11 offset:43008
v_mfma_f32_16x16x32_bf16 v[128:131], a[116:119], v[220:223], v[128:131]
buffer_load_dwordx4 v1, s[12:15], s41 offen offset:0 lds
v_mfma_f32_16x16x32_bf16 v[104:107], a[120:123], v[216:219], v[104:107]
ds_read_b128 a[92:95], v11 offset:45056
v_mfma_f32_16x16x32_bf16 v[104:107], a[148:151], v[224:227], v[104:107]
ds_read_b128 a[96:99], v11 offset:46080
v_mfma_f32_16x16x32_bf16 v[132:135], a[148:151], v[228:231], v[132:135]
buffer_load_dwordx4 v1, s[12:15], s41 offen offset:1024 lds
v_mfma_f32_16x16x32_bf16 v[132:135], a[120:123], v[220:223], v[132:135]
ds_read_b128 a[100:103], v11 offset:47104
v_mfma_f32_16x16x32_bf16 v[108:111], a[124:127], v[216:219], v[108:111]
v_mfma_f32_16x16x32_bf16 v[108:111], a[152:155], v[224:227], v[108:111]
v_mfma_f32_16x16x32_bf16 v[136:139], a[152:155], v[228:231], v[136:139]
buffer_load_dwordx4 v1, s[12:15], s41 offen offset:2048 lds
v_mfma_f32_16x16x32_bf16 v[136:139], a[124:127], v[220:223], v[136:139]
v_mfma_f32_16x16x32_bf16 v[112:115], a[128:131], v[216:219], v[112:115]
v_mfma_f32_16x16x32_bf16 v[112:115], a[156:159], v[224:227], v[112:115]
buffer_load_dwordx4 v1, s[12:15], s42 offen offset:3072 lds
v_mfma_f32_16x16x32_bf16 v[140:143], a[156:159], v[228:231], v[140:143]
v_mfma_f32_16x16x32_bf16 v[140:143], a[128:131], v[220:223], v[140:143]
s_waitcnt vmcnt(33)
s_barrier
s_waitcnt vmcnt(29) lgkmcnt(0)
s_add_u32 s43, s52, 47104
s_add_u32 m0, s40, 0
s_add_u32 s41, s53, 444416
s_add_u32 s42, s41, s39
v_mfma_f32_16x16x32_bf16 v[88:91], a[48:51], v[232:235], v[88:91]
ds_read_b128 a[104:107], v11 offset:49152
v_mfma_f32_16x16x32_bf16 v[88:91], a[76:79], v[240:243], v[88:91]
buffer_load_dwordx4 v[200:203], v26, s[12:15], s43 offen offset:0
v_mfma_f32_16x16x32_bf16 v[116:119], a[76:79], v[244:247], v[116:119]
ds_read_b128 a[108:111], v11 offset:50176
v_mfma_f32_16x16x32_bf16 v[116:119], a[48:51], v[236:239], v[116:119]
ds_read_b128 a[112:115], v11 offset:51200
v_mfma_f32_16x16x32_bf16 v[92:95], a[52:55], v[232:235], v[92:95]
buffer_load_dwordx4 v[204:207], v27, s[12:15], s43 offen offset:0
v_mfma_f32_16x16x32_bf16 v[92:95], a[80:83], v[240:243], v[92:95]
ds_read_b128 a[116:119], v11 offset:52224
v_mfma_f32_16x16x32_bf16 v[120:123], a[80:83], v[244:247], v[120:123]
ds_read_b128 a[120:123], v11 offset:53248
v_mfma_f32_16x16x32_bf16 v[120:123], a[52:55], v[236:239], v[120:123]
ds_read_b128 a[124:127], v11 offset:54272
v_mfma_f32_16x16x32_bf16 v[96:99], a[56:59], v[232:235], v[96:99]
buffer_load_dwordx4 v[208:211], v26, s[12:15], s43 offen offset:1024
v_mfma_f32_16x16x32_bf16 v[96:99], a[84:87], v[240:243], v[96:99]
ds_read_b128 a[128:131], v11 offset:55296
v_mfma_f32_16x16x32_bf16 v[124:127], a[84:87], v[244:247], v[124:127]
ds_read_b128 a[132:135], v11 offset:56320
v_mfma_f32_16x16x32_bf16 v[124:127], a[56:59], v[236:239], v[124:127]
buffer_load_dwordx4 v[212:215], v27, s[12:15], s43 offen offset:1024
v_mfma_f32_16x16x32_bf16 v[100:103], a[60:63], v[232:235], v[100:103]
ds_read_b128 a[136:139], v11 offset:57344
v_mfma_f32_16x16x32_bf16 v[100:103], a[88:91], v[240:243], v[100:103]
ds_read_b128 a[140:143], v11 offset:58368
v_mfma_f32_16x16x32_bf16 v[128:131], a[88:91], v[244:247], v[128:131]
ds_read_b128 a[144:147], v11 offset:59392
v_mfma_f32_16x16x32_bf16 v[128:131], a[60:63], v[236:239], v[128:131]
buffer_load_dwordx4 v1, s[12:15], s41 offen offset:0 lds
v_mfma_f32_16x16x32_bf16 v[104:107], a[64:67], v[232:235], v[104:107]
ds_read_b128 a[148:151], v11 offset:61440
v_mfma_f32_16x16x32_bf16 v[104:107], a[92:95], v[240:243], v[104:107]
ds_read_b128 a[152:155], v11 offset:62464
v_mfma_f32_16x16x32_bf16 v[132:135], a[92:95], v[244:247], v[132:135]
buffer_load_dwordx4 v1, s[12:15], s41 offen offset:1024 lds
v_mfma_f32_16x16x32_bf16 v[132:135], a[64:67], v[236:239], v[132:135]
ds_read_b128 a[156:159], v11 offset:63488
v_mfma_f32_16x16x32_bf16 v[108:111], a[68:71], v[232:235], v[108:111]
v_mfma_f32_16x16x32_bf16 v[108:111], a[96:99], v[240:243], v[108:111]
v_mfma_f32_16x16x32_bf16 v[136:139], a[96:99], v[244:247], v[136:139]
buffer_load_dwordx4 v1, s[12:15], s41 offen offset:2048 lds
v_mfma_f32_16x16x32_bf16 v[136:139], a[68:71], v[236:239], v[136:139]
v_mfma_f32_16x16x32_bf16 v[112:115], a[72:75], v[232:235], v[112:115]
v_mfma_f32_16x16x32_bf16 v[112:115], a[100:103], v[240:243], v[112:115]
buffer_load_dwordx4 v1, s[12:15], s42 offen offset:3072 lds
v_mfma_f32_16x16x32_bf16 v[140:143], a[100:103], v[244:247], v[140:143]
v_mfma_f32_16x16x32_bf16 v[140:143], a[72:75], v[236:239], v[140:143]
s_waitcnt vmcnt(33)
s_barrier
s_waitcnt vmcnt(24)
v_cmp_ne_u32 vcc, 1, v7
s_nop 4
s_cbranch_vccz L_k3_l2ok
s_mov_b32 s42, 0
L_poll17:
buffer_load_dword v7, v6, s[12:15], s45 offen sc0 sc1
s_waitcnt vmcnt(0)
v_cmp_ne_u32 vcc, 1, v7
s_nop 4
s_cbranch_vccnz L_poll17_r
s_branch L_poll17_ok
L_poll17_r:
s_add_u32 s42, s42, 1
s_cmp_lt_u32 s42, 32768
s_sleep 4
s_cbranch_scc1 L_poll17
L_poll17_ok:
L_k3_l2ok:
s_waitcnt vmcnt(29) lgkmcnt(0)
s_add_u32 s43, s52, 61440
v_mfma_f32_16x16x32_bf16 v[88:91], a[104:107], v[152:155], v[88:91]
ds_read_b128 a[48:51], v11 offset:0
v_mfma_f32_16x16x32_bf16 v[88:91], a[132:135], v[160:163], v[88:91]
buffer_load_dwordx4 v[216:219], v26, s[12:15], s43 offen offset:0
v_mfma_f32_16x16x32_bf16 v[116:119], a[132:135], v[164:167], v[116:119]
ds_read_b128 a[52:55], v11 offset:1024
v_mfma_f32_16x16x32_bf16 v[116:119], a[104:107], v[156:159], v[116:119]
ds_read_b128 a[56:59], v11 offset:2048
v_mfma_f32_16x16x32_bf16 v[92:95], a[108:111], v[152:155], v[92:95]
ds_read_b128 a[60:63], v11 offset:3072
v_mfma_f32_16x16x32_bf16 v[92:95], a[136:139], v[160:163], v[92:95]
ds_read_b128 a[64:67], v11 offset:4096
v_mfma_f32_16x16x32_bf16 v[120:123], a[136:139], v[164:167], v[120:123]
ds_read_b128 a[68:71], v11 offset:5120
v_mfma_f32_16x16x32_bf16 v[120:123], a[108:111], v[156:159], v[120:123]
ds_read_b128 a[72:75], v11 offset:6144
v_mfma_f32_16x16x32_bf16 v[96:99], a[112:115], v[152:155], v[96:99]
buffer_load_dwordx4 v[220:223], v27, s[12:15], s43 offen offset:0
v_mfma_f32_16x16x32_bf16 v[96:99], a[140:143], v[160:163], v[96:99]
ds_read_b128 a[76:79], v11 offset:7168
v_mfma_f32_16x16x32_bf16 v[124:127], a[140:143], v[164:167], v[124:127]
ds_read_b128 a[80:83], v11 offset:8192
v_mfma_f32_16x16x32_bf16 v[124:127], a[112:115], v[156:159], v[124:127]
ds_read_b128 a[84:87], v11 offset:9216
v_mfma_f32_16x16x32_bf16 v[100:103], a[116:119], v[152:155], v[100:103]
ds_read_b128 a[88:91], v11 offset:10240
v_mfma_f32_16x16x32_bf16 v[100:103], a[144:147], v[160:163], v[100:103]
ds_read_b128 a[92:95], v11 offset:12288
v_mfma_f32_16x16x32_bf16 v[128:131], a[144:147], v[164:167], v[128:131]
ds_read_b128 a[96:99], v11 offset:13312
v_mfma_f32_16x16x32_bf16 v[128:131], a[116:119], v[156:159], v[128:131]
buffer_load_dwordx4 v[224:227], v26, s[12:15], s43 offen offset:1024
v_mfma_f32_16x16x32_bf16 v[104:107], a[120:123], v[152:155], v[104:107]
ds_read_b128 a[100:103], v11 offset:14336
v_mfma_f32_16x16x32_bf16 v[104:107], a[148:151], v[160:163], v[104:107]
v_mfma_f32_16x16x32_bf16 v[132:135], a[148:151], v[164:167], v[132:135]
v_mfma_f32_16x16x32_bf16 v[132:135], a[120:123], v[156:159], v[132:135]
v_mfma_f32_16x16x32_bf16 v[108:111], a[124:127], v[152:155], v[108:111]
v_mfma_f32_16x16x32_bf16 v[108:111], a[152:155], v[160:163], v[108:111]
v_mfma_f32_16x16x32_bf16 v[136:139], a[152:155], v[164:167], v[136:139]
buffer_load_dwordx4 v[228:231], v27, s[12:15], s43 offen offset:1024
v_mfma_f32_16x16x32_bf16 v[136:139], a[124:127], v[156:159], v[136:139]
v_mfma_f32_16x16x32_bf16 v[112:115], a[128:131], v[152:155], v[112:115]
v_mfma_f32_16x16x32_bf16 v[112:115], a[156:159], v[160:163], v[112:115]
v_mfma_f32_16x16x32_bf16 v[140:143], a[156:159], v[164:167], v[140:143]
v_mfma_f32_16x16x32_bf16 v[140:143], a[128:131], v[156:159], v[140:143]
s_waitcnt vmcnt(29)
s_barrier
s_waitcnt vmcnt(24) lgkmcnt(0)
s_add_u32 s43, s52, 63488
v_mfma_f32_16x16x32_bf16 v[88:91], a[48:51], v[168:171], v[88:91]
ds_read_b128 a[104:107], v11 offset:16384
v_mfma_f32_16x16x32_bf16 v[88:91], a[76:79], v[176:179], v[88:91]
buffer_load_dwordx4 v[232:235], v26, s[12:15], s43 offen offset:0
v_mfma_f32_16x16x32_bf16 v[116:119], a[76:79], v[180:183], v[116:119]
ds_read_b128 a[108:111], v11 offset:17408
v_mfma_f32_16x16x32_bf16 v[116:119], a[48:51], v[172:175], v[116:119]
ds_read_b128 a[112:115], v11 offset:18432
v_mfma_f32_16x16x32_bf16 v[92:95], a[52:55], v[168:171], v[92:95]
ds_read_b128 a[116:119], v11 offset:19456
v_mfma_f32_16x16x32_bf16 v[92:95], a[80:83], v[176:179], v[92:95]
ds_read_b128 a[120:123], v11 offset:20480
v_mfma_f32_16x16x32_bf16 v[120:123], a[80:83], v[180:183], v[120:123]
ds_read_b128 a[124:127], v11 offset:21504
v_mfma_f32_16x16x32_bf16 v[120:123], a[52:55], v[172:175], v[120:123]
ds_read_b128 a[128:131], v11 offset:22528
v_mfma_f32_16x16x32_bf16 v[96:99], a[56:59], v[168:171], v[96:99]
buffer_load_dwordx4 v[236:239], v27, s[12:15], s43 offen offset:0
v_mfma_f32_16x16x32_bf16 v[96:99], a[84:87], v[176:179], v[96:99]
ds_read_b128 a[132:135], v11 offset:23552
v_mfma_f32_16x16x32_bf16 v[124:127], a[84:87], v[180:183], v[124:127]
ds_read_b128 a[136:139], v11 offset:24576
v_mfma_f32_16x16x32_bf16 v[124:127], a[56:59], v[172:175], v[124:127]
ds_read_b128 a[140:143], v11 offset:25600
v_mfma_f32_16x16x32_bf16 v[100:103], a[60:63], v[168:171], v[100:103]
ds_read_b128 a[144:147], v11 offset:26624
v_mfma_f32_16x16x32_bf16 v[100:103], a[88:91], v[176:179], v[100:103]
ds_read_b128 a[148:151], v11 offset:28672
v_mfma_f32_16x16x32_bf16 v[128:131], a[88:91], v[180:183], v[128:131]
ds_read_b128 a[152:155], v11 offset:29696
v_mfma_f32_16x16x32_bf16 v[128:131], a[60:63], v[172:175], v[128:131]
buffer_load_dwordx4 v[240:243], v26, s[12:15], s43 offen offset:1024
v_mfma_f32_16x16x32_bf16 v[104:107], a[64:67], v[168:171], v[104:107]
ds_read_b128 a[156:159], v11 offset:30720
v_mfma_f32_16x16x32_bf16 v[104:107], a[92:95], v[176:179], v[104:107]
v_mfma_f32_16x16x32_bf16 v[132:135], a[92:95], v[180:183], v[132:135]
v_mfma_f32_16x16x32_bf16 v[132:135], a[64:67], v[172:175], v[132:135]
v_mfma_f32_16x16x32_bf16 v[108:111], a[68:71], v[168:171], v[108:111]
v_mfma_f32_16x16x32_bf16 v[108:111], a[96:99], v[176:179], v[108:111]
v_mfma_f32_16x16x32_bf16 v[136:139], a[96:99], v[180:183], v[136:139]
buffer_load_dwordx4 v[244:247], v27, s[12:15], s43 offen offset:1024
v_mfma_f32_16x16x32_bf16 v[136:139], a[68:71], v[172:175], v[136:139]
v_mfma_f32_16x16x32_bf16 v[112:115], a[72:75], v[168:171], v[112:115]
v_mfma_f32_16x16x32_bf16 v[112:115], a[100:103], v[176:179], v[112:115]
v_mfma_f32_16x16x32_bf16 v[140:143], a[100:103], v[180:183], v[140:143]
v_mfma_f32_16x16x32_bf16 v[140:143], a[72:75], v[172:175], v[140:143]
s_waitcnt vmcnt(24)
s_barrier
s_bitcmp1_b32 s2, 0
s_cbranch_scc1 L_k3_gdone
s_waitcnt vmcnt(20) lgkmcnt(0)
v_mfma_f32_16x16x32_bf16 v[88:91], a[104:107], v[184:187], v[88:91]
ds_read_b128 a[48:51], v12 offset:0
v_mfma_f32_16x16x32_bf16 v[88:91], a[132:135], v[192:195], v[88:91]
v_mfma_f32_16x16x32_bf16 v[116:119], a[132:135], v[196:199], v[116:119]
ds_read_b128 a[52:55], v12 offset:1024
v_mfma_f32_16x16x32_bf16 v[116:119], a[104:107], v[188:191], v[116:119]
ds_read_b128 a[56:59], v12 offset:2048
v_mfma_f32_16x16x32_bf16 v[92:95], a[108:111], v[184:187], v[92:95]
ds_read_b128 a[60:63], v12 offset:3072
v_mfma_f32_16x16x32_bf16 v[92:95], a[136:139], v[192:195], v[92:95]
ds_read_b128 a[64:67], v12 offset:4096
v_mfma_f32_16x16x32_bf16 v[120:123], a[136:139], v[196:199], v[120:123]
ds_read_b128 a[68:71], v12 offset:5120
v_mfma_f32_16x16x32_bf16 v[120:123], a[108:111], v[188:191], v[120:123]
ds_read_b128 a[72:75], v12 offset:6144
v_mfma_f32_16x16x32_bf16 v[96:99], a[112:115], v[184:187], v[96:99]
v_mfma_f32_16x16x32_bf16 v[96:99], a[140:143], v[192:195], v[96:99]
ds_read_b128 a[76:79], v12 offset:7168
v_mfma_f32_16x16x32_bf16 v[124:127], a[140:143], v[196:199], v[124:127]
ds_read_b128 a[80:83], v12 offset:8192
v_mfma_f32_16x16x32_bf16 v[124:127], a[112:115], v[188:191], v[124:127]
ds_read_b128 a[84:87], v12 offset:9216
v_mfma_f32_16x16x32_bf16 v[100:103], a[116:119], v[184:187], v[100:103]
ds_read_b128 a[88:91], v12 offset:10240
v_mfma_f32_16x16x32_bf16 v[100:103], a[144:147], v[192:195], v[100:103]
ds_read_b128 a[92:95], v12 offset:12288
v_mfma_f32_16x16x32_bf16 v[128:131], a[144:147], v[196:199], v[128:131]
ds_read_b128 a[96:99], v12 offset:13312
v_mfma_f32_16x16x32_bf16 v[128:131], a[116:119], v[188:191], v[128:131]
v_mfma_f32_16x16x32_bf16 v[104:107], a[120:123], v[184:187], v[104:107]
ds_read_b128 a[100:103], v12 offset:14336
v_mfma_f32_16x16x32_bf16 v[104:107], a[148:151], v[192:195], v[104:107]
v_mfma_f32_16x16x32_bf16 v[132:135], a[148:151], v[196:199], v[132:135]
v_mfma_f32_16x16x32_bf16 v[132:135], a[120:123], v[188:191], v[132:135]
v_mfma_f32_16x16x32_bf16 v[108:111], a[124:127], v[184:187], v[108:111]
v_mfma_f32_16x16x32_bf16 v[108:111], a[152:155], v[192:195], v[108:111]
v_mfma_f32_16x16x32_bf16 v[136:139], a[152:155], v[196:199], v[136:139]
v_mfma_f32_16x16x32_bf16 v[136:139], a[124:127], v[188:191], v[136:139]
v_mfma_f32_16x16x32_bf16 v[112:115], a[128:131], v[184:187], v[112:115]
v_mfma_f32_16x16x32_bf16 v[112:115], a[156:159], v[192:195], v[112:115]
v_mfma_f32_16x16x32_bf16 v[140:143], a[156:159], v[196:199], v[140:143]
v_mfma_f32_16x16x32_bf16 v[140:143], a[128:131], v[188:191], v[140:143]
s_waitcnt vmcnt(16)
s_barrier
s_waitcnt vmcnt(12) lgkmcnt(0)
v_mfma_f32_16x16x32_bf16 v[88:91], a[48:51], v[200:203], v[88:91]
ds_read_b128 a[104:107], v12 offset:16384
v_mfma_f32_16x16x32_bf16 v[88:91], a[76:79], v[208:211], v[88:91]
v_mfma_f32_16x16x32_bf16 v[116:119], a[76:79], v[212:215], v[116:119]
ds_read_b128 a[108:111], v12 offset:17408
v_mfma_f32_16x16x32_bf16 v[116:119], a[48:51], v[204:207], v[116:119]
ds_read_b128 a[112:115], v12 offset:18432
v_mfma_f32_16x16x32_bf16 v[92:95], a[52:55], v[200:203], v[92:95]
ds_read_b128 a[116:119], v12 offset:19456
v_mfma_f32_16x16x32_bf16 v[92:95], a[80:83], v[208:211], v[92:95]
ds_read_b128 a[120:123], v12 offset:20480
v_mfma_f32_16x16x32_bf16 v[120:123], a[80:83], v[212:215], v[120:123]
ds_read_b128 a[124:127], v12 offset:21504
v_mfma_f32_16x16x32_bf16 v[120:123], a[52:55], v[204:207], v[120:123]
ds_read_b128 a[128:131], v12 offset:22528
v_mfma_f32_16x16x32_bf16 v[96:99], a[56:59], v[200:203], v[96:99]
v_mfma_f32_16x16x32_bf16 v[96:99], a[84:87], v[208:211], v[96:99]
ds_read_b128 a[132:135], v12 offset:23552
v_mfma_f32_16x16x32_bf16 v[124:127], a[84:87], v[212:215], v[124:127]
ds_read_b128 a[136:139], v12 offset:24576
v_mfma_f32_16x16x32_bf16 v[124:127], a[56:59], v[204:207], v[124:127]
ds_read_b128 a[140:143], v12 offset:25600
v_mfma_f32_16x16x32_bf16 v[100:103], a[60:63], v[200:203], v[100:103]
ds_read_b128 a[144:147], v12 offset:26624
v_mfma_f32_16x16x32_bf16 v[100:103], a[88:91], v[208:211], v[100:103]
ds_read_b128 a[148:151], v12 offset:28672
v_mfma_f32_16x16x32_bf16 v[128:131], a[88:91], v[212:215], v[128:131]
ds_read_b128 a[152:155], v12 offset:29696
v_mfma_f32_16x16x32_bf16 v[128:131], a[60:63], v[204:207], v[128:131]
v_mfma_f32_16x16x32_bf16 v[104:107], a[64:67], v[200:203], v[104:107]
ds_read_b128 a[156:159], v12 offset:30720
v_mfma_f32_16x16x32_bf16 v[104:107], a[92:95], v[208:211], v[104:107]
v_mfma_f32_16x16x32_bf16 v[132:135], a[92:95], v[212:215], v[132:135]
v_mfma_f32_16x16x32_bf16 v[132:135], a[64:67], v[204:207], v[132:135]
v_mfma_f32_16x16x32_bf16 v[108:111], a[68:71], v[200:203], v[108:111]
v_mfma_f32_16x16x32_bf16 v[108:111], a[96:99], v[208:211], v[108:111]
v_mfma_f32_16x16x32_bf16 v[136:139], a[96:99], v[212:215], v[136:139]
v_mfma_f32_16x16x32_bf16 v[136:139], a[68:71], v[204:207], v[136:139]
v_mfma_f32_16x16x32_bf16 v[112:115], a[72:75], v[200:203], v[112:115]
v_mfma_f32_16x16x32_bf16 v[112:115], a[100:103], v[208:211], v[112:115]
v_mfma_f32_16x16x32_bf16 v[140:143], a[100:103], v[212:215], v[140:143]
v_mfma_f32_16x16x32_bf16 v[140:143], a[72:75], v[204:207], v[140:143]
s_waitcnt vmcnt(8)
s_barrier
s_waitcnt vmcnt(4) lgkmcnt(0)
v_mfma_f32_16x16x32_bf16 v[88:91], a[104:107], v[216:219], v[88:91]
ds_read_b128 a[48:51], v10 offset:0
v_mfma_f32_16x16x32_bf16 v[88:91], a[132:135], v[224:227], v[88:91]
v_mfma_f32_16x16x32_bf16 v[116:119], a[132:135], v[228:231], v[116:119]
ds_read_b128 a[52:55], v10 offset:1024
v_mfma_f32_16x16x32_bf16 v[116:119], a[104:107], v[220:223], v[116:119]
ds_read_b128 a[56:59], v10 offset:2048
v_mfma_f32_16x16x32_bf16 v[92:95], a[108:111], v[216:219], v[92:95]
ds_read_b128 a[60:63], v10 offset:3072
v_mfma_f32_16x16x32_bf16 v[92:95], a[136:139], v[224:227], v[92:95]
ds_read_b128 a[64:67], v10 offset:4096
v_mfma_f32_16x16x32_bf16 v[120:123], a[136:139], v[228:231], v[120:123]
ds_read_b128 a[68:71], v10 offset:5120
v_mfma_f32_16x16x32_bf16 v[120:123], a[108:111], v[220:223], v[120:123]
ds_read_b128 a[72:75], v10 offset:6144
v_mfma_f32_16x16x32_bf16 v[96:99], a[112:115], v[216:219], v[96:99]
v_mfma_f32_16x16x32_bf16 v[96:99], a[140:143], v[224:227], v[96:99]
ds_read_b128 a[76:79], v10 offset:7168
v_mfma_f32_16x16x32_bf16 v[124:127], a[140:143], v[228:231], v[124:127]
ds_read_b128 a[80:83], v10 offset:8192
v_mfma_f32_16x16x32_bf16 v[124:127], a[112:115], v[220:223], v[124:127]
ds_read_b128 a[84:87], v10 offset:9216
v_mfma_f32_16x16x32_bf16 v[100:103], a[116:119], v[216:219], v[100:103]
ds_read_b128 a[88:91], v10 offset:10240
v_mfma_f32_16x16x32_bf16 v[100:103], a[144:147], v[224:227], v[100:103]
ds_read_b128 a[92:95], v10 offset:12288
v_mfma_f32_16x16x32_bf16 v[128:131], a[144:147], v[228:231], v[128:131]
ds_read_b128 a[96:99], v10 offset:13312
v_mfma_f32_16x16x32_bf16 v[128:131], a[116:119], v[220:223], v[128:131]
v_mfma_f32_16x16x32_bf16 v[104:107], a[120:123], v[216:219], v[104:107]
ds_read_b128 a[100:103], v10 offset:14336
v_mfma_f32_16x16x32_bf16 v[104:107], a[148:151], v[224:227], v[104:107]
v_mfma_f32_16x16x32_bf16 v[132:135], a[148:151], v[228:231], v[132:135]
v_mfma_f32_16x16x32_bf16 v[132:135], a[120:123], v[220:223], v[132:135]
v_mfma_f32_16x16x32_bf16 v[108:111], a[124:127], v[216:219], v[108:111]
v_mfma_f32_16x16x32_bf16 v[108:111], a[152:155], v[224:227], v[108:111]
v_mfma_f32_16x16x32_bf16 v[136:139], a[152:155], v[228:231], v[136:139]
v_mfma_f32_16x16x32_bf16 v[136:139], a[124:127], v[220:223], v[136:139]
v_mfma_f32_16x16x32_bf16 v[112:115], a[128:131], v[216:219], v[112:115]
v_mfma_f32_16x16x32_bf16 v[112:115], a[156:159], v[224:227], v[112:115]
v_mfma_f32_16x16x32_bf16 v[140:143], a[156:159], v[228:231], v[140:143]
v_mfma_f32_16x16x32_bf16 v[140:143], a[128:131], v[220:223], v[140:143]
s_waitcnt vmcnt(0) lgkmcnt(0)
v_mfma_f32_16x16x32_bf16 v[88:91], a[48:51], v[232:235], v[88:91]
v_mfma_f32_16x16x32_bf16 v[88:91], a[76:79], v[240:243], v[88:91]
v_mfma_f32_16x16x32_bf16 v[116:119], a[76:79], v[244:247], v[116:119]
v_mfma_f32_16x16x32_bf16 v[116:119], a[48:51], v[236:239], v[116:119]
v_mfma_f32_16x16x32_bf16 v[92:95], a[52:55], v[232:235], v[92:95]
v_mfma_f32_16x16x32_bf16 v[92:95], a[80:83], v[240:243], v[92:95]
v_mfma_f32_16x16x32_bf16 v[120:123], a[80:83], v[244:247], v[120:123]
v_mfma_f32_16x16x32_bf16 v[120:123], a[52:55], v[236:239], v[120:123]
v_mfma_f32_16x16x32_bf16 v[96:99], a[56:59], v[232:235], v[96:99]
v_mfma_f32_16x16x32_bf16 v[96:99], a[84:87], v[240:243], v[96:99]
v_mfma_f32_16x16x32_bf16 v[124:127], a[84:87], v[244:247], v[124:127]
v_mfma_f32_16x16x32_bf16 v[124:127], a[56:59], v[236:239], v[124:127]
v_mfma_f32_16x16x32_bf16 v[100:103], a[60:63], v[232:235], v[100:103]
v_mfma_f32_16x16x32_bf16 v[100:103], a[88:91], v[240:243], v[100:103]
v_mfma_f32_16x16x32_bf16 v[128:131], a[88:91], v[244:247], v[128:131]
v_mfma_f32_16x16x32_bf16 v[128:131], a[60:63], v[236:239], v[128:131]
v_mfma_f32_16x16x32_bf16 v[104:107], a[64:67], v[232:235], v[104:107]
v_mfma_f32_16x16x32_bf16 v[104:107], a[92:95], v[240:243], v[104:107]
v_mfma_f32_16x16x32_bf16 v[132:135], a[92:95], v[244:247], v[132:135]
v_mfma_f32_16x16x32_bf16 v[132:135], a[64:67], v[236:239], v[132:135]
v_mfma_f32_16x16x32_bf16 v[108:111], a[68:71], v[232:235], v[108:111]
v_mfma_f32_16x16x32_bf16 v[108:111], a[96:99], v[240:243], v[108:111]
v_mfma_f32_16x16x32_bf16 v[136:139], a[96:99], v[244:247], v[136:139]
v_mfma_f32_16x16x32_bf16 v[136:139], a[68:71], v[236:239], v[136:139]
v_mfma_f32_16x16x32_bf16 v[112:115], a[72:75], v[232:235], v[112:115]
v_mfma_f32_16x16x32_bf16 v[112:115], a[100:103], v[240:243], v[112:115]
v_mfma_f32_16x16x32_bf16 v[140:143], a[100:103], v[244:247], v[140:143]
v_mfma_f32_16x16x32_bf16 v[140:143], a[72:75], v[236:239], v[140:143]
L_k3_gdone:
s_lshl_b32 s41, s32, 2
s_add_u32 s41, s41, s33
s_and_b32 s45, s2, 0xfa
s_lshl_b32 s45, s45, 8
s_add_u32 s45, s45, 82903168
s_lshl_b32 s41, s41, 4
s_add_u32 s41, s41, s16
s_mul_i32 s44, s41, 14336
s_add_u32 s44, s44, 94371840
s_mul_i32 s41, s34, 57344
s_add_u32 s41, s41, s44
s_cmp_eq_u32 s34, 0
s_cselect_b32 s36, 0x40000000, s41
s_cmp_eq_u32 s34, 1
s_cselect_b32 s37, 0x40000000, s41
s_cmp_eq_u32 s34, 2
s_cselect_b32 s38, 0x40000000, s41
s_cmp_eq_u32 s34, 3
s_cselect_b32 s39, 0x40000000, s41
v_pk_add_f32 v[88:89], v[88:89], v[32:33] op_sel:[0,0] op_sel_hi:[1,1] neg_lo:[0,1] neg_hi:[0,1]
v_pk_add_f32 v[90:91], v[90:91], v[34:35] op_sel:[0,0] op_sel_hi:[1,1] neg_lo:[0,1] neg_hi:[0,1]
v_pk_fma_f32 v[88:89], v[88:89], v[8:9], v[32:33] op_sel:[0,0,0] op_sel_hi:[1,0,1]
v_pk_fma_f32 v[90:91], v[90:91], v[8:9], v[34:35] op_sel:[0,0,0] op_sel_hi:[1,0,1]
buffer_store_dwordx4 v[88:91], v1, s[12:15], s36 offen offset:0 sc0 sc1
s_add_u32 s36, s36, 4096
v_pk_add_f32 v[92:93], v[92:93], v[36:37] op_sel:[0,0] op_sel_hi:[1,1] neg_lo:[0,1] neg_hi:[0,1]
v_pk_add_f32 v[94:95], v[94:95], v[38:39] op_sel:[0,0] op_sel_hi:[1,1] neg_lo:[0,1] neg_hi:[0,1]
v_pk_fma_f32 v[92:93], v[92:93], v[8:9], v[36:37] op_sel:[0,0,0] op_sel_hi:[1,0,1]
v_pk_fma_f32 v[94:95], v[94:95], v[8:9], v[38:39] op_sel:[0,0,0] op_sel_hi:[1,0,1]
buffer_store_dwordx4 v[92:95], v1, s[12:15], s37 offen offset:1024 sc0 sc1
s_add_u32 s37, s37, 4096
v_pk_add_f32 v[96:97], v[96:97], v[40:41] op_sel:[0,0] op_sel_hi:[1,1] neg_lo:[0,1] neg_hi:[0,1]
v_pk_add_f32 v[98:99], v[98:99], v[42:43] op_sel:[0,0] op_sel_hi:[1,1] neg_lo:[0,1] neg_hi:[0,1]
v_pk_fma_f32 v[96:97], v[96:97], v[8:9], v[40:41] op_sel:[0,0,0] op_sel_hi:[1,0,1]
v_pk_fma_f32 v[98:99], v[98:99], v[8:9], v[42:43] op_sel:[0,0,0] op_sel_hi:[1,0,1]
buffer_store_dwordx4 v[96:99], v1, s[12:15], s38 offen offset:2048 sc0 sc1
s_add_u32 s38, s38, 4096
v_pk_add_f32 v[100:101], v[100:101], v[44:45] op_sel:[0,0] op_sel_hi:[1,1] neg_lo:[0,1] neg_hi:[0,1]
v_pk_add_f32 v[102:103], v[102:103], v[46:47] op_sel:[0,0] op_sel_hi:[1,1] neg_lo:[0,1] neg_hi:[0,1]
v_pk_fma_f32 v[100:101], v[100:101], v[8:9], v[44:45] op_sel:[0,0,0] op_sel_hi:[1,0,1]
v_pk_fma_f32 v[102:103], v[102:103], v[8:9], v[46:47] op_sel:[0,0,0] op_sel_hi:[1,0,1]
buffer_store_dwordx4 v[100:103], v1, s[12:15], s39 offen offset:3072 sc0 sc1
s_add_u32 s39, s39, 4096
v_pk_add_f32 v[104:105], v[104:105], v[48:49] op_sel:[0,0] op_sel_hi:[1,1] neg_lo:[0,1] neg_hi:[0,1]
v_pk_add_f32 v[106:107], v[106:107], v[50:51] op_sel:[0,0] op_sel_hi:[1,1] neg_lo:[0,1] neg_hi:[0,1]
v_pk_fma_f32 v[104:105], v[104:105], v[8:9], v[48:49] op_sel:[0,0,0] op_sel_hi:[1,0,1]
v_pk_fma_f32 v[106:107], v[106:107], v[8:9], v[50:51] op_sel:[0,0,0] op_sel_hi:[1,0,1]
buffer_store_dwordx4 v[104:107], v1, s[12:15], s36 offen offset:0 sc0 sc1
s_add_u32 s36, s36, 4096
v_pk_add_f32 v[108:109], v[108:109], v[52:53] op_sel:[0,0] op_sel_hi:[1,1] neg_lo:[0,1] neg_hi:[0,1]
v_pk_add_f32 v[110:111], v[110:111], v[54:55] op_sel:[0,0] op_sel_hi:[1,1] neg_lo:[0,1] neg_hi:[0,1]
v_pk_fma_f32 v[108:109], v[108:109], v[8:9], v[52:53] op_sel:[0,0,0] op_sel_hi:[1,0,1]
v_pk_fma_f32 v[110:111], v[110:111], v[8:9], v[54:55] op_sel:[0,0,0] op_sel_hi:[1,0,1]
buffer_store_dwordx4 v[108:111], v1, s[12:15], s37 offen offset:1024 sc0 sc1
s_add_u32 s37, s37, 4096
v_pk_add_f32 v[112:113], v[112:113], v[56:57] op_sel:[0,0] op_sel_hi:[1,1] neg_lo:[0,1] neg_hi:[0,1]
v_pk_add_f32 v[114:115], v[114:115], v[58:59] op_sel:[0,0] op_sel_hi:[1,1] neg_lo:[0,1] neg_hi:[0,1]
v_pk_fma_f32 v[112:113], v[112:113], v[8:9], v[56:57] op_sel:[0,0,0] op_sel_hi:[1,0,1]
v_pk_fma_f32 v[114:115], v[114:115], v[8:9], v[58:59] op_sel:[0,0,0] op_sel_hi:[1,0,1]
buffer_store_dwordx4 v[112:115], v1, s[12:15], s38 offen offset:2048 sc0 sc1
s_add_u32 s38, s38, 4096
v_pk_add_f32 v[116:117], v[116:117], v[60:61] op_sel:[0,0] op_sel_hi:[1,1] neg_lo:[0,1] neg_hi:[0,1]
v_pk_add_f32 v[118:119], v[118:119], v[62:63] op_sel:[0,0] op_sel_hi:[1,1] neg_lo:[0,1] neg_hi:[0,1]
v_pk_fma_f32 v[116:117], v[116:117], v[8:9], v[60:61] op_sel:[0,1,0] op_sel_hi:[1,1,1]
v_pk_fma_f32 v[118:119], v[118:119], v[8:9], v[62:63] op_sel:[0,1,0] op_sel_hi:[1,1,1]
buffer_store_dwordx4 v[116:119], v1, s[12:15], s39 offen offset:3072 sc0 sc1
s_add_u32 s39, s39, 4096
v_pk_add_f32 v[120:121], v[120:121], v[64:65] op_sel:[0,0] op_sel_hi:[1,1] neg_lo:[0,1] neg_hi:[0,1]
v_pk_add_f32 v[122:123], v[122:123], v[66:67] op_sel:[0,0] op_sel_hi:[1,1] neg_lo:[0,1] neg_hi:[0,1]
v_pk_fma_f32 v[120:121], v[120:121], v[8:9], v[64:65] op_sel:[0,1,0] op_sel_hi:[1,1,1]
v_pk_fma_f32 v[122:123], v[122:123], v[8:9], v[66:67] op_sel:[0,1,0] op_sel_hi:[1,1,1]
buffer_store_dwordx4 v[120:123], v1, s[12:15], s36 offen offset:0 sc0 sc1
s_add_u32 s36, s36, 4096
v_pk_add_f32 v[124:125], v[124:125], v[68:69] op_sel:[0,0] op_sel_hi:[1,1] neg_lo:[0,1] neg_hi:[0,1]
v_pk_add_f32 v[126:127], v[126:127], v[70:71] op_sel:[0,0] op_sel_hi:[1,1] neg_lo:[0,1] neg_hi:[0,1]
v_pk_fma_f32 v[124:125], v[124:125], v[8:9], v[68:69] op_sel:[0,1,0] op_sel_hi:[1,1,1]
v_pk_fma_f32 v[126:127], v[126:127], v[8:9], v[70:71] op_sel:[0,1,0] op_sel_hi:[1,1,1]
buffer_store_dwordx4 v[124:127], v1, s[12:15], s37 offen offset:1024 sc0 sc1
s_add_u32 s37, s37, 4096
v_pk_add_f32 v[128:129], v[128:129], v[72:73] op_sel:[0,0] op_sel_hi:[1,1] neg_lo:[0,1] neg_hi:[0,1]
v_pk_add_f32 v[130:131], v[130:131], v[74:75] op_sel:[0,0] op_sel_hi:[1,1] neg_lo:[0,1] neg_hi:[0,1]
v_pk_fma_f32 v[128:129], v[128:129], v[8:9], v[72:73] op_sel:[0,1,0] op_sel_hi:[1,1,1]
v_pk_fma_f32 v[130:131], v[130:131], v[8:9], v[74:75] op_sel:[0,1,0] op_sel_hi:[1,1,1]
buffer_store_dwordx4 v[128:131], v1, s[12:15], s38 offen offset:2048 sc0 sc1
v_pk_add_f32 v[132:133], v[132:133], v[76:77] op_sel:[0,0] op_sel_hi:[1,1] neg_lo:[0,1] neg_hi:[0,1]
v_pk_add_f32 v[134:135], v[134:135], v[78:79] op_sel:[0,0] op_sel_hi:[1,1] neg_lo:[0,1] neg_hi:[0,1]
v_pk_fma_f32 v[132:133], v[132:133], v[8:9], v[76:77] op_sel:[0,1,0] op_sel_hi:[1,1,1]
v_pk_fma_f32 v[134:135], v[134:135], v[8:9], v[78:79] op_sel:[0,1,0] op_sel_hi:[1,1,1]
buffer_store_dwordx4 v[132:135], v1, s[12:15], s39 offen offset:3072 sc0 sc1
v_pk_add_f32 v[136:137], v[136:137], v[80:81] op_sel:[0,0] op_sel_hi:[1,1] neg_lo:[0,1] neg_hi:[0,1]
v_pk_add_f32 v[138:139], v[138:139], v[82:83] op_sel:[0,0] op_sel_hi:[1,1] neg_lo:[0,1] neg_hi:[0,1]
v_pk_fma_f32 v[136:137], v[136:137], v[8:9], v[80:81] op_sel:[0,1,0] op_sel_hi:[1,1,1]
v_pk_fma_f32 v[138:139], v[138:139], v[8:9], v[82:83] op_sel:[0,1,0] op_sel_hi:[1,1,1]
buffer_store_dwordx4 v[136:139], v1, s[12:15], s36 offen offset:0 sc0 sc1
v_pk_add_f32 v[140:141], v[140:141], v[84:85] op_sel:[0,0] op_sel_hi:[1,1] neg_lo:[0,1] neg_hi:[0,1]
v_pk_add_f32 v[142:143], v[142:143], v[86:87] op_sel:[0,0] op_sel_hi:[1,1] neg_lo:[0,1] neg_hi:[0,1]
v_pk_fma_f32 v[140:141], v[140:141], v[8:9], v[84:85] op_sel:[0,1,0] op_sel_hi:[1,1,1]
v_pk_fma_f32 v[142:143], v[142:143], v[8:9], v[86:87] op_sel:[0,1,0] op_sel_hi:[1,1,1]
buffer_store_dwordx4 v[140:143], v1, s[12:15], s37 offen offset:1024 sc0 sc1
s_waitcnt vmcnt(14)
s_cmp_eq_u32 s34, 0
s_cbranch_scc0 L_k3_own1
v_mov_b64 v[160:161], v[88:89]
v_mov_b64 v[162:163], v[90:91]
v_mov_b64 v[176:177], v[104:105]
v_mov_b64 v[178:179], v[106:107]
v_mov_b64 v[192:193], v[120:121]
v_mov_b64 v[194:195], v[122:123]
v_mov_b64 v[208:209], v[136:137]
v_mov_b64 v[210:211], v[138:139]
s_branch L_k3_ownd
L_k3_own1:
s_cmp_eq_u32 s34, 1
s_cbranch_scc0 L_k3_own2
v_mov_b64 v[160:161], v[92:93]
v_mov_b64 v[162:163], v[94:95]
v_mov_b64 v[176:177], v[108:109]
v_mov_b64 v[178:179], v[110:111]
v_mov_b64 v[192:193], v[124:125]
v_mov_b64 v[194:195], v[126:127]
v_mov_b64 v[208:209], v[140:141]
v_mov_b64 v[210:211], v[142:143]
s_branch L_k3_ownd
L_k3_own2:
s_cmp_eq_u32 s34, 2
s_cbranch_scc0 L_k3_own3
v_mov_b64 v[160:161], v[96:97]
v_mov_b64 v[162:163], v[98:99]
v_mov_b64 v[176:177], v[112:113]
v_mov_b64 v[178:179], v[114:115]
v_mov_b64 v[192:193], v[128:129]
v_mov_b64 v[194:195], v[130:131]
v_mov_b64 v[208:209], v[140:141]
v_mov_b64 v[210:211], v[142:143]
s_branch L_k3_ownd
L_k3_own3:
v_mov_b64 v[160:161], v[100:101]
v_mov_b64 v[162:163], v[102:103]
v_mov_b64 v[176:177], v[116:117]
v_mov_b64 v[178:179], v[118:119]
v_mov_b64 v[192:193], v[132:133]
v_mov_b64 v[194:195], v[134:135]
v_mov_b64 v[208:209], v[140:141]
v_mov_b64 v[210:211], v[142:143]
L_k3_ownd:
s_mov_b32 s48, s54
s_mov_b32 s49, s55
s_mov_b32 s50, 1835008
s_mov_b32 s51, 0x20000
v_and_b32 v6, 15, v0
v_mul_u32_u24 v6, 896, v6
v_lshrrev_b32 v7, 4, v0
v_lshl_add_u32 v6, v7, 3, v6
s_lshl_b32 s41, s32, 2
s_add_u32 s41, s41, s16
s_mul_i32 s35, s41, 28672
s_mul_i32 s41, s33, 224
s_add_u32 s35, s35, s41
s_lshl_b32 s41, s34, 10
s_add_u32 s44, s44, s41
v_and_b32 v5, 5, v0
v_lshlrev_b32 v5, 8, v5
s_lshl_b32 s41, s16, 2
s_add_u32 s45, s45, s41
s_and_b32 s41, s2, 5
s_lshl_b32 s41, s41, 8
s_add_u32 s41, s41, s45
v_mov_b32 v4, 1
v_mov_b32 v28, 0
s_add_u32 s37, s34, 1
s_and_b32 s37, s37, 3
s_mul_i32 s37, s37, 57344
s_add_u32 s37, s37, s44
s_add_u32 s38, s34, 2
s_and_b32 s38, s38, 3
s_mul_i32 s38, s38, 57344
s_add_u32 s38, s38, s44
s_add_u32 s39, s34, 3
s_and_b32 s39, s39, 3
s_mul_i32 s39, s39, 57344
s_add_u32 s39, s39, s44
s_mov_b32 s36, 4096
s_cmp_ge_u32 s34, 2
s_cselect_b32 s36, 0x40000000, s36
s_waitcnt vmcnt(0)
s_mov_b64 exec, 1
buffer_store_dword v4, v28, s[12:15], s41 offen sc0 sc1
s_mov_b64 exec, -1
s_mov_b32 s42, 0
L_poll18:
buffer_load_dword v4, v5, s[12:15], s45 offen sc0 sc1
s_waitcnt vmcnt(0)
v_cmp_ne_u32 vcc, 1, v4
s_nop 4
s_cbranch_vccnz L_poll18_r
s_branch L_poll18_ok
L_poll18_r:
s_add_u32 s42, s42, 1
s_cmp_lt_u32 s42, 32768
s_sleep 1
s_cbranch_scc1 L_poll18
L_poll18_ok:
buffer_load_dwordx4 v[164:167], v1, s[12:15], s37 offen sc0 sc1
s_add_u32 s37, s37, 4096
buffer_load_dwordx4 v[168:171], v1, s[12:15], s38 offen sc0 sc1
s_add_u32 s38, s38, 4096
buffer_load_dwordx4 v[172:175], v1, s[12:15], s39 offen sc0 sc1
s_add_u32 s39, s39, 4096
buffer_load_dwordx4 v[180:183], v1, s[12:15], s37 offen sc0 sc1
s_add_u32 s37, s37, 4096
buffer_load_dwordx4 v[184:187], v1, s[12:15], s38 offen sc0 sc1
s_add_u32 s38, s38, 4096
buffer_load_dwordx4 v[188:191], v1, s[12:15], s39 offen sc0 sc1
s_add_u32 s39, s39, 4096
buffer_load_dwordx4 v[196:199], v1, s[12:15], s37 offen sc0 sc1
s_add_u32 s37, s37, s36
buffer_load_dwordx4 v[200:203], v1, s[12:15], s38 offen sc0 sc1
s_add_u32 s38, s38, s36
buffer_load_dwordx4 v[204:207], v1, s[12:15], s39 offen sc0 sc1
s_add_u32 s39, s39, s36
buffer_load_dwordx4 v[212:215], v1, s[12:15], s37 offen sc0 sc1
buffer_load_dwordx4 v[216:219], v1, s[12:15], s38 offen sc0 sc1
buffer_load_dwordx4 v[220:223], v1, s[12:15], s39 offen sc0 sc1
s_add_u32 s41, s34, 0
s_lshl_b32 s42, s41, 5
s_cmp_ge_u32 s41, 7
s_cselect_b32 s43, 14112, 0
s_add_u32 s42, s42, s43
s_cmp_ge_u32 s41, 14
s_cselect_b32 s43, 0x40000000, 0
s_add_u32 s42, s42, s43
s_add_u32 s42, s42, s35
s_waitcnt vmcnt(9)
v_add_f32 v160, v160, v164
v_add_f32 v161, v161, v165
v_add_f32 v162, v162, v166
v_add_f32 v163, v163, v167
v_add_f32 v168, v168, v172
v_add_f32 v169, v169, v173
v_add_f32 v170, v170, v174
v_add_f32 v171, v171, v175
v_add_f32 v160, v160, v168
v_add_f32 v161, v161, v169
v_add_f32 v162, v162, v170
v_add_f32 v163, v163, v171
v_cvt_pk_bf16_f32 v160, v160, v161
v_cvt_pk_bf16_f32 v161, v162, v163
buffer_store_dwordx2 v[160:161], v6, s[48:51], s42 offen sc0 sc1
s_add_u32 s41, s34, 4
s_lshl_b32 s42, s41, 5
s_cmp_ge_u32 s41, 7
s_cselect_b32 s43, 14112, 0
s_add_u32 s42, s42, s43
s_cmp_ge_u32 s41, 14
s_cselect_b32 s43, 0x40000000, 0
s_add_u32 s42, s42, s43
s_add_u32 s42, s42, s35
s_waitcnt vmcnt(7)
v_add_f32 v176, v176, v180
v_add_f32 v177, v177, v181
v_add_f32 v178, v178, v182
v_add_f32 v179, v179, v183
v_add_f32 v184, v184, v188
v_add_f32 v185, v185, v189
v_add_f32 v186, v186, v190
v_add_f32 v187, v187, v191
v_add_f32 v176, v176, v184
v_add_f32 v177, v177, v185
v_add_f32 v178, v178, v186
v_add_f32 v179, v179, v187
v_cvt_pk_bf16_f32 v176, v176, v177
v_cvt_pk_bf16_f32 v177, v178, v179
buffer_store_dwordx2 v[176:177], v6, s[48:51], s42 offen sc0 sc1
s_add_u32 s41, s34, 8
s_lshl_b32 s42, s41, 5
s_cmp_ge_u32 s41, 7
s_cselect_b32 s43, 14112, 0
s_add_u32 s42, s42, s43
s_cmp_ge_u32 s41, 14
s_cselect_b32 s43, 0x40000000, 0
s_add_u32 s42, s42, s43
s_add_u32 s42, s42, s35
s_waitcnt vmcnt(5)
v_add_f32 v192, v192, v196
v_add_f32 v193, v193, v197
v_add_f32 v194, v194, v198
v_add_f32 v195, v195, v199
v_add_f32 v200, v200, v204
v_add_f32 v201, v201, v205
v_add_f32 v202, v202, v206
v_add_f32 v203, v203, v207
v_add_f32 v192, v192, v200
v_add_f32 v193, v193, v201
v_add_f32 v194, v194, v202
v_add_f32 v195, v195, v203
v_cvt_pk_bf16_f32 v192, v192, v193
v_cvt_pk_bf16_f32 v193, v194, v195
buffer_store_dwordx2 v[192:193], v6, s[48:51], s42 offen sc0 sc1
s_add_u32 s41, s34, 12
s_lshl_b32 s42, s41, 5
s_cmp_ge_u32 s41, 7
s_cselect_b32 s43, 14112, 0
s_add_u32 s42, s42, s43
s_cmp_ge_u32 s41, 14
s_cselect_b32 s43, 0x40000000, 0
s_add_u32 s42, s42, s43
s_add_u32 s42, s42, s35
s_waitcnt vmcnt(3)
v_add_f32 v208, v208, v212
v_add_f32 v209, v209, v213
v_add_f32 v210, v210, v214
v_add_f32 v211, v211, v215
v_add_f32 v216, v216, v220
v_add_f32 v217, v217, v221
v_add_f32 v218, v218, v222
v_add_f32 v219, v219, v223
v_add_f32 v208, v208, v216
v_add_f32 v209, v209, v217
v_add_f32 v210, v210, v218
v_add_f32 v211, v211, v219
v_cvt_pk_bf16_f32 v208, v208, v209
v_cvt_pk_bf16_f32 v209, v210, v211
buffer_store_dwordx2 v[208:209], v6, s[48:51], s42 offen sc0 sc1
s_endpgm
L_k2_late:
v_mov_b32 v15, 0
s_mov_b32 s30, 0
L_poll19:
buffer_load_dword v14, v15, s[12:15], s71 offen offset:8 sc0 sc1
s_waitcnt vmcnt(0)
v_cmp_ne_u32 vcc, 1, v14
s_nop 4
s_cbranch_vccnz L_poll19_r
s_branch L_poll19_ok
L_poll19_r:
s_add_u32 s30, s30, 1
s_cmp_lt_u32 s30, 32768
s_sleep 4
s_cbranch_scc1 L_poll19
L_poll19_ok:
s_add_u32 s64, s70, 0
buffer_load_dwordx4 a[128:131], v1, s[12:15], s64 offen offset:0 sc0 sc1
buffer_load_dwordx4 a[132:135], v1, s[12:15], s64 offen offset:1024 sc0 sc1
buffer_load_dwordx4 a[136:139], v1, s[12:15], s64 offen offset:2048 sc0 sc1
buffer_load_dwordx4 a[140:143], v1, s[12:15], s64 offen offset:3072 sc0 sc1
s_add_u32 s64, s70, 4096
buffer_load_dwordx4 a[144:147], v1, s[12:15], s64 offen offset:0 sc0 sc1
buffer_load_dwordx4 a[148:151], v1, s[12:15], s64 offen offset:1024 sc0 sc1
buffer_load_dwordx4 a[152:155], v1, s[12:15], s64 offen offset:2048 sc0 sc1
buffer_load_dwordx4 a[156:159], v1, s[12:15], s64 offen offset:3072 sc0 sc1
s_add_u32 s64, s70, 8192
buffer_load_dwordx4 a[160:163], v1, s[12:15], s64 offen offset:0 sc0 sc1
buffer_load_dwordx4 a[164:167], v1, s[12:15], s64 offen offset:1024 sc0 sc1
buffer_load_dwordx4 a[168:171], v1, s[12:15], s64 offen offset:2048 sc0 sc1
buffer_load_dwordx4 a[172:175], v1, s[12:15], s64 offen offset:3072 sc0 sc1
s_add_u32 s64, s70, 12288
buffer_load_dwordx4 a[176:179], v1, s[12:15], s64 offen offset:0 sc0 sc1
buffer_load_dwordx4 a[180:183], v1, s[12:15], s64 offen offset:1024 sc0 sc1
buffer_load_dwordx4 a[184:187], v1, s[12:15], s64 offen offset:2048 sc0 sc1
buffer_load_dwordx4 a[188:191], v1, s[12:15], s64 offen offset:3072 sc0 sc1
s_add_u32 s64, s70, 16384
buffer_load_dwordx4 v[20:23], v1, s[12:15], s64 offen sc0 sc1
s_branch L_k2_lateback
L_k2_ostore:
s_nop 7
s_add_u32 s29, s70, 0
v_cvt_pk_bf16_f32 v128, v128, v129
v_cvt_pk_bf16_f32 v129, v130, v131
v_cvt_pk_bf16_f32 v130, v136, v137
v_cvt_pk_bf16_f32 v131, v138, v139
buffer_store_dwordx4 v[128:131], v1, s[12:15], s29 offen offset:0 sc0 sc1
v_mov_b64 v[136:137], 0
v_mov_b64 v[138:139], 0
v_mov_b64 v[128:129], 0
v_mov_b64 v[130:131], 0
v_cvt_pk_bf16_f32 v144, v144, v145
v_cvt_pk_bf16_f32 v145, v146, v147
v_cvt_pk_bf16_f32 v146, v152, v153
v_cvt_pk_bf16_f32 v147, v154, v155
buffer_store_dwordx4 v[144:147], v1, s[12:15], s29 offen offset:1024 sc0 sc1
v_mov_b64 v[152:153], 0
v_mov_b64 v[154:155], 0
v_mov_b64 v[144:145], 0
v_mov_b64 v[146:147], 0
v_cvt_pk_bf16_f32 v160, v160, v161
v_cvt_pk_bf16_f32 v161, v162, v163
v_cvt_pk_bf16_f32 v162, v168, v169
v_cvt_pk_bf16_f32 v163, v170, v171
buffer_store_dwordx4 v[160:163], v1, s[12:15], s29 offen offset:2048 sc0 sc1
v_mov_b64 v[168:169], 0
v_mov_b64 v[170:171], 0
v_mov_b64 v[160:161], 0
v_mov_b64 v[162:163], 0
v_cvt_pk_bf16_f32 v176, v176, v177
v_cvt_pk_bf16_f32 v177, v178, v179
v_cvt_pk_bf16_f32 v178, v184, v185
v_cvt_pk_bf16_f32 v179, v186, v187
buffer_store_dwordx4 v[176:179], v1, s[12:15], s29 offen offset:3072 sc0 sc1
v_mov_b64 v[184:185], 0
v_mov_b64 v[186:187], 0
v_mov_b64 v[176:177], 0
v_mov_b64 v[178:179], 0
s_add_u32 s29, s70, 4096
v_cvt_pk_bf16_f32 v192, v192, v193
v_cvt_pk_bf16_f32 v193, v194, v195
v_cvt_pk_bf16_f32 v194, v200, v201
v_cvt_pk_bf16_f32 v195, v202, v203
buffer_store_dwordx4 v[192:195], v1, s[12:15], s29 offen offset:0 sc0 sc1
v_mov_b64 v[200:201], 0
v_mov_b64 v[202:203], 0
v_mov_b64 v[192:193], 0
v_mov_b64 v[194:195], 0
v_cvt_pk_bf16_f32 v208, v208, v209
v_cvt_pk_bf16_f32 v209, v210, v211
v_cvt_pk_bf16_f32 v210, v216, v217
v_cvt_pk_bf16_f32 v211, v218, v219
buffer_store_dwordx4 v[208:211], v1, s[12:15], s29 offen offset:1024 sc0 sc1
v_mov_b64 v[216:217], 0
v_mov_b64 v[218:219], 0
v_mov_b64 v[208:209], 0
v_mov_b64 v[210:211], 0
v_cvt_pk_bf16_f32 v224, v224, v225
v_cvt_pk_bf16_f32 v225, v226, v227
v_cvt_pk_bf16_f32 v226, v232, v233
v_cvt_pk_bf16_f32 v227, v234, v235
buffer_store_dwordx4 v[224:227], v1, s[12:15], s29 offen offset:2048 sc0 sc1
v_mov_b64 v[232:233], 0
v_mov_b64 v[234:235], 0
v_mov_b64 v[224:225], 0
v_mov_b64 v[226:227], 0
v_cvt_pk_bf16_f32 v240, v240, v241
v_cvt_pk_bf16_f32 v241, v242, v243
v_cvt_pk_bf16_f32 v242, v248, v249
v_cvt_pk_bf16_f32 v243, v250, v251
buffer_store_dwordx4 v[240:243], v1, s[12:15], s29 offen offset:3072 sc0 sc1
v_mov_b64 v[248:249], 0
v_mov_b64 v[250:251], 0
v_mov_b64 v[240:241], 0
v_mov_b64 v[242:243], 0
s_add_u32 s29, s70, 8192
v_cvt_pk_bf16_f32 v132, v132, v133
v_cvt_pk_bf16_f32 v133, v134, v135
v_cvt_pk_bf16_f32 v134, v140, v141
v_cvt_pk_bf16_f32 v135, v142, v143
buffer_store_dwordx4 v[132:135], v1, s[12:15], s29 offen offset:0 sc0 sc1
v_mov_b64 v[140:141], 0
v_mov_b64 v[142:143], 0
v_mov_b64 v[132:133], 0
v_mov_b64 v[134:135], 0
v_cvt_pk_bf16_f32 v148, v148, v149
v_cvt_pk_bf16_f32 v149, v150, v151
v_cvt_pk_bf16_f32 v150, v156, v157
v_cvt_pk_bf16_f32 v151, v158, v159
buffer_store_dwordx4 v[148:151], v1, s[12:15], s29 offen offset:1024 sc0 sc1
v_mov_b64 v[156:157], 0
v_mov_b64 v[158:159], 0
v_mov_b64 v[148:149], 0
v_mov_b64 v[150:151], 0
v_cvt_pk_bf16_f32 v164, v164, v165
v_cvt_pk_bf16_f32 v165, v166, v167
v_cvt_pk_bf16_f32 v166, v172, v173
v_cvt_pk_bf16_f32 v167, v174, v175
buffer_store_dwordx4 v[164:167], v1, s[12:15], s29 offen offset:2048 sc0 sc1
v_mov_b64 v[172:173], 0
v_mov_b64 v[174:175], 0
v_mov_b64 v[164:165], 0
v_mov_b64 v[166:167], 0
v_cvt_pk_bf16_f32 v180, v180, v181
v_cvt_pk_bf16_f32 v181, v182, v183
v_cvt_pk_bf16_f32 v182, v188, v189
v_cvt_pk_bf16_f32 v183, v190, v191
buffer_store_dwordx4 v[180:183], v1, s[12:15], s29 offen offset:3072 sc0 sc1
v_mov_b64 v[188:189], 0
v_mov_b64 v[190:191], 0
v_mov_b64 v[180:181], 0
v_mov_b64 v[182:183], 0
s_add_u32 s29, s70, 12288
v_cvt_pk_bf16_f32 v196, v196, v197
v_cvt_pk_bf16_f32 v197, v198, v199
v_cvt_pk_bf16_f32 v198, v204, v205
v_cvt_pk_bf16_f32 v199, v206, v207
buffer_store_dwordx4 v[196:199], v1, s[12:15], s29 offen offset:0 sc0 sc1
v_mov_b64 v[204:205], 0
v_mov_b64 v[206:207], 0
v_mov_b64 v[196:197], 0
v_mov_b64 v[198:199], 0
v_cvt_pk_bf16_f32 v212, v212, v213
v_cvt_pk_bf16_f32 v213, v214, v215
v_cvt_pk_bf16_f32 v214, v220, v221
v_cvt_pk_bf16_f32 v215, v222, v223
buffer_store_dwordx4 v[212:215], v1, s[12:15], s29 offen offset:1024 sc0 sc1
v_mov_b64 v[220:221], 0
v_mov_b64 v[222:223], 0
v_mov_b64 v[212:213], 0
v_mov_b64 v[214:215], 0
v_cvt_pk_bf16_f32 v228, v228, v229
v_cvt_pk_bf16_f32 v229, v230, v231
v_cvt_pk_bf16_f32 v230, v236, v237
v_cvt_pk_bf16_f32 v231, v238, v239
buffer_store_dwordx4 v[228:231], v1, s[12:15], s29 offen offset:2048 sc0 sc1
v_mov_b64 v[236:237], 0
v_mov_b64 v[238:239], 0
v_mov_b64 v[228:229], 0
v_mov_b64 v[230:231], 0
v_cvt_pk_bf16_f32 v244, v244, v245
v_cvt_pk_bf16_f32 v245, v246, v247
v_cvt_pk_bf16_f32 v246, v252, v253
v_cvt_pk_bf16_f32 v247, v254, v255
buffer_store_dwordx4 v[244:247], v1, s[12:15], s29 offen offset:3072 sc0 sc1
v_mov_b64 v[252:253], 0
v_mov_b64 v[254:255], 0
v_mov_b64 v[244:245], 0
v_mov_b64 v[246:247], 0
s_add_u32 s29, s70, 16384
buffer_store_dwordx4 v[20:23], v1, s[12:15], s29 offen sc0 sc1
s_mov_b32 s67, s66
s_setpc_b64 s[46:47]
L_k2_x:
s_nop 4
v_mov_b32 v20, v6
v_add_f32 v22, v8, v10
v_mov_b32 v8, 0
v_mov_b32 v10, 0
v_max3_f32 v6, v64, v65, v66
v_max3_f32 v6, v6, v67, v72
v_max3_f32 v6, v6, v73, v74
v_max3_f32 v6, v6, v75, v80
v_max3_f32 v6, v6, v81, v82
v_max3_f32 v6, v6, v83, v88
v_max3_f32 v6, v6, v89, v90
v_max_f32 v6, v6, v91
v_mov_b32 v14, v6
s_nop 1
v_permlane16_swap_b32 v6, v14
s_nop 1
v_max_f32 v6, v6, v14
v_mov_b32 v14, v6
s_nop 1
v_permlane32_swap_b32 v6, v14
s_nop 1
v_max_f32 v6, v6, v14
v_mul_f32 v6, s27, v6
v_mov_b32 v21, v7
v_add_f32 v23, v9, v11
v_mov_b32 v9, 0
v_mov_b32 v11, 0
v_max3_f32 v7, v68, v69, v70
v_max3_f32 v7, v7, v71, v76
v_max3_f32 v7, v7, v77, v78
v_max3_f32 v7, v7, v79, v84
v_max3_f32 v7, v7, v85, v86
v_max3_f32 v7, v7, v87, v92
v_max3_f32 v7, v7, v93, v94
v_max_f32 v7, v7, v95
v_mov_b32 v14, v7
s_nop 1
v_permlane16_swap_b32 v7, v14
s_nop 1
v_max_f32 v7, v7, v14
v_mov_b32 v14, v7
s_nop 1
v_permlane32_swap_b32 v7, v14
s_nop 1
v_max_f32 v7, v7, v14
v_mul_f32 v7, s27, v7
s_setpc_b64 s[46:47]
L_k2_pub:
s_barrier
s_cmp_eq_u32 s16, 0
s_cbranch_scc0 L_sig20
s_lshl_b32 s29, s2, 8
s_add_u32 s29, s29, 82903048
v_mov_b32 v14, 1
v_mov_b32 v15, 0
s_mov_b64 exec, 1
buffer_store_dword v14, v15, s[12:15], s29 offen sc0 sc1
s_mov_b64 exec, -1
L_sig20:
s_setpc_b64 s[46:47]
L_k2_slow0:
s_nop 7
v_max3_f32 v14, v32, v33, v34
v_max3_f32 v14, v14, v35, v40
v_max3_f32 v14, v14, v41, v42
v_max3_f32 v14, v14, v43, v48
v_max3_f32 v14, v14, v49, v50
v_max3_f32 v14, v14, v51, v56
v_max3_f32 v14, v14, v57, v58
v_max_f32 v14, v14, v59
v_mov_b32 v15, v14
s_nop 1
v_permlane16_swap_b32 v14, v15
s_nop 1
v_max_f32 v14, v14, v15
v_mov_b32 v15, v14
s_nop 1
v_permlane32_swap_b32 v14, v15
s_nop 1
v_max_f32 v14, v14, v15
v_mul_f32 v14, s27, v14
v_max_f32 v14, v14, v6
v_sub_f32 v15, v6, v14
v_exp_f32 v15, v15
v_mov_b32 v6, v14
v_mul_f32 v8, v8, v15
v_pk_mul_f32 v[128:129], v[128:129], v[14:15] op_sel:[0,1] op_sel_hi:[1,1]
v_pk_mul_f32 v[130:131], v[130:131], v[14:15] op_sel:[0,1] op_sel_hi:[1,1]
v_pk_mul_f32 v[136:137], v[136:137], v[14:15] op_sel:[0,1] op_sel_hi:[1,1]
v_pk_mul_f32 v[138:139], v[138:139], v[14:15] op_sel:[0,1] op_sel_hi:[1,1]
v_pk_mul_f32 v[144:145], v[144:145], v[14:15] op_sel:[0,1] op_sel_hi:[1,1]
v_pk_mul_f32 v[146:147], v[146:147], v[14:15] op_sel:[0,1] op_sel_hi:[1,1]
v_pk_mul_f32 v[152:153], v[152:153], v[14:15] op_sel:[0,1] op_sel_hi:[1,1]
v_pk_mul_f32 v[154:155], v[154:155], v[14:15] op_sel:[0,1] op_sel_hi:[1,1]
v_pk_mul_f32 v[160:161], v[160:161], v[14:15] op_sel:[0,1] op_sel_hi:[1,1]
v_pk_mul_f32 v[162:163], v[162:163], v[14:15] op_sel:[0,1] op_sel_hi:[1,1]
v_pk_mul_f32 v[168:169], v[168:169], v[14:15] op_sel:[0,1] op_sel_hi:[1,1]
v_pk_mul_f32 v[170:171], v[170:171], v[14:15] op_sel:[0,1] op_sel_hi:[1,1]
v_pk_mul_f32 v[176:177], v[176:177], v[14:15] op_sel:[0,1] op_sel_hi:[1,1]
v_pk_mul_f32 v[178:179], v[178:179], v[14:15] op_sel:[0,1] op_sel_hi:[1,1]
v_pk_mul_f32 v[184:185], v[184:185], v[14:15] op_sel:[0,1] op_sel_hi:[1,1]
v_pk_mul_f32 v[186:187], v[186:187], v[14:15] op_sel:[0,1] op_sel_hi:[1,1]
v_pk_mul_f32 v[192:193], v[192:193], v[14:15] op_sel:[0,1] op_sel_hi:[1,1]
v_pk_mul_f32 v[194:195], v[194:195], v[14:15] op_sel:[0,1] op_sel_hi:[1,1]
v_pk_mul_f32 v[200:201], v[200:201], v[14:15] op_sel:[0,1] op_sel_hi:[1,1]
v_pk_mul_f32 v[202:203], v[202:203], v[14:15] op_sel:[0,1] op_sel_hi:[1,1]
v_pk_mul_f32 v[208:209], v[208:209], v[14:15] op_sel:[0,1] op_sel_hi:[1,1]
v_pk_mul_f32 v[210:211], v[210:211], v[14:15] op_sel:[0,1] op_sel_hi:[1,1]
v_pk_mul_f32 v[216:217], v[216:217], v[14:15] op_sel:[0,1] op_sel_hi:[1,1]
v_pk_mul_f32 v[218:219], v[218:219], v[14:15] op_sel:[0,1] op_sel_hi:[1,1]
v_pk_mul_f32 v[224:225], v[224:225], v[14:15] op_sel:[0,1] op_sel_hi:[1,1]
v_pk_mul_f32 v[226:227], v[226:227], v[14:15] op_sel:[0,1] op_sel_hi:[1,1]
v_pk_mul_f32 v[232:233], v[232:233], v[14:15] op_sel:[0,1] op_sel_hi:[1,1]
v_pk_mul_f32 v[234:235], v[234:235], v[14:15] op_sel:[0,1] op_sel_hi:[1,1]
v_pk_mul_f32 v[240:241], v[240:241], v[14:15] op_sel:[0,1] op_sel_hi:[1,1]
v_pk_mul_f32 v[242:243], v[242:243], v[14:15] op_sel:[0,1] op_sel_hi:[1,1]
v_pk_mul_f32 v[248:249], v[248:249], v[14:15] op_sel:[0,1] op_sel_hi:[1,1]
v_pk_mul_f32 v[250:251], v[250:251], v[14:15] op_sel:[0,1] op_sel_hi:[1,1]
v_max3_f32 v14, v36, v37, v38
v_max3_f32 v14, v14, v39, v44
v_max3_f32 v14, v14, v45, v46
v_max3_f32 v14, v14, v47, v52
v_max3_f32 v14, v14, v53, v54
v_max3_f32 v14, v14, v55, v60
v_max3_f32 v14, v14, v61, v62
v_max_f32 v14, v14, v63
v_mov_b32 v15, v14
s_nop 1
v_permlane16_swap_b32 v14, v15
s_nop 1
v_max_f32 v14, v14, v15
v_mov_b32 v15, v14
s_nop 1
v_permlane32_swap_b32 v14, v15
s_nop 1
v_max_f32 v14, v14, v15
v_mul_f32 v14, s27, v14
v_max_f32 v14, v14, v7
v_sub_f32 v15, v7, v14
v_exp_f32 v15, v15
v_mov_b32 v7, v14
v_mul_f32 v9, v9, v15
v_pk_mul_f32 v[132:133], v[132:133], v[14:15] op_sel:[0,1] op_sel_hi:[1,1]
v_pk_mul_f32 v[134:135], v[134:135], v[14:15] op_sel:[0,1] op_sel_hi:[1,1]
v_pk_mul_f32 v[140:141], v[140:141], v[14:15] op_sel:[0,1] op_sel_hi:[1,1]
v_pk_mul_f32 v[142:143], v[142:143], v[14:15] op_sel:[0,1] op_sel_hi:[1,1]
v_pk_mul_f32 v[148:149], v[148:149], v[14:15] op_sel:[0,1] op_sel_hi:[1,1]
v_pk_mul_f32 v[150:151], v[150:151], v[14:15] op_sel:[0,1] op_sel_hi:[1,1]
v_pk_mul_f32 v[156:157], v[156:157], v[14:15] op_sel:[0,1] op_sel_hi:[1,1]
v_pk_mul_f32 v[158:159], v[158:159], v[14:15] op_sel:[0,1] op_sel_hi:[1,1]
v_pk_mul_f32 v[164:165], v[164:165], v[14:15] op_sel:[0,1] op_sel_hi:[1,1]
v_pk_mul_f32 v[166:167], v[166:167], v[14:15] op_sel:[0,1] op_sel_hi:[1,1]
v_pk_mul_f32 v[172:173], v[172:173], v[14:15] op_sel:[0,1] op_sel_hi:[1,1]
v_pk_mul_f32 v[174:175], v[174:175], v[14:15] op_sel:[0,1] op_sel_hi:[1,1]
v_pk_mul_f32 v[180:181], v[180:181], v[14:15] op_sel:[0,1] op_sel_hi:[1,1]
v_pk_mul_f32 v[182:183], v[182:183], v[14:15] op_sel:[0,1] op_sel_hi:[1,1]
v_pk_mul_f32 v[188:189], v[188:189], v[14:15] op_sel:[0,1] op_sel_hi:[1,1]
v_pk_mul_f32 v[190:191], v[190:191], v[14:15] op_sel:[0,1] op_sel_hi:[1,1]
v_pk_mul_f32 v[196:197], v[196:197], v[14:15] op_sel:[0,1] op_sel_hi:[1,1]
v_pk_mul_f32 v[198:199], v[198:199], v[14:15] op_sel:[0,1] op_sel_hi:[1,1]
v_pk_mul_f32 v[204:205], v[204:205], v[14:15] op_sel:[0,1] op_sel_hi:[1,1]
v_pk_mul_f32 v[206:207], v[206:207], v[14:15] op_sel:[0,1] op_sel_hi:[1,1]
v_pk_mul_f32 v[212:213], v[212:213], v[14:15] op_sel:[0,1] op_sel_hi:[1,1]
v_pk_mul_f32 v[214:215], v[214:215], v[14:15] op_sel:[0,1] op_sel_hi:[1,1]
v_pk_mul_f32 v[220:221], v[220:221], v[14:15] op_sel:[0,1] op_sel_hi:[1,1]
v_pk_mul_f32 v[222:223], v[222:223], v[14:15] op_sel:[0,1] op_sel_hi:[1,1]
v_pk_mul_f32 v[228:229], v[228:229], v[14:15] op_sel:[0,1] op_sel_hi:[1,1]
v_pk_mul_f32 v[230:231], v[230:231], v[14:15] op_sel:[0,1] op_sel_hi:[1,1]
v_pk_mul_f32 v[236:237], v[236:237], v[14:15] op_sel:[0,1] op_sel_hi:[1,1]
v_pk_mul_f32 v[238:239], v[238:239], v[14:15] op_sel:[0,1] op_sel_hi:[1,1]
v_pk_mul_f32 v[244:245], v[244:245], v[14:15] op_sel:[0,1] op_sel_hi:[1,1]
v_pk_mul_f32 v[246:247], v[246:247], v[14:15] op_sel:[0,1] op_sel_hi:[1,1]
v_pk_mul_f32 v[252:253], v[252:253], v[14:15] op_sel:[0,1] op_sel_hi:[1,1]
v_pk_mul_f32 v[254:255], v[254:255], v[14:15] op_sel:[0,1] op_sel_hi:[1,1]
v_fma_f32 v16, v32, s27, -v6
v_fma_f32 v17, v33, s27, -v6
v_fma_f32 v18, v34, s27, -v6
v_fma_f32 v19, v35, s27, -v6
v_exp_f32 v16, v16
v_exp_f32 v17, v17
v_exp_f32 v18, v18
v_exp_f32 v19, v19
v_mov_b32 v10, v16
v_add_f32 v10, v10, v17
v_cvt_pk_bf16_f32 v96, v16, v17
v_add_f32 v10, v10, v18
v_add_f32 v10, v10, v19
v_cvt_pk_bf16_f32 v97, v18, v19
v_fma_f32 v16, v36, s27, -v7
v_fma_f32 v17, v37, s27, -v7
v_fma_f32 v18, v38, s27, -v7
v_fma_f32 v19, v39, s27, -v7
v_exp_f32 v16, v16
v_exp_f32 v17, v17
v_exp_f32 v18, v18
v_exp_f32 v19, v19
v_mov_b32 v11, v16
v_add_f32 v11, v11, v17
v_cvt_pk_bf16_f32 v100, v16, v17
v_add_f32 v11, v11, v18
v_add_f32 v11, v11, v19
v_cvt_pk_bf16_f32 v101, v18, v19
v_fma_f32 v16, v40, s27, -v6
v_fma_f32 v17, v41, s27, -v6
v_fma_f32 v18, v42, s27, -v6
v_fma_f32 v19, v43, s27, -v6
v_exp_f32 v16, v16
v_exp_f32 v17, v17
v_exp_f32 v18, v18
v_exp_f32 v19, v19
v_add_f32 v10, v10, v16
v_add_f32 v10, v10, v17
v_cvt_pk_bf16_f32 v98, v16, v17
v_add_f32 v10, v10, v18
v_add_f32 v10, v10, v19
v_cvt_pk_bf16_f32 v99, v18, v19
v_fma_f32 v16, v44, s27, -v7
v_fma_f32 v17, v45, s27, -v7
v_fma_f32 v18, v46, s27, -v7
v_fma_f32 v19, v47, s27, -v7
v_exp_f32 v16, v16
v_exp_f32 v17, v17
v_exp_f32 v18, v18
v_exp_f32 v19, v19
v_add_f32 v11, v11, v16
v_add_f32 v11, v11, v17
v_cvt_pk_bf16_f32 v102, v16, v17
v_add_f32 v11, v11, v18
v_add_f32 v11, v11, v19
v_cvt_pk_bf16_f32 v103, v18, v19
v_fma_f32 v24, v48, s27, -v6
v_fma_f32 v25, v49, s27, -v6
v_fma_f32 v18, v50, s27, -v6
v_fma_f32 v19, v51, s27, -v6
v_exp_f32 v24, v24
v_exp_f32 v25, v25
v_exp_f32 v18, v18
v_exp_f32 v19, v19
v_add_f32 v10, v10, v24
v_add_f32 v10, v10, v25
v_cvt_pk_bf16_f32 v104, v24, v25
v_add_f32 v10, v10, v18
v_add_f32 v10, v10, v19
v_cvt_pk_bf16_f32 v105, v18, v19
v_fma_f32 v16, v52, s27, -v7
v_fma_f32 v17, v53, s27, -v7
v_fma_f32 v18, v54, s27, -v7
v_fma_f32 v19, v55, s27, -v7
v_exp_f32 v16, v16
v_exp_f32 v17, v17
v_exp_f32 v18, v18
v_exp_f32 v19, v19
v_add_f32 v11, v11, v16
v_add_f32 v11, v11, v17
v_cvt_pk_bf16_f32 v108, v16, v17
v_add_f32 v11, v11, v18
v_add_f32 v11, v11, v19
v_cvt_pk_bf16_f32 v109, v18, v19
v_fma_f32 v16, v56, s27, -v6
v_fma_f32 v17, v57, s27, -v6
v_fma_f32 v18, v58, s27, -v6
v_fma_f32 v19, v59, s27, -v6
v_exp_f32 v16, v16
v_exp_f32 v17, v17
v_exp_f32 v18, v18
v_exp_f32 v19, v19
v_add_f32 v10, v10, v16
v_add_f32 v10, v10, v17
v_cvt_pk_bf16_f32 v106, v16, v17
v_add_f32 v10, v10, v18
v_add_f32 v10, v10, v19
v_cvt_pk_bf16_f32 v107, v18, v19
v_fma_f32 v16, v60, s27, -v7
v_fma_f32 v17, v61, s27, -v7
v_fma_f32 v18, v62, s27, -v7
v_fma_f32 v19, v63, s27, -v7
v_exp_f32 v16, v16
v_exp_f32 v17, v17
v_exp_f32 v18, v18
v_exp_f32 v19, v19
v_add_f32 v11, v11, v16
v_add_f32 v11, v11, v17
v_cvt_pk_bf16_f32 v110, v16, v17
v_add_f32 v11, v11, v18
v_add_f32 v11, v11, v19
v_cvt_pk_bf16_f32 v111, v18, v19
s_nop 1
s_setpc_b64 s[46:47]
L_k2_slow1:
s_nop 7
v_max3_f32 v14, v64, v65, v66
v_max3_f32 v14, v14, v67, v72
v_max3_f32 v14, v14, v73, v74
v_max3_f32 v14, v14, v75, v80
v_max3_f32 v14, v14, v81, v82
v_max3_f32 v14, v14, v83, v88
v_max3_f32 v14, v14, v89, v90
v_max_f32 v14, v14, v91
v_mov_b32 v15, v14
s_nop 1
v_permlane16_swap_b32 v14, v15
s_nop 1
v_max_f32 v14, v14, v15
v_mov_b32 v15, v14
s_nop 1
v_permlane32_swap_b32 v14, v15
s_nop 1
v_max_f32 v14, v14, v15
v_mul_f32 v14, s27, v14
v_max_f32 v14, v14, v6
v_sub_f32 v15, v6, v14
v_exp_f32 v15, v15
v_mov_b32 v6, v14
v_mul_f32 v8, v8, v15
v_pk_mul_f32 v[128:129], v[128:129], v[14:15] op_sel:[0,1] op_sel_hi:[1,1]
v_pk_mul_f32 v[130:131], v[130:131], v[14:15] op_sel:[0,1] op_sel_hi:[1,1]
v_pk_mul_f32 v[136:137], v[136:137], v[14:15] op_sel:[0,1] op_sel_hi:[1,1]
v_pk_mul_f32 v[138:139], v[138:139], v[14:15] op_sel:[0,1] op_sel_hi:[1,1]
v_pk_mul_f32 v[144:145], v[144:145], v[14:15] op_sel:[0,1] op_sel_hi:[1,1]
v_pk_mul_f32 v[146:147], v[146:147], v[14:15] op_sel:[0,1] op_sel_hi:[1,1]
v_pk_mul_f32 v[152:153], v[152:153], v[14:15] op_sel:[0,1] op_sel_hi:[1,1]
v_pk_mul_f32 v[154:155], v[154:155], v[14:15] op_sel:[0,1] op_sel_hi:[1,1]
v_pk_mul_f32 v[160:161], v[160:161], v[14:15] op_sel:[0,1] op_sel_hi:[1,1]
v_pk_mul_f32 v[162:163], v[162:163], v[14:15] op_sel:[0,1] op_sel_hi:[1,1]
v_pk_mul_f32 v[168:169], v[168:169], v[14:15] op_sel:[0,1] op_sel_hi:[1,1]
v_pk_mul_f32 v[170:171], v[170:171], v[14:15] op_sel:[0,1] op_sel_hi:[1,1]
v_pk_mul_f32 v[176:177], v[176:177], v[14:15] op_sel:[0,1] op_sel_hi:[1,1]
v_pk_mul_f32 v[178:179], v[178:179], v[14:15] op_sel:[0,1] op_sel_hi:[1,1]
v_pk_mul_f32 v[184:185], v[184:185], v[14:15] op_sel:[0,1] op_sel_hi:[1,1]
v_pk_mul_f32 v[186:187], v[186:187], v[14:15] op_sel:[0,1] op_sel_hi:[1,1]
v_pk_mul_f32 v[192:193], v[192:193], v[14:15] op_sel:[0,1] op_sel_hi:[1,1]
v_pk_mul_f32 v[194:195], v[194:195], v[14:15] op_sel:[0,1] op_sel_hi:[1,1]
v_pk_mul_f32 v[200:201], v[200:201], v[14:15] op_sel:[0,1] op_sel_hi:[1,1]
v_pk_mul_f32 v[202:203], v[202:203], v[14:15] op_sel:[0,1] op_sel_hi:[1,1]
v_pk_mul_f32 v[208:209], v[208:209], v[14:15] op_sel:[0,1] op_sel_hi:[1,1]
v_pk_mul_f32 v[210:211], v[210:211], v[14:15] op_sel:[0,1] op_sel_hi:[1,1]
v_pk_mul_f32 v[216:217], v[216:217], v[14:15] op_sel:[0,1] op_sel_hi:[1,1]
v_pk_mul_f32 v[218:219], v[218:219], v[14:15] op_sel:[0,1] op_sel_hi:[1,1]
v_pk_mul_f32 v[224:225], v[224:225], v[14:15] op_sel:[0,1] op_sel_hi:[1,1]
v_pk_mul_f32 v[226:227], v[226:227], v[14:15] op_sel:[0,1] op_sel_hi:[1,1]
v_pk_mul_f32 v[232:233], v[232:233], v[14:15] op_sel:[0,1] op_sel_hi:[1,1]
v_pk_mul_f32 v[234:235], v[234:235], v[14:15] op_sel:[0,1] op_sel_hi:[1,1]
v_pk_mul_f32 v[240:241], v[240:241], v[14:15] op_sel:[0,1] op_sel_hi:[1,1]
v_pk_mul_f32 v[242:243], v[242:243], v[14:15] op_sel:[0,1] op_sel_hi:[1,1]
v_pk_mul_f32 v[248:249], v[248:249], v[14:15] op_sel:[0,1] op_sel_hi:[1,1]
v_pk_mul_f32 v[250:251], v[250:251], v[14:15] op_sel:[0,1] op_sel_hi:[1,1]
v_max3_f32 v14, v68, v69, v70
v_max3_f32 v14, v14, v71, v76
v_max3_f32 v14, v14, v77, v78
v_max3_f32 v14, v14, v79, v84
v_max3_f32 v14, v14, v85, v86
v_max3_f32 v14, v14, v87, v92
v_max3_f32 v14, v14, v93, v94
v_max_f32 v14, v14, v95
v_mov_b32 v15, v14
s_nop 1
v_permlane16_swap_b32 v14, v15
s_nop 1
v_max_f32 v14, v14, v15
v_mov_b32 v15, v14
s_nop 1
v_permlane32_swap_b32 v14, v15
s_nop 1
v_max_f32 v14, v14, v15
v_mul_f32 v14, s27, v14
v_max_f32 v14, v14, v7
v_sub_f32 v15, v7, v14
v_exp_f32 v15, v15
v_mov_b32 v7, v14
v_mul_f32 v9, v9, v15
v_pk_mul_f32 v[132:133], v[132:133], v[14:15] op_sel:[0,1] op_sel_hi:[1,1]
v_pk_mul_f32 v[134:135], v[134:135], v[14:15] op_sel:[0,1] op_sel_hi:[1,1]
v_pk_mul_f32 v[140:141], v[140:141], v[14:15] op_sel:[0,1] op_sel_hi:[1,1]
v_pk_mul_f32 v[142:143], v[142:143], v[14:15] op_sel:[0,1] op_sel_hi:[1,1]
v_pk_mul_f32 v[148:149], v[148:149], v[14:15] op_sel:[0,1] op_sel_hi:[1,1]
v_pk_mul_f32 v[150:151], v[150:151], v[14:15] op_sel:[0,1] op_sel_hi:[1,1]
v_pk_mul_f32 v[156:157], v[156:157], v[14:15] op_sel:[0,1] op_sel_hi:[1,1]
v_pk_mul_f32 v[158:159], v[158:159], v[14:15] op_sel:[0,1] op_sel_hi:[1,1]
v_pk_mul_f32 v[164:165], v[164:165], v[14:15] op_sel:[0,1] op_sel_hi:[1,1]
v_pk_mul_f32 v[166:167], v[166:167], v[14:15] op_sel:[0,1] op_sel_hi:[1,1]
v_pk_mul_f32 v[172:173], v[172:173], v[14:15] op_sel:[0,1] op_sel_hi:[1,1]
v_pk_mul_f32 v[174:175], v[174:175], v[14:15] op_sel:[0,1] op_sel_hi:[1,1]
v_pk_mul_f32 v[180:181], v[180:181], v[14:15] op_sel:[0,1] op_sel_hi:[1,1]
v_pk_mul_f32 v[182:183], v[182:183], v[14:15] op_sel:[0,1] op_sel_hi:[1,1]
v_pk_mul_f32 v[188:189], v[188:189], v[14:15] op_sel:[0,1] op_sel_hi:[1,1]
v_pk_mul_f32 v[190:191], v[190:191], v[14:15] op_sel:[0,1] op_sel_hi:[1,1]
v_pk_mul_f32 v[196:197], v[196:197], v[14:15] op_sel:[0,1] op_sel_hi:[1,1]
v_pk_mul_f32 v[198:199], v[198:199], v[14:15] op_sel:[0,1] op_sel_hi:[1,1]
v_pk_mul_f32 v[204:205], v[204:205], v[14:15] op_sel:[0,1] op_sel_hi:[1,1]
v_pk_mul_f32 v[206:207], v[206:207], v[14:15] op_sel:[0,1] op_sel_hi:[1,1]
v_pk_mul_f32 v[212:213], v[212:213], v[14:15] op_sel:[0,1] op_sel_hi:[1,1]
v_pk_mul_f32 v[214:215], v[214:215], v[14:15] op_sel:[0,1] op_sel_hi:[1,1]
v_pk_mul_f32 v[220:221], v[220:221], v[14:15] op_sel:[0,1] op_sel_hi:[1,1]
v_pk_mul_f32 v[222:223], v[222:223], v[14:15] op_sel:[0,1] op_sel_hi:[1,1]
v_pk_mul_f32 v[228:229], v[228:229], v[14:15] op_sel:[0,1] op_sel_hi:[1,1]
v_pk_mul_f32 v[230:231], v[230:231], v[14:15] op_sel:[0,1] op_sel_hi:[1,1]
v_pk_mul_f32 v[236:237], v[236:237], v[14:15] op_sel:[0,1] op_sel_hi:[1,1]
v_pk_mul_f32 v[238:239], v[238:239], v[14:15] op_sel:[0,1] op_sel_hi:[1,1]
v_pk_mul_f32 v[244:245], v[244:245], v[14:15] op_sel:[0,1] op_sel_hi:[1,1]
v_pk_mul_f32 v[246:247], v[246:247], v[14:15] op_sel:[0,1] op_sel_hi:[1,1]
v_pk_mul_f32 v[252:253], v[252:253], v[14:15] op_sel:[0,1] op_sel_hi:[1,1]
v_pk_mul_f32 v[254:255], v[254:255], v[14:15] op_sel:[0,1] op_sel_hi:[1,1]
v_fma_f32 v16, v64, s27, -v6
v_fma_f32 v17, v65, s27, -v6
v_fma_f32 v18, v66, s27, -v6
v_fma_f32 v19, v67, s27, -v6
v_exp_f32 v16, v16
v_exp_f32 v17, v17
v_exp_f32 v18, v18
v_exp_f32 v19, v19
v_mov_b32 v12, v16
v_add_f32 v12, v12, v17
v_cvt_pk_bf16_f32 v112, v16, v17
v_add_f32 v12, v12, v18
v_add_f32 v12, v12, v19
v_cvt_pk_bf16_f32 v113, v18, v19
v_fma_f32 v16, v68, s27, -v7
v_fma_f32 v17, v69, s27, -v7
v_fma_f32 v18, v70, s27, -v7
v_fma_f32 v19, v71, s27, -v7
v_exp_f32 v16, v16
v_exp_f32 v17, v17
v_exp_f32 v18, v18
v_exp_f32 v19, v19
v_mov_b32 v13, v16
v_add_f32 v13, v13, v17
v_cvt_pk_bf16_f32 v116, v16, v17
v_add_f32 v13, v13, v18
v_add_f32 v13, v13, v19
v_cvt_pk_bf16_f32 v117, v18, v19
v_fma_f32 v16, v72, s27, -v6
v_fma_f32 v17, v73, s27, -v6
v_fma_f32 v18, v74, s27, -v6
v_fma_f32 v19, v75, s27, -v6
v_exp_f32 v16, v16
v_exp_f32 v17, v17
v_exp_f32 v18, v18
v_exp_f32 v19, v19
v_add_f32 v12, v12, v16
v_add_f32 v12, v12, v17
v_cvt_pk_bf16_f32 v114, v16, v17
v_add_f32 v12, v12, v18
v_add_f32 v12, v12, v19
v_cvt_pk_bf16_f32 v115, v18, v19
v_fma_f32 v16, v76, s27, -v7
v_fma_f32 v17, v77, s27, -v7
v_fma_f32 v18, v78, s27, -v7
v_fma_f32 v19, v79, s27, -v7
v_exp_f32 v16, v16
v_exp_f32 v17, v17
v_exp_f32 v18, v18
v_exp_f32 v19, v19
v_add_f32 v13, v13, v16
v_add_f32 v13, v13, v17
v_cvt_pk_bf16_f32 v118, v16, v17
v_add_f32 v13, v13, v18
v_add_f32 v13, v13, v19
v_cvt_pk_bf16_f32 v119, v18, v19
v_fma_f32 v24, v80, s27, -v6
v_fma_f32 v25, v81, s27, -v6
v_fma_f32 v18, v82, s27, -v6
v_fma_f32 v19, v83, s27, -v6
v_exp_f32 v24, v24
v_exp_f32 v25, v25
v_exp_f32 v18, v18
v_exp_f32 v19, v19
v_add_f32 v12, v12, v24
v_add_f32 v12, v12, v25
v_cvt_pk_bf16_f32 v120, v24, v25
v_add_f32 v12, v12, v18
v_add_f32 v12, v12, v19
v_cvt_pk_bf16_f32 v121, v18, v19
v_fma_f32 v16, v84, s27, -v7
v_fma_f32 v17, v85, s27, -v7
v_fma_f32 v18, v86, s27, -v7
v_fma_f32 v19, v87, s27, -v7
v_exp_f32 v16, v16
v_exp_f32 v17, v17
v_exp_f32 v18, v18
v_exp_f32 v19, v19
v_add_f32 v13, v13, v16
v_add_f32 v13, v13, v17
v_cvt_pk_bf16_f32 v124, v16, v17
v_add_f32 v13, v13, v18
v_add_f32 v13, v13, v19
v_cvt_pk_bf16_f32 v125, v18, v19
v_fma_f32 v16, v88, s27, -v6
v_fma_f32 v17, v89, s27, -v6
v_fma_f32 v18, v90, s27, -v6
v_fma_f32 v19, v91, s27, -v6
v_exp_f32 v16, v16
v_exp_f32 v17, v17
v_exp_f32 v18, v18
v_exp_f32 v19, v19
v_add_f32 v12, v12, v16
v_add_f32 v12, v12, v17
v_cvt_pk_bf16_f32 v122, v16, v17
v_add_f32 v12, v12, v18
v_add_f32 v12, v12, v19
v_cvt_pk_bf16_f32 v123, v18, v19
v_fma_f32 v16, v92, s27, -v7
v_fma_f32 v17, v93, s27, -v7
v_fma_f32 v18, v94, s27, -v7
v_fma_f32 v19, v95, s27, -v7
v_exp_f32 v16, v16
v_exp_f32 v17, v17
v_exp_f32 v18, v18
v_exp_f32 v19, v19
v_add_f32 v13, v13, v16
v_add_f32 v13, v13, v17
v_cvt_pk_bf16_f32 v126, v16, v17
v_add_f32 v13, v13, v18
v_add_f32 v13, v13, v19
v_cvt_pk_bf16_f32 v127, v18, v19
s_nop 1
s_setpc_b64 s[46:47]
L_k2_slowl:
s_nop 7
v_max3_f32 v14, v36, v37, v38
v_max3_f32 v14, v14, v39, v44
v_max3_f32 v14, v14, v45, v46
v_max3_f32 v14, v14, v47, v52
v_max3_f32 v14, v14, v53, v54
v_max3_f32 v14, v14, v55, v60
v_max3_f32 v14, v14, v61, v62
v_max_f32 v14, v14, v63
v_mov_b32 v15, v14
s_nop 1
v_permlane16_swap_b32 v14, v15
s_nop 1
v_max_f32 v14, v14, v15
v_mov_b32 v15, v14
s_nop 1
v_permlane32_swap_b32 v14, v15
s_nop 1
v_max_f32 v14, v14, v15
v_mul_f32 v14, s27, v14
v_max_f32 v14, v14, v7
v_sub_f32 v15, v7, v14
v_exp_f32 v15, v15
v_mov_b32 v7, v14
v_mul_f32 v9, v9, v15
v_pk_mul_f32 v[132:133], v[132:133], v[14:15] op_sel:[0,1] op_sel_hi:[1,1]
v_pk_mul_f32 v[134:135], v[134:135], v[14:15] op_sel:[0,1] op_sel_hi:[1,1]
v_pk_mul_f32 v[140:141], v[140:141], v[14:15] op_sel:[0,1] op_sel_hi:[1,1]
v_pk_mul_f32 v[142:143], v[142:143], v[14:15] op_sel:[0,1] op_sel_hi:[1,1]
v_pk_mul_f32 v[148:149], v[148:149], v[14:15] op_sel:[0,1] op_sel_hi:[1,1]
v_pk_mul_f32 v[150:151], v[150:151], v[14:15] op_sel:[0,1] op_sel_hi:[1,1]
v_pk_mul_f32 v[156:157], v[156:157], v[14:15] op_sel:[0,1] op_sel_hi:[1,1]
v_pk_mul_f32 v[158:159], v[158:159], v[14:15] op_sel:[0,1] op_sel_hi:[1,1]
v_pk_mul_f32 v[164:165], v[164:165], v[14:15] op_sel:[0,1] op_sel_hi:[1,1]
v_pk_mul_f32 v[166:167], v[166:167], v[14:15] op_sel:[0,1] op_sel_hi:[1,1]
v_pk_mul_f32 v[172:173], v[172:173], v[14:15] op_sel:[0,1] op_sel_hi:[1,1]
v_pk_mul_f32 v[174:175], v[174:175], v[14:15] op_sel:[0,1] op_sel_hi:[1,1]
v_pk_mul_f32 v[180:181], v[180:181], v[14:15] op_sel:[0,1] op_sel_hi:[1,1]
v_pk_mul_f32 v[182:183], v[182:183], v[14:15] op_sel:[0,1] op_sel_hi:[1,1]
v_pk_mul_f32 v[188:189], v[188:189], v[14:15] op_sel:[0,1] op_sel_hi:[1,1]
v_pk_mul_f32 v[190:191], v[190:191], v[14:15] op_sel:[0,1] op_sel_hi:[1,1]
v_pk_mul_f32 v[196:197], v[196:197], v[14:15] op_sel:[0,1] op_sel_hi:[1,1]
v_pk_mul_f32 v[198:199], v[198:199], v[14:15] op_sel:[0,1] op_sel_hi:[1,1]
v_pk_mul_f32 v[204:205], v[204:205], v[14:15] op_sel:[0,1] op_sel_hi:[1,1]
v_pk_mul_f32 v[206:207], v[206:207], v[14:15] op_sel:[0,1] op_sel_hi:[1,1]
v_pk_mul_f32 v[212:213], v[212:213], v[14:15] op_sel:[0,1] op_sel_hi:[1,1]
v_pk_mul_f32 v[214:215], v[214:215], v[14:15] op_sel:[0,1] op_sel_hi:[1,1]
v_pk_mul_f32 v[220:221], v[220:221], v[14:15] op_sel:[0,1] op_sel_hi:[1,1]
v_pk_mul_f32 v[222:223], v[222:223], v[14:15] op_sel:[0,1] op_sel_hi:[1,1]
v_pk_mul_f32 v[228:229], v[228:229], v[14:15] op_sel:[0,1] op_sel_hi:[1,1]
v_pk_mul_f32 v[230:231], v[230:231], v[14:15] op_sel:[0,1] op_sel_hi:[1,1]
v_pk_mul_f32 v[236:237], v[236:237], v[14:15] op_sel:[0,1] op_sel_hi:[1,1]
v_pk_mul_f32 v[238:239], v[238:239], v[14:15] op_sel:[0,1] op_sel_hi:[1,1]
v_pk_mul_f32 v[244:245], v[244:245], v[14:15] op_sel:[0,1] op_sel_hi:[1,1]
v_pk_mul_f32 v[246:247], v[246:247], v[14:15] op_sel:[0,1] op_sel_hi:[1,1]
v_pk_mul_f32 v[252:253], v[252:253], v[14:15] op_sel:[0,1] op_sel_hi:[1,1]
v_pk_mul_f32 v[254:255], v[254:255], v[14:15] op_sel:[0,1] op_sel_hi:[1,1]
v_fma_f32 v16, v36, s27, -v7
v_fma_f32 v17, v37, s27, -v7
v_fma_f32 v18, v38, s27, -v7
v_fma_f32 v19, v39, s27, -v7
v_exp_f32 v16, v16
v_exp_f32 v17, v17
v_exp_f32 v18, v18
v_exp_f32 v19, v19
v_mov_b32 v11, v16
v_add_f32 v11, v11, v17
v_cvt_pk_bf16_f32 v100, v16, v17
v_add_f32 v11, v11, v18
v_add_f32 v11, v11, v19
v_cvt_pk_bf16_f32 v101, v18, v19
v_fma_f32 v16, v44, s27, -v7
v_fma_f32 v17, v45, s27, -v7
v_fma_f32 v18, v46, s27, -v7
v_fma_f32 v19, v47, s27, -v7
v_exp_f32 v16, v16
v_exp_f32 v17, v17
v_exp_f32 v18, v18
v_exp_f32 v19, v19
v_add_f32 v11, v11, v16
v_add_f32 v11, v11, v17
v_cvt_pk_bf16_f32 v102, v16, v17
v_add_f32 v11, v11, v18
v_add_f32 v11, v11, v19
v_cvt_pk_bf16_f32 v103, v18, v19
v_fma_f32 v16, v52, s27, -v7
v_fma_f32 v17, v53, s27, -v7
v_fma_f32 v18, v54, s27, -v7
v_fma_f32 v19, v55, s27, -v7
v_exp_f32 v16, v16
v_exp_f32 v17, v17
v_exp_f32 v18, v18
v_exp_f32 v19, v19
v_add_f32 v11, v11, v16
v_add_f32 v11, v11, v17
v_cvt_pk_bf16_f32 v108, v16, v17
v_add_f32 v11, v11, v18
v_add_f32 v11, v11, v19
v_cvt_pk_bf16_f32 v109, v18, v19
v_fma_f32 v16, v60, s27, -v7
v_fma_f32 v17, v61, s27, -v7
v_fma_f32 v18, v62, s27, -v7
v_fma_f32 v19, v63, s27, -v7
v_exp_f32 v16, v16
v_exp_f32 v17, v17
v_exp_f32 v18, v18
v_exp_f32 v19, v19
v_add_f32 v11, v11, v16
v_add_f32 v11, v11, v17
v_cvt_pk_bf16_f32 v110, v16, v17
v_add_f32 v11, v11, v18
v_add_f32 v11, v11, v19
v_cvt_pk_bf16_f32 v111, v18, v19
s_nop 1
s_setpc_b64 s[46:47]
L_pf4041_do:
v_mov_b32 v17, 1
v_mov_b32 v30, 0
s_mov_b64 exec, 1
global_atomic_add v30, v17, s[56:57] sc1
s_mov_b64 exec, -1
s_branch L_pf4041_back
L_pf4159_do:
v_mov_b32 v17, 1
v_mov_b32 v30, 0
s_mov_b64 exec, 1
global_atomic_add v30, v17, s[56:57] sc1
s_mov_b64 exec, -1
s_branch L_pf4159_back
L_pf4287_do:
v_mov_b32 v17, 1
v_mov_b32 v30, 0
s_mov_b64 exec, 1
global_atomic_add v30, v17, s[56:57] sc1
s_mov_b64 exec, -1
s_branch L_pf4287_back
L_pf4409_do:
v_mov_b32 v17, 1
v_mov_b32 v30, 0
s_mov_b64 exec, 1
global_atomic_add v30, v17, s[56:57] sc1
s_mov_b64 exec, -1
s_branch L_pf4409_back
L_pf4534_do:
v_mov_b32 v17, 1
v_mov_b32 v30, 0
s_mov_b64 exec, 1
global_atomic_add v30, v17, s[56:57] sc1
s_mov_b64 exec, -1
s_branch L_pf4534_back
L_pf4653_do:
v_mov_b32 v17, 1
v_mov_b32 v30, 0
s_mov_b64 exec, 1
global_atomic_add v30, v17, s[56:57] sc1
s_mov_b64 exec, -1
s_branch L_pf4653_back
L_k1_side:
s_nop 7
s_add_u32 s30, s28, 0
v_cvt_pk_bf16_f32 v32, v32, v33
v_cvt_pk_bf16_f32 v33, v34, v35
v_cvt_pk_bf16_f32 v34, v36, v37
v_cvt_pk_bf16_f32 v35, v38, v39
buffer_store_dwordx4 v[32:35], v16, s[12:15], s30 offen offset:0 sc0 sc1
v_cvt_pk_bf16_f32 v64, v64, v65
v_cvt_pk_bf16_f32 v65, v66, v67
v_cvt_pk_bf16_f32 v66, v68, v69
v_cvt_pk_bf16_f32 v67, v70, v71
buffer_store_dwordx4 v[64:67], v16, s[12:15], s30 offen offset:1024 sc0 sc1
v_cvt_pk_bf16_f32 v96, v96, v97
v_cvt_pk_bf16_f32 v97, v98, v99
v_cvt_pk_bf16_f32 v98, v100, v101
v_cvt_pk_bf16_f32 v99, v102, v103
buffer_store_dwordx4 v[96:99], v16, s[12:15], s30 offen offset:2048 sc0 sc1
v_cvt_pk_bf16_f32 v128, v128, v129
v_cvt_pk_bf16_f32 v129, v130, v131
v_cvt_pk_bf16_f32 v130, v132, v133
v_cvt_pk_bf16_f32 v131, v134, v135
buffer_store_dwordx4 v[128:131], v16, s[12:15], s30 offen offset:3072 sc0 sc1
s_add_u32 s30, s28, 8192
v_cvt_pk_bf16_f32 v160, v160, v161
v_cvt_pk_bf16_f32 v161, v162, v163
v_cvt_pk_bf16_f32 v162, v164, v165
v_cvt_pk_bf16_f32 v163, v166, v167
buffer_store_dwordx4 v[160:163], v16, s[12:15], s30 offen offset:0 sc0 sc1
v_cvt_pk_bf16_f32 v192, v192, v193
v_cvt_pk_bf16_f32 v193, v194, v195
v_cvt_pk_bf16_f32 v194, v196, v197
v_cvt_pk_bf16_f32 v195, v198, v199
buffer_store_dwordx4 v[192:195], v16, s[12:15], s30 offen offset:1024 sc0 sc1
v_cvt_pk_bf16_f32 v224, v224, v225
v_cvt_pk_bf16_f32 v225, v226, v227
v_cvt_pk_bf16_f32 v226, v228, v229
v_cvt_pk_bf16_f32 v227, v230, v231
buffer_store_dwordx4 v[224:227], v16, s[12:15], s30 offen offset:2048 sc0 sc1
v_accvgpr_read_b32 v36, a128
v_accvgpr_read_b32 v37, a129
v_accvgpr_read_b32 v38, a130
v_accvgpr_read_b32 v39, a131
v_accvgpr_read_b32 v68, a132
v_accvgpr_read_b32 v69, a133
v_accvgpr_read_b32 v70, a134
v_accvgpr_read_b32 v71, a135
v_cvt_pk_bf16_f32 v36, v36, v37
v_cvt_pk_bf16_f32 v37, v38, v39
v_cvt_pk_bf16_f32 v38, v68, v69
v_cvt_pk_bf16_f32 v39, v70, v71
buffer_store_dwordx4 v[36:39], v16, s[12:15], s30 offen offset:3072 sc0 sc1
s_add_u32 s30, s28, 16384
v_cvt_pk_bf16_f32 v40, v40, v41
v_cvt_pk_bf16_f32 v41, v42, v43
v_cvt_pk_bf16_f32 v42, v44, v45
v_cvt_pk_bf16_f32 v43, v46, v47
buffer_store_dwordx4 v[40:43], v16, s[12:15], s30 offen offset:0 sc0 sc1
v_cvt_pk_bf16_f32 v72, v72, v73
v_cvt_pk_bf16_f32 v73, v74, v75
v_cvt_pk_bf16_f32 v74, v76, v77
v_cvt_pk_bf16_f32 v75, v78, v79
buffer_store_dwordx4 v[72:75], v16, s[12:15], s30 offen offset:1024 sc0 sc1
v_cvt_pk_bf16_f32 v104, v104, v105
v_cvt_pk_bf16_f32 v105, v106, v107
v_cvt_pk_bf16_f32 v106, v108, v109
v_cvt_pk_bf16_f32 v107, v110, v111
buffer_store_dwordx4 v[104:107], v16, s[12:15], s30 offen offset:2048 sc0 sc1
v_cvt_pk_bf16_f32 v136, v136, v137
v_cvt_pk_bf16_f32 v137, v138, v139
v_cvt_pk_bf16_f32 v138, v140, v141
v_cvt_pk_bf16_f32 v139, v142, v143
buffer_store_dwordx4 v[136:139], v16, s[12:15], s30 offen offset:3072 sc0 sc1
s_add_u32 s30, s28, 24576
v_cvt_pk_bf16_f32 v168, v168, v169
v_cvt_pk_bf16_f32 v169, v170, v171
v_cvt_pk_bf16_f32 v170, v172, v173
v_cvt_pk_bf16_f32 v171, v174, v175
buffer_store_dwordx4 v[168:171], v16, s[12:15], s30 offen offset:0 sc0 sc1
v_cvt_pk_bf16_f32 v200, v200, v201
v_cvt_pk_bf16_f32 v201, v202, v203
v_cvt_pk_bf16_f32 v202, v204, v205
v_cvt_pk_bf16_f32 v203, v206, v207
buffer_store_dwordx4 v[200:203], v16, s[12:15], s30 offen offset:1024 sc0 sc1
v_cvt_pk_bf16_f32 v232, v232, v233
v_cvt_pk_bf16_f32 v233, v234, v235
v_cvt_pk_bf16_f32 v234, v236, v237
v_cvt_pk_bf16_f32 v235, v238, v239
buffer_store_dwordx4 v[232:235], v16, s[12:15], s30 offen offset:2048 sc0 sc1
v_accvgpr_read_b32 v44, a136
v_accvgpr_read_b32 v45, a137
v_accvgpr_read_b32 v46, a138
v_accvgpr_read_b32 v47, a139
v_accvgpr_read_b32 v76, a140
v_accvgpr_read_b32 v77, a141
v_accvgpr_read_b32 v78, a142
v_accvgpr_read_b32 v79, a143
v_cvt_pk_bf16_f32 v44, v44, v45
v_cvt_pk_bf16_f32 v45, v46, v47
v_cvt_pk_bf16_f32 v46, v76, v77
v_cvt_pk_bf16_f32 v47, v78, v79
buffer_store_dwordx4 v[44:47], v16, s[12:15], s30 offen offset:3072 sc0 sc1
s_add_u32 s30, s28, 32768
v_cvt_pk_bf16_f32 v48, v48, v49
v_cvt_pk_bf16_f32 v49, v50, v51
v_cvt_pk_bf16_f32 v50, v52, v53
v_cvt_pk_bf16_f32 v51, v54, v55
buffer_store_dwordx4 v[48:51], v16, s[12:15], s30 offen offset:0 sc0 sc1
v_cvt_pk_bf16_f32 v80, v80, v81
v_cvt_pk_bf16_f32 v81, v82, v83
v_cvt_pk_bf16_f32 v82, v84, v85
v_cvt_pk_bf16_f32 v83, v86, v87
buffer_store_dwordx4 v[80:83], v16, s[12:15], s30 offen offset:1024 sc0 sc1
v_cvt_pk_bf16_f32 v112, v112, v113
v_cvt_pk_bf16_f32 v113, v114, v115
v_cvt_pk_bf16_f32 v114, v116, v117
v_cvt_pk_bf16_f32 v115, v118, v119
buffer_store_dwordx4 v[112:115], v16, s[12:15], s30 offen offset:2048 sc0 sc1
v_cvt_pk_bf16_f32 v144, v144, v145
v_cvt_pk_bf16_f32 v145, v146, v147
v_cvt_pk_bf16_f32 v146, v148, v149
v_cvt_pk_bf16_f32 v147, v150, v151
buffer_store_dwordx4 v[144:147], v16, s[12:15], s30 offen offset:3072 sc0 sc1
s_add_u32 s30, s28, 40960
v_cvt_pk_bf16_f32 v176, v176, v177
v_cvt_pk_bf16_f32 v177, v178, v179
v_cvt_pk_bf16_f32 v178, v180, v181
v_cvt_pk_bf16_f32 v179, v182, v183
buffer_store_dwordx4 v[176:179], v16, s[12:15], s30 offen offset:0 sc0 sc1
v_cvt_pk_bf16_f32 v208, v208, v209
v_cvt_pk_bf16_f32 v209, v210, v211
v_cvt_pk_bf16_f32 v210, v212, v213
v_cvt_pk_bf16_f32 v211, v214, v215
buffer_store_dwordx4 v[208:211], v16, s[12:15], s30 offen offset:1024 sc0 sc1
v_cvt_pk_bf16_f32 v240, v240, v241
v_cvt_pk_bf16_f32 v241, v242, v243
v_cvt_pk_bf16_f32 v242, v244, v245
v_cvt_pk_bf16_f32 v243, v246, v247
buffer_store_dwordx4 v[240:243], v16, s[12:15], s30 offen offset:2048 sc0 sc1
v_accvgpr_read_b32 v52, a144
v_accvgpr_read_b32 v53, a145
v_accvgpr_read_b32 v54, a146
v_accvgpr_read_b32 v55, a147
v_accvgpr_read_b32 v84, a148
v_accvgpr_read_b32 v85, a149
v_accvgpr_read_b32 v86, a150
v_accvgpr_read_b32 v87, a151
v_cvt_pk_bf16_f32 v52, v52, v53
v_cvt_pk_bf16_f32 v53, v54, v55
v_cvt_pk_bf16_f32 v54, v84, v85
v_cvt_pk_bf16_f32 v55, v86, v87
buffer_store_dwordx4 v[52:55], v16, s[12:15], s30 offen offset:3072 sc0 sc1
s_add_u32 s30, s28, 49152
v_cvt_pk_bf16_f32 v56, v56, v57
v_cvt_pk_bf16_f32 v57, v58, v59
v_cvt_pk_bf16_f32 v58, v60, v61
v_cvt_pk_bf16_f32 v59, v62, v63
buffer_store_dwordx4 v[56:59], v16, s[12:15], s30 offen offset:0 sc0 sc1
v_cvt_pk_bf16_f32 v88, v88, v89
v_cvt_pk_bf16_f32 v89, v90, v91
v_cvt_pk_bf16_f32 v90, v92, v93
v_cvt_pk_bf16_f32 v91, v94, v95
buffer_store_dwordx4 v[88:91], v16, s[12:15], s30 offen offset:1024 sc0 sc1
v_cvt_pk_bf16_f32 v120, v120, v121
v_cvt_pk_bf16_f32 v121, v122, v123
v_cvt_pk_bf16_f32 v122, v124, v125
v_cvt_pk_bf16_f32 v123, v126, v127
buffer_store_dwordx4 v[120:123], v16, s[12:15], s30 offen offset:2048 sc0 sc1
v_cvt_pk_bf16_f32 v152, v152, v153
v_cvt_pk_bf16_f32 v153, v154, v155
v_cvt_pk_bf16_f32 v154, v156, v157
v_cvt_pk_bf16_f32 v155, v158, v159
buffer_store_dwordx4 v[152:155], v16, s[12:15], s30 offen offset:3072 sc0 sc1
s_add_u32 s30, s28, 57344
v_cvt_pk_bf16_f32 v184, v184, v185
v_cvt_pk_bf16_f32 v185, v186, v187
v_cvt_pk_bf16_f32 v186, v188, v189
v_cvt_pk_bf16_f32 v187, v190, v191
buffer_store_dwordx4 v[184:187], v16, s[12:15], s30 offen offset:0 sc0 sc1
v_cvt_pk_bf16_f32 v216, v216, v217
v_cvt_pk_bf16_f32 v217, v218, v219
v_cvt_pk_bf16_f32 v218, v220, v221
v_cvt_pk_bf16_f32 v219, v222, v223
buffer_store_dwordx4 v[216:219], v16, s[12:15], s30 offen offset:1024 sc0 sc1
v_cvt_pk_bf16_f32 v248, v248, v249
v_cvt_pk_bf16_f32 v249, v250, v251
v_cvt_pk_bf16_f32 v250, v252, v253
v_cvt_pk_bf16_f32 v251, v254, v255
buffer_store_dwordx4 v[248:251], v16, s[12:15], s30 offen offset:2048 sc0 sc1
v_accvgpr_read_b32 v60, a152
v_accvgpr_read_b32 v61, a153
v_accvgpr_read_b32 v62, a154
v_accvgpr_read_b32 v63, a155
v_accvgpr_read_b32 v92, a156
v_accvgpr_read_b32 v93, a157
v_accvgpr_read_b32 v94, a158
v_accvgpr_read_b32 v95, a159
v_cvt_pk_bf16_f32 v60, v60, v61
v_cvt_pk_bf16_f32 v61, v62, v63
v_cvt_pk_bf16_f32 v62, v92, v93
v_cvt_pk_bf16_f32 v63, v94, v95
buffer_store_dwordx4 v[60:63], v16, s[12:15], s30 offen offset:3072 sc0 sc1
s_nop 1
s_sub_u32 s74, s70, 14
s_lshl_b32 s74, s74, 3
s_add_u32 s74, s74, s71
s_lshl_b32 s74, s74, 2
s_add_u32 s74, s74, s16
s_mov_b32 s4, s32
s_mov_b32 s5, s33
s_mov_b32 s6, 1835008
s_mov_b32 s8, s52
s_mov_b32 s9, s53
s_mov_b32 s10, 896
v_and_b32 v17, 15, v0
v_mul_u32_u24 v17, 896, v17
v_lshrrev_b32 v18, 4, v0
v_lshlrev_b32 v18, 4, v18
v_add_u32 v17, v17, v18
s_mul_i32 s30, s74, 28672
s_add_u32 s31, s30, 14336
buffer_load_dwordx4 a[0:3], v18, s[8:11], 0 offen offset:0
buffer_load_dwordx4 a[56:59], v17, s[4:7], s30 offen offset:0
buffer_load_dwordx4 a[112:115], v17, s[4:7], s31 offen offset:0
buffer_load_dwordx4 a[4:7], v18, s[8:11], 0 offen offset:64
buffer_load_dwordx4 a[60:63], v17, s[4:7], s30 offen offset:64
buffer_load_dwordx4 a[116:119], v17, s[4:7], s31 offen offset:64
buffer_load_dwordx4 a[8:11], v18, s[8:11], 0 offen offset:128
buffer_load_dwordx4 a[64:67], v17, s[4:7], s30 offen offset:128
buffer_load_dwordx4 a[120:123], v17, s[4:7], s31 offen offset:128
buffer_load_dwordx4 a[12:15], v18, s[8:11], 0 offen offset:192
buffer_load_dwordx4 a[68:71], v17, s[4:7], s30 offen offset:192
buffer_load_dwordx4 a[124:127], v17, s[4:7], s31 offen offset:192
buffer_load_dwordx4 a[16:19], v18, s[8:11], 0 offen offset:256
buffer_load_dwordx4 a[72:75], v17, s[4:7], s30 offen offset:256
buffer_load_dwordx4 a[128:131], v17, s[4:7], s31 offen offset:256
buffer_load_dwordx4 a[20:23], v18, s[8:11], 0 offen offset:320
buffer_load_dwordx4 a[76:79], v17, s[4:7], s30 offen offset:320
buffer_load_dwordx4 a[132:135], v17, s[4:7], s31 offen offset:320
buffer_load_dwordx4 a[24:27], v18, s[8:11], 0 offen offset:384
buffer_load_dwordx4 a[80:83], v17, s[4:7], s30 offen offset:384
buffer_load_dwordx4 a[136:139], v17, s[4:7], s31 offen offset:384
buffer_load_dwordx4 a[28:31], v18, s[8:11], 0 offen offset:448
buffer_load_dwordx4 a[84:87], v17, s[4:7], s30 offen offset:448
buffer_load_dwordx4 a[140:143], v17, s[4:7], s31 offen offset:448
buffer_load_dwordx4 a[32:35], v18, s[8:11], 0 offen offset:512
buffer_load_dwordx4 a[88:91], v17, s[4:7], s30 offen offset:512
buffer_load_dwordx4 a[144:147], v17, s[4:7], s31 offen offset:512
buffer_load_dwordx4 a[36:39], v18, s[8:11], 0 offen offset:576
buffer_load_dwordx4 a[92:95], v17, s[4:7], s30 offen offset:576
buffer_load_dwordx4 a[148:151], v17, s[4:7], s31 offen offset:576
buffer_load_dwordx4 a[40:43], v18, s[8:11], 0 offen offset:640
buffer_load_dwordx4 a[96:99], v17, s[4:7], s30 offen offset:640
buffer_load_dwordx4 a[152:155], v17, s[4:7], s31 offen offset:640
buffer_load_dwordx4 a[44:47], v18, s[8:11], 0 offen offset:704
buffer_load_dwordx4 a[100:103], v17, s[4:7], s30 offen offset:704
buffer_load_dwordx4 a[156:159], v17, s[4:7], s31 offen offset:704
buffer_load_dwordx4 a[48:51], v18, s[8:11], 0 offen offset:768
buffer_load_dwordx4 a[104:107], v17, s[4:7], s30 offen offset:768
buffer_load_dwordx4 a[160:163], v17, s[4:7], s31 offen offset:768
buffer_load_dwordx4 a[52:55], v18, s[8:11], 0 offen offset:832
buffer_load_dwordx4 a[108:111], v17, s[4:7], s30 offen offset:832
buffer_load_dwordx4 a[164:167], v17, s[4:7], s31 offen offset:832
s_waitcnt vmcnt(42)
s_barrier
s_cmp_eq_u32 s16, 0
s_cbranch_scc0 L_sig21
s_lshl_b32 s31, s2, 8
s_add_u32 s31, s31, 82903040
v_mov_b32 v23, 1
v_mov_b32 v24, 0
s_mov_b64 exec, 1
buffer_store_dword v23, v24, s[12:15], s31 offen sc0 sc1
s_mov_b64 exec, -1
L_sig21:
s_mov_b32 s4, s42
s_mov_b32 s5, s43
s_mov_b32 s6, 3670016
s_mul_i32 s19, s2, 28672
s_mul_i32 s22, s16, 7168
s_add_u32 s19, s19, s22
s_add_u32 s22, s22, 131072
s_mul_i32 s20, s2, 7168
s_mul_i32 s21, s16, 1318912
s_add_u32 s20, s20, s21
s_add_u32 s20, s20, 75497472
s_mul_i32 s21, s16, 224
s_add_u32 s21, s21, 131072
v_lshrrev_b32 v17, 2, v0
v_mul_u32_u24 v17, 896, v17
v_and_b32 v18, 3, v0
v_lshl_add_u32 v17, v18, 3, v17
v_add_u32 v19, s21, v17
s_mov_b32 m0, s22
s_nop 0
buffer_load_dwordx4 v16, s[4:7], s19 offen offset:0 lds
s_nop 0
buffer_load_dwordx4 v16, s[4:7], s19 offen offset:1024 lds
s_nop 0
buffer_load_dwordx4 v16, s[4:7], s19 offen offset:2048 lds
s_nop 0
buffer_load_dwordx4 v16, s[4:7], s19 offen offset:3072 lds
s_nop 0
s_add_u32 m0, m0, 4096
s_add_u32 s19, s19, 4096
s_nop 0
buffer_load_dwordx4 v16, s[4:7], s19 offen offset:0 lds
s_nop 0
buffer_load_dwordx4 v16, s[4:7], s19 offen offset:1024 lds
s_nop 0
buffer_load_dwordx4 v16, s[4:7], s19 offen offset:2048 lds
s_nop 0
s_mov_b32 s8, s50
s_mov_b32 s9, s51
s_mov_b32 s10, 1605632
s_mul_i32 s30, s74, 28672
s_mul_i32 s25, s16, 28672
v_add_u32 v9, s25, v17
s_add_u32 m0, s25, 0
s_add_u32 s31, s30, 0
buffer_load_dwordx4 v16, s[8:11], s31 offen offset:0 lds
buffer_load_dwordx4 v16, s[8:11], s31 offen offset:1024 lds
buffer_load_dwordx4 v16, s[8:11], s31 offen offset:2048 lds
buffer_load_dwordx4 v16, s[8:11], s31 offen offset:3072 lds
s_add_u32 m0, s25, 4096
s_add_u32 s31, s30, 4096
buffer_load_dwordx4 v16, s[8:11], s31 offen offset:0 lds
buffer_load_dwordx4 v16, s[8:11], s31 offen offset:1024 lds
buffer_load_dwordx4 v16, s[8:11], s31 offen offset:2048 lds
buffer_load_dwordx4 v16, s[8:11], s31 offen offset:3072 lds
s_add_u32 m0, s25, 8192
s_add_u32 s31, s30, 8192
buffer_load_dwordx4 v16, s[8:11], s31 offen offset:0 lds
buffer_load_dwordx4 v16, s[8:11], s31 offen offset:1024 lds
buffer_load_dwordx4 v16, s[8:11], s31 offen offset:2048 lds
buffer_load_dwordx4 v16, s[8:11], s31 offen offset:3072 lds
s_add_u32 m0, s25, 12288
s_add_u32 s31, s30, 12288
buffer_load_dwordx4 v16, s[8:11], s31 offen offset:0 lds
buffer_load_dwordx4 v16, s[8:11], s31 offen offset:1024 lds
buffer_load_dwordx4 v16, s[8:11], s31 offen offset:2048 lds
buffer_load_dwordx4 v16, s[8:11], s31 offen offset:3072 lds
s_add_u32 m0, s25, 16384
s_add_u32 s31, s30, 16384
buffer_load_dwordx4 v16, s[8:11], s31 offen offset:0 lds
buffer_load_dwordx4 v16, s[8:11], s31 offen offset:1024 lds
buffer_load_dwordx4 v16, s[8:11], s31 offen offset:2048 lds
buffer_load_dwordx4 v16, s[8:11], s31 offen offset:3072 lds
s_add_u32 m0, s25, 20480
s_add_u32 s31, s30, 20480
buffer_load_dwordx4 v16, s[8:11], s31 offen offset:0 lds
buffer_load_dwordx4 v16, s[8:11], s31 offen offset:1024 lds
buffer_load_dwordx4 v16, s[8:11], s31 offen offset:2048 lds
buffer_load_dwordx4 v16, s[8:11], s31 offen offset:3072 lds
s_add_u32 m0, s25, 24576
s_add_u32 s31, s30, 24576
buffer_load_dwordx4 v16, s[8:11], s31 offen offset:0 lds
buffer_load_dwordx4 v16, s[8:11], s31 offen offset:1024 lds
buffer_load_dwordx4 v16, s[8:11], s31 offen offset:2048 lds
buffer_load_dwordx4 v16, s[8:11], s31 offen offset:3072 lds
s_waitcnt vmcnt(35)
v_mfma_f32_16x16x32_bf16 v[144:147], a[0:3], a[56:59], 0
v_mfma_f32_16x16x32_bf16 v[148:151], a[0:3], a[112:115], 0
v_mfma_f32_16x16x32_bf16 v[144:147], a[4:7], a[60:63], v[144:147]
v_mfma_f32_16x16x32_bf16 v[148:151], a[4:7], a[116:119], v[148:151]
v_mfma_f32_16x16x32_bf16 v[144:147], a[8:11], a[64:67], v[144:147]
v_mfma_f32_16x16x32_bf16 v[148:151], a[8:11], a[120:123], v[148:151]
v_mfma_f32_16x16x32_bf16 v[144:147], a[12:15], a[68:71], v[144:147]
v_mfma_f32_16x16x32_bf16 v[148:151], a[12:15], a[124:127], v[148:151]
v_mfma_f32_16x16x32_bf16 v[144:147], a[16:19], a[72:75], v[144:147]
v_mfma_f32_16x16x32_bf16 v[148:151], a[16:19], a[128:131], v[148:151]
v_mfma_f32_16x16x32_bf16 v[144:147], a[20:23], a[76:79], v[144:147]
v_mfma_f32_16x16x32_bf16 v[148:151], a[20:23], a[132:135], v[148:151]
v_mfma_f32_16x16x32_bf16 v[144:147], a[24:27], a[80:83], v[144:147]
v_mfma_f32_16x16x32_bf16 v[148:151], a[24:27], a[136:139], v[148:151]
v_mfma_f32_16x16x32_bf16 v[144:147], a[28:31], a[84:87], v[144:147]
v_mfma_f32_16x16x32_bf16 v[148:151], a[28:31], a[140:143], v[148:151]
v_mfma_f32_16x16x32_bf16 v[144:147], a[32:35], a[88:91], v[144:147]
v_mfma_f32_16x16x32_bf16 v[148:151], a[32:35], a[144:147], v[148:151]
v_mfma_f32_16x16x32_bf16 v[144:147], a[36:39], a[92:95], v[144:147]
v_mfma_f32_16x16x32_bf16 v[148:151], a[36:39], a[148:151], v[148:151]
v_mfma_f32_16x16x32_bf16 v[144:147], a[40:43], a[96:99], v[144:147]
v_mfma_f32_16x16x32_bf16 v[148:151], a[40:43], a[152:155], v[148:151]
v_mfma_f32_16x16x32_bf16 v[144:147], a[44:47], a[100:103], v[144:147]
v_mfma_f32_16x16x32_bf16 v[148:151], a[44:47], a[156:159], v[148:151]
v_mfma_f32_16x16x32_bf16 v[144:147], a[48:51], a[104:107], v[144:147]
v_mfma_f32_16x16x32_bf16 v[148:151], a[48:51], a[160:163], v[148:151]
v_mfma_f32_16x16x32_bf16 v[144:147], a[52:55], a[108:111], v[144:147]
v_mfma_f32_16x16x32_bf16 v[148:151], a[52:55], a[164:167], v[148:151]
s_mov_b32 s80, 0xbfb8aa3b
v_and_b32 v17, 15, v0
v_lshlrev_b32 v17, 2, v17
s_lshl_b32 s30, s74, 7
s_add_u32 s30, s30, 82837504
s_waitcnt vmcnt(0)
s_barrier
s_nop 2
v_mul_f32 v144, s80, v144
v_exp_f32 v144, v144
s_nop 0
v_add_f32 v144, 1.0, v144
v_rcp_f32 v144, v144
s_nop 0
buffer_store_dword v144, v17, s[12:15], s30 offen offset:0 sc0 sc1
v_mul_f32 v148, s80, v148
v_exp_f32 v148, v148
s_nop 0
v_add_f32 v148, 1.0, v148
v_rcp_f32 v148, v148
s_nop 0
buffer_store_dword v148, v17, s[12:15], s30 offen offset:64 sc0 sc1
ds_read_b64_tr_b16 v[32:33], v9 offset:0
ds_read_b64_tr_b16 v[34:35], v9 offset:14336
ds_read_b64_tr_b16 v[36:37], v9 offset:32
ds_read_b64_tr_b16 v[38:39], v9 offset:14368
ds_read_b64_tr_b16 v[40:41], v9 offset:64
ds_read_b64_tr_b16 v[42:43], v9 offset:14400
ds_read_b64_tr_b16 v[44:45], v9 offset:96
ds_read_b64_tr_b16 v[46:47], v9 offset:14432
ds_read_b64_tr_b16 v[48:49], v9 offset:128
ds_read_b64_tr_b16 v[50:51], v9 offset:14464
ds_read_b64_tr_b16 v[52:53], v9 offset:160
ds_read_b64_tr_b16 v[54:55], v9 offset:14496
ds_read_b64_tr_b16 v[56:57], v9 offset:192
ds_read_b64_tr_b16 v[58:59], v9 offset:14528
ds_read_b64_tr_b16 v[60:61], v9 offset:224
ds_read_b64_tr_b16 v[62:63], v9 offset:14560
ds_read_b64_tr_b16 v[64:65], v9 offset:256
ds_read_b64_tr_b16 v[66:67], v9 offset:14592
ds_read_b64_tr_b16 v[68:69], v9 offset:288
ds_read_b64_tr_b16 v[70:71], v9 offset:14624
ds_read_b64_tr_b16 v[72:73], v9 offset:320
ds_read_b64_tr_b16 v[74:75], v9 offset:14656
ds_read_b64_tr_b16 v[76:77], v9 offset:352
ds_read_b64_tr_b16 v[78:79], v9 offset:14688
ds_read_b64_tr_b16 v[80:81], v9 offset:384
ds_read_b64_tr_b16 v[82:83], v9 offset:14720
ds_read_b64_tr_b16 v[84:85], v9 offset:416
ds_read_b64_tr_b16 v[86:87], v9 offset:14752
ds_read_b64_tr_b16 v[88:89], v9 offset:448
ds_read_b64_tr_b16 v[90:91], v9 offset:14784
ds_read_b64_tr_b16 v[92:93], v9 offset:480
ds_read_b64_tr_b16 v[94:95], v9 offset:14816
ds_read_b64_tr_b16 v[96:97], v9 offset:512
ds_read_b64_tr_b16 v[98:99], v9 offset:14848
ds_read_b64_tr_b16 v[100:101], v9 offset:544
ds_read_b64_tr_b16 v[102:103], v9 offset:14880
ds_read_b64_tr_b16 v[104:105], v9 offset:576
ds_read_b64_tr_b16 v[106:107], v9 offset:14912
ds_read_b64_tr_b16 v[108:109], v9 offset:608
ds_read_b64_tr_b16 v[110:111], v9 offset:14944
ds_read_b64_tr_b16 v[112:113], v9 offset:640
ds_read_b64_tr_b16 v[114:115], v9 offset:14976
ds_read_b64_tr_b16 v[116:117], v9 offset:672
ds_read_b64_tr_b16 v[118:119], v9 offset:15008
ds_read_b64_tr_b16 v[120:121], v9 offset:704
ds_read_b64_tr_b16 v[122:123], v9 offset:15040
ds_read_b64_tr_b16 v[124:125], v9 offset:736
ds_read_b64_tr_b16 v[126:127], v9 offset:15072
ds_read_b64_tr_b16 v[128:129], v9 offset:768
ds_read_b64_tr_b16 v[130:131], v9 offset:15104
ds_read_b64_tr_b16 v[132:133], v9 offset:800
ds_read_b64_tr_b16 v[134:135], v9 offset:15136
ds_read_b64_tr_b16 v[136:137], v9 offset:832
ds_read_b64_tr_b16 v[138:139], v9 offset:15168
ds_read_b64_tr_b16 v[140:141], v9 offset:864
ds_read_b64_tr_b16 v[142:143], v9 offset:15200
ds_read_b64_tr_b16 a[224:225], v19 offset:0
ds_read_b64_tr_b16 a[226:227], v19 offset:14336
ds_read_b64_tr_b16 a[228:229], v19 offset:32
ds_read_b64_tr_b16 a[230:231], v19 offset:14368
ds_read_b64_tr_b16 a[232:233], v19 offset:64
ds_read_b64_tr_b16 a[234:235], v19 offset:14400
ds_read_b64_tr_b16 a[236:237], v19 offset:96
ds_read_b64_tr_b16 a[238:239], v19 offset:14432
ds_read_b64_tr_b16 a[240:241], v19 offset:128
ds_read_b64_tr_b16 a[242:243], v19 offset:14464
ds_read_b64_tr_b16 a[244:245], v19 offset:160
ds_read_b64_tr_b16 a[246:247], v19 offset:14496
ds_read_b64_tr_b16 a[248:249], v19 offset:192
ds_read_b64_tr_b16 a[250:251], v19 offset:14528
s_waitcnt lgkmcnt(0)
s_barrier
s_mul_i32 s30, s74, 7168
s_add_u32 s30, s30, 76414976
s_cmp_ge_u32 s74, 56
s_cselect_b32 s30, 0x40000000, s30
s_add_u32 s31, s30, 0
buffer_store_dwordx4 v[32:35], v16, s[12:15], s31 offen offset:0 sc0 sc1
buffer_store_dwordx4 v[36:39], v16, s[12:15], s31 offen offset:1024 sc0 sc1
buffer_store_dwordx4 v[40:43], v16, s[12:15], s31 offen offset:2048 sc0 sc1
buffer_store_dwordx4 v[44:47], v16, s[12:15], s31 offen offset:3072 sc0 sc1
s_add_u32 s31, s30, 4096
buffer_store_dwordx4 v[48:51], v16, s[12:15], s31 offen offset:0 sc0 sc1
buffer_store_dwordx4 v[52:55], v16, s[12:15], s31 offen offset:1024 sc0 sc1
buffer_store_dwordx4 v[56:59], v16, s[12:15], s31 offen offset:2048 sc0 sc1
s_add_u32 s31, s30, 1318912
buffer_store_dwordx4 v[60:63], v16, s[12:15], s31 offen offset:0 sc0 sc1
buffer_store_dwordx4 v[64:67], v16, s[12:15], s31 offen offset:1024 sc0 sc1
buffer_store_dwordx4 v[68:71], v16, s[12:15], s31 offen offset:2048 sc0 sc1
buffer_store_dwordx4 v[72:75], v16, s[12:15], s31 offen offset:3072 sc0 sc1
s_add_u32 s31, s30, 1323008
buffer_store_dwordx4 v[76:79], v16, s[12:15], s31 offen offset:0 sc0 sc1
buffer_store_dwordx4 v[80:83], v16, s[12:15], s31 offen offset:1024 sc0 sc1
buffer_store_dwordx4 v[84:87], v16, s[12:15], s31 offen offset:2048 sc0 sc1
s_add_u32 s31, s30, 2637824
buffer_store_dwordx4 v[88:91], v16, s[12:15], s31 offen offset:0 sc0 sc1
buffer_store_dwordx4 v[92:95], v16, s[12:15], s31 offen offset:1024 sc0 sc1
buffer_store_dwordx4 v[96:99], v16, s[12:15], s31 offen offset:2048 sc0 sc1
buffer_store_dwordx4 v[100:103], v16, s[12:15], s31 offen offset:3072 sc0 sc1
s_add_u32 s31, s30, 2641920
buffer_store_dwordx4 v[104:107], v16, s[12:15], s31 offen offset:0 sc0 sc1
buffer_store_dwordx4 v[108:111], v16, s[12:15], s31 offen offset:1024 sc0 sc1
buffer_store_dwordx4 v[112:115], v16, s[12:15], s31 offen offset:2048 sc0 sc1
s_add_u32 s31, s30, 3956736
buffer_store_dwordx4 v[116:119], v16, s[12:15], s31 offen offset:0 sc0 sc1
buffer_store_dwordx4 v[120:123], v16, s[12:15], s31 offen offset:1024 sc0 sc1
buffer_store_dwordx4 v[124:127], v16, s[12:15], s31 offen offset:2048 sc0 sc1
buffer_store_dwordx4 v[128:131], v16, s[12:15], s31 offen offset:3072 sc0 sc1
s_add_u32 s31, s30, 3960832
buffer_store_dwordx4 v[132:135], v16, s[12:15], s31 offen offset:0 sc0 sc1
buffer_store_dwordx4 v[136:139], v16, s[12:15], s31 offen offset:1024 sc0 sc1
buffer_store_dwordx4 v[140:143], v16, s[12:15], s31 offen offset:2048 sc0 sc1
s_mov_b32 s4, s29
s_mov_b32 s5, s20
s_mov_b32 s8, s18
s_mov_b32 s9, s17
s_mov_b32 s4, 0x40000000
v_and_b32 v21, 7, v0
v_lshlrev_b32 v21, 11, v21
v_bfe_u32 v22, v0, 3, 1
v_lshl_add_u32 v21, v22, 15, v21
s_and_b32 s47, s2, 0x47
s_lshl_b32 s47, s47, 8
s_add_u32 s47, s47, 82903040
v_lshlrev_b32 v1, 4, v0
s_lshl_b32 s17, s16, 13
s_and_b32 s29, s2, 7
s_lshr_b32 s30, s2, 3
s_lshl_b32 s65, s29, 1
s_bfe_u32 s29, s30, 0x10003
s_add_u32 s65, s65, s29
s_lshr_b32 s25, s30, 4
s_and_b32 s66, s30, 7
s_sub_u32 s67, 15, s66
s_lshl_b32 s31, s66, 1
s_sub_u32 s31, 15, s31
s_lshl_b32 s29, s65, 20
s_lshl_b32 s30, s67, 16
s_add_u32 s26, s29, s30
s_add_u32 s29, s29, s17
s_sub_u32 s69, 16, s31
s_mov_b32 s10, 28672
s_cmp_eq_u32 s25, 0
s_cselect_b32 s30, 32768, 0
s_cselect_b32 s23, 0x7fff, s31
s_cselect_b32 s69, s69, s31
s_cselect_b32 s10, 4294930432, s10
s_mov_b32 s11, s10
s_lshl_b32 s31, s30, 4
s_add_u32 s29, s29, s31
s_add_u32 s72, s29, 16777216
s_add_u32 s73, s29, 33554432
s_sub_u32 s20, s72, s30
s_sub_u32 s21, s73, s30
s_mov_b32 s60, s56
s_mov_b32 s61, s57
s_mov_b32 s62, 256
s_mov_b32 s63, 0x20000
s_or_b32 s71, s2, 128
s_lshl_b32 s71, s71, 8
s_add_u32 s71, s71, 82903040
v_and_b32 v4, 15, v0
v_lshrrev_b32 v14, 4, v0
v_lshlrev_b32 v14, 2, v14
v_sub_u32 v4, v4, v14
s_mov_b32 s27, 0x3db8aa3b
s_mov_b32 s28, 1149239296
s_lshl_b32 s29, s65, 3
s_add_u32 s29, s29, s66
s_mul_i32 s70, s29, 69632
s_mul_i32 s30, s16, 17408
s_add_u32 s70, s70, s30
s_add_u32 s70, s70, 83886080
s_sub_u32 s83, s23, 1
s_lshl_b32 s24, 3, s83
s_cmp_eq_u32 s25, 0
s_cselect_b32 s24, 0, s24
s_cselect_b32 s68, 340, s24
s_or_b32 s68, s68, 20480
v_mov_b32 v8, 0
v_mov_b32 v9, 0
s_mov_b32 s22, 0
v_add_u32 v3, 131072, v1
v_add_u32 v2, 0, v1
s_bfe_u32 s34, s2, 0x10002
s_lshl_b32 s34, s34, 1
s_and_b32 s41, s2, 1
s_add_u32 s34, s34, s41
s_and_b32 s41, s2, 2
s_lshl_b32 s32, s41, 1
s_and_b32 s44, s2, 5
s_bfe_u32 s42, s2, 0x20005
s_add_u32 s32, s32, s42
s_lshr_b32 s42, s2, 7
s_xor_b32 s42, s42, 1
s_lshl_b32 s42, s42, 3
s_add_u32 s32, s32, s42
s_bfe_u32 s33, s2, 0x20003
v_mov_b32 v26, v1
v_add_u32 v27, 188416, v1
s_lshl_b32 s41, s32, 2
s_add_u32 s41, s41, s16
s_mul_i32 s41, s41, 376832
s_add_u32 s41, s41, 50331648
s_mul_i32 s42, s34, 14336
s_add_u32 s35, s41, s42
s_add_u32 s35, s35, 131072
s_lshl_b32 s42, s44, 14
s_add_u32 s36, s41, s42
s_mul_i32 s41, s33, 1318912
s_lshl_b32 s42, s16, 12
s_add_u32 s41, s41, s42
s_cmp_eq_u32 s16, 3
s_cselect_b32 s42, 1024, 0
s_sub_u32 s41, s41, s42
s_add_u32 s41, s41, 75497472
s_mul_i32 s42, s34, 100352
s_add_u32 s37, s41, s42
s_add_u32 s37, s37, 917504
s_mul_i32 s42, s44, 114688
s_add_u32 s38, s41, s42
s_cmp_ge_u32 s16, 2
s_cselect_b32 s39, 0x40000000, 0
s_lshl_b32 s40, s16, 12
s_lshl_b32 s41, s44, 4
s_mul_i32 s42, s34, 14
s_add_u32 s43, s42, 416
v_and_b32 v28, 16, v0
v_add3_u32 v29, v28, v0, s41
v_min_u32 v28, 45, v0
v_add_u32 v28, s43, v28
v_cmp_gt_u32 vcc, 32, v0
v_lshrrev_b32 v28, 2, v28
s_and_b32 s41, s41, 64
v_cndmask_b32 v29, v28, v29, vcc
v_cmp_gt_u32 vcc, 56, v0
v_add_u32 v28, s41, v0
s_nop 0
v_cndmask_b32 v29, v28, v29, vcc
s_lshr_b32 s42, s42, 2
s_add_u32 s41, s42, 0
s_min_u32 s41, s41, 13
s_lshl_b32 s41, s41, 3
s_lshr_b32 s43, s32, 1
s_add_u32 s41, s41, s43
s_mul_i32 s43, s41, 4682
s_lshr_b32 s43, s43, 16
s_lshl_b32 s41, s41, 3
s_mul_i32 s43, s43, 111
s_sub_u32 s41, s41, s43
v_writelane_b32 v29, s41, 46
s_add_u32 s41, s42, 1
s_min_u32 s41, s41, 13
s_lshl_b32 s41, s41, 3
s_lshr_b32 s43, s32, 1
s_add_u32 s41, s41, s43
s_mul_i32 s43, s41, 4682
s_lshr_b32 s43, s43, 16
s_lshl_b32 s41, s41, 3
s_mul_i32 s43, s43, 111
s_sub_u32 s41, s41, s43
v_writelane_b32 v29, s41, 47
s_add_u32 s41, s42, 2
s_min_u32 s41, s41, 13
s_lshl_b32 s41, s41, 3
s_lshr_b32 s43, s32, 1
s_add_u32 s41, s41, s43
s_mul_i32 s43, s41, 4682
s_lshr_b32 s43, s43, 16
s_lshl_b32 s41, s41, 3
s_mul_i32 s43, s43, 111
s_sub_u32 s41, s41, s43
v_writelane_b32 v29, s41, 48
s_add_u32 s41, s42, 3
s_min_u32 s41, s41, 13
s_lshl_b32 s41, s41, 3
s_lshr_b32 s43, s32, 1
s_add_u32 s41, s41, s43
s_mul_i32 s43, s41, 4682
s_lshr_b32 s43, s43, 16
s_lshl_b32 s41, s41, 3
s_mul_i32 s43, s43, 111
s_sub_u32 s41, s41, s43
v_writelane_b32 v29, s41, 49
s_add_u32 s41, s42, 4
s_min_u32 s41, s41, 13
s_lshl_b32 s41, s41, 3
s_lshr_b32 s43, s32, 1
s_add_u32 s41, s41, s43
s_mul_i32 s43, s41, 4682
s_lshr_b32 s43, s43, 16
s_lshl_b32 s41, s41, 3
s_mul_i32 s43, s43, 111
s_sub_u32 s41, s41, s43
v_writelane_b32 v29, s41, 50
s_add_u32 s41, s32, 112
v_writelane_b32 v29, s41, 51
v_lshlrev_b32 v29, 8, v29
s_mov_b32 s45, 82903056
s_mov_b32 s31, 256
v_cmp_gt_u32 vcc, s31, v30
v_mov_b32 v5, 0
s_nop 3
s_cbranch_vccnz L_kv22_s
s_branch L_kv22_p
L_kv22_s:
s_mov_b32 s30, 0
L_poll23:
buffer_load_dword v14, v5, s[60:63], 0 offen sc0 sc1
s_waitcnt vmcnt(0)
v_cmp_gt_u32 vcc, s31, v14
s_nop 4
s_cbranch_vccnz L_poll23_r
s_branch L_poll23_ok
L_poll23_r:
s_add_u32 s30, s30, 1
s_cmp_lt_u32 s30, 32768
s_sleep 32
s_cbranch_scc1 L_poll23
L_poll23_ok:
L_kv22_p:
s_mov_b32 s30, 0
L_poll24:
buffer_load_dword v22, v21, s[12:15], s47 offen sc0 sc1
s_waitcnt vmcnt(0)
v_cmp_ne_u32 vcc, 1, v22
s_nop 4
s_cbranch_vccnz L_poll24_r
s_branch L_poll24_ok
L_poll24_r:
s_add_u32 s30, s30, 1
s_cmp_lt_u32 s30, 32768
s_sleep 4
s_cbranch_scc1 L_poll24
L_poll24_ok:
L_kv22_ok:
s_add_u32 m0, s17, 131072
s_nop 0
buffer_load_dwordx4 v1, s[12:15], s20 offen offset:0 lds
buffer_load_dwordx4 v1, s[12:15], s20 offen offset:1024 lds
buffer_load_dwordx4 v1, s[12:15], s20 offen offset:2048 lds
buffer_load_dwordx4 v1, s[12:15], s20 offen offset:3072 lds
s_add_u32 s20, s20, 4096
s_add_u32 m0, s17, 135168
s_nop 0
buffer_load_dwordx4 v1, s[12:15], s20 offen offset:0 lds
buffer_load_dwordx4 v1, s[12:15], s20 offen offset:1024 lds
buffer_load_dwordx4 v1, s[12:15], s20 offen offset:2048 lds
buffer_load_dwordx4 v1, s[12:15], s20 offen offset:3072 lds
s_add_u32 s20, s20, s10
s_cmp_eq_u32 s69, 1
s_cselect_b32 s20, s72, s20
s_cselect_b32 s10, 28672, s10
s_add_u32 m0, s17, 0
s_nop 0
buffer_load_dwordx4 v1, s[12:15], s20 offen offset:0 lds
buffer_load_dwordx4 v1, s[12:15], s20 offen offset:1024 lds
buffer_load_dwordx4 v1, s[12:15], s20 offen offset:2048 lds
buffer_load_dwordx4 v1, s[12:15], s20 offen offset:3072 lds
s_add_u32 s20, s20, 4096
s_add_u32 m0, s17, 4096
s_nop 0
buffer_load_dwordx4 v1, s[12:15], s20 offen offset:0 lds
buffer_load_dwordx4 v1, s[12:15], s20 offen offset:1024 lds
buffer_load_dwordx4 v1, s[12:15], s20 offen offset:2048 lds
buffer_load_dwordx4 v1, s[12:15], s20 offen offset:3072 lds
s_add_u32 s20, s20, s10
s_add_u32 m0, s17, 32768
s_nop 0
buffer_load_dwordx4 v1, s[12:15], s21 offen offset:0 lds
buffer_load_dwordx4 v1, s[12:15], s21 offen offset:1024 lds
buffer_load_dwordx4 v1, s[12:15], s21 offen offset:2048 lds
buffer_load_dwordx4 v1, s[12:15], s21 offen offset:3072 lds
s_add_u32 s21, s21, 4096
s_add_u32 m0, s17, 36864
s_nop 0
buffer_load_dwordx4 v1, s[12:15], s21 offen offset:0 lds
buffer_load_dwordx4 v1, s[12:15], s21 offen offset:1024 lds
buffer_load_dwordx4 v1, s[12:15], s21 offen offset:2048 lds
buffer_load_dwordx4 v1, s[12:15], s21 offen offset:3072 lds
s_add_u32 s21, s21, s11
v_mov_b32 v15, 0
s_mov_b32 s30, 0
L_poll25:
buffer_load_dword v14, v15, s[12:15], s71 offen offset:4 sc0 sc1
s_waitcnt vmcnt(0)
v_cmp_ne_u32 vcc, 1, v14
s_nop 4
s_cbranch_vccnz L_poll25_r
s_branch L_poll25_ok
L_poll25_r:
s_add_u32 s30, s30, 1
s_cmp_lt_u32 s30, 32768
s_sleep 4
s_cbranch_scc1 L_poll25
L_poll25_ok:
s_add_u32 s30, s26, s17
s_sub_u32 s29, s26, s17
s_add_u32 s29, s29, 57344
buffer_load_dwordx4 a[0:3], v1, s[12:15], s30 offen offset:0
buffer_load_dwordx4 a[32:35], v1, s[12:15], s29 offen offset:0
buffer_load_dwordx4 a[4:7], v1, s[12:15], s30 offen offset:1024
buffer_load_dwordx4 a[36:39], v1, s[12:15], s29 offen offset:1024
buffer_load_dwordx4 a[8:11], v1, s[12:15], s30 offen offset:2048
buffer_load_dwordx4 a[40:43], v1, s[12:15], s29 offen offset:2048
buffer_load_dwordx4 a[12:15], v1, s[12:15], s30 offen offset:3072
buffer_load_dwordx4 a[44:47], v1, s[12:15], s29 offen offset:3072
s_add_u32 s30, s30, 4096
s_add_u32 s29, s29, 4096
buffer_load_dwordx4 a[16:19], v1, s[12:15], s30 offen offset:0
buffer_load_dwordx4 a[48:51], v1, s[12:15], s29 offen offset:0
buffer_load_dwordx4 a[20:23], v1, s[12:15], s30 offen offset:1024
buffer_load_dwordx4 a[52:55], v1, s[12:15], s29 offen offset:1024
buffer_load_dwordx4 a[24:27], v1, s[12:15], s30 offen offset:2048
buffer_load_dwordx4 a[56:59], v1, s[12:15], s29 offen offset:2048
buffer_load_dwordx4 a[28:31], v1, s[12:15], s30 offen offset:3072
buffer_load_dwordx4 a[60:63], v1, s[12:15], s29 offen offset:3072
s_branch L_f_p0
L_f_end:
s_endpgm
.section .rodata,"a"
.p2align 6
.amdhsa_kernel gated_mix__compressed_kv_cla__glu_gated_glu__prompt_kernel
  .amdhsa_next_free_vgpr 512
  .amdhsa_next_free_sgpr 102
  .amdhsa_accum_offset 256
  .amdhsa_group_segment_fixed_size 0
  .amdhsa_kernarg_size 112
  .amdhsa_user_sgpr_count 2
  .amdhsa_user_sgpr_kernarg_segment_ptr 1
  .amdhsa_system_sgpr_workgroup_id_x 1
.end_amdhsa_kernel
```
